```python
import torch

def _softmax(x, axis=-1):
    return torch.softmax(x, dim=axis)
def _gelu(x):
    return torch.nn.functional.gelu(x, approximate="tanh")
def _silu(x):
    return torch.nn.functional.silu(x)
def _sigmoid(x):
    return torch.sigmoid(x)
def _layernorm(x, axis=-1, eps=1e-5):
    m = x.mean(dim=axis, keepdim=True)
    v = x.var(dim=axis, keepdim=True, unbiased=False)
    return (x - m) / torch.sqrt(v + eps)
def _scatter_add(tgt, idx, src, axis=0):
    return tgt.clone().index_add_(axis, idx, src)
def _segment_sum(src, seg, n):
    out = torch.zeros((n,) + src.shape[1:], dtype=src.dtype)
    return out.index_add_(0, seg, src)
def _pad(x, pw):
    flat = tuple(v for pair in reversed(pw) for v in pair)
    return torch.nn.functional.pad(x, flat)

kernel_name = 'standalone__mha_softmax__near_ridge'

def setup_inputs():

    _w = (lambda a: (lambda t: t.to(torch.bfloat16) if t.is_floating_point() else t)(torch.as_tensor(a)))
    B, H, Sq, Sk, D = 16, 32, 288, 1024, 128
    return {
        "q": _w((lambda *s: torch.randn(*s, dtype=torch.bfloat16) * 0.8)(B, H, Sq, D)),
        "k": _w((lambda *s: torch.randn(*s, dtype=torch.bfloat16) * 0.8)(B, H, Sk, D)),
        "v": _w((lambda *s: torch.randn(*s, dtype=torch.bfloat16) * 0.05)(B, H, Sk, D)),
    }

def reference(q, k, v):
    scale = q.shape[-1] ** -0.5
    scores = torch.einsum("bhqd,bhkd->bhqk", q, k) * scale
    p = _softmax(scores, axis=-1)
    return torch.einsum("bhqk,bhkd->bhqd", p, v)
```

```asm
; @launch grid=(256,1,1) block=(256,1,1) lds=157184
.amdgcn_target "amdgcn-amd-amdhsa--gfx950"
.text
.globl standalone__mha_softmax__near_ridge_kernel
.p2align 8
.type standalone__mha_softmax__near_ridge_kernel,@function
standalone__mha_softmax__near_ridge_kernel:
s_cmp_ge_u32 s2, 256
s_cbranch_scc1 L_end
s_load_dwordx4 s[48:51], s[0:1], 0
s_load_dwordx4 s[52:55], s[0:1], 16
s_getpc_b64 s[40:41]
L_pc:
s_mov_b32 s42, L_end-L_pc
s_mov_b32 s43, 0x20000
s_and_b32 s41, s41, 0xffff
s_bfe_u32 s62, s2, 0x20003
s_lshl_b32 s62, s62, 15
v_lshlrev_b32 v21, 7, v0
buffer_load_dword v40, v21, s[40:43], s62 offen
v_lshrrev_b32 v16, 6, v0
v_and_b32 v0, 63, v0
v_readfirstlane_b32 s20, v16
v_and_b32 v16, 15, v0
v_lshlrev_b32 v80, 4, v0
v_lshrrev_b32 v17, 4, v0
v_lshlrev_b32 v12, 8, v16
v_lshl_add_u32 v12, v17, 4, v12
v_lshrrev_b32 v18, 3, v0
v_and_b32 v19, 6, v18
v_and_b32 v20, 7, v0
v_xor_b32 v19, v19, v20
v_lshlrev_b32 v18, 8, v18
v_lshl_add_u32 v11, v19, 4, v18
s_lshr_b32 s58, s20, 1
s_and_b32 s59, s20, 1
s_mul_i32 s22, s2, 147456
s_lshl_b32 s60, s20, 14
s_add_u32 s35, s22, s60
s_lshl_b32 s21, s2, 19
s_mov_b32 s37, s21
s_lshl_b32 s61, s58, 12
s_lshl_b32 s62, s59, 10
s_add_u32 s30, s61, s62
s_lshl_b32 s63, s59, 7
s_add_u32 s63, s63, s61
v_add_u32 v11, s63, v11
s_mov_b32 s68, s35
s_add_u32 s69, s35, 4096
s_add_u32 s70, s35, 8192
s_add_u32 s71, s35, 12288
s_add_u32 s72, s22, 0x10000
s_mov_b32 s10, 134217728
s_mov_b32 s14, 134217728
s_mov_b32 s6, 37748736
s_mov_b32 s18, 37748736
s_mov_b32 s7, 0x20000
s_mov_b32 s11, 0x20000
s_mov_b32 s15, 0x20000
s_mov_b32 s19, 0x20000
s_waitcnt lgkmcnt(0)
s_mov_b32 s4, s48
s_and_b32 s5, s49, 0xffff
s_mov_b32 s8, s50
s_and_b32 s9, s51, 0xffff
s_mov_b32 s12, s52
s_and_b32 s13, s53, 0xffff
s_mov_b32 s16, s54
s_and_b32 s17, s55, 0xffff
buffer_load_dwordx4 v[128:131], v12, s[4:7], s68 offen offset:0 nt
buffer_load_dwordx4 v[132:135], v12, s[4:7], s68 offen offset:64 nt
buffer_load_dwordx4 v[136:139], v12, s[4:7], s68 offen offset:128 nt
buffer_load_dwordx4 v[140:143], v12, s[4:7], s68 offen offset:192 nt
buffer_load_dwordx4 v[144:147], v12, s[4:7], s69 offen offset:0 nt
buffer_load_dwordx4 v[148:151], v12, s[4:7], s69 offen offset:64 nt
buffer_load_dwordx4 v[152:155], v12, s[4:7], s69 offen offset:128 nt
buffer_load_dwordx4 v[156:159], v12, s[4:7], s69 offen offset:192 nt
buffer_load_dwordx4 v[120:123], v11, s[4:7], s72 offen nt
buffer_load_dwordx4 v[124:127], v11, s[4:7], s72 offen offset:2048 nt
buffer_load_dwordx4 v[160:163], v12, s[4:7], s70 offen offset:0 nt
buffer_load_dwordx4 v[164:167], v12, s[4:7], s70 offen offset:64 nt
buffer_load_dwordx4 v[168:171], v12, s[4:7], s70 offen offset:128 nt
buffer_load_dwordx4 v[172:175], v12, s[4:7], s70 offen offset:192 nt
buffer_load_dwordx4 v[176:179], v12, s[4:7], s71 offen offset:0 nt
buffer_load_dwordx4 v[180:183], v12, s[4:7], s71 offen offset:64 nt
buffer_load_dwordx4 v[184:187], v12, s[4:7], s71 offen offset:128 nt
buffer_load_dwordx4 v[188:191], v12, s[4:7], s71 offen offset:192 nt
s_add_u32 m0, s30, 0xc000
s_nop 0
buffer_load_dwordx4 v11, s[8:11], s21 offen nt lds
buffer_load_dwordx4 v11, s[8:11], s21 offen offset:2048 nt lds
s_mov_b32 s25, 0xffff0000
s_mov_b32 s26, 0x3e0293ee
s_mov_b32 s27, 0x3e0293ee
s_mov_b32 s28, 0x35800000
s_mov_b32 s29, 0x19000000
s_mov_b32 s34, 0
s_add_u32 s36, s30, 8192
v_lshrrev_b32 v18, 3, v16
v_lshlrev_b32 v18, 11, v18
v_and_b32 v19, 7, v16
v_lshl_add_u32 v18, v19, 7, v18
v_and_b32 v19, 6, v16
v_xor_b32 v19, v19, v17
v_lshl_add_u32 v1, v19, 4, v18
v_xor_b32 v2, 64, v1
s_lshl_b32 s48, s20, 12
v_add_u32 v3, s48, v1
v_add_u32 v4, s48, v2
v_lshlrev_b32 v10, 4, v0
v_add_u32 v10, 131072, v10
s_lshl_b32 s48, s58, 11
s_lshl_b32 s49, s59, 3
s_add_u32 s48, s48, s49
v_add_u32 v9, s48, v10
v_lshrrev_b32 v18, 5, v0
v_lshlrev_b32 v18, 11, v18
v_bfe_u32 v19, v0, 2, 3
v_lshl_add_u32 v18, v19, 7, v18
v_and_b32 v19, 6, v19
v_bfe_u32 v20, v0, 1, 1
v_or_b32 v19, v19, v20
v_lshl_add_u32 v18, v19, 4, v18
v_and_b32 v20, 1, v0
v_lshl_add_u32 v18, v20, 3, v18
s_mul_i32 s49, s20, 2304
s_add_u32 s49, s49, 139264
v_mul_u32_u24 v19, 144, v16
v_lshl_add_u32 v19, v17, 3, v19
v_add_u32 v13, s49, v19
v_lshrrev_b32 v19, 3, v0
v_and_b32 v20, 7, v0
v_lshlrev_b32 v20, 4, v20
v_mul_u32_u24 v21, 144, v19
v_add3_u32 v14, v21, v20, s49
s_lshl_b32 s48, s20, 5
v_xor_b32 v20, s48, v20
v_lshl_add_u32 v15, v19, 8, v20
s_sub_u32 s44, s48, s49
s_add_u32 s44, s44, 148480
s_mul_i32 s45, s20, 2176
s_add_u32 s45, s45, 17408
s_lshl_b32 s46, s20, 11
s_sub_u32 s46, s46, 131072
s_add_u32 s48, s48, 0x10000
v_xor_b32 v5, s48, v18
v_xor_b32 v6, 32, v5
v_xor_b32 v7, 64, v5
v_xor_b32 v8, 0x60, v5
v_lshrrev_b32 v18, 4, v0
v_xor_b32 v18, v18, v0
v_and_b32 v18, 2, v18
v_mov_b32 v19, 0x3f803f80
v_and_b32 v20, 1, v0
v_mul_u32_u24 v20, 0xaaaa, v20
v_add_u32 v110, 0x4444, v20
v_add_u32 v104, 139264, v1
v_add_u32 v105, 139264, v2
s_add_u32 s73, s72, 4096
s_add_u32 s74, s68, 73728
s_add_u32 s75, s69, 73728
s_add_u32 s76, s70, 73728
s_add_u32 s77, s71, 73728
s_add_u32 s78, s72, 73728
s_add_u32 s79, s73, 73728
v_cmp_eq_u32 vcc, 0, v18
s_nop 1
v_cndmask_b32 v20, 0, v19, vcc
v_accvgpr_write_b32 a240, v20
v_accvgpr_write_b32 a241, v20
v_accvgpr_write_b32 a242, v20
v_accvgpr_write_b32 a243, v20
v_accvgpr_write_b32 a244, 0
v_accvgpr_write_b32 a245, 0
v_accvgpr_write_b32 a246, 0
v_accvgpr_write_b32 a247, 0
v_accvgpr_write_b32 a248, 0
v_accvgpr_write_b32 a249, 0
v_accvgpr_write_b32 a250, 0
v_accvgpr_write_b32 a251, 0
v_accvgpr_write_b32 a252, 0
v_accvgpr_write_b32 a253, 0
v_accvgpr_write_b32 a254, 0
v_accvgpr_write_b32 a255, 0
s_waitcnt vmcnt(19)
v_lshlrev_b32 v16, 16, v128
v_lshlrev_b32 v18, 16, v129
v_lshlrev_b32 v20, 16, v130
v_lshlrev_b32 v22, 16, v131
v_and_b32 v17, s25, v128
v_and_b32 v19, s25, v129
v_and_b32 v21, s25, v130
v_and_b32 v23, s25, v131
v_pk_mul_f32 v[16:17], v[16:17], s[26:27]
v_pk_mul_f32 v[18:19], v[18:19], s[26:27]
v_pk_mul_f32 v[20:21], v[20:21], s[26:27]
v_pk_mul_f32 v[22:23], v[22:23], s[26:27]
v_cvt_pk_bf16_f32 v128, v16, v17
v_cvt_pk_bf16_f32 v129, v18, v19
v_cvt_pk_bf16_f32 v130, v20, v21
v_cvt_pk_bf16_f32 v131, v22, v23
v_accvgpr_write_b32 a0, v128
v_accvgpr_write_b32 a1, v129
v_accvgpr_write_b32 a2, v130
v_accvgpr_write_b32 a3, v131
s_waitcnt vmcnt(18)
v_lshlrev_b32 v24, 16, v132
v_lshlrev_b32 v26, 16, v133
v_lshlrev_b32 v28, 16, v134
v_lshlrev_b32 v30, 16, v135
v_and_b32 v25, s25, v132
v_and_b32 v27, s25, v133
v_and_b32 v29, s25, v134
v_and_b32 v31, s25, v135
v_pk_mul_f32 v[24:25], v[24:25], s[26:27]
v_pk_mul_f32 v[26:27], v[26:27], s[26:27]
v_pk_mul_f32 v[28:29], v[28:29], s[26:27]
v_pk_mul_f32 v[30:31], v[30:31], s[26:27]
v_cvt_pk_bf16_f32 v132, v24, v25
v_cvt_pk_bf16_f32 v133, v26, v27
v_cvt_pk_bf16_f32 v134, v28, v29
v_cvt_pk_bf16_f32 v135, v30, v31
v_accvgpr_write_b32 a4, v132
v_accvgpr_write_b32 a5, v133
v_accvgpr_write_b32 a6, v134
v_accvgpr_write_b32 a7, v135
s_waitcnt vmcnt(17)
v_lshlrev_b32 v16, 16, v136
v_lshlrev_b32 v18, 16, v137
v_lshlrev_b32 v20, 16, v138
v_lshlrev_b32 v22, 16, v139
v_and_b32 v17, s25, v136
v_and_b32 v19, s25, v137
v_and_b32 v21, s25, v138
v_and_b32 v23, s25, v139
v_pk_mul_f32 v[16:17], v[16:17], s[26:27]
v_pk_mul_f32 v[18:19], v[18:19], s[26:27]
v_pk_mul_f32 v[20:21], v[20:21], s[26:27]
v_pk_mul_f32 v[22:23], v[22:23], s[26:27]
v_cvt_pk_bf16_f32 v136, v16, v17
v_cvt_pk_bf16_f32 v137, v18, v19
v_cvt_pk_bf16_f32 v138, v20, v21
v_cvt_pk_bf16_f32 v139, v22, v23
v_accvgpr_write_b32 a8, v136
v_accvgpr_write_b32 a9, v137
v_accvgpr_write_b32 a10, v138
v_accvgpr_write_b32 a11, v139
s_waitcnt vmcnt(16)
v_lshlrev_b32 v24, 16, v140
v_lshlrev_b32 v26, 16, v141
v_lshlrev_b32 v28, 16, v142
v_lshlrev_b32 v30, 16, v143
v_and_b32 v25, s25, v140
v_and_b32 v27, s25, v141
v_and_b32 v29, s25, v142
v_and_b32 v31, s25, v143
v_pk_mul_f32 v[24:25], v[24:25], s[26:27]
v_pk_mul_f32 v[26:27], v[26:27], s[26:27]
v_pk_mul_f32 v[28:29], v[28:29], s[26:27]
v_pk_mul_f32 v[30:31], v[30:31], s[26:27]
v_cvt_pk_bf16_f32 v140, v24, v25
v_cvt_pk_bf16_f32 v141, v26, v27
v_cvt_pk_bf16_f32 v142, v28, v29
v_cvt_pk_bf16_f32 v143, v30, v31
v_accvgpr_write_b32 a12, v140
v_accvgpr_write_b32 a13, v141
v_accvgpr_write_b32 a14, v142
v_accvgpr_write_b32 a15, v143
s_add_u32 m0, s30, 0xe000
s_add_u32 s21, s21, 0x2000
buffer_load_dwordx4 v11, s[8:11], s21 offen nt lds
buffer_load_dwordx4 v11, s[8:11], s21 offen offset:2048 nt lds
s_add_u32 m0, s30, 0x1e000
s_nop 0
buffer_load_dwordx4 v11, s[12:15], s37 offen nt lds
buffer_load_dwordx4 v11, s[12:15], s37 offen offset:2048 nt lds
s_waitcnt vmcnt(19)
v_lshlrev_b32 v16, 16, v144
v_lshlrev_b32 v18, 16, v145
v_lshlrev_b32 v20, 16, v146
v_lshlrev_b32 v22, 16, v147
v_and_b32 v17, s25, v144
v_and_b32 v19, s25, v145
v_and_b32 v21, s25, v146
v_and_b32 v23, s25, v147
v_pk_mul_f32 v[16:17], v[16:17], s[26:27]
v_pk_mul_f32 v[18:19], v[18:19], s[26:27]
v_pk_mul_f32 v[20:21], v[20:21], s[26:27]
v_pk_mul_f32 v[22:23], v[22:23], s[26:27]
v_cvt_pk_bf16_f32 v144, v16, v17
v_cvt_pk_bf16_f32 v145, v18, v19
v_cvt_pk_bf16_f32 v146, v20, v21
v_cvt_pk_bf16_f32 v147, v22, v23
v_accvgpr_write_b32 a16, v144
v_accvgpr_write_b32 a17, v145
v_accvgpr_write_b32 a18, v146
v_accvgpr_write_b32 a19, v147
s_waitcnt vmcnt(18)
v_lshlrev_b32 v24, 16, v148
v_lshlrev_b32 v26, 16, v149
v_lshlrev_b32 v28, 16, v150
v_lshlrev_b32 v30, 16, v151
v_and_b32 v25, s25, v148
v_and_b32 v27, s25, v149
v_and_b32 v29, s25, v150
v_and_b32 v31, s25, v151
v_pk_mul_f32 v[24:25], v[24:25], s[26:27]
v_pk_mul_f32 v[26:27], v[26:27], s[26:27]
v_pk_mul_f32 v[28:29], v[28:29], s[26:27]
v_pk_mul_f32 v[30:31], v[30:31], s[26:27]
v_cvt_pk_bf16_f32 v148, v24, v25
v_cvt_pk_bf16_f32 v149, v26, v27
v_cvt_pk_bf16_f32 v150, v28, v29
v_cvt_pk_bf16_f32 v151, v30, v31
v_accvgpr_write_b32 a20, v148
v_accvgpr_write_b32 a21, v149
v_accvgpr_write_b32 a22, v150
v_accvgpr_write_b32 a23, v151
s_waitcnt vmcnt(17)
v_lshlrev_b32 v16, 16, v152
v_lshlrev_b32 v18, 16, v153
v_lshlrev_b32 v20, 16, v154
v_lshlrev_b32 v22, 16, v155
v_and_b32 v17, s25, v152
v_and_b32 v19, s25, v153
v_and_b32 v21, s25, v154
v_and_b32 v23, s25, v155
v_pk_mul_f32 v[16:17], v[16:17], s[26:27]
v_pk_mul_f32 v[18:19], v[18:19], s[26:27]
v_pk_mul_f32 v[20:21], v[20:21], s[26:27]
v_pk_mul_f32 v[22:23], v[22:23], s[26:27]
v_cvt_pk_bf16_f32 v152, v16, v17
v_cvt_pk_bf16_f32 v153, v18, v19
v_cvt_pk_bf16_f32 v154, v20, v21
v_cvt_pk_bf16_f32 v155, v22, v23
v_accvgpr_write_b32 a24, v152
v_accvgpr_write_b32 a25, v153
v_accvgpr_write_b32 a26, v154
v_accvgpr_write_b32 a27, v155
s_waitcnt vmcnt(16)
v_lshlrev_b32 v24, 16, v156
v_lshlrev_b32 v26, 16, v157
v_lshlrev_b32 v28, 16, v158
v_lshlrev_b32 v30, 16, v159
v_and_b32 v25, s25, v156
v_and_b32 v27, s25, v157
v_and_b32 v29, s25, v158
v_and_b32 v31, s25, v159
v_pk_mul_f32 v[24:25], v[24:25], s[26:27]
v_pk_mul_f32 v[26:27], v[26:27], s[26:27]
v_pk_mul_f32 v[28:29], v[28:29], s[26:27]
v_pk_mul_f32 v[30:31], v[30:31], s[26:27]
v_cvt_pk_bf16_f32 v156, v24, v25
v_cvt_pk_bf16_f32 v157, v26, v27
v_cvt_pk_bf16_f32 v158, v28, v29
v_cvt_pk_bf16_f32 v159, v30, v31
v_accvgpr_write_b32 a28, v156
v_accvgpr_write_b32 a29, v157
v_accvgpr_write_b32 a30, v158
v_accvgpr_write_b32 a31, v159
s_waitcnt vmcnt(14)
v_lshlrev_b32 v112, 16, v120
v_lshlrev_b32 v114, 16, v121
v_lshlrev_b32 v116, 16, v122
v_lshlrev_b32 v118, 16, v123
v_and_b32 v113, s25, v120
v_and_b32 v115, s25, v121
v_and_b32 v117, s25, v122
v_and_b32 v119, s25, v123
v_pk_mul_f32 v[112:113], v[112:113], s[26:27]
v_pk_mul_f32 v[114:115], v[114:115], s[26:27]
v_pk_mul_f32 v[116:117], v[116:117], s[26:27]
v_pk_mul_f32 v[118:119], v[118:119], s[26:27]
v_cvt_pk_bf16_f32 v120, v112, v113
v_cvt_pk_bf16_f32 v121, v114, v115
v_cvt_pk_bf16_f32 v122, v116, v117
v_cvt_pk_bf16_f32 v123, v118, v119
v_lshlrev_b32 v112, 16, v124
v_lshlrev_b32 v114, 16, v125
v_lshlrev_b32 v116, 16, v126
v_lshlrev_b32 v118, 16, v127
v_and_b32 v113, s25, v124
v_and_b32 v115, s25, v125
v_and_b32 v117, s25, v126
v_and_b32 v119, s25, v127
v_pk_mul_f32 v[112:113], v[112:113], s[26:27]
v_pk_mul_f32 v[114:115], v[114:115], s[26:27]
v_pk_mul_f32 v[116:117], v[116:117], s[26:27]
v_pk_mul_f32 v[118:119], v[118:119], s[26:27]
v_cvt_pk_bf16_f32 v124, v112, v113
v_cvt_pk_bf16_f32 v125, v114, v115
v_cvt_pk_bf16_f32 v126, v116, v117
v_cvt_pk_bf16_f32 v127, v118, v119
v_add_u32 v112, s36, v10
ds_write_b128 v112, v[120:123] offset:0
ds_write_b128 v112, v[124:127] offset:2048
s_add_u32 m0, s30, 0x10000
s_add_u32 s37, s37, 0x2000
buffer_load_dwordx4 v11, s[12:15], s37 offen nt lds
buffer_load_dwordx4 v11, s[12:15], s37 offen offset:2048 nt lds
s_add_u32 m0, s30, 0x0
s_add_u32 s21, s21, 0x2000
buffer_load_dwordx4 v11, s[8:11], s21 offen nt lds
buffer_load_dwordx4 v11, s[8:11], s21 offen offset:2048 nt lds
s_waitcnt vmcnt(17)
v_lshlrev_b32 v16, 16, v160
v_lshlrev_b32 v18, 16, v161
v_lshlrev_b32 v20, 16, v162
v_lshlrev_b32 v22, 16, v163
v_and_b32 v17, s25, v160
v_and_b32 v19, s25, v161
v_and_b32 v21, s25, v162
v_and_b32 v23, s25, v163
v_pk_mul_f32 v[16:17], v[16:17], s[26:27]
v_pk_mul_f32 v[18:19], v[18:19], s[26:27]
v_pk_mul_f32 v[20:21], v[20:21], s[26:27]
v_pk_mul_f32 v[22:23], v[22:23], s[26:27]
v_cvt_pk_bf16_f32 v160, v16, v17
v_cvt_pk_bf16_f32 v161, v18, v19
v_cvt_pk_bf16_f32 v162, v20, v21
v_cvt_pk_bf16_f32 v163, v22, v23
v_accvgpr_write_b32 a32, v160
v_accvgpr_write_b32 a33, v161
v_accvgpr_write_b32 a34, v162
v_accvgpr_write_b32 a35, v163
s_waitcnt vmcnt(16)
v_lshlrev_b32 v24, 16, v164
v_lshlrev_b32 v26, 16, v165
v_lshlrev_b32 v28, 16, v166
v_lshlrev_b32 v30, 16, v167
v_and_b32 v25, s25, v164
v_and_b32 v27, s25, v165
v_and_b32 v29, s25, v166
v_and_b32 v31, s25, v167
v_pk_mul_f32 v[24:25], v[24:25], s[26:27]
v_pk_mul_f32 v[26:27], v[26:27], s[26:27]
v_pk_mul_f32 v[28:29], v[28:29], s[26:27]
v_pk_mul_f32 v[30:31], v[30:31], s[26:27]
v_cvt_pk_bf16_f32 v164, v24, v25
v_cvt_pk_bf16_f32 v165, v26, v27
v_cvt_pk_bf16_f32 v166, v28, v29
v_cvt_pk_bf16_f32 v167, v30, v31
v_accvgpr_write_b32 a36, v164
v_accvgpr_write_b32 a37, v165
v_accvgpr_write_b32 a38, v166
v_accvgpr_write_b32 a39, v167
s_waitcnt vmcnt(15)
v_lshlrev_b32 v16, 16, v168
v_lshlrev_b32 v18, 16, v169
v_lshlrev_b32 v20, 16, v170
v_lshlrev_b32 v22, 16, v171
v_and_b32 v17, s25, v168
v_and_b32 v19, s25, v169
v_and_b32 v21, s25, v170
v_and_b32 v23, s25, v171
v_pk_mul_f32 v[16:17], v[16:17], s[26:27]
v_pk_mul_f32 v[18:19], v[18:19], s[26:27]
v_pk_mul_f32 v[20:21], v[20:21], s[26:27]
v_pk_mul_f32 v[22:23], v[22:23], s[26:27]
v_cvt_pk_bf16_f32 v168, v16, v17
v_cvt_pk_bf16_f32 v169, v18, v19
v_cvt_pk_bf16_f32 v170, v20, v21
v_cvt_pk_bf16_f32 v171, v22, v23
v_accvgpr_write_b32 a40, v168
v_accvgpr_write_b32 a41, v169
v_accvgpr_write_b32 a42, v170
v_accvgpr_write_b32 a43, v171
s_waitcnt vmcnt(14)
v_lshlrev_b32 v24, 16, v172
v_lshlrev_b32 v26, 16, v173
v_lshlrev_b32 v28, 16, v174
v_lshlrev_b32 v30, 16, v175
v_and_b32 v25, s25, v172
v_and_b32 v27, s25, v173
v_and_b32 v29, s25, v174
v_and_b32 v31, s25, v175
v_pk_mul_f32 v[24:25], v[24:25], s[26:27]
v_pk_mul_f32 v[26:27], v[26:27], s[26:27]
v_pk_mul_f32 v[28:29], v[28:29], s[26:27]
v_pk_mul_f32 v[30:31], v[30:31], s[26:27]
v_cvt_pk_bf16_f32 v172, v24, v25
v_cvt_pk_bf16_f32 v173, v26, v27
v_cvt_pk_bf16_f32 v174, v28, v29
v_cvt_pk_bf16_f32 v175, v30, v31
v_accvgpr_write_b32 a44, v172
v_accvgpr_write_b32 a45, v173
v_accvgpr_write_b32 a46, v174
v_accvgpr_write_b32 a47, v175
s_waitcnt vmcnt(13)
v_lshlrev_b32 v16, 16, v176
v_lshlrev_b32 v18, 16, v177
v_lshlrev_b32 v20, 16, v178
v_lshlrev_b32 v22, 16, v179
v_and_b32 v17, s25, v176
v_and_b32 v19, s25, v177
v_and_b32 v21, s25, v178
v_and_b32 v23, s25, v179
v_pk_mul_f32 v[16:17], v[16:17], s[26:27]
v_pk_mul_f32 v[18:19], v[18:19], s[26:27]
v_pk_mul_f32 v[20:21], v[20:21], s[26:27]
v_pk_mul_f32 v[22:23], v[22:23], s[26:27]
v_cvt_pk_bf16_f32 v176, v16, v17
v_cvt_pk_bf16_f32 v177, v18, v19
v_cvt_pk_bf16_f32 v178, v20, v21
v_cvt_pk_bf16_f32 v179, v22, v23
v_accvgpr_write_b32 a48, v176
v_accvgpr_write_b32 a49, v177
v_accvgpr_write_b32 a50, v178
v_accvgpr_write_b32 a51, v179
s_waitcnt vmcnt(12)
v_lshlrev_b32 v24, 16, v180
v_lshlrev_b32 v26, 16, v181
v_lshlrev_b32 v28, 16, v182
v_lshlrev_b32 v30, 16, v183
v_and_b32 v25, s25, v180
v_and_b32 v27, s25, v181
v_and_b32 v29, s25, v182
v_and_b32 v31, s25, v183
v_pk_mul_f32 v[24:25], v[24:25], s[26:27]
v_pk_mul_f32 v[26:27], v[26:27], s[26:27]
v_pk_mul_f32 v[28:29], v[28:29], s[26:27]
v_pk_mul_f32 v[30:31], v[30:31], s[26:27]
v_cvt_pk_bf16_f32 v180, v24, v25
v_cvt_pk_bf16_f32 v181, v26, v27
v_cvt_pk_bf16_f32 v182, v28, v29
v_cvt_pk_bf16_f32 v183, v30, v31
v_accvgpr_write_b32 a52, v180
v_accvgpr_write_b32 a53, v181
v_accvgpr_write_b32 a54, v182
v_accvgpr_write_b32 a55, v183
s_waitcnt vmcnt(11)
v_lshlrev_b32 v16, 16, v184
v_lshlrev_b32 v18, 16, v185
v_lshlrev_b32 v20, 16, v186
v_lshlrev_b32 v22, 16, v187
v_and_b32 v17, s25, v184
v_and_b32 v19, s25, v185
v_and_b32 v21, s25, v186
v_and_b32 v23, s25, v187
v_pk_mul_f32 v[16:17], v[16:17], s[26:27]
v_pk_mul_f32 v[18:19], v[18:19], s[26:27]
v_pk_mul_f32 v[20:21], v[20:21], s[26:27]
v_pk_mul_f32 v[22:23], v[22:23], s[26:27]
v_cvt_pk_bf16_f32 v184, v16, v17
v_cvt_pk_bf16_f32 v185, v18, v19
v_cvt_pk_bf16_f32 v186, v20, v21
v_cvt_pk_bf16_f32 v187, v22, v23
v_accvgpr_write_b32 a56, v184
v_accvgpr_write_b32 a57, v185
v_accvgpr_write_b32 a58, v186
v_accvgpr_write_b32 a59, v187
s_waitcnt vmcnt(10)
v_lshlrev_b32 v24, 16, v188
v_lshlrev_b32 v26, 16, v189
v_lshlrev_b32 v28, 16, v190
v_lshlrev_b32 v30, 16, v191
v_and_b32 v25, s25, v188
v_and_b32 v27, s25, v189
v_and_b32 v29, s25, v190
v_and_b32 v31, s25, v191
v_pk_mul_f32 v[24:25], v[24:25], s[26:27]
v_pk_mul_f32 v[26:27], v[26:27], s[26:27]
v_pk_mul_f32 v[28:29], v[28:29], s[26:27]
v_pk_mul_f32 v[30:31], v[30:31], s[26:27]
v_cvt_pk_bf16_f32 v188, v24, v25
v_cvt_pk_bf16_f32 v189, v26, v27
v_cvt_pk_bf16_f32 v190, v28, v29
v_cvt_pk_bf16_f32 v191, v30, v31
v_accvgpr_write_b32 a60, v188
v_accvgpr_write_b32 a61, v189
v_accvgpr_write_b32 a62, v190
v_accvgpr_write_b32 a63, v191
s_waitcnt vmcnt(4) lgkmcnt(0)
s_barrier
ds_read_b128 a[192:195], v1 offset:49152
ds_read_b128 a[196:199], v2 offset:49152
ds_read_b128 a[200:203], v1 offset:50176
ds_read_b128 a[204:207], v2 offset:50176
s_waitcnt lgkmcnt(3)
v_mfma_f32_16x16x32_bf16 v[20:23], a[192:195], a[0:3], 0
ds_read_b128 a[208:211], v1 offset:53248
v_mfma_f32_16x16x32_bf16 v[24:27], a[192:195], a[16:19], 0
ds_read_b128 a[212:215], v2 offset:53248
v_mfma_f32_16x16x32_bf16 v[36:39], a[192:195], a[32:35], 0
ds_read_b128 a[216:219], v1 offset:54272
v_mfma_f32_16x16x32_bf16 v[40:43], a[192:195], a[48:51], 0
ds_read_b128 a[220:223], v2 offset:54272
s_waitcnt lgkmcnt(6)
v_mfma_f32_16x16x32_bf16 v[20:23], a[196:199], a[4:7], v[20:23]
ds_read_b128 a[64:67], v104 offset:0
v_mfma_f32_16x16x32_bf16 v[24:27], a[196:199], a[20:23], v[24:27]
ds_read_b128 a[232:235], v3 offset:49152
v_mfma_f32_16x16x32_bf16 v[36:39], a[196:199], a[36:39], v[36:39]
ds_read_b128 a[80:83], v104 offset:4096
v_mfma_f32_16x16x32_bf16 v[40:43], a[196:199], a[52:55], v[40:43]
ds_read_b128 a[68:71], v105 offset:0
s_waitcnt lgkmcnt(9)
v_mfma_f32_16x16x32_bf16 v[20:23], a[200:203], a[8:11], v[20:23]
ds_read_b128 a[236:239], v4 offset:49152
v_mfma_f32_16x16x32_bf16 v[24:27], a[200:203], a[24:27], v[24:27]
v_mfma_f32_16x16x32_bf16 v[36:39], a[200:203], a[40:43], v[36:39]
ds_read_b128 a[84:87], v105 offset:4096
v_mfma_f32_16x16x32_bf16 v[40:43], a[200:203], a[56:59], v[40:43]
ds_read_b128 a[72:75], v104 offset:1024
s_waitcnt lgkmcnt(10)
v_mfma_f32_16x16x32_bf16 v[20:23], a[204:207], a[12:15], v[20:23]
v_mfma_f32_16x16x32_bf16 v[24:27], a[204:207], a[28:31], v[24:27]
ds_read_b128 a[224:227], v3 offset:50176
v_mfma_f32_16x16x32_bf16 v[36:39], a[204:207], a[44:47], v[36:39]
v_mfma_f32_16x16x32_bf16 v[40:43], a[204:207], a[60:63], v[40:43]
ds_read_b128 a[88:91], v104 offset:5120
v_mfma_f32_16x16x32_bf16 v[16:19], a[208:211], a[0:3], 0
ds_read_b128 a[76:79], v105 offset:1024
v_mfma_f32_16x16x32_bf16 v[28:31], a[208:211], a[16:19], 0
s_add_u32 m0, s30, 0x12000
s_add_u32 s37, s37, 0x2000
ds_read_b128 a[228:231], v4 offset:50176
v_exp_f32 v20, v20
v_mfma_f32_16x16x32_bf16 v[32:35], a[208:211], a[32:35], 0
buffer_load_dwordx4 v11, s[12:15], s37 offen nt lds
v_mfma_f32_16x16x32_bf16 v[44:47], a[208:211], a[48:51], 0
ds_read_b128 a[92:95], v105 offset:5120
v_exp_f32 v21, v21
s_waitcnt lgkmcnt(7)
v_mfma_f32_16x16x32_bf16 v[16:19], a[212:215], a[4:7], v[16:19]
ds_read_b128 a[192:195], v1 offset:57344
v_exp_f32 v22, v22
v_mfma_f32_16x16x32_bf16 v[28:31], a[212:215], a[20:23], v[28:31]
buffer_load_dwordx4 v11, s[12:15], s37 offen offset:2048 nt lds
v_cvt_pk_bf16_f32 v20, v20, v21
v_mfma_f32_16x16x32_bf16 v[32:35], a[212:215], a[36:39], v[32:35]
ds_read_b128 a[196:199], v2 offset:57344
v_exp_f32 v23, v23
v_mfma_f32_16x16x32_bf16 v[44:47], a[212:215], a[52:55], v[44:47]
s_add_u32 m0, s30, 0x2000
s_add_u32 s21, s21, 0x2000
ds_read_b128 a[200:203], v1 offset:58368
v_exp_f32 v24, v24
v_mfma_f32_16x16x32_bf16 v[16:19], a[216:219], a[8:11], v[16:19]
buffer_load_dwordx4 v11, s[8:11], s21 offen nt lds
v_cvt_pk_bf16_f32 v21, v22, v23
v_mfma_f32_16x16x32_bf16 v[28:31], a[216:219], a[24:27], v[28:31]
ds_read_b128 a[204:207], v2 offset:58368
v_exp_f32 v25, v25
v_mfma_f32_16x16x32_bf16 v[32:35], a[216:219], a[40:43], v[32:35]
ds_read_b128 a[208:211], v1 offset:61440
v_exp_f32 v26, v26
v_mfma_f32_16x16x32_bf16 v[44:47], a[216:219], a[56:59], v[44:47]
buffer_load_dwordx4 v11, s[8:11], s21 offen offset:2048 nt lds
v_cvt_pk_bf16_f32 v24, v24, v25
v_mfma_f32_16x16x32_bf16 v[16:19], a[220:223], a[12:15], v[16:19]
ds_read_b128 a[212:215], v2 offset:61440
v_exp_f32 v27, v27
v_mfma_f32_16x16x32_bf16 v[28:31], a[220:223], a[28:31], v[28:31]
s_add_u32 m0, s30, 0x14000
s_add_u32 s37, s37, 0x2000
ds_read_b128 a[216:219], v1 offset:62464
v_exp_f32 v36, v36
v_mfma_f32_16x16x32_bf16 v[32:35], a[220:223], a[44:47], v[32:35]
buffer_load_dwordx4 v11, s[12:15], s37 offen nt lds
v_cvt_pk_bf16_f32 v25, v26, v27
v_mfma_f32_16x16x32_bf16 v[44:47], a[220:223], a[60:63], v[44:47]
ds_read_b128 a[220:223], v2 offset:62464
v_exp_f32 v37, v37
v_mfma_f32_16x16x32_bf16 v[80:83], a[232:235], a[64:67], 0
s_waitcnt lgkmcnt(5)
ds_read_b64_tr_b16 a[160:161], v6 offset:57344
v_exp_f32 v38, v38
v_mfma_f32_16x16x32_bf16 v[84:87], a[232:235], a[80:83], 0
buffer_load_dwordx4 v11, s[12:15], s37 offen offset:2048 nt lds
v_cvt_pk_bf16_f32 v36, v36, v37
v_mfma_f32_16x16x32_bf16 v[80:83], a[236:239], a[68:71], v[80:83]
ds_read_b64_tr_b16 a[162:163], v6 offset:61440
v_exp_f32 v39, v39
v_mfma_f32_16x16x32_bf16 v[84:87], a[236:239], a[84:87], v[84:87]
s_add_u32 m0, s30, 0x4000
s_add_u32 s21, s21, 0x2000
ds_read_b64_tr_b16 a[164:165], v6 offset:58368
v_exp_f32 v40, v40
v_mfma_f32_16x16x32_bf16 v[80:83], a[224:227], a[72:75], v[80:83]
buffer_load_dwordx4 v11, s[8:11], s21 offen nt lds
v_cvt_pk_bf16_f32 v37, v38, v39
v_mfma_f32_16x16x32_bf16 v[84:87], a[224:227], a[88:91], v[84:87]
ds_read_b64_tr_b16 a[166:167], v6 offset:62464
v_exp_f32 v41, v41
v_mfma_f32_16x16x32_bf16 v[80:83], a[228:231], a[76:79], v[80:83]
ds_read_b64_tr_b16 a[168:169], v7 offset:57344
v_exp_f32 v42, v42
v_mfma_f32_16x16x32_bf16 v[84:87], a[228:231], a[92:95], v[84:87]
buffer_load_dwordx4 v11, s[8:11], s21 offen offset:2048 nt lds
v_cvt_pk_bf16_f32 v40, v40, v41
v_mfma_f32_16x16x32_bf16 v[52:55], a[192:195], a[0:3], 0
ds_read_b64_tr_b16 a[170:171], v7 offset:61440
v_exp_f32 v43, v43
v_mfma_f32_16x16x32_bf16 v[56:59], a[192:195], a[16:19], 0
ds_read_b64_tr_b16 a[172:173], v7 offset:58368
v_exp_f32 v80, v80
v_mfma_f32_16x16x32_bf16 v[68:71], a[192:195], a[32:35], 0
v_exp_f32 v81, v81
v_cvt_pk_bf16_f32 v41, v42, v43
v_mfma_f32_16x16x32_bf16 v[72:75], a[192:195], a[48:51], 0
ds_read_b64_tr_b16 a[174:175], v7 offset:62464
v_exp_f32 v82, v82
v_mfma_f32_16x16x32_bf16 v[52:55], a[196:199], a[4:7], v[52:55]
v_exp_f32 v83, v83
v_cvt_pk_bf16_f32 v80, v80, v81
v_mfma_f32_16x16x32_bf16 v[56:59], a[196:199], a[20:23], v[56:59]
ds_read_b64_tr_b16 a[176:177], v8 offset:57344
v_exp_f32 v84, v84
v_mfma_f32_16x16x32_bf16 v[68:71], a[196:199], a[36:39], v[68:71]
v_exp_f32 v85, v85
v_cvt_pk_bf16_f32 v81, v82, v83
v_mfma_f32_16x16x32_bf16 v[72:75], a[196:199], a[52:55], v[72:75]
ds_read_b64_tr_b16 a[178:179], v8 offset:61440
v_exp_f32 v86, v86
v_mfma_f32_16x16x32_bf16 v[52:55], a[200:203], a[8:11], v[52:55]
s_waitcnt lgkmcnt(5)
ds_write_b64 v9, v[80:81] offset:0
v_exp_f32 v87, v87
v_mfma_f32_16x16x32_bf16 v[56:59], a[200:203], a[24:27], v[56:59]
ds_read_b64_tr_b16 a[180:181], v8 offset:58368
v_cvt_pk_bf16_f32 v84, v84, v85
v_cvt_pk_bf16_f32 v85, v86, v87
v_mfma_f32_16x16x32_bf16 v[68:71], a[200:203], a[40:43], v[68:71]
ds_write_b64 v9, v[84:85] offset:1024
v_exp_f32 v16, v16
v_mfma_f32_16x16x32_bf16 v[72:75], a[200:203], a[56:59], v[72:75]
ds_read_b64_tr_b16 a[182:183], v8 offset:62464
v_exp_f32 v17, v17
v_mfma_f32_16x16x32_bf16 v[52:55], a[204:207], a[12:15], v[52:55]
v_exp_f32 v18, v18
v_cvt_pk_bf16_f32 v22, v16, v17
v_mfma_f32_16x16x32_bf16 v[56:59], a[204:207], a[28:31], v[56:59]
ds_read_b64_tr_b16 a[184:185], v5 offset:57344
v_exp_f32 v19, v19
v_mfma_f32_16x16x32_bf16 v[68:71], a[204:207], a[44:47], v[68:71]
v_exp_f32 v28, v28
v_cvt_pk_bf16_f32 v23, v18, v19
v_mfma_f32_16x16x32_bf16 v[72:75], a[204:207], a[60:63], v[72:75]
ds_read_b64_tr_b16 a[186:187], v5 offset:61440
v_exp_f32 v29, v29
v_mfma_f32_16x16x32_bf16 v[48:51], a[208:211], a[0:3], 0
v_exp_f32 v30, v30
v_cvt_pk_bf16_f32 v26, v28, v29
v_mfma_f32_16x16x32_bf16 v[60:63], a[208:211], a[16:19], 0
ds_read_b64_tr_b16 a[188:189], v5 offset:58368
v_exp_f32 v31, v31
v_mfma_f32_16x16x32_bf16 v[64:67], a[208:211], a[32:35], 0
v_exp_f32 v32, v32
v_cvt_pk_bf16_f32 v27, v30, v31
v_mfma_f32_16x16x32_bf16 v[76:79], a[208:211], a[48:51], 0
ds_read_b64_tr_b16 a[190:191], v5 offset:62464
v_exp_f32 v33, v33
v_mfma_f32_16x16x32_bf16 v[48:51], a[212:215], a[4:7], v[48:51]
v_exp_f32 v34, v34
v_cvt_pk_bf16_f32 v38, v32, v33
v_mfma_f32_16x16x32_bf16 v[60:63], a[212:215], a[20:23], v[60:63]
v_exp_f32 v35, v35
v_mfma_f32_16x16x32_bf16 v[64:67], a[212:215], a[36:39], v[64:67]
v_exp_f32 v44, v44
v_cvt_pk_bf16_f32 v39, v34, v35
v_mfma_f32_16x16x32_bf16 v[76:79], a[212:215], a[52:55], v[76:79]
v_exp_f32 v45, v45
v_mfma_f32_16x16x32_bf16 v[48:51], a[216:219], a[8:11], v[48:51]
v_exp_f32 v46, v46
v_cvt_pk_bf16_f32 v42, v44, v45
v_mfma_f32_16x16x32_bf16 v[60:63], a[216:219], a[24:27], v[60:63]
v_exp_f32 v47, v47
v_mfma_f32_16x16x32_bf16 v[64:67], a[216:219], a[40:43], v[64:67]
v_exp_f32 v52, v52
v_cvt_pk_bf16_f32 v43, v46, v47
v_mfma_f32_16x16x32_bf16 v[76:79], a[216:219], a[56:59], v[76:79]
v_exp_f32 v53, v53
v_mfma_f32_16x16x32_bf16 v[48:51], a[220:223], a[12:15], v[48:51]
v_exp_f32 v54, v54
v_cvt_pk_bf16_f32 v52, v52, v53
v_mfma_f32_16x16x32_bf16 v[60:63], a[220:223], a[28:31], v[60:63]
v_exp_f32 v55, v55
v_mfma_f32_16x16x32_bf16 v[64:67], a[220:223], a[44:47], v[64:67]
v_exp_f32 v56, v56
v_cvt_pk_bf16_f32 v53, v54, v55
v_mfma_f32_16x16x32_bf16 v[76:79], a[220:223], a[60:63], v[76:79]
s_waitcnt vmcnt(4) lgkmcnt(0)
s_barrier
ds_read_b128 a[224:227], v10 offset:0
v_exp_f32 v57, v57
v_mfma_f32_16x16x32_bf16 v[132:135], a[160:163], v[20:23], 0
v_exp_f32 v58, v58
v_exp_f32 v59, v59
v_exp_f32 v68, v68
v_exp_f32 v69, v69
v_exp_f32 v70, v70
v_exp_f32 v71, v71
v_cvt_pk_bf16_f32 v56, v56, v57
v_mfma_f32_16x16x32_bf16 v[164:167], a[160:163], v[24:27], 0
ds_read_b128 a[228:231], v10 offset:1024
v_exp_f32 v72, v72
v_exp_f32 v73, v73
v_exp_f32 v74, v74
v_exp_f32 v75, v75
v_exp_f32 v48, v48
v_exp_f32 v49, v49
v_mfma_f32_16x16x32_bf16 v[196:199], a[160:163], v[36:39], 0
v_cvt_pk_bf16_f32 v57, v58, v59
v_exp_f32 v50, v50
v_exp_f32 v51, v51
v_exp_f32 v60, v60
v_exp_f32 v61, v61
v_exp_f32 v62, v62
v_exp_f32 v63, v63
v_mfma_f32_16x16x32_bf16 v[228:231], a[160:163], v[40:43], 0
ds_read_b128 a[192:195], v1 offset:0
v_cvt_pk_bf16_f32 v54, v48, v49
v_cvt_pk_bf16_f32 v55, v50, v51
v_exp_f32 v64, v64
v_exp_f32 v65, v65
v_exp_f32 v66, v66
v_exp_f32 v67, v67
v_cvt_pk_bf16_f32 v68, v68, v69
v_cvt_pk_bf16_f32 v69, v70, v71
v_mfma_f32_16x16x32_bf16 v[148:151], a[164:167], v[20:23], 0
v_cvt_pk_bf16_f32 v58, v60, v61
v_cvt_pk_bf16_f32 v59, v62, v63
v_exp_f32 v76, v76
v_exp_f32 v77, v77
v_exp_f32 v78, v78
v_exp_f32 v79, v79
v_cvt_pk_bf16_f32 v72, v72, v73
v_cvt_pk_bf16_f32 v73, v74, v75
v_cvt_pk_bf16_f32 v70, v64, v65
v_mfma_f32_16x16x32_bf16 v[180:183], a[164:167], v[24:27], 0
s_add_u32 m0, s30, 0x16000
s_add_u32 s37, s37, 0x2000
ds_read_b128 a[196:199], v2 offset:0
v_cvt_pk_bf16_f32 v71, v66, v67
v_cvt_pk_bf16_f32 v74, v76, v77
v_cvt_pk_bf16_f32 v75, v78, v79
v_mfma_f32_16x16x32_bf16 v[212:215], a[164:167], v[36:39], 0
buffer_load_dwordx4 v11, s[12:15], s37 offen nt lds
v_mfma_f32_16x16x32_bf16 v[244:247], a[164:167], v[40:43], 0
ds_read_b128 a[200:203], v1 offset:1024
v_smfmac_f32_16x16x64_bf16 a[244:247], a[240:243], v[20:27], v110
ds_read_b128 a[204:207], v2 offset:1024
v_mfma_f32_16x16x32_bf16 v[136:139], a[168:171], v[20:23], 0
v_mfma_f32_16x16x32_bf16 v[168:171], a[168:171], v[24:27], 0
ds_read_b128 a[208:211], v1 offset:4096
v_mfma_f32_16x16x32_bf16 v[200:203], a[168:171], v[36:39], 0
v_mfma_f32_16x16x32_bf16 v[232:235], a[168:171], v[40:43], 0
ds_read_b128 a[212:215], v2 offset:4096
v_mfma_f32_16x16x32_bf16 v[152:155], a[172:175], v[20:23], 0
v_mfma_f32_16x16x32_bf16 v[184:187], a[172:175], v[24:27], 0
buffer_load_dwordx4 v[120:123], v11, s[4:7], s78 offen nt
v_mfma_f32_16x16x32_bf16 v[216:219], a[172:175], v[36:39], 0
buffer_load_dwordx4 v[124:127], v11, s[4:7], s78 offen offset:2048 nt
v_mfma_f32_16x16x32_bf16 v[248:251], a[172:175], v[40:43], 0
ds_read_b128 a[216:219], v1 offset:5120
v_smfmac_f32_16x16x64_bf16 a[248:251], a[240:243], v[36:43], v110
ds_read_b128 a[220:223], v2 offset:5120
v_mfma_f32_16x16x32_bf16 v[140:143], a[176:179], v[20:23], 0
v_mfma_f32_16x16x32_bf16 v[172:175], a[176:179], v[24:27], 0
ds_read_b128 a[232:235], v3 offset:0
v_mfma_f32_16x16x32_bf16 v[204:207], a[176:179], v[36:39], 0
v_mfma_f32_16x16x32_bf16 v[236:239], a[176:179], v[40:43], 0
ds_read_b128 a[236:239], v4 offset:0
v_mfma_f32_16x16x32_bf16 v[156:159], a[180:183], v[20:23], 0
v_mfma_f32_16x16x32_bf16 v[188:191], a[180:183], v[24:27], 0
ds_read_b64_tr_b16 a[160:161], v6 offset:0
v_mfma_f32_16x16x32_bf16 v[220:223], a[180:183], v[36:39], 0
v_mfma_f32_16x16x32_bf16 v[252:255], a[180:183], v[40:43], 0
buffer_load_dwordx4 v11, s[12:15], s37 offen offset:2048 nt lds
v_mfma_f32_16x16x32_bf16 v[128:131], a[184:187], v[20:23], 0
ds_read_b64_tr_b16 a[162:163], v6 offset:4096
v_mfma_f32_16x16x32_bf16 v[160:163], a[184:187], v[24:27], 0
v_mfma_f32_16x16x32_bf16 v[192:195], a[184:187], v[36:39], 0
ds_read_b64_tr_b16 a[164:165], v6 offset:1024
v_mfma_f32_16x16x32_bf16 v[224:227], a[184:187], v[40:43], 0
s_waitcnt lgkmcnt(5)
v_mfma_f32_16x16x32_bf16 v[88:91], a[184:187], a[224:227], 0
ds_read_b64_tr_b16 a[166:167], v6 offset:5120
v_mfma_f32_16x16x32_bf16 v[96:99], a[184:187], a[228:231], 0
v_smfmac_f32_16x16x64_bf16 a[252:255], a[240:243], a[224:231], v110
ds_read_b64_tr_b16 a[168:169], v7 offset:0
v_mfma_f32_16x16x32_bf16 v[144:147], a[188:191], v[20:23], 0
v_mfma_f32_16x16x32_bf16 v[176:179], a[188:191], v[24:27], 0
ds_read_b64_tr_b16 a[170:171], v7 offset:4096
v_mfma_f32_16x16x32_bf16 v[208:211], a[188:191], v[36:39], 0
v_mfma_f32_16x16x32_bf16 v[240:243], a[188:191], v[40:43], 0
ds_read_b64_tr_b16 a[172:173], v7 offset:1024
v_mfma_f32_16x16x32_bf16 v[92:95], a[188:191], a[224:227], 0
v_mfma_f32_16x16x32_bf16 v[100:103], a[188:191], a[228:231], 0
ds_read_b128 a[224:227], v3 offset:1024
v_mfma_f32_16x16x32_bf16 v[20:23], a[192:195], a[0:3], 0
v_mfma_f32_16x16x32_bf16 v[24:27], a[192:195], a[16:19], 0
ds_read_b128 a[228:231], v4 offset:1024
v_mfma_f32_16x16x32_bf16 v[36:39], a[192:195], a[32:35], 0
v_mfma_f32_16x16x32_bf16 v[40:43], a[192:195], a[48:51], 0
ds_read_b64_tr_b16 a[174:175], v7 offset:5120
v_mfma_f32_16x16x32_bf16 v[20:23], a[196:199], a[4:7], v[20:23]
s_add_u32 m0, s30, 0x6000
s_add_u32 s21, s21, 0x2000
v_mfma_f32_16x16x32_bf16 v[24:27], a[196:199], a[20:23], v[24:27]
buffer_load_dwordx4 v11, s[8:11], s21 offen nt lds
v_mfma_f32_16x16x32_bf16 v[36:39], a[196:199], a[36:39], v[36:39]
ds_read_b64_tr_b16 a[176:177], v8 offset:0
v_mfma_f32_16x16x32_bf16 v[40:43], a[196:199], a[52:55], v[40:43]
v_mfma_f32_16x16x32_bf16 v[20:23], a[200:203], a[8:11], v[20:23]
ds_read_b64_tr_b16 a[178:179], v8 offset:4096
v_mfma_f32_16x16x32_bf16 v[24:27], a[200:203], a[24:27], v[24:27]
v_mfma_f32_16x16x32_bf16 v[36:39], a[200:203], a[40:43], v[36:39]
ds_read_b64_tr_b16 a[180:181], v8 offset:1024
v_mfma_f32_16x16x32_bf16 v[40:43], a[200:203], a[56:59], v[40:43]
v_mfma_f32_16x16x32_bf16 v[20:23], a[204:207], a[12:15], v[20:23]
s_waitcnt lgkmcnt(4)
ds_read_b64_tr_b16 a[182:183], v8 offset:5120
v_mfma_f32_16x16x32_bf16 v[24:27], a[204:207], a[28:31], v[24:27]
v_mfma_f32_16x16x32_bf16 v[36:39], a[204:207], a[44:47], v[36:39]
ds_read_b64_tr_b16 a[184:185], v5 offset:0
v_mfma_f32_16x16x32_bf16 v[40:43], a[204:207], a[60:63], v[40:43]
v_mfma_f32_16x16x32_bf16 v[16:19], a[208:211], a[0:3], 0
ds_read_b64_tr_b16 a[186:187], v5 offset:4096
v_mfma_f32_16x16x32_bf16 v[28:31], a[208:211], a[16:19], 0
v_exp_f32 v20, v20
v_exp_f32 v21, v21
v_exp_f32 v22, v22
v_exp_f32 v23, v23
v_exp_f32 v24, v24
v_exp_f32 v25, v25
v_cvt_pk_bf16_f32 v20, v20, v21
v_mfma_f32_16x16x32_bf16 v[32:35], a[208:211], a[32:35], 0
ds_read_b64_tr_b16 a[188:189], v5 offset:1024
v_exp_f32 v26, v26
v_exp_f32 v27, v27
v_exp_f32 v36, v36
v_exp_f32 v37, v37
v_exp_f32 v38, v38
v_exp_f32 v39, v39
v_mfma_f32_16x16x32_bf16 v[44:47], a[208:211], a[48:51], 0
v_exp_f32 v40, v40
v_exp_f32 v41, v41
v_exp_f32 v42, v42
v_exp_f32 v43, v43
v_cvt_pk_bf16_f32 v21, v22, v23
v_cvt_pk_bf16_f32 v24, v24, v25
v_cvt_pk_bf16_f32 v25, v26, v27
v_cvt_pk_bf16_f32 v36, v36, v37
v_cvt_pk_bf16_f32 v37, v38, v39
v_mfma_f32_16x16x32_bf16 v[16:19], a[212:215], a[4:7], v[16:19]
ds_read_b64_tr_b16 a[190:191], v5 offset:5120
v_cvt_pk_bf16_f32 v40, v40, v41
v_cvt_pk_bf16_f32 v41, v42, v43
v_mfma_f32_16x16x32_bf16 v[28:31], a[212:215], a[20:23], v[28:31]
v_mfma_f32_16x16x32_bf16 v[32:35], a[212:215], a[36:39], v[32:35]
ds_read_b128 a[192:195], v1 offset:8192
v_mfma_f32_16x16x32_bf16 v[44:47], a[212:215], a[52:55], v[44:47]
v_mfma_f32_16x16x32_bf16 v[16:19], a[216:219], a[8:11], v[16:19]
buffer_load_dwordx4 v11, s[8:11], s21 offen offset:2048 nt lds
v_mfma_f32_16x16x32_bf16 v[28:31], a[216:219], a[24:27], v[28:31]
ds_read_b128 a[196:199], v2 offset:8192
v_mfma_f32_16x16x32_bf16 v[32:35], a[216:219], a[40:43], v[32:35]
v_mfma_f32_16x16x32_bf16 v[44:47], a[216:219], a[56:59], v[44:47]
ds_read_b128 a[200:203], v1 offset:9216
v_mfma_f32_16x16x32_bf16 v[16:19], a[220:223], a[12:15], v[16:19]
v_mfma_f32_16x16x32_bf16 v[28:31], a[220:223], a[28:31], v[28:31]
ds_read_b128 a[204:207], v2 offset:9216
v_mfma_f32_16x16x32_bf16 v[32:35], a[220:223], a[44:47], v[32:35]
v_mfma_f32_16x16x32_bf16 v[44:47], a[220:223], a[60:63], v[44:47]
ds_read_b128 a[208:211], v1 offset:12288
v_mfma_f32_16x16x32_bf16 v[80:83], a[232:235], a[64:67], 0
v_mfma_f32_16x16x32_bf16 v[84:87], a[232:235], a[80:83], 0
ds_read_b128 a[232:235], v10 offset:2048
v_exp_f32 v16, v16
v_exp_f32 v17, v17
v_exp_f32 v18, v18
v_exp_f32 v19, v19
v_exp_f32 v28, v28
v_exp_f32 v29, v29
v_mfma_f32_16x16x32_bf16 v[80:83], a[236:239], a[68:71], v[80:83]
v_exp_f32 v30, v30
v_exp_f32 v31, v31
v_cvt_pk_bf16_f32 v22, v16, v17
v_cvt_pk_bf16_f32 v23, v18, v19
v_exp_f32 v32, v32
v_exp_f32 v33, v33
v_exp_f32 v34, v34
v_cvt_pk_bf16_f32 v26, v28, v29
v_mfma_f32_16x16x32_bf16 v[84:87], a[236:239], a[84:87], v[84:87]
s_waitcnt lgkmcnt(2)
ds_read_b128 a[236:239], v10 offset:3072
v_exp_f32 v35, v35
v_cvt_pk_bf16_f32 v27, v30, v31
v_exp_f32 v44, v44
v_exp_f32 v45, v45
v_exp_f32 v46, v46
v_exp_f32 v47, v47
v_cvt_pk_bf16_f32 v38, v32, v33
v_mfma_f32_16x16x32_bf16 v[80:83], a[224:227], a[72:75], v[80:83]
v_cvt_pk_bf16_f32 v39, v34, v35
v_cvt_pk_bf16_f32 v42, v44, v45
v_cvt_pk_bf16_f32 v43, v46, v47
v_mfma_f32_16x16x32_bf16 v[84:87], a[224:227], a[88:91], v[84:87]
ds_read_b128 a[212:215], v2 offset:12288
v_mfma_f32_16x16x32_bf16 v[80:83], a[228:231], a[76:79], v[80:83]
v_mfma_f32_16x16x32_bf16 v[84:87], a[228:231], a[92:95], v[84:87]
ds_read_b128 a[216:219], v1 offset:13312
v_mfma_f32_16x16x32_bf16 v[132:135], a[160:163], v[52:55], v[132:135]
v_mfma_f32_16x16x32_bf16 v[164:167], a[160:163], v[56:59], v[164:167]
ds_read_b128 a[220:223], v2 offset:13312
v_mfma_f32_16x16x32_bf16 v[196:199], a[160:163], v[68:71], v[196:199]
s_add_u32 m0, s30, 0x18000
s_add_u32 s37, s37, 0x2000
v_exp_f32 v80, v80
v_exp_f32 v81, v81
v_exp_f32 v82, v82
v_exp_f32 v83, v83
v_exp_f32 v84, v84
v_exp_f32 v85, v85
v_cvt_pk_bf16_f32 v80, v80, v81
v_mfma_f32_16x16x32_bf16 v[228:231], a[160:163], v[72:75], v[228:231]
buffer_load_dwordx4 v11, s[12:15], s37 offen nt lds
v_exp_f32 v86, v86
v_exp_f32 v87, v87
v_cvt_pk_bf16_f32 v81, v82, v83
v_cvt_pk_bf16_f32 v84, v84, v85
v_cvt_pk_bf16_f32 v85, v86, v87
v_mfma_f32_16x16x32_bf16 v[148:151], a[164:167], v[52:55], v[148:151]
ds_read_b64_tr_b16 a[160:161], v6 offset:8192
v_mfma_f32_16x16x32_bf16 v[180:183], a[164:167], v[56:59], v[180:183]
ds_write_b64 v9, v[80:81] offset:4096
v_mfma_f32_16x16x32_bf16 v[212:215], a[164:167], v[68:71], v[212:215]
ds_read_b64_tr_b16 a[162:163], v6 offset:12288
v_mfma_f32_16x16x32_bf16 v[244:247], a[164:167], v[72:75], v[244:247]
ds_write_b64 v9, v[84:85] offset:5120
v_smfmac_f32_16x16x64_bf16 a[244:247], a[240:243], v[52:59], v110
ds_read_b64_tr_b16 a[164:165], v6 offset:9216
v_mfma_f32_16x16x32_bf16 v[136:139], a[168:171], v[52:55], v[136:139]
v_mfma_f32_16x16x32_bf16 v[168:171], a[168:171], v[56:59], v[168:171]
ds_read_b64_tr_b16 a[166:167], v6 offset:13312
v_mfma_f32_16x16x32_bf16 v[200:203], a[168:171], v[68:71], v[200:203]
v_mfma_f32_16x16x32_bf16 v[232:235], a[168:171], v[72:75], v[232:235]
ds_read_b64_tr_b16 a[168:169], v7 offset:8192
v_mfma_f32_16x16x32_bf16 v[152:155], a[172:175], v[52:55], v[152:155]
v_mfma_f32_16x16x32_bf16 v[184:187], a[172:175], v[56:59], v[184:187]
ds_read_b64_tr_b16 a[170:171], v7 offset:12288
v_mfma_f32_16x16x32_bf16 v[216:219], a[172:175], v[68:71], v[216:219]
v_mfma_f32_16x16x32_bf16 v[248:251], a[172:175], v[72:75], v[248:251]
ds_read_b64_tr_b16 a[172:173], v7 offset:9216
v_smfmac_f32_16x16x64_bf16 a[248:251], a[240:243], v[68:75], v110
s_waitcnt lgkmcnt(6)
ds_read_b64_tr_b16 a[174:175], v7 offset:13312
v_mfma_f32_16x16x32_bf16 v[140:143], a[176:179], v[52:55], v[140:143]
v_mfma_f32_16x16x32_bf16 v[172:175], a[176:179], v[56:59], v[172:175]
v_mfma_f32_16x16x32_bf16 v[204:207], a[176:179], v[68:71], v[204:207]
v_mfma_f32_16x16x32_bf16 v[236:239], a[176:179], v[72:75], v[236:239]
ds_read_b64_tr_b16 a[176:177], v8 offset:8192
v_mfma_f32_16x16x32_bf16 v[156:159], a[180:183], v[52:55], v[156:159]
buffer_load_dwordx4 v11, s[12:15], s37 offen offset:2048 nt lds
v_mfma_f32_16x16x32_bf16 v[188:191], a[180:183], v[56:59], v[188:191]
ds_read_b64_tr_b16 a[178:179], v8 offset:12288
v_mfma_f32_16x16x32_bf16 v[220:223], a[180:183], v[68:71], v[220:223]
v_mfma_f32_16x16x32_bf16 v[252:255], a[180:183], v[72:75], v[252:255]
ds_read_b64_tr_b16 a[180:181], v8 offset:9216
v_mfma_f32_16x16x32_bf16 v[128:131], a[184:187], v[52:55], v[128:131]
v_mfma_f32_16x16x32_bf16 v[160:163], a[184:187], v[56:59], v[160:163]
ds_read_b64_tr_b16 a[182:183], v8 offset:13312
v_mfma_f32_16x16x32_bf16 v[192:195], a[184:187], v[68:71], v[192:195]
v_mfma_f32_16x16x32_bf16 v[224:227], a[184:187], v[72:75], v[224:227]
v_mfma_f32_16x16x32_bf16 v[88:91], a[184:187], a[232:235], v[88:91]
v_mfma_f32_16x16x32_bf16 v[96:99], a[184:187], a[236:239], v[96:99]
ds_read_b64_tr_b16 a[184:185], v5 offset:8192
v_smfmac_f32_16x16x64_bf16 a[252:255], a[240:243], a[232:239], v110
ds_read_b64_tr_b16 a[186:187], v5 offset:12288
v_mfma_f32_16x16x32_bf16 v[144:147], a[188:191], v[52:55], v[144:147]
v_mfma_f32_16x16x32_bf16 v[176:179], a[188:191], v[56:59], v[176:179]
v_mfma_f32_16x16x32_bf16 v[208:211], a[188:191], v[68:71], v[208:211]
v_mfma_f32_16x16x32_bf16 v[240:243], a[188:191], v[72:75], v[240:243]
v_mfma_f32_16x16x32_bf16 v[92:95], a[188:191], a[232:235], v[92:95]
v_mfma_f32_16x16x32_bf16 v[100:103], a[188:191], a[236:239], v[100:103]
ds_read_b64_tr_b16 a[188:189], v5 offset:9216
v_mfma_f32_16x16x32_bf16 v[52:55], a[192:195], a[0:3], 0
v_mfma_f32_16x16x32_bf16 v[56:59], a[192:195], a[16:19], 0
s_add_u32 m0, s30, 0x8000
s_add_u32 s21, s21, 0x2000
ds_read_b64_tr_b16 a[190:191], v5 offset:13312
v_mfma_f32_16x16x32_bf16 v[68:71], a[192:195], a[32:35], 0
buffer_load_dwordx4 v11, s[8:11], s21 offen nt lds
v_mfma_f32_16x16x32_bf16 v[72:75], a[192:195], a[48:51], 0
v_mfma_f32_16x16x32_bf16 v[52:55], a[196:199], a[4:7], v[52:55]
v_mfma_f32_16x16x32_bf16 v[56:59], a[196:199], a[20:23], v[56:59]
v_mfma_f32_16x16x32_bf16 v[68:71], a[196:199], a[36:39], v[68:71]
v_mfma_f32_16x16x32_bf16 v[72:75], a[196:199], a[52:55], v[72:75]
v_mfma_f32_16x16x32_bf16 v[52:55], a[200:203], a[8:11], v[52:55]
v_mfma_f32_16x16x32_bf16 v[56:59], a[200:203], a[24:27], v[56:59]
v_mfma_f32_16x16x32_bf16 v[68:71], a[200:203], a[40:43], v[68:71]
v_mfma_f32_16x16x32_bf16 v[72:75], a[200:203], a[56:59], v[72:75]
v_mfma_f32_16x16x32_bf16 v[52:55], a[204:207], a[12:15], v[52:55]
v_mfma_f32_16x16x32_bf16 v[56:59], a[204:207], a[28:31], v[56:59]
v_mfma_f32_16x16x32_bf16 v[68:71], a[204:207], a[44:47], v[68:71]
v_mfma_f32_16x16x32_bf16 v[72:75], a[204:207], a[60:63], v[72:75]
v_mfma_f32_16x16x32_bf16 v[48:51], a[208:211], a[0:3], 0
v_mfma_f32_16x16x32_bf16 v[60:63], a[208:211], a[16:19], 0
v_mfma_f32_16x16x32_bf16 v[64:67], a[208:211], a[32:35], 0
v_mfma_f32_16x16x32_bf16 v[76:79], a[208:211], a[48:51], 0
v_mfma_f32_16x16x32_bf16 v[48:51], a[212:215], a[4:7], v[48:51]
buffer_load_dwordx4 v11, s[8:11], s21 offen offset:2048 nt lds
v_exp_f32 v52, v52
v_exp_f32 v53, v53
v_exp_f32 v54, v54
v_exp_f32 v55, v55
v_exp_f32 v56, v56
v_cvt_pk_bf16_f32 v52, v52, v53
v_mfma_f32_16x16x32_bf16 v[60:63], a[212:215], a[20:23], v[60:63]
v_exp_f32 v57, v57
v_exp_f32 v58, v58
v_exp_f32 v59, v59
v_exp_f32 v68, v68
v_exp_f32 v69, v69
v_exp_f32 v70, v70
v_cvt_pk_bf16_f32 v53, v54, v55
v_mfma_f32_16x16x32_bf16 v[64:67], a[212:215], a[36:39], v[64:67]
v_exp_f32 v71, v71
v_exp_f32 v72, v72
v_exp_f32 v73, v73
v_exp_f32 v74, v74
v_exp_f32 v75, v75
v_cvt_pk_bf16_f32 v56, v56, v57
v_cvt_pk_bf16_f32 v57, v58, v59
v_cvt_pk_bf16_f32 v68, v68, v69
v_mfma_f32_16x16x32_bf16 v[76:79], a[212:215], a[52:55], v[76:79]
v_cvt_pk_bf16_f32 v69, v70, v71
v_cvt_pk_bf16_f32 v72, v72, v73
v_cvt_pk_bf16_f32 v73, v74, v75
v_mfma_f32_16x16x32_bf16 v[48:51], a[216:219], a[8:11], v[48:51]
v_mfma_f32_16x16x32_bf16 v[60:63], a[216:219], a[24:27], v[60:63]
v_mfma_f32_16x16x32_bf16 v[64:67], a[216:219], a[40:43], v[64:67]
v_mfma_f32_16x16x32_bf16 v[76:79], a[216:219], a[56:59], v[76:79]
v_mfma_f32_16x16x32_bf16 v[48:51], a[220:223], a[12:15], v[48:51]
v_mfma_f32_16x16x32_bf16 v[60:63], a[220:223], a[28:31], v[60:63]
v_mfma_f32_16x16x32_bf16 v[64:67], a[220:223], a[44:47], v[64:67]
v_mfma_f32_16x16x32_bf16 v[76:79], a[220:223], a[60:63], v[76:79]
s_waitcnt vmcnt(4) lgkmcnt(0)
s_barrier
ds_read_b128 a[224:227], v10 offset:4096
v_mfma_f32_16x16x32_bf16 v[132:135], a[160:163], v[20:23], v[132:135]
v_mfma_f32_16x16x32_bf16 v[164:167], a[160:163], v[24:27], v[164:167]
ds_read_b128 a[228:231], v10 offset:5120
v_exp_f32 v48, v48
v_exp_f32 v49, v49
v_exp_f32 v50, v50
v_exp_f32 v51, v51
v_exp_f32 v60, v60
v_exp_f32 v61, v61
v_mfma_f32_16x16x32_bf16 v[196:199], a[160:163], v[36:39], v[196:199]
v_exp_f32 v62, v62
v_exp_f32 v63, v63
v_cvt_pk_bf16_f32 v54, v48, v49
v_cvt_pk_bf16_f32 v55, v50, v51
v_exp_f32 v64, v64
v_exp_f32 v65, v65
v_exp_f32 v66, v66
v_cvt_pk_bf16_f32 v58, v60, v61
v_mfma_f32_16x16x32_bf16 v[228:231], a[160:163], v[40:43], v[228:231]
ds_read_b128 a[192:195], v1 offset:16384
v_exp_f32 v67, v67
v_cvt_pk_bf16_f32 v59, v62, v63
v_exp_f32 v76, v76
v_exp_f32 v77, v77
v_exp_f32 v78, v78
v_exp_f32 v79, v79
v_cvt_pk_bf16_f32 v70, v64, v65
v_mfma_f32_16x16x32_bf16 v[148:151], a[164:167], v[20:23], v[148:151]
v_cvt_pk_bf16_f32 v71, v66, v67
v_cvt_pk_bf16_f32 v74, v76, v77
v_cvt_pk_bf16_f32 v75, v78, v79
v_mfma_f32_16x16x32_bf16 v[180:183], a[164:167], v[24:27], v[180:183]
s_add_u32 m0, s30, 0x1a000
s_add_u32 s37, s37, 0x2000
ds_read_b128 a[196:199], v2 offset:16384
v_mfma_f32_16x16x32_bf16 v[212:215], a[164:167], v[36:39], v[212:215]
buffer_load_dwordx4 v11, s[12:15], s37 offen nt lds
v_mfma_f32_16x16x32_bf16 v[244:247], a[164:167], v[40:43], v[244:247]
ds_read_b128 a[200:203], v1 offset:17408
v_smfmac_f32_16x16x64_bf16 a[244:247], a[240:243], v[20:27], v110
ds_read_b128 a[204:207], v2 offset:17408
v_mfma_f32_16x16x32_bf16 v[136:139], a[168:171], v[20:23], v[136:139]
v_mfma_f32_16x16x32_bf16 v[168:171], a[168:171], v[24:27], v[168:171]
ds_read_b128 a[208:211], v1 offset:20480
v_mfma_f32_16x16x32_bf16 v[200:203], a[168:171], v[36:39], v[200:203]
v_mfma_f32_16x16x32_bf16 v[232:235], a[168:171], v[40:43], v[232:235]
ds_read_b128 a[212:215], v2 offset:20480
v_mfma_f32_16x16x32_bf16 v[152:155], a[172:175], v[20:23], v[152:155]
v_mfma_f32_16x16x32_bf16 v[184:187], a[172:175], v[24:27], v[184:187]
buffer_load_dwordx4 a[96:99], v12, s[4:7], s74 offen offset:0 nt
v_mfma_f32_16x16x32_bf16 v[216:219], a[172:175], v[36:39], v[216:219]
buffer_load_dwordx4 a[100:103], v12, s[4:7], s74 offen offset:64 nt
v_mfma_f32_16x16x32_bf16 v[248:251], a[172:175], v[40:43], v[248:251]
ds_read_b128 a[216:219], v1 offset:21504
v_smfmac_f32_16x16x64_bf16 a[248:251], a[240:243], v[36:43], v110
ds_read_b128 a[220:223], v2 offset:21504
v_mfma_f32_16x16x32_bf16 v[140:143], a[176:179], v[20:23], v[140:143]
v_mfma_f32_16x16x32_bf16 v[172:175], a[176:179], v[24:27], v[172:175]
ds_read_b128 a[232:235], v3 offset:16384
v_mfma_f32_16x16x32_bf16 v[204:207], a[176:179], v[36:39], v[204:207]
buffer_load_dwordx4 v11, s[12:15], s37 offen offset:2048 nt lds
v_mfma_f32_16x16x32_bf16 v[236:239], a[176:179], v[40:43], v[236:239]
ds_read_b128 a[236:239], v4 offset:16384
v_mfma_f32_16x16x32_bf16 v[156:159], a[180:183], v[20:23], v[156:159]
v_mfma_f32_16x16x32_bf16 v[188:191], a[180:183], v[24:27], v[188:191]
ds_read_b64_tr_b16 a[160:161], v6 offset:16384
v_mfma_f32_16x16x32_bf16 v[220:223], a[180:183], v[36:39], v[220:223]
v_mfma_f32_16x16x32_bf16 v[252:255], a[180:183], v[40:43], v[252:255]
ds_read_b64_tr_b16 a[162:163], v6 offset:20480
v_mfma_f32_16x16x32_bf16 v[128:131], a[184:187], v[20:23], v[128:131]
v_mfma_f32_16x16x32_bf16 v[160:163], a[184:187], v[24:27], v[160:163]
ds_read_b64_tr_b16 a[164:165], v6 offset:17408
v_mfma_f32_16x16x32_bf16 v[192:195], a[184:187], v[36:39], v[192:195]
v_mfma_f32_16x16x32_bf16 v[224:227], a[184:187], v[40:43], v[224:227]
s_waitcnt lgkmcnt(5)
ds_read_b64_tr_b16 a[166:167], v6 offset:21504
v_mfma_f32_16x16x32_bf16 v[88:91], a[184:187], a[224:227], v[88:91]
v_mfma_f32_16x16x32_bf16 v[96:99], a[184:187], a[228:231], v[96:99]
ds_read_b64_tr_b16 a[168:169], v7 offset:16384
v_smfmac_f32_16x16x64_bf16 a[252:255], a[240:243], a[224:231], v110
ds_read_b64_tr_b16 a[170:171], v7 offset:20480
v_mfma_f32_16x16x32_bf16 v[144:147], a[188:191], v[20:23], v[144:147]
v_mfma_f32_16x16x32_bf16 v[176:179], a[188:191], v[24:27], v[176:179]
s_add_u32 m0, s30, 0xa000
s_add_u32 s21, s21, 0x2000
ds_read_b64_tr_b16 a[172:173], v7 offset:17408
v_mfma_f32_16x16x32_bf16 v[208:211], a[188:191], v[36:39], v[208:211]
buffer_load_dwordx4 v11, s[8:11], s21 offen nt lds
v_mfma_f32_16x16x32_bf16 v[240:243], a[188:191], v[40:43], v[240:243]
ds_read_b64_tr_b16 a[174:175], v7 offset:21504
v_mfma_f32_16x16x32_bf16 v[92:95], a[188:191], a[224:227], v[92:95]
v_mfma_f32_16x16x32_bf16 v[100:103], a[188:191], a[228:231], v[100:103]
ds_read_b128 a[224:227], v3 offset:17408
v_mfma_f32_16x16x32_bf16 v[20:23], a[192:195], a[0:3], 0
v_mfma_f32_16x16x32_bf16 v[24:27], a[192:195], a[16:19], 0
ds_read_b128 a[228:231], v4 offset:17408
v_mfma_f32_16x16x32_bf16 v[36:39], a[192:195], a[32:35], 0
v_mfma_f32_16x16x32_bf16 v[40:43], a[192:195], a[48:51], 0
ds_read_b64_tr_b16 a[176:177], v8 offset:16384
v_mfma_f32_16x16x32_bf16 v[20:23], a[196:199], a[4:7], v[20:23]
v_mfma_f32_16x16x32_bf16 v[24:27], a[196:199], a[20:23], v[24:27]
ds_read_b64_tr_b16 a[178:179], v8 offset:20480
v_mfma_f32_16x16x32_bf16 v[36:39], a[196:199], a[36:39], v[36:39]
v_mfma_f32_16x16x32_bf16 v[40:43], a[196:199], a[52:55], v[40:43]
ds_read_b64_tr_b16 a[180:181], v8 offset:17408
v_mfma_f32_16x16x32_bf16 v[20:23], a[200:203], a[8:11], v[20:23]
v_mfma_f32_16x16x32_bf16 v[24:27], a[200:203], a[24:27], v[24:27]
s_waitcnt lgkmcnt(5)
ds_read_b64_tr_b16 a[182:183], v8 offset:21504
v_mfma_f32_16x16x32_bf16 v[36:39], a[200:203], a[40:43], v[36:39]
v_mfma_f32_16x16x32_bf16 v[40:43], a[200:203], a[56:59], v[40:43]
buffer_load_dwordx4 v11, s[8:11], s21 offen offset:2048 nt lds
v_mfma_f32_16x16x32_bf16 v[20:23], a[204:207], a[12:15], v[20:23]
ds_read_b64_tr_b16 a[184:185], v5 offset:16384
v_mfma_f32_16x16x32_bf16 v[24:27], a[204:207], a[28:31], v[24:27]
v_mfma_f32_16x16x32_bf16 v[36:39], a[204:207], a[44:47], v[36:39]
ds_read_b64_tr_b16 a[186:187], v5 offset:20480
v_mfma_f32_16x16x32_bf16 v[40:43], a[204:207], a[60:63], v[40:43]
v_mfma_f32_16x16x32_bf16 v[16:19], a[208:211], a[0:3], 0
ds_read_b64_tr_b16 a[188:189], v5 offset:17408
v_mfma_f32_16x16x32_bf16 v[28:31], a[208:211], a[16:19], 0
v_exp_f32 v20, v20
v_exp_f32 v21, v21
v_exp_f32 v22, v22
v_exp_f32 v23, v23
v_exp_f32 v24, v24
v_exp_f32 v25, v25
v_cvt_pk_bf16_f32 v20, v20, v21
v_mfma_f32_16x16x32_bf16 v[32:35], a[208:211], a[32:35], 0
ds_read_b64_tr_b16 a[190:191], v5 offset:21504
v_exp_f32 v26, v26
v_exp_f32 v27, v27
v_exp_f32 v36, v36
v_exp_f32 v37, v37
v_exp_f32 v38, v38
v_exp_f32 v39, v39
v_mfma_f32_16x16x32_bf16 v[44:47], a[208:211], a[48:51], 0
v_exp_f32 v40, v40
v_exp_f32 v41, v41
v_exp_f32 v42, v42
v_exp_f32 v43, v43
v_cvt_pk_bf16_f32 v21, v22, v23
v_cvt_pk_bf16_f32 v24, v24, v25
v_cvt_pk_bf16_f32 v25, v26, v27
v_cvt_pk_bf16_f32 v36, v36, v37
v_cvt_pk_bf16_f32 v37, v38, v39
v_mfma_f32_16x16x32_bf16 v[16:19], a[212:215], a[4:7], v[16:19]
ds_read_b128 a[192:195], v1 offset:24576
v_cvt_pk_bf16_f32 v40, v40, v41
v_cvt_pk_bf16_f32 v41, v42, v43
v_mfma_f32_16x16x32_bf16 v[28:31], a[212:215], a[20:23], v[28:31]
v_mfma_f32_16x16x32_bf16 v[32:35], a[212:215], a[36:39], v[32:35]
ds_read_b128 a[196:199], v2 offset:24576
v_mfma_f32_16x16x32_bf16 v[44:47], a[212:215], a[52:55], v[44:47]
v_mfma_f32_16x16x32_bf16 v[16:19], a[216:219], a[8:11], v[16:19]
ds_read_b128 a[200:203], v1 offset:25600
v_mfma_f32_16x16x32_bf16 v[28:31], a[216:219], a[24:27], v[28:31]
s_add_u32 m0, s30, 0x1c000
s_add_u32 s37, s37, 0x2000
v_mfma_f32_16x16x32_bf16 v[32:35], a[216:219], a[40:43], v[32:35]
buffer_load_dwordx4 v11, s[12:15], s37 offen nt lds
v_mfma_f32_16x16x32_bf16 v[44:47], a[216:219], a[56:59], v[44:47]
ds_read_b128 a[204:207], v2 offset:25600
v_mfma_f32_16x16x32_bf16 v[16:19], a[220:223], a[12:15], v[16:19]
v_mfma_f32_16x16x32_bf16 v[28:31], a[220:223], a[28:31], v[28:31]
ds_read_b128 a[208:211], v1 offset:28672
v_mfma_f32_16x16x32_bf16 v[32:35], a[220:223], a[44:47], v[32:35]
v_mfma_f32_16x16x32_bf16 v[44:47], a[220:223], a[60:63], v[44:47]
s_waitcnt lgkmcnt(4)
ds_read_b128 a[212:215], v2 offset:28672
v_mfma_f32_16x16x32_bf16 v[80:83], a[232:235], a[64:67], 0
v_mfma_f32_16x16x32_bf16 v[84:87], a[232:235], a[80:83], 0
ds_read_b128 a[232:235], v10 offset:6144
v_exp_f32 v16, v16
v_exp_f32 v17, v17
v_exp_f32 v18, v18
v_exp_f32 v19, v19
v_exp_f32 v28, v28
v_exp_f32 v29, v29
v_mfma_f32_16x16x32_bf16 v[80:83], a[236:239], a[68:71], v[80:83]
v_exp_f32 v30, v30
v_exp_f32 v31, v31
v_cvt_pk_bf16_f32 v22, v16, v17
v_cvt_pk_bf16_f32 v23, v18, v19
v_exp_f32 v32, v32
v_exp_f32 v33, v33
v_exp_f32 v34, v34
v_cvt_pk_bf16_f32 v26, v28, v29
v_mfma_f32_16x16x32_bf16 v[84:87], a[236:239], a[84:87], v[84:87]
ds_read_b128 a[236:239], v10 offset:7168
v_exp_f32 v35, v35
v_cvt_pk_bf16_f32 v27, v30, v31
v_exp_f32 v44, v44
v_exp_f32 v45, v45
v_exp_f32 v46, v46
v_exp_f32 v47, v47
v_cvt_pk_bf16_f32 v38, v32, v33
v_mfma_f32_16x16x32_bf16 v[80:83], a[224:227], a[72:75], v[80:83]
v_cvt_pk_bf16_f32 v39, v34, v35
v_cvt_pk_bf16_f32 v42, v44, v45
v_cvt_pk_bf16_f32 v43, v46, v47
v_mfma_f32_16x16x32_bf16 v[84:87], a[224:227], a[88:91], v[84:87]
ds_read_b128 a[216:219], v1 offset:29696
v_mfma_f32_16x16x32_bf16 v[80:83], a[228:231], a[76:79], v[80:83]
v_mfma_f32_16x16x32_bf16 v[84:87], a[228:231], a[92:95], v[84:87]
ds_read_b128 a[220:223], v2 offset:29696
v_mfma_f32_16x16x32_bf16 v[132:135], a[160:163], v[52:55], v[132:135]
v_mfma_f32_16x16x32_bf16 v[164:167], a[160:163], v[56:59], v[164:167]
buffer_load_dwordx4 v11, s[12:15], s37 offen offset:2048 nt lds
v_mfma_f32_16x16x32_bf16 v[196:199], a[160:163], v[68:71], v[196:199]
v_mfma_f32_16x16x32_bf16 v[228:231], a[160:163], v[72:75], v[228:231]
ds_read_b64_tr_b16 a[160:161], v6 offset:24576
v_exp_f32 v80, v80
v_exp_f32 v81, v81
v_exp_f32 v82, v82
v_exp_f32 v83, v83
v_exp_f32 v84, v84
v_exp_f32 v85, v85
v_mfma_f32_16x16x32_bf16 v[148:151], a[164:167], v[52:55], v[148:151]
v_exp_f32 v86, v86
v_exp_f32 v87, v87
v_cvt_pk_bf16_f32 v80, v80, v81
v_cvt_pk_bf16_f32 v81, v82, v83
v_cvt_pk_bf16_f32 v84, v84, v85
v_cvt_pk_bf16_f32 v85, v86, v87
v_mfma_f32_16x16x32_bf16 v[180:183], a[164:167], v[56:59], v[180:183]
ds_read_b64_tr_b16 a[162:163], v6 offset:28672
v_mfma_f32_16x16x32_bf16 v[212:215], a[164:167], v[68:71], v[212:215]
ds_write_b64 v9, v[80:81] offset:0
v_mfma_f32_16x16x32_bf16 v[244:247], a[164:167], v[72:75], v[244:247]
ds_read_b64_tr_b16 a[164:165], v6 offset:25600
v_smfmac_f32_16x16x64_bf16 a[244:247], a[240:243], v[52:59], v110
ds_read_b64_tr_b16 a[166:167], v6 offset:29696
v_mfma_f32_16x16x32_bf16 v[136:139], a[168:171], v[52:55], v[136:139]
ds_write_b64 v9, v[84:85] offset:1024
v_mfma_f32_16x16x32_bf16 v[168:171], a[168:171], v[56:59], v[168:171]
v_mfma_f32_16x16x32_bf16 v[200:203], a[168:171], v[68:71], v[200:203]
v_mfma_f32_16x16x32_bf16 v[232:235], a[168:171], v[72:75], v[232:235]
s_waitcnt lgkmcnt(5)
ds_read_b64_tr_b16 a[168:169], v7 offset:24576
v_mfma_f32_16x16x32_bf16 v[152:155], a[172:175], v[52:55], v[152:155]
v_mfma_f32_16x16x32_bf16 v[184:187], a[172:175], v[56:59], v[184:187]
ds_read_b64_tr_b16 a[170:171], v7 offset:28672
v_mfma_f32_16x16x32_bf16 v[216:219], a[172:175], v[68:71], v[216:219]
s_add_u32 m0, s30, 0xc000
s_add_u32 s21, s21, 0x2000
v_mfma_f32_16x16x32_bf16 v[248:251], a[172:175], v[72:75], v[248:251]
buffer_load_dwordx4 v11, s[8:11], s21 offen nt lds
v_smfmac_f32_16x16x64_bf16 a[248:251], a[240:243], v[68:75], v110
ds_read_b64_tr_b16 a[172:173], v7 offset:25600
v_mfma_f32_16x16x32_bf16 v[140:143], a[176:179], v[52:55], v[140:143]
v_mfma_f32_16x16x32_bf16 v[172:175], a[176:179], v[56:59], v[172:175]
ds_read_b64_tr_b16 a[174:175], v7 offset:29696
v_mfma_f32_16x16x32_bf16 v[204:207], a[176:179], v[68:71], v[204:207]
v_mfma_f32_16x16x32_bf16 v[236:239], a[176:179], v[72:75], v[236:239]
ds_read_b64_tr_b16 a[176:177], v8 offset:24576
v_mfma_f32_16x16x32_bf16 v[156:159], a[180:183], v[52:55], v[156:159]
v_mfma_f32_16x16x32_bf16 v[188:191], a[180:183], v[56:59], v[188:191]
ds_read_b64_tr_b16 a[178:179], v8 offset:28672
v_mfma_f32_16x16x32_bf16 v[220:223], a[180:183], v[68:71], v[220:223]
v_mfma_f32_16x16x32_bf16 v[252:255], a[180:183], v[72:75], v[252:255]
ds_read_b64_tr_b16 a[180:181], v8 offset:25600
v_mfma_f32_16x16x32_bf16 v[128:131], a[184:187], v[52:55], v[128:131]
v_mfma_f32_16x16x32_bf16 v[160:163], a[184:187], v[56:59], v[160:163]
ds_read_b64_tr_b16 a[182:183], v8 offset:29696
v_mfma_f32_16x16x32_bf16 v[192:195], a[184:187], v[68:71], v[192:195]
v_mfma_f32_16x16x32_bf16 v[224:227], a[184:187], v[72:75], v[224:227]
v_mfma_f32_16x16x32_bf16 v[88:91], a[184:187], a[232:235], v[88:91]
v_mfma_f32_16x16x32_bf16 v[96:99], a[184:187], a[236:239], v[96:99]
buffer_load_dwordx4 v11, s[8:11], s21 offen offset:2048 nt lds
v_smfmac_f32_16x16x64_bf16 a[252:255], a[240:243], a[232:239], v110
ds_read_b64_tr_b16 a[184:185], v5 offset:24576
v_mfma_f32_16x16x32_bf16 v[144:147], a[188:191], v[52:55], v[144:147]
v_mfma_f32_16x16x32_bf16 v[176:179], a[188:191], v[56:59], v[176:179]
ds_read_b64_tr_b16 a[186:187], v5 offset:28672
v_mfma_f32_16x16x32_bf16 v[208:211], a[188:191], v[68:71], v[208:211]
v_mfma_f32_16x16x32_bf16 v[240:243], a[188:191], v[72:75], v[240:243]
v_mfma_f32_16x16x32_bf16 v[92:95], a[188:191], a[232:235], v[92:95]
v_mfma_f32_16x16x32_bf16 v[100:103], a[188:191], a[236:239], v[100:103]
s_waitcnt lgkmcnt(2)
ds_read_b64_tr_b16 a[188:189], v5 offset:25600
v_mfma_f32_16x16x32_bf16 v[52:55], a[192:195], a[0:3], 0
v_mfma_f32_16x16x32_bf16 v[56:59], a[192:195], a[16:19], 0
ds_read_b64_tr_b16 a[190:191], v5 offset:29696
v_mfma_f32_16x16x32_bf16 v[68:71], a[192:195], a[32:35], 0
v_mfma_f32_16x16x32_bf16 v[72:75], a[192:195], a[48:51], 0
v_mfma_f32_16x16x32_bf16 v[52:55], a[196:199], a[4:7], v[52:55]
v_mfma_f32_16x16x32_bf16 v[56:59], a[196:199], a[20:23], v[56:59]
v_mfma_f32_16x16x32_bf16 v[68:71], a[196:199], a[36:39], v[68:71]
s_add_u32 m0, s30, 0x1e000
s_add_u32 s37, s37, 0x2000
v_mfma_f32_16x16x32_bf16 v[72:75], a[196:199], a[52:55], v[72:75]
buffer_load_dwordx4 v11, s[12:15], s37 offen nt lds
v_mfma_f32_16x16x32_bf16 v[52:55], a[200:203], a[8:11], v[52:55]
v_mfma_f32_16x16x32_bf16 v[56:59], a[200:203], a[24:27], v[56:59]
v_mfma_f32_16x16x32_bf16 v[68:71], a[200:203], a[40:43], v[68:71]
v_mfma_f32_16x16x32_bf16 v[72:75], a[200:203], a[56:59], v[72:75]
v_mfma_f32_16x16x32_bf16 v[52:55], a[204:207], a[12:15], v[52:55]
v_mfma_f32_16x16x32_bf16 v[56:59], a[204:207], a[28:31], v[56:59]
v_mfma_f32_16x16x32_bf16 v[68:71], a[204:207], a[44:47], v[68:71]
v_mfma_f32_16x16x32_bf16 v[72:75], a[204:207], a[60:63], v[72:75]
v_mfma_f32_16x16x32_bf16 v[48:51], a[208:211], a[0:3], 0
v_mfma_f32_16x16x32_bf16 v[60:63], a[208:211], a[16:19], 0
v_mfma_f32_16x16x32_bf16 v[64:67], a[208:211], a[32:35], 0
v_mfma_f32_16x16x32_bf16 v[76:79], a[208:211], a[48:51], 0
v_mfma_f32_16x16x32_bf16 v[48:51], a[212:215], a[4:7], v[48:51]
v_exp_f32 v52, v52
v_exp_f32 v53, v53
v_exp_f32 v54, v54
v_exp_f32 v55, v55
v_exp_f32 v56, v56
v_exp_f32 v57, v57
v_cvt_pk_bf16_f32 v52, v52, v53
v_mfma_f32_16x16x32_bf16 v[60:63], a[212:215], a[20:23], v[60:63]
v_exp_f32 v58, v58
v_exp_f32 v59, v59
v_exp_f32 v68, v68
v_exp_f32 v69, v69
v_exp_f32 v70, v70
v_exp_f32 v71, v71
v_cvt_pk_bf16_f32 v53, v54, v55
v_mfma_f32_16x16x32_bf16 v[64:67], a[212:215], a[36:39], v[64:67]
buffer_load_dwordx4 v11, s[12:15], s37 offen offset:2048 nt lds
v_exp_f32 v72, v72
v_exp_f32 v73, v73
v_exp_f32 v74, v74
v_exp_f32 v75, v75
v_cvt_pk_bf16_f32 v56, v56, v57
v_cvt_pk_bf16_f32 v57, v58, v59
v_cvt_pk_bf16_f32 v68, v68, v69
v_mfma_f32_16x16x32_bf16 v[76:79], a[212:215], a[52:55], v[76:79]
v_cvt_pk_bf16_f32 v69, v70, v71
v_cvt_pk_bf16_f32 v72, v72, v73
v_cvt_pk_bf16_f32 v73, v74, v75
v_mfma_f32_16x16x32_bf16 v[48:51], a[216:219], a[8:11], v[48:51]
v_mfma_f32_16x16x32_bf16 v[60:63], a[216:219], a[24:27], v[60:63]
v_mfma_f32_16x16x32_bf16 v[64:67], a[216:219], a[40:43], v[64:67]
v_mfma_f32_16x16x32_bf16 v[76:79], a[216:219], a[56:59], v[76:79]
v_mfma_f32_16x16x32_bf16 v[48:51], a[220:223], a[12:15], v[48:51]
v_mfma_f32_16x16x32_bf16 v[60:63], a[220:223], a[28:31], v[60:63]
v_mfma_f32_16x16x32_bf16 v[64:67], a[220:223], a[44:47], v[64:67]
v_mfma_f32_16x16x32_bf16 v[76:79], a[220:223], a[60:63], v[76:79]
s_waitcnt vmcnt(6) lgkmcnt(0)
s_barrier
ds_read_b128 a[224:227], v10 offset:0
v_lshlrev_b32 v112, 16, v120
s_nop 0
v_exp_f32 v48, v48
v_exp_f32 v49, v49
v_exp_f32 v50, v50
v_exp_f32 v51, v51
v_exp_f32 v60, v60
v_cvt_pk_bf16_f32 v54, v48, v49
v_mfma_f32_16x16x32_bf16 v[132:135], a[160:163], v[20:23], v[132:135]
v_exp_f32 v61, v61
v_cvt_pk_bf16_f32 v55, v50, v51
v_mfma_f32_16x16x32_bf16 v[164:167], a[160:163], v[24:27], v[164:167]
ds_read_b128 a[228:231], v10 offset:1024
v_exp_f32 v62, v62
v_mfma_f32_16x16x32_bf16 v[196:199], a[160:163], v[36:39], v[196:199]
v_exp_f32 v63, v63
v_cvt_pk_bf16_f32 v58, v60, v61
v_mfma_f32_16x16x32_bf16 v[228:231], a[160:163], v[40:43], v[228:231]
ds_read_b128 a[192:195], v1 offset:32768
v_exp_f32 v64, v64
v_mfma_f32_16x16x32_bf16 v[148:151], a[164:167], v[20:23], v[148:151]
v_exp_f32 v65, v65
v_cvt_pk_bf16_f32 v59, v62, v63
v_mfma_f32_16x16x32_bf16 v[180:183], a[164:167], v[24:27], v[180:183]
s_add_u32 m0, s30, 0xe000
s_add_u32 s21, s21, 0x2000
ds_read_b128 a[196:199], v2 offset:32768
v_exp_f32 v66, v66
v_mfma_f32_16x16x32_bf16 v[212:215], a[164:167], v[36:39], v[212:215]
buffer_load_dwordx4 v11, s[8:11], s21 offen nt lds
v_cvt_pk_bf16_f32 v70, v64, v65
v_mfma_f32_16x16x32_bf16 v[244:247], a[164:167], v[40:43], v[244:247]
ds_read_b128 a[200:203], v1 offset:33792
v_exp_f32 v67, v67
v_smfmac_f32_16x16x64_bf16 a[244:247], a[240:243], v[20:27], v110
ds_read_b128 a[204:207], v2 offset:33792
v_cvt_pk_bf16_f32 v71, v66, v67
v_mfma_f32_16x16x32_bf16 v[136:139], a[168:171], v[20:23], v[136:139]
v_exp_f32 v76, v76
v_lshlrev_b32 v114, 16, v121
v_mfma_f32_16x16x32_bf16 v[168:171], a[168:171], v[24:27], v[168:171]
ds_read_b128 a[208:211], v1 offset:36864
v_exp_f32 v77, v77
v_mfma_f32_16x16x32_bf16 v[200:203], a[168:171], v[36:39], v[200:203]
v_exp_f32 v78, v78
v_cvt_pk_bf16_f32 v74, v76, v77
v_mfma_f32_16x16x32_bf16 v[232:235], a[168:171], v[40:43], v[232:235]
ds_read_b128 a[212:215], v2 offset:36864
v_exp_f32 v79, v79
v_mfma_f32_16x16x32_bf16 v[152:155], a[172:175], v[20:23], v[152:155]
v_cvt_pk_bf16_f32 v75, v78, v79
v_lshlrev_b32 v116, 16, v122
v_lshlrev_b32 v118, 16, v123
v_mfma_f32_16x16x32_bf16 v[184:187], a[172:175], v[24:27], v[184:187]
buffer_load_dwordx4 a[104:107], v12, s[4:7], s74 offen offset:128 nt
v_and_b32 v113, s25, v120
v_mfma_f32_16x16x32_bf16 v[216:219], a[172:175], v[36:39], v[216:219]
buffer_load_dwordx4 a[108:111], v12, s[4:7], s74 offen offset:192 nt
v_and_b32 v115, s25, v121
v_mfma_f32_16x16x32_bf16 v[248:251], a[172:175], v[40:43], v[248:251]
ds_read_b128 a[216:219], v1 offset:37888
v_and_b32 v117, s25, v122
v_and_b32 v119, s25, v123
v_smfmac_f32_16x16x64_bf16 a[248:251], a[240:243], v[36:43], v110
ds_read_b128 a[220:223], v2 offset:37888
v_mul_f32 v112, s26, v112
v_mfma_f32_16x16x32_bf16 v[140:143], a[176:179], v[20:23], v[140:143]
v_mul_f32 v113, s26, v113
v_mul_f32 v114, s26, v114
v_mul_f32 v115, s26, v115
v_mfma_f32_16x16x32_bf16 v[172:175], a[176:179], v[24:27], v[172:175]
ds_read_b128 a[232:235], v3 offset:32768
v_mul_f32 v116, s26, v116
v_mul_f32 v117, s26, v117
v_mfma_f32_16x16x32_bf16 v[204:207], a[176:179], v[36:39], v[204:207]
buffer_load_dwordx4 v11, s[8:11], s21 offen offset:2048 nt lds
v_mul_f32 v118, s26, v118
v_mfma_f32_16x16x32_bf16 v[236:239], a[176:179], v[40:43], v[236:239]
ds_read_b128 a[236:239], v4 offset:32768
v_mul_f32 v119, s26, v119
v_cvt_pk_bf16_f32 v120, v112, v113
v_mfma_f32_16x16x32_bf16 v[156:159], a[180:183], v[20:23], v[156:159]
v_cvt_pk_bf16_f32 v121, v114, v115
v_cvt_pk_bf16_f32 v122, v116, v117
v_cvt_pk_bf16_f32 v123, v118, v119
v_mfma_f32_16x16x32_bf16 v[188:191], a[180:183], v[24:27], v[188:191]
ds_read_b64_tr_b16 a[160:161], v6 offset:32768
v_lshlrev_b32 v112, 16, v124
v_lshlrev_b32 v114, 16, v125
v_mfma_f32_16x16x32_bf16 v[220:223], a[180:183], v[36:39], v[220:223]
v_lshlrev_b32 v116, 16, v126
v_lshlrev_b32 v118, 16, v127
v_and_b32 v113, s25, v124
v_mfma_f32_16x16x32_bf16 v[252:255], a[180:183], v[40:43], v[252:255]
ds_read_b64_tr_b16 a[162:163], v6 offset:36864
v_and_b32 v115, s25, v125
v_and_b32 v117, s25, v126
v_mfma_f32_16x16x32_bf16 v[128:131], a[184:187], v[20:23], v[128:131]
v_and_b32 v119, s25, v127
v_mul_f32 v112, s26, v112
v_mul_f32 v113, s26, v113
v_mfma_f32_16x16x32_bf16 v[160:163], a[184:187], v[24:27], v[160:163]
ds_read_b64_tr_b16 a[164:165], v6 offset:33792
v_mul_f32 v114, s26, v114
v_mul_f32 v115, s26, v115
v_mfma_f32_16x16x32_bf16 v[192:195], a[184:187], v[36:39], v[192:195]
v_mul_f32 v116, s26, v116
v_mul_f32 v117, s26, v117
v_mul_f32 v118, s26, v118
v_mfma_f32_16x16x32_bf16 v[224:227], a[184:187], v[40:43], v[224:227]
s_waitcnt lgkmcnt(3)
ds_read_b64_tr_b16 a[166:167], v6 offset:37888
v_mul_f32 v119, s26, v119
v_cvt_pk_bf16_f32 v124, v112, v113
v_mfma_f32_16x16x32_bf16 v[88:91], a[184:187], a[224:227], v[88:91]
v_cvt_pk_bf16_f32 v125, v114, v115
v_cvt_pk_bf16_f32 v126, v116, v117
v_cvt_pk_bf16_f32 v127, v118, v119
v_mfma_f32_16x16x32_bf16 v[96:99], a[184:187], a[228:231], v[96:99]
ds_read_b64_tr_b16 a[168:169], v7 offset:32768
v_add_u32 v112, s36, v10
v_smfmac_f32_16x16x64_bf16 a[252:255], a[240:243], a[224:231], v110
ds_read_b64_tr_b16 a[170:171], v7 offset:36864
v_mfma_f32_16x16x32_bf16 v[144:147], a[188:191], v[20:23], v[144:147]
ds_write_b128 v112, v[120:123] offset:0
v_mfma_f32_16x16x32_bf16 v[176:179], a[188:191], v[24:27], v[176:179]
s_add_u32 m0, s30, 0x10000
s_add_u32 s37, s37, 0x2000
ds_read_b64_tr_b16 a[172:173], v7 offset:33792
v_mfma_f32_16x16x32_bf16 v[208:211], a[188:191], v[36:39], v[208:211]
buffer_load_dwordx4 v11, s[12:15], s37 offen nt lds
v_mfma_f32_16x16x32_bf16 v[240:243], a[188:191], v[40:43], v[240:243]
ds_read_b64_tr_b16 a[174:175], v7 offset:37888
v_mfma_f32_16x16x32_bf16 v[92:95], a[188:191], a[224:227], v[92:95]
ds_write_b128 v112, v[124:127] offset:2048
v_mfma_f32_16x16x32_bf16 v[100:103], a[188:191], a[228:231], v[100:103]
ds_read_b128 a[224:227], v3 offset:33792
v_mfma_f32_16x16x32_bf16 v[20:23], a[192:195], a[0:3], 0
v_mfma_f32_16x16x32_bf16 v[24:27], a[192:195], a[16:19], 0
ds_read_b128 a[228:231], v4 offset:33792
v_mfma_f32_16x16x32_bf16 v[36:39], a[192:195], a[32:35], 0
v_mfma_f32_16x16x32_bf16 v[40:43], a[192:195], a[48:51], 0
ds_read_b64_tr_b16 a[176:177], v8 offset:32768
v_mfma_f32_16x16x32_bf16 v[20:23], a[196:199], a[4:7], v[20:23]
v_mfma_f32_16x16x32_bf16 v[24:27], a[196:199], a[20:23], v[24:27]
ds_read_b64_tr_b16 a[178:179], v8 offset:36864
v_mfma_f32_16x16x32_bf16 v[36:39], a[196:199], a[36:39], v[36:39]
v_mfma_f32_16x16x32_bf16 v[40:43], a[196:199], a[52:55], v[40:43]
ds_read_b64_tr_b16 a[180:181], v8 offset:33792
v_mfma_f32_16x16x32_bf16 v[20:23], a[200:203], a[8:11], v[20:23]
v_mfma_f32_16x16x32_bf16 v[24:27], a[200:203], a[24:27], v[24:27]
s_waitcnt lgkmcnt(5)
ds_read_b64_tr_b16 a[182:183], v8 offset:37888
v_mfma_f32_16x16x32_bf16 v[36:39], a[200:203], a[40:43], v[36:39]
v_mfma_f32_16x16x32_bf16 v[40:43], a[200:203], a[56:59], v[40:43]
buffer_load_dwordx4 v11, s[12:15], s37 offen offset:2048 nt lds
v_mfma_f32_16x16x32_bf16 v[20:23], a[204:207], a[12:15], v[20:23]
ds_read_b64_tr_b16 a[184:185], v5 offset:32768
v_mfma_f32_16x16x32_bf16 v[24:27], a[204:207], a[28:31], v[24:27]
v_mfma_f32_16x16x32_bf16 v[36:39], a[204:207], a[44:47], v[36:39]
ds_read_b64_tr_b16 a[186:187], v5 offset:36864
v_mfma_f32_16x16x32_bf16 v[40:43], a[204:207], a[60:63], v[40:43]
v_mfma_f32_16x16x32_bf16 v[16:19], a[208:211], a[0:3], 0
ds_read_b64_tr_b16 a[188:189], v5 offset:33792
v_mfma_f32_16x16x32_bf16 v[28:31], a[208:211], a[16:19], 0
v_exp_f32 v20, v20
v_mfma_f32_16x16x32_bf16 v[32:35], a[208:211], a[32:35], 0
ds_read_b64_tr_b16 a[190:191], v5 offset:37888
v_exp_f32 v21, v21
v_mfma_f32_16x16x32_bf16 v[44:47], a[208:211], a[48:51], 0
v_exp_f32 v22, v22
v_cvt_pk_bf16_f32 v20, v20, v21
v_mfma_f32_16x16x32_bf16 v[16:19], a[212:215], a[4:7], v[16:19]
ds_read_b128 a[192:195], v1 offset:40960
v_exp_f32 v23, v23
v_mfma_f32_16x16x32_bf16 v[28:31], a[212:215], a[20:23], v[28:31]
v_exp_f32 v24, v24
v_cvt_pk_bf16_f32 v21, v22, v23
v_mfma_f32_16x16x32_bf16 v[32:35], a[212:215], a[36:39], v[32:35]
ds_read_b128 a[196:199], v2 offset:40960
v_exp_f32 v25, v25
v_mfma_f32_16x16x32_bf16 v[44:47], a[212:215], a[52:55], v[44:47]
v_exp_f32 v26, v26
v_cvt_pk_bf16_f32 v24, v24, v25
v_mfma_f32_16x16x32_bf16 v[16:19], a[216:219], a[8:11], v[16:19]
ds_read_b128 a[200:203], v1 offset:41984
v_exp_f32 v27, v27
v_mfma_f32_16x16x32_bf16 v[28:31], a[216:219], a[24:27], v[28:31]
s_add_u32 m0, s30, 0x0
s_add_u32 s21, s21, 0x2000
v_exp_f32 v36, v36
v_cvt_pk_bf16_f32 v25, v26, v27
v_mfma_f32_16x16x32_bf16 v[32:35], a[216:219], a[40:43], v[32:35]
buffer_load_dwordx4 v11, s[8:11], s21 offen nt lds
v_mfma_f32_16x16x32_bf16 v[44:47], a[216:219], a[56:59], v[44:47]
ds_read_b128 a[204:207], v2 offset:41984
v_exp_f32 v37, v37
v_mfma_f32_16x16x32_bf16 v[16:19], a[220:223], a[12:15], v[16:19]
v_exp_f32 v38, v38
v_cvt_pk_bf16_f32 v36, v36, v37
v_mfma_f32_16x16x32_bf16 v[28:31], a[220:223], a[28:31], v[28:31]
ds_read_b128 a[208:211], v1 offset:45056
v_exp_f32 v39, v39
v_mfma_f32_16x16x32_bf16 v[32:35], a[220:223], a[44:47], v[32:35]
v_exp_f32 v40, v40
v_cvt_pk_bf16_f32 v37, v38, v39
v_mfma_f32_16x16x32_bf16 v[44:47], a[220:223], a[60:63], v[44:47]
s_waitcnt lgkmcnt(3)
ds_read_b128 a[212:215], v2 offset:45056
v_exp_f32 v41, v41
v_mfma_f32_16x16x32_bf16 v[80:83], a[232:235], a[64:67], 0
v_exp_f32 v42, v42
v_cvt_pk_bf16_f32 v40, v40, v41
v_mfma_f32_16x16x32_bf16 v[84:87], a[232:235], a[80:83], 0
ds_read_b128 a[232:235], v10 offset:2048
v_exp_f32 v43, v43
v_mfma_f32_16x16x32_bf16 v[80:83], a[236:239], a[68:71], v[80:83]
v_exp_f32 v16, v16
v_cvt_pk_bf16_f32 v41, v42, v43
v_mfma_f32_16x16x32_bf16 v[84:87], a[236:239], a[84:87], v[84:87]
ds_read_b128 a[236:239], v10 offset:3072
v_exp_f32 v17, v17
v_mfma_f32_16x16x32_bf16 v[80:83], a[224:227], a[72:75], v[80:83]
v_exp_f32 v18, v18
v_cvt_pk_bf16_f32 v22, v16, v17
v_mfma_f32_16x16x32_bf16 v[84:87], a[224:227], a[88:91], v[84:87]
ds_read_b128 a[216:219], v1 offset:46080
v_exp_f32 v19, v19
v_mfma_f32_16x16x32_bf16 v[80:83], a[228:231], a[76:79], v[80:83]
v_exp_f32 v28, v28
v_cvt_pk_bf16_f32 v23, v18, v19
v_mfma_f32_16x16x32_bf16 v[84:87], a[228:231], a[92:95], v[84:87]
ds_read_b128 a[220:223], v2 offset:46080
v_exp_f32 v29, v29
v_mfma_f32_16x16x32_bf16 v[132:135], a[160:163], v[52:55], v[132:135]
v_exp_f32 v30, v30
v_cvt_pk_bf16_f32 v26, v28, v29
v_mfma_f32_16x16x32_bf16 v[164:167], a[160:163], v[56:59], v[164:167]
buffer_load_dwordx4 v11, s[8:11], s21 offen offset:2048 nt lds
v_mfma_f32_16x16x32_bf16 v[196:199], a[160:163], v[68:71], v[196:199]
v_exp_f32 v80, v80
v_mfma_f32_16x16x32_bf16 v[228:231], a[160:163], v[72:75], v[228:231]
ds_read_b64_tr_b16 a[160:161], v6 offset:40960
v_exp_f32 v81, v81
v_mfma_f32_16x16x32_bf16 v[148:151], a[164:167], v[52:55], v[148:151]
v_exp_f32 v82, v82
v_cvt_pk_bf16_f32 v80, v80, v81
v_mfma_f32_16x16x32_bf16 v[180:183], a[164:167], v[56:59], v[180:183]
ds_read_b64_tr_b16 a[162:163], v6 offset:45056
v_exp_f32 v83, v83
v_mfma_f32_16x16x32_bf16 v[212:215], a[164:167], v[68:71], v[212:215]
v_exp_f32 v84, v84
v_cvt_pk_bf16_f32 v81, v82, v83
v_mfma_f32_16x16x32_bf16 v[244:247], a[164:167], v[72:75], v[244:247]
ds_read_b64_tr_b16 a[164:165], v6 offset:41984
v_exp_f32 v85, v85
v_smfmac_f32_16x16x64_bf16 a[244:247], a[240:243], v[52:59], v110
ds_read_b64_tr_b16 a[166:167], v6 offset:46080
v_cvt_pk_bf16_f32 v84, v84, v85
v_mfma_f32_16x16x32_bf16 v[136:139], a[168:171], v[52:55], v[136:139]
ds_write_b64 v9, v[80:81] offset:4096
v_exp_f32 v86, v86
v_mfma_f32_16x16x32_bf16 v[168:171], a[168:171], v[56:59], v[168:171]
v_exp_f32 v87, v87
v_mfma_f32_16x16x32_bf16 v[200:203], a[168:171], v[68:71], v[200:203]
v_exp_f32 v31, v31
v_cvt_pk_bf16_f32 v85, v86, v87
v_mfma_f32_16x16x32_bf16 v[232:235], a[168:171], v[72:75], v[232:235]
ds_read_b64_tr_b16 a[168:169], v7 offset:40960
v_exp_f32 v32, v32
v_mfma_f32_16x16x32_bf16 v[152:155], a[172:175], v[52:55], v[152:155]
ds_write_b64 v9, v[84:85] offset:5120
v_exp_f32 v33, v33
v_mfma_f32_16x16x32_bf16 v[184:187], a[172:175], v[56:59], v[184:187]
s_waitcnt lgkmcnt(5)
ds_read_b64_tr_b16 a[170:171], v7 offset:45056
v_exp_f32 v34, v34
v_mfma_f32_16x16x32_bf16 v[216:219], a[172:175], v[68:71], v[216:219]
s_add_u32 m0, s30, 0x12000
s_add_u32 s37, s37, 0x2000
v_exp_f32 v35, v35
v_cvt_pk_bf16_f32 v27, v30, v31
v_mfma_f32_16x16x32_bf16 v[248:251], a[172:175], v[72:75], v[248:251]
buffer_load_dwordx4 v11, s[12:15], s37 offen nt lds
v_cvt_pk_bf16_f32 v38, v32, v33
v_smfmac_f32_16x16x64_bf16 a[248:251], a[240:243], v[68:75], v110
ds_read_b64_tr_b16 a[172:173], v7 offset:41984
v_cvt_pk_bf16_f32 v39, v34, v35
v_mfma_f32_16x16x32_bf16 v[140:143], a[176:179], v[52:55], v[140:143]
v_exp_f32 v44, v44
v_mfma_f32_16x16x32_bf16 v[172:175], a[176:179], v[56:59], v[172:175]
ds_read_b64_tr_b16 a[174:175], v7 offset:46080
v_exp_f32 v45, v45
v_mfma_f32_16x16x32_bf16 v[204:207], a[176:179], v[68:71], v[204:207]
v_exp_f32 v46, v46
v_cvt_pk_bf16_f32 v42, v44, v45
v_mfma_f32_16x16x32_bf16 v[236:239], a[176:179], v[72:75], v[236:239]
ds_read_b64_tr_b16 a[176:177], v8 offset:40960
v_exp_f32 v47, v47
v_mfma_f32_16x16x32_bf16 v[156:159], a[180:183], v[52:55], v[156:159]
v_cvt_pk_bf16_f32 v43, v46, v47
v_mfma_f32_16x16x32_bf16 v[188:191], a[180:183], v[56:59], v[188:191]
ds_read_b64_tr_b16 a[178:179], v8 offset:45056
v_mfma_f32_16x16x32_bf16 v[220:223], a[180:183], v[68:71], v[220:223]
v_mfma_f32_16x16x32_bf16 v[252:255], a[180:183], v[72:75], v[252:255]
ds_read_b64_tr_b16 a[180:181], v8 offset:41984
v_mfma_f32_16x16x32_bf16 v[128:131], a[184:187], v[52:55], v[128:131]
v_mfma_f32_16x16x32_bf16 v[160:163], a[184:187], v[56:59], v[160:163]
ds_read_b64_tr_b16 a[182:183], v8 offset:46080
v_mfma_f32_16x16x32_bf16 v[192:195], a[184:187], v[68:71], v[192:195]
v_mfma_f32_16x16x32_bf16 v[224:227], a[184:187], v[72:75], v[224:227]
v_mfma_f32_16x16x32_bf16 v[88:91], a[184:187], a[232:235], v[88:91]
v_mfma_f32_16x16x32_bf16 v[96:99], a[184:187], a[236:239], v[96:99]
buffer_load_dwordx4 v11, s[12:15], s37 offen offset:2048 nt lds
v_smfmac_f32_16x16x64_bf16 a[252:255], a[240:243], a[232:239], v110
ds_read_b64_tr_b16 a[184:185], v5 offset:40960
v_mfma_f32_16x16x32_bf16 v[144:147], a[188:191], v[52:55], v[144:147]
v_mfma_f32_16x16x32_bf16 v[176:179], a[188:191], v[56:59], v[176:179]
ds_read_b64_tr_b16 a[186:187], v5 offset:45056
v_mfma_f32_16x16x32_bf16 v[208:211], a[188:191], v[68:71], v[208:211]
v_mfma_f32_16x16x32_bf16 v[240:243], a[188:191], v[72:75], v[240:243]
v_mfma_f32_16x16x32_bf16 v[92:95], a[188:191], a[232:235], v[92:95]
v_mfma_f32_16x16x32_bf16 v[100:103], a[188:191], a[236:239], v[100:103]
ds_read_b64_tr_b16 a[188:189], v5 offset:41984
v_mfma_f32_16x16x32_bf16 v[52:55], a[192:195], a[0:3], 0
v_mfma_f32_16x16x32_bf16 v[56:59], a[192:195], a[16:19], 0
s_waitcnt lgkmcnt(3)
ds_read_b64_tr_b16 a[190:191], v5 offset:46080
v_mfma_f32_16x16x32_bf16 v[68:71], a[192:195], a[32:35], 0
v_mfma_f32_16x16x32_bf16 v[72:75], a[192:195], a[48:51], 0
v_mfma_f32_16x16x32_bf16 v[52:55], a[196:199], a[4:7], v[52:55]
v_mfma_f32_16x16x32_bf16 v[56:59], a[196:199], a[20:23], v[56:59]
v_mfma_f32_16x16x32_bf16 v[68:71], a[196:199], a[36:39], v[68:71]
s_add_u32 m0, s30, 0x2000
s_add_u32 s21, s21, 0x2000
v_mfma_f32_16x16x32_bf16 v[72:75], a[196:199], a[52:55], v[72:75]
buffer_load_dwordx4 v11, s[8:11], s21 offen nt lds
v_mfma_f32_16x16x32_bf16 v[52:55], a[200:203], a[8:11], v[52:55]
v_mfma_f32_16x16x32_bf16 v[56:59], a[200:203], a[24:27], v[56:59]
v_mfma_f32_16x16x32_bf16 v[68:71], a[200:203], a[40:43], v[68:71]
v_mfma_f32_16x16x32_bf16 v[72:75], a[200:203], a[56:59], v[72:75]
v_mfma_f32_16x16x32_bf16 v[52:55], a[204:207], a[12:15], v[52:55]
v_mfma_f32_16x16x32_bf16 v[56:59], a[204:207], a[28:31], v[56:59]
v_mfma_f32_16x16x32_bf16 v[68:71], a[204:207], a[44:47], v[68:71]
v_mfma_f32_16x16x32_bf16 v[72:75], a[204:207], a[60:63], v[72:75]
v_mfma_f32_16x16x32_bf16 v[48:51], a[208:211], a[0:3], 0
v_mfma_f32_16x16x32_bf16 v[60:63], a[208:211], a[16:19], 0
v_mfma_f32_16x16x32_bf16 v[64:67], a[208:211], a[32:35], 0
v_mfma_f32_16x16x32_bf16 v[76:79], a[208:211], a[48:51], 0
v_mfma_f32_16x16x32_bf16 v[48:51], a[212:215], a[4:7], v[48:51]
v_exp_f32 v52, v52
v_mfma_f32_16x16x32_bf16 v[60:63], a[212:215], a[20:23], v[60:63]
v_exp_f32 v53, v53
v_mfma_f32_16x16x32_bf16 v[64:67], a[212:215], a[36:39], v[64:67]
buffer_load_dwordx4 v11, s[8:11], s21 offen offset:2048 nt lds
v_cvt_pk_bf16_f32 v52, v52, v53
v_mfma_f32_16x16x32_bf16 v[76:79], a[212:215], a[52:55], v[76:79]
v_exp_f32 v54, v54
v_mfma_f32_16x16x32_bf16 v[48:51], a[216:219], a[8:11], v[48:51]
v_exp_f32 v55, v55
v_mfma_f32_16x16x32_bf16 v[60:63], a[216:219], a[24:27], v[60:63]
v_exp_f32 v56, v56
v_cvt_pk_bf16_f32 v53, v54, v55
v_mfma_f32_16x16x32_bf16 v[64:67], a[216:219], a[40:43], v[64:67]
v_exp_f32 v57, v57
v_mfma_f32_16x16x32_bf16 v[76:79], a[216:219], a[56:59], v[76:79]
v_exp_f32 v58, v58
v_cvt_pk_bf16_f32 v56, v56, v57
v_mfma_f32_16x16x32_bf16 v[48:51], a[220:223], a[12:15], v[48:51]
v_exp_f32 v59, v59
v_mfma_f32_16x16x32_bf16 v[60:63], a[220:223], a[28:31], v[60:63]
v_exp_f32 v68, v68
v_cvt_pk_bf16_f32 v57, v58, v59
v_mfma_f32_16x16x32_bf16 v[64:67], a[220:223], a[44:47], v[64:67]
v_exp_f32 v69, v69
v_mfma_f32_16x16x32_bf16 v[76:79], a[220:223], a[60:63], v[76:79]
s_waitcnt vmcnt(8) lgkmcnt(0)
s_barrier
ds_read_b128 a[224:227], v10 offset:4096
v_exp_f32 v70, v70
v_mfma_f32_16x16x32_bf16 v[132:135], a[160:163], v[20:23], v[132:135]
v_exp_f32 v71, v71
v_mfma_f32_16x16x32_bf16 v[164:167], a[160:163], v[24:27], v[164:167]
ds_read_b128 a[228:231], v10 offset:5120
v_exp_f32 v72, v72
v_mfma_f32_16x16x32_bf16 v[196:199], a[160:163], v[36:39], v[196:199]
v_exp_f32 v73, v73
v_mfma_f32_16x16x32_bf16 v[228:231], a[160:163], v[40:43], v[228:231]
ds_read_b128 a[192:195], v1 offset:49152
v_exp_f32 v74, v74
v_mfma_f32_16x16x32_bf16 v[148:151], a[164:167], v[20:23], v[148:151]
v_exp_f32 v75, v75
v_mfma_f32_16x16x32_bf16 v[180:183], a[164:167], v[24:27], v[180:183]
s_add_u32 m0, s30, 0x14000
s_add_u32 s37, s37, 0x2000
ds_read_b128 a[196:199], v2 offset:49152
v_cvt_pk_bf16_f32 v68, v68, v69
v_mfma_f32_16x16x32_bf16 v[212:215], a[164:167], v[36:39], v[212:215]
buffer_load_dwordx4 v11, s[12:15], s37 offen nt lds
v_mfma_f32_16x16x32_bf16 v[244:247], a[164:167], v[40:43], v[244:247]
ds_read_b128 a[200:203], v1 offset:50176
v_exp_f32 v48, v48
v_smfmac_f32_16x16x64_bf16 a[244:247], a[240:243], v[20:27], v110
ds_read_b128 a[204:207], v2 offset:50176
v_cvt_pk_bf16_f32 v69, v70, v71
v_mfma_f32_16x16x32_bf16 v[136:139], a[168:171], v[20:23], v[136:139]
v_exp_f32 v49, v49
v_mfma_f32_16x16x32_bf16 v[168:171], a[168:171], v[24:27], v[168:171]
ds_read_b128 a[208:211], v1 offset:53248
v_exp_f32 v50, v50
v_mfma_f32_16x16x32_bf16 v[200:203], a[168:171], v[36:39], v[200:203]
v_exp_f32 v51, v51
v_mfma_f32_16x16x32_bf16 v[232:235], a[168:171], v[40:43], v[232:235]
ds_read_b128 a[212:215], v2 offset:53248
v_exp_f32 v60, v60
v_mfma_f32_16x16x32_bf16 v[152:155], a[172:175], v[20:23], v[152:155]
v_exp_f32 v61, v61
v_mfma_f32_16x16x32_bf16 v[184:187], a[172:175], v[24:27], v[184:187]
buffer_load_dwordx4 a[112:115], v12, s[4:7], s75 offen offset:0 nt
v_mfma_f32_16x16x32_bf16 v[216:219], a[172:175], v[36:39], v[216:219]
buffer_load_dwordx4 a[116:119], v12, s[4:7], s75 offen offset:64 nt
v_mfma_f32_16x16x32_bf16 v[248:251], a[172:175], v[40:43], v[248:251]
ds_read_b128 a[216:219], v1 offset:54272
v_exp_f32 v62, v62
v_smfmac_f32_16x16x64_bf16 a[248:251], a[240:243], v[36:43], v110
ds_read_b128 a[220:223], v2 offset:54272
v_cvt_pk_bf16_f32 v54, v48, v49
v_mfma_f32_16x16x32_bf16 v[140:143], a[176:179], v[20:23], v[140:143]
v_exp_f32 v63, v63
v_mfma_f32_16x16x32_bf16 v[172:175], a[176:179], v[24:27], v[172:175]
ds_read_b128 a[232:235], v3 offset:49152
v_cvt_pk_bf16_f32 v55, v50, v51
v_mfma_f32_16x16x32_bf16 v[204:207], a[176:179], v[36:39], v[204:207]
v_exp_f32 v64, v64
v_mfma_f32_16x16x32_bf16 v[236:239], a[176:179], v[40:43], v[236:239]
ds_read_b128 a[236:239], v4 offset:49152
v_exp_f32 v65, v65
v_mfma_f32_16x16x32_bf16 v[156:159], a[180:183], v[20:23], v[156:159]
v_exp_f32 v66, v66
v_mfma_f32_16x16x32_bf16 v[188:191], a[180:183], v[24:27], v[188:191]
ds_read_b64_tr_b16 a[160:161], v6 offset:49152
v_exp_f32 v67, v67
v_mfma_f32_16x16x32_bf16 v[220:223], a[180:183], v[36:39], v[220:223]
v_cvt_pk_bf16_f32 v58, v60, v61
v_cvt_pk_bf16_f32 v59, v62, v63
v_mfma_f32_16x16x32_bf16 v[252:255], a[180:183], v[40:43], v[252:255]
buffer_load_dwordx4 v11, s[12:15], s37 offen offset:2048 nt lds
v_mfma_f32_16x16x32_bf16 v[128:131], a[184:187], v[20:23], v[128:131]
ds_read_b64_tr_b16 a[162:163], v6 offset:53248
v_exp_f32 v76, v76
v_mfma_f32_16x16x32_bf16 v[160:163], a[184:187], v[24:27], v[160:163]
v_exp_f32 v77, v77
v_mfma_f32_16x16x32_bf16 v[192:195], a[184:187], v[36:39], v[192:195]
ds_read_b64_tr_b16 a[164:165], v6 offset:50176
v_exp_f32 v78, v78
v_mfma_f32_16x16x32_bf16 v[224:227], a[184:187], v[40:43], v[224:227]
v_exp_f32 v79, v79
s_waitcnt lgkmcnt(4)
v_mfma_f32_16x16x32_bf16 v[88:91], a[184:187], a[224:227], v[88:91]
ds_read_b64_tr_b16 a[166:167], v6 offset:54272
v_cvt_pk_bf16_f32 v72, v72, v73
v_mfma_f32_16x16x32_bf16 v[96:99], a[184:187], a[228:231], v[96:99]
v_cvt_pk_bf16_f32 v73, v74, v75
v_cvt_pk_bf16_f32 v70, v64, v65
v_smfmac_f32_16x16x64_bf16 a[252:255], a[240:243], a[224:231], v110
ds_read_b64_tr_b16 a[168:169], v7 offset:49152
v_cvt_pk_bf16_f32 v71, v66, v67
v_mfma_f32_16x16x32_bf16 v[144:147], a[188:191], v[20:23], v[144:147]
v_cvt_pk_bf16_f32 v74, v76, v77
v_cvt_pk_bf16_f32 v75, v78, v79
v_mfma_f32_16x16x32_bf16 v[176:179], a[188:191], v[24:27], v[176:179]
ds_read_b64_tr_b16 a[170:171], v7 offset:53248
v_accvgpr_read_b32 v113, a96
v_mfma_f32_16x16x32_bf16 v[208:211], a[188:191], v[36:39], v[208:211]
v_accvgpr_read_b32 v115, a97
v_accvgpr_read_b32 v117, a98
v_mfma_f32_16x16x32_bf16 v[240:243], a[188:191], v[40:43], v[240:243]
ds_read_b64_tr_b16 a[172:173], v7 offset:50176
v_accvgpr_read_b32 v119, a99
v_mfma_f32_16x16x32_bf16 v[92:95], a[188:191], a[224:227], v[92:95]
v_lshlrev_b32 v112, 16, v113
v_lshlrev_b32 v114, 16, v115
v_mfma_f32_16x16x32_bf16 v[100:103], a[188:191], a[228:231], v[100:103]
ds_read_b128 a[224:227], v3 offset:50176
v_lshlrev_b32 v116, 16, v117
v_mfma_f32_16x16x32_bf16 v[20:23], a[192:195], a[0:3], 0
v_lshlrev_b32 v118, 16, v119
v_and_b32 v113, s25, v113
v_mfma_f32_16x16x32_bf16 v[24:27], a[192:195], a[16:19], 0
ds_read_b128 a[228:231], v4 offset:50176
v_and_b32 v115, s25, v115
v_mfma_f32_16x16x32_bf16 v[36:39], a[192:195], a[32:35], 0
v_and_b32 v117, s25, v117
v_and_b32 v119, s25, v119
v_mfma_f32_16x16x32_bf16 v[40:43], a[192:195], a[48:51], 0
ds_read_b64_tr_b16 a[174:175], v7 offset:54272
v_mul_f32 v112, s26, v112
v_mfma_f32_16x16x32_bf16 v[20:23], a[196:199], a[4:7], v[20:23]
s_add_u32 m0, s30, 0x4000
s_add_u32 s21, s21, 0x2000
v_mul_f32 v113, s26, v113
v_mul_f32 v114, s26, v114
v_mfma_f32_16x16x32_bf16 v[24:27], a[196:199], a[20:23], v[24:27]
buffer_load_dwordx4 v11, s[8:11], s21 offen nt lds
v_mfma_f32_16x16x32_bf16 v[36:39], a[196:199], a[36:39], v[36:39]
ds_read_b64_tr_b16 a[176:177], v8 offset:49152
v_mul_f32 v115, s26, v115
v_mfma_f32_16x16x32_bf16 v[40:43], a[196:199], a[52:55], v[40:43]
v_mul_f32 v116, s26, v116
v_mul_f32 v117, s26, v117
v_mfma_f32_16x16x32_bf16 v[20:23], a[200:203], a[8:11], v[20:23]
ds_read_b64_tr_b16 a[178:179], v8 offset:53248
v_mul_f32 v118, s26, v118
v_mfma_f32_16x16x32_bf16 v[24:27], a[200:203], a[24:27], v[24:27]
v_mul_f32 v119, s26, v119
v_cvt_pk_bf16_f32 v112, v112, v113
v_mfma_f32_16x16x32_bf16 v[36:39], a[200:203], a[40:43], v[36:39]
ds_read_b64_tr_b16 a[180:181], v8 offset:50176
v_cvt_pk_bf16_f32 v114, v114, v115
v_mfma_f32_16x16x32_bf16 v[40:43], a[200:203], a[56:59], v[40:43]
v_cvt_pk_bf16_f32 v116, v116, v117
v_cvt_pk_bf16_f32 v118, v118, v119
v_mfma_f32_16x16x32_bf16 v[20:23], a[204:207], a[12:15], v[20:23]
ds_read_b64_tr_b16 a[182:183], v8 offset:54272
v_accvgpr_write_b32 a96, v112
v_mfma_f32_16x16x32_bf16 v[24:27], a[204:207], a[28:31], v[24:27]
v_accvgpr_write_b32 a97, v114
v_accvgpr_write_b32 a98, v116
v_mfma_f32_16x16x32_bf16 v[36:39], a[204:207], a[44:47], v[36:39]
s_waitcnt lgkmcnt(4)
ds_read_b64_tr_b16 a[184:185], v5 offset:49152
v_accvgpr_write_b32 a99, v118
v_mfma_f32_16x16x32_bf16 v[40:43], a[204:207], a[60:63], v[40:43]
v_exp_f32 v20, v20
v_mfma_f32_16x16x32_bf16 v[16:19], a[208:211], a[0:3], 0
ds_read_b64_tr_b16 a[186:187], v5 offset:53248
v_exp_f32 v21, v21
v_mfma_f32_16x16x32_bf16 v[28:31], a[208:211], a[16:19], 0
v_exp_f32 v22, v22
v_mfma_f32_16x16x32_bf16 v[32:35], a[208:211], a[32:35], 0
ds_read_b64_tr_b16 a[188:189], v5 offset:50176
v_exp_f32 v23, v23
v_mfma_f32_16x16x32_bf16 v[44:47], a[208:211], a[48:51], 0
v_exp_f32 v24, v24
v_mfma_f32_16x16x32_bf16 v[16:19], a[212:215], a[4:7], v[16:19]
ds_read_b64_tr_b16 a[190:191], v5 offset:54272
v_exp_f32 v25, v25
v_mfma_f32_16x16x32_bf16 v[28:31], a[212:215], a[20:23], v[28:31]
v_exp_f32 v26, v26
v_mfma_f32_16x16x32_bf16 v[32:35], a[212:215], a[36:39], v[32:35]
ds_read_b128 a[192:195], v1 offset:57344
v_exp_f32 v27, v27
v_mfma_f32_16x16x32_bf16 v[44:47], a[212:215], a[52:55], v[44:47]
v_exp_f32 v36, v36
v_mfma_f32_16x16x32_bf16 v[16:19], a[216:219], a[8:11], v[16:19]
buffer_load_dwordx4 v11, s[8:11], s21 offen offset:2048 nt lds
v_mfma_f32_16x16x32_bf16 v[28:31], a[216:219], a[24:27], v[28:31]
ds_read_b128 a[196:199], v2 offset:57344
v_exp_f32 v37, v37
v_mfma_f32_16x16x32_bf16 v[32:35], a[216:219], a[40:43], v[32:35]
v_exp_f32 v38, v38
v_mfma_f32_16x16x32_bf16 v[44:47], a[216:219], a[56:59], v[44:47]
ds_read_b128 a[200:203], v1 offset:58368
v_exp_f32 v39, v39
v_mfma_f32_16x16x32_bf16 v[16:19], a[220:223], a[12:15], v[16:19]
v_cvt_pk_bf16_f32 v20, v20, v21
v_cvt_pk_bf16_f32 v21, v22, v23
v_mfma_f32_16x16x32_bf16 v[28:31], a[220:223], a[28:31], v[28:31]
ds_read_b128 a[204:207], v2 offset:58368
v_exp_f32 v40, v40
v_mfma_f32_16x16x32_bf16 v[32:35], a[220:223], a[44:47], v[32:35]
v_exp_f32 v41, v41
v_mfma_f32_16x16x32_bf16 v[44:47], a[220:223], a[60:63], v[44:47]
ds_read_b128 a[208:211], v1 offset:61440
v_exp_f32 v42, v42
v_mfma_f32_16x16x32_bf16 v[80:83], a[232:235], a[64:67], 0
v_exp_f32 v43, v43
v_mfma_f32_16x16x32_bf16 v[84:87], a[232:235], a[80:83], 0
ds_read_b128 a[232:235], v10 offset:6144
v_exp_f32 v16, v16
v_mfma_f32_16x16x32_bf16 v[80:83], a[236:239], a[68:71], v[80:83]
v_cvt_pk_bf16_f32 v24, v24, v25
v_cvt_pk_bf16_f32 v25, v26, v27
v_mfma_f32_16x16x32_bf16 v[84:87], a[236:239], a[84:87], v[84:87]
ds_read_b128 a[236:239], v10 offset:7168
v_exp_f32 v17, v17
v_mfma_f32_16x16x32_bf16 v[80:83], a[224:227], a[72:75], v[80:83]
v_exp_f32 v18, v18
v_mfma_f32_16x16x32_bf16 v[84:87], a[224:227], a[88:91], v[84:87]
s_waitcnt lgkmcnt(4)
ds_read_b128 a[212:215], v2 offset:61440
v_exp_f32 v19, v19
v_mfma_f32_16x16x32_bf16 v[80:83], a[228:231], a[76:79], v[80:83]
v_cvt_pk_bf16_f32 v22, v16, v17
v_cvt_pk_bf16_f32 v23, v18, v19
v_mfma_f32_16x16x32_bf16 v[84:87], a[228:231], a[92:95], v[84:87]
ds_read_b128 a[216:219], v1 offset:62464
v_exp_f32 v28, v28
v_mfma_f32_16x16x32_bf16 v[132:135], a[160:163], v[52:55], v[132:135]
v_exp_f32 v29, v29
v_mfma_f32_16x16x32_bf16 v[164:167], a[160:163], v[56:59], v[164:167]
ds_read_b128 a[220:223], v2 offset:62464
v_exp_f32 v80, v80
v_mfma_f32_16x16x32_bf16 v[196:199], a[160:163], v[68:71], v[196:199]
s_add_u32 m0, s30, 0x16000
s_add_u32 s37, s37, 0x2000
v_exp_f32 v81, v81
v_mfma_f32_16x16x32_bf16 v[228:231], a[160:163], v[72:75], v[228:231]
buffer_load_dwordx4 v11, s[12:15], s37 offen nt lds
v_mfma_f32_16x16x32_bf16 v[148:151], a[164:167], v[52:55], v[148:151]
ds_read_b64_tr_b16 a[160:161], v6 offset:57344
v_exp_f32 v82, v82
v_mfma_f32_16x16x32_bf16 v[180:183], a[164:167], v[56:59], v[180:183]
v_cvt_pk_bf16_f32 v80, v80, v81
v_cvt_pk_bf16_f32 v36, v36, v37
v_mfma_f32_16x16x32_bf16 v[212:215], a[164:167], v[68:71], v[212:215]
ds_read_b64_tr_b16 a[162:163], v6 offset:61440
v_exp_f32 v83, v83
v_mfma_f32_16x16x32_bf16 v[244:247], a[164:167], v[72:75], v[244:247]
v_exp_f32 v84, v84
v_smfmac_f32_16x16x64_bf16 a[244:247], a[240:243], v[52:59], v110
ds_read_b64_tr_b16 a[164:165], v6 offset:58368
v_cvt_pk_bf16_f32 v81, v82, v83
v_mfma_f32_16x16x32_bf16 v[136:139], a[168:171], v[52:55], v[136:139]
ds_write_b64 v9, v[80:81] offset:0
v_exp_f32 v85, v85
v_mfma_f32_16x16x32_bf16 v[168:171], a[168:171], v[56:59], v[168:171]
ds_read_b64_tr_b16 a[166:167], v6 offset:62464
v_exp_f32 v86, v86
v_mfma_f32_16x16x32_bf16 v[200:203], a[168:171], v[68:71], v[200:203]
v_exp_f32 v87, v87
v_mfma_f32_16x16x32_bf16 v[232:235], a[168:171], v[72:75], v[232:235]
ds_read_b64_tr_b16 a[168:169], v7 offset:57344
v_cvt_pk_bf16_f32 v84, v84, v85
v_mfma_f32_16x16x32_bf16 v[152:155], a[172:175], v[52:55], v[152:155]
v_exp_f32 v30, v30
v_mfma_f32_16x16x32_bf16 v[184:187], a[172:175], v[56:59], v[184:187]
ds_read_b64_tr_b16 a[170:171], v7 offset:61440
v_cvt_pk_bf16_f32 v85, v86, v87
v_mfma_f32_16x16x32_bf16 v[216:219], a[172:175], v[68:71], v[216:219]
ds_write_b64 v9, v[84:85] offset:1024
v_exp_f32 v31, v31
v_mfma_f32_16x16x32_bf16 v[248:251], a[172:175], v[72:75], v[248:251]
s_waitcnt lgkmcnt(6)
ds_read_b64_tr_b16 a[172:173], v7 offset:58368
v_exp_f32 v32, v32
v_smfmac_f32_16x16x64_bf16 a[248:251], a[240:243], v[68:75], v110
ds_read_b64_tr_b16 a[174:175], v7 offset:62464
v_cvt_pk_bf16_f32 v37, v38, v39
v_mfma_f32_16x16x32_bf16 v[140:143], a[176:179], v[52:55], v[140:143]
v_exp_f32 v33, v33
v_mfma_f32_16x16x32_bf16 v[172:175], a[176:179], v[56:59], v[172:175]
v_exp_f32 v34, v34
v_mfma_f32_16x16x32_bf16 v[204:207], a[176:179], v[68:71], v[204:207]
v_exp_f32 v35, v35
v_mfma_f32_16x16x32_bf16 v[236:239], a[176:179], v[72:75], v[236:239]
ds_read_b64_tr_b16 a[176:177], v8 offset:57344
v_cvt_pk_bf16_f32 v26, v28, v29
v_mfma_f32_16x16x32_bf16 v[156:159], a[180:183], v[52:55], v[156:159]
buffer_load_dwordx4 v11, s[12:15], s37 offen offset:2048 nt lds
v_mfma_f32_16x16x32_bf16 v[188:191], a[180:183], v[56:59], v[188:191]
ds_read_b64_tr_b16 a[178:179], v8 offset:61440
v_cvt_pk_bf16_f32 v27, v30, v31
v_mfma_f32_16x16x32_bf16 v[220:223], a[180:183], v[68:71], v[220:223]
v_exp_f32 v44, v44
v_mfma_f32_16x16x32_bf16 v[252:255], a[180:183], v[72:75], v[252:255]
ds_read_b64_tr_b16 a[180:181], v8 offset:58368
v_exp_f32 v45, v45
v_mfma_f32_16x16x32_bf16 v[128:131], a[184:187], v[52:55], v[128:131]
v_exp_f32 v46, v46
v_mfma_f32_16x16x32_bf16 v[160:163], a[184:187], v[56:59], v[160:163]
ds_read_b64_tr_b16 a[182:183], v8 offset:62464
v_exp_f32 v47, v47
v_mfma_f32_16x16x32_bf16 v[192:195], a[184:187], v[68:71], v[192:195]
v_cvt_pk_bf16_f32 v40, v40, v41
v_cvt_pk_bf16_f32 v41, v42, v43
v_mfma_f32_16x16x32_bf16 v[224:227], a[184:187], v[72:75], v[224:227]
v_cvt_pk_bf16_f32 v38, v32, v33
v_cvt_pk_bf16_f32 v39, v34, v35
v_mfma_f32_16x16x32_bf16 v[88:91], a[184:187], a[232:235], v[88:91]
v_cvt_pk_bf16_f32 v42, v44, v45
v_cvt_pk_bf16_f32 v43, v46, v47
v_mfma_f32_16x16x32_bf16 v[96:99], a[184:187], a[236:239], v[96:99]
ds_read_b64_tr_b16 a[184:185], v5 offset:57344
v_accvgpr_read_b32 v113, a100
v_smfmac_f32_16x16x64_bf16 a[252:255], a[240:243], a[232:239], v110
ds_read_b64_tr_b16 a[186:187], v5 offset:61440
v_accvgpr_read_b32 v115, a101
v_mfma_f32_16x16x32_bf16 v[144:147], a[188:191], v[52:55], v[144:147]
v_accvgpr_read_b32 v117, a102
v_accvgpr_read_b32 v119, a103
v_mfma_f32_16x16x32_bf16 v[176:179], a[188:191], v[56:59], v[176:179]
v_lshlrev_b32 v112, 16, v113
v_lshlrev_b32 v114, 16, v115
v_mfma_f32_16x16x32_bf16 v[208:211], a[188:191], v[68:71], v[208:211]
v_lshlrev_b32 v116, 16, v117
v_lshlrev_b32 v118, 16, v119
v_mfma_f32_16x16x32_bf16 v[240:243], a[188:191], v[72:75], v[240:243]
v_and_b32 v113, s25, v113
v_and_b32 v115, s25, v115
v_mfma_f32_16x16x32_bf16 v[92:95], a[188:191], a[232:235], v[92:95]
v_and_b32 v117, s25, v117
v_and_b32 v119, s25, v119
v_mfma_f32_16x16x32_bf16 v[100:103], a[188:191], a[236:239], v[100:103]
ds_read_b64_tr_b16 a[188:189], v5 offset:58368
v_mul_f32 v112, s26, v112
v_mfma_f32_16x16x32_bf16 v[52:55], a[192:195], a[0:3], 0
v_mul_f32 v113, s26, v113
v_mul_f32 v114, s26, v114
v_mfma_f32_16x16x32_bf16 v[56:59], a[192:195], a[16:19], 0
s_add_u32 m0, s30, 0x6000
s_add_u32 s21, s21, 0x2000
s_waitcnt lgkmcnt(3)
ds_read_b64_tr_b16 a[190:191], v5 offset:62464
v_mul_f32 v115, s26, v115
v_mfma_f32_16x16x32_bf16 v[68:71], a[192:195], a[32:35], 0
buffer_load_dwordx4 v11, s[8:11], s21 offen nt lds
v_mfma_f32_16x16x32_bf16 v[72:75], a[192:195], a[48:51], 0
v_mul_f32 v116, s26, v116
v_mul_f32 v117, s26, v117
v_mfma_f32_16x16x32_bf16 v[52:55], a[196:199], a[4:7], v[52:55]
v_mul_f32 v118, s26, v118
v_mul_f32 v119, s26, v119
v_mfma_f32_16x16x32_bf16 v[56:59], a[196:199], a[20:23], v[56:59]
v_cvt_pk_bf16_f32 v112, v112, v113
v_cvt_pk_bf16_f32 v114, v114, v115
v_mfma_f32_16x16x32_bf16 v[68:71], a[196:199], a[36:39], v[68:71]
v_cvt_pk_bf16_f32 v116, v116, v117
v_cvt_pk_bf16_f32 v118, v118, v119
v_mfma_f32_16x16x32_bf16 v[72:75], a[196:199], a[52:55], v[72:75]
v_accvgpr_write_b32 a100, v112
v_accvgpr_write_b32 a101, v114
v_mfma_f32_16x16x32_bf16 v[52:55], a[200:203], a[8:11], v[52:55]
v_accvgpr_write_b32 a102, v116
v_accvgpr_write_b32 a103, v118
v_mfma_f32_16x16x32_bf16 v[56:59], a[200:203], a[24:27], v[56:59]
v_mfma_f32_16x16x32_bf16 v[68:71], a[200:203], a[40:43], v[68:71]
v_mfma_f32_16x16x32_bf16 v[72:75], a[200:203], a[56:59], v[72:75]
v_mfma_f32_16x16x32_bf16 v[52:55], a[204:207], a[12:15], v[52:55]
v_mfma_f32_16x16x32_bf16 v[56:59], a[204:207], a[28:31], v[56:59]
v_mfma_f32_16x16x32_bf16 v[68:71], a[204:207], a[44:47], v[68:71]
v_mfma_f32_16x16x32_bf16 v[72:75], a[204:207], a[60:63], v[72:75]
v_mfma_f32_16x16x32_bf16 v[48:51], a[208:211], a[0:3], 0
v_mfma_f32_16x16x32_bf16 v[60:63], a[208:211], a[16:19], 0
v_mfma_f32_16x16x32_bf16 v[64:67], a[208:211], a[32:35], 0
v_mfma_f32_16x16x32_bf16 v[76:79], a[208:211], a[48:51], 0
v_mfma_f32_16x16x32_bf16 v[48:51], a[212:215], a[4:7], v[48:51]
buffer_load_dwordx4 v11, s[8:11], s21 offen offset:2048 nt lds
v_mfma_f32_16x16x32_bf16 v[60:63], a[212:215], a[20:23], v[60:63]
v_exp_f32 v52, v52
v_mfma_f32_16x16x32_bf16 v[64:67], a[212:215], a[36:39], v[64:67]
v_exp_f32 v53, v53
v_mfma_f32_16x16x32_bf16 v[76:79], a[212:215], a[52:55], v[76:79]
v_exp_f32 v54, v54
v_mfma_f32_16x16x32_bf16 v[48:51], a[216:219], a[8:11], v[48:51]
v_exp_f32 v55, v55
v_mfma_f32_16x16x32_bf16 v[60:63], a[216:219], a[24:27], v[60:63]
v_exp_f32 v56, v56
v_mfma_f32_16x16x32_bf16 v[64:67], a[216:219], a[40:43], v[64:67]
v_exp_f32 v57, v57
v_mfma_f32_16x16x32_bf16 v[76:79], a[216:219], a[56:59], v[76:79]
v_exp_f32 v58, v58
v_mfma_f32_16x16x32_bf16 v[48:51], a[220:223], a[12:15], v[48:51]
v_exp_f32 v59, v59
v_mfma_f32_16x16x32_bf16 v[60:63], a[220:223], a[28:31], v[60:63]
v_exp_f32 v68, v68
v_mfma_f32_16x16x32_bf16 v[64:67], a[220:223], a[44:47], v[64:67]
v_exp_f32 v69, v69
v_mfma_f32_16x16x32_bf16 v[76:79], a[220:223], a[60:63], v[76:79]
s_waitcnt vmcnt(10) lgkmcnt(0)
s_barrier
ds_read_b128 a[224:227], v10 offset:0
v_cvt_pk_bf16_f32 v52, v52, v53
v_mfma_f32_16x16x32_bf16 v[132:135], a[160:163], v[20:23], v[132:135]
v_exp_f32 v70, v70
v_mfma_f32_16x16x32_bf16 v[164:167], a[160:163], v[24:27], v[164:167]
ds_read_b128 a[228:231], v10 offset:1024
v_exp_f32 v71, v71
v_mfma_f32_16x16x32_bf16 v[196:199], a[160:163], v[36:39], v[196:199]
v_exp_f32 v72, v72
v_mfma_f32_16x16x32_bf16 v[228:231], a[160:163], v[40:43], v[228:231]
ds_read_b128 a[192:195], v1 offset:0
v_exp_f32 v73, v73
v_mfma_f32_16x16x32_bf16 v[148:151], a[164:167], v[20:23], v[148:151]
v_cvt_pk_bf16_f32 v53, v54, v55
v_cvt_pk_bf16_f32 v56, v56, v57
v_mfma_f32_16x16x32_bf16 v[180:183], a[164:167], v[24:27], v[180:183]
s_add_u32 m0, s30, 0x18000
s_add_u32 s37, s37, 0x2000
ds_read_b128 a[196:199], v2 offset:0
v_cvt_pk_bf16_f32 v57, v58, v59
v_mfma_f32_16x16x32_bf16 v[212:215], a[164:167], v[36:39], v[212:215]
buffer_load_dwordx4 v11, s[12:15], s37 offen nt lds
v_mfma_f32_16x16x32_bf16 v[244:247], a[164:167], v[40:43], v[244:247]
ds_read_b128 a[200:203], v1 offset:1024
v_exp_f32 v74, v74
v_smfmac_f32_16x16x64_bf16 a[244:247], a[240:243], v[20:27], v110
ds_read_b128 a[204:207], v2 offset:1024
v_cvt_pk_bf16_f32 v68, v68, v69
v_mfma_f32_16x16x32_bf16 v[136:139], a[168:171], v[20:23], v[136:139]
v_exp_f32 v75, v75
v_mfma_f32_16x16x32_bf16 v[168:171], a[168:171], v[24:27], v[168:171]
ds_read_b128 a[208:211], v1 offset:4096
v_exp_f32 v48, v48
v_mfma_f32_16x16x32_bf16 v[200:203], a[168:171], v[36:39], v[200:203]
v_exp_f32 v49, v49
v_mfma_f32_16x16x32_bf16 v[232:235], a[168:171], v[40:43], v[232:235]
ds_read_b128 a[212:215], v2 offset:4096
v_exp_f32 v50, v50
v_mfma_f32_16x16x32_bf16 v[152:155], a[172:175], v[20:23], v[152:155]
v_exp_f32 v51, v51
v_mfma_f32_16x16x32_bf16 v[184:187], a[172:175], v[24:27], v[184:187]
buffer_load_dwordx4 a[120:123], v12, s[4:7], s75 offen offset:128 nt
v_mfma_f32_16x16x32_bf16 v[216:219], a[172:175], v[36:39], v[216:219]
buffer_load_dwordx4 a[124:127], v12, s[4:7], s75 offen offset:192 nt
v_mfma_f32_16x16x32_bf16 v[248:251], a[172:175], v[40:43], v[248:251]
ds_read_b128 a[216:219], v1 offset:5120
v_exp_f32 v60, v60
v_smfmac_f32_16x16x64_bf16 a[248:251], a[240:243], v[36:43], v110
ds_read_b128 a[220:223], v2 offset:5120
v_cvt_pk_bf16_f32 v54, v48, v49
v_mfma_f32_16x16x32_bf16 v[140:143], a[176:179], v[20:23], v[140:143]
v_exp_f32 v61, v61
v_mfma_f32_16x16x32_bf16 v[172:175], a[176:179], v[24:27], v[172:175]
ds_read_b128 a[232:235], v3 offset:0
v_exp_f32 v62, v62
v_mfma_f32_16x16x32_bf16 v[204:207], a[176:179], v[36:39], v[204:207]
v_exp_f32 v63, v63
v_mfma_f32_16x16x32_bf16 v[236:239], a[176:179], v[40:43], v[236:239]
ds_read_b128 a[236:239], v4 offset:0
v_cvt_pk_bf16_f32 v55, v50, v51
v_mfma_f32_16x16x32_bf16 v[156:159], a[180:183], v[20:23], v[156:159]
v_exp_f32 v64, v64
v_mfma_f32_16x16x32_bf16 v[188:191], a[180:183], v[24:27], v[188:191]
ds_read_b64_tr_b16 a[160:161], v6 offset:0
v_exp_f32 v65, v65
v_mfma_f32_16x16x32_bf16 v[220:223], a[180:183], v[36:39], v[220:223]
v_cvt_pk_bf16_f32 v69, v70, v71
v_cvt_pk_bf16_f32 v58, v60, v61
v_mfma_f32_16x16x32_bf16 v[252:255], a[180:183], v[40:43], v[252:255]
buffer_load_dwordx4 v11, s[12:15], s37 offen offset:2048 nt lds
v_mfma_f32_16x16x32_bf16 v[128:131], a[184:187], v[20:23], v[128:131]
ds_read_b64_tr_b16 a[162:163], v6 offset:4096
v_exp_f32 v66, v66
v_mfma_f32_16x16x32_bf16 v[160:163], a[184:187], v[24:27], v[160:163]
v_exp_f32 v67, v67
v_mfma_f32_16x16x32_bf16 v[192:195], a[184:187], v[36:39], v[192:195]
ds_read_b64_tr_b16 a[164:165], v6 offset:1024
v_cvt_pk_bf16_f32 v59, v62, v63
v_mfma_f32_16x16x32_bf16 v[224:227], a[184:187], v[40:43], v[224:227]
v_exp_f32 v76, v76
s_waitcnt lgkmcnt(4)
v_mfma_f32_16x16x32_bf16 v[88:91], a[184:187], a[224:227], v[88:91]
ds_read_b64_tr_b16 a[166:167], v6 offset:5120
v_exp_f32 v77, v77
v_mfma_f32_16x16x32_bf16 v[96:99], a[184:187], a[228:231], v[96:99]
v_exp_f32 v78, v78
v_smfmac_f32_16x16x64_bf16 a[252:255], a[240:243], a[224:231], v110
ds_read_b64_tr_b16 a[168:169], v7 offset:0
v_cvt_pk_bf16_f32 v72, v72, v73
v_mfma_f32_16x16x32_bf16 v[144:147], a[188:191], v[20:23], v[144:147]
v_exp_f32 v79, v79
v_mfma_f32_16x16x32_bf16 v[176:179], a[188:191], v[24:27], v[176:179]
ds_read_b64_tr_b16 a[170:171], v7 offset:4096
v_cvt_pk_bf16_f32 v73, v74, v75
v_mfma_f32_16x16x32_bf16 v[208:211], a[188:191], v[36:39], v[208:211]
v_cvt_pk_bf16_f32 v70, v64, v65
v_cvt_pk_bf16_f32 v71, v66, v67
v_mfma_f32_16x16x32_bf16 v[240:243], a[188:191], v[40:43], v[240:243]
ds_read_b64_tr_b16 a[172:173], v7 offset:1024
v_cvt_pk_bf16_f32 v74, v76, v77
v_mfma_f32_16x16x32_bf16 v[92:95], a[188:191], a[224:227], v[92:95]
v_cvt_pk_bf16_f32 v75, v78, v79
v_accvgpr_read_b32 v113, a104
v_mfma_f32_16x16x32_bf16 v[100:103], a[188:191], a[228:231], v[100:103]
ds_read_b128 a[224:227], v3 offset:1024
v_accvgpr_read_b32 v115, a105
v_mfma_f32_16x16x32_bf16 v[20:23], a[192:195], a[0:3], 0
v_accvgpr_read_b32 v117, a106
v_accvgpr_read_b32 v119, a107
v_mfma_f32_16x16x32_bf16 v[24:27], a[192:195], a[16:19], 0
ds_read_b128 a[228:231], v4 offset:1024
v_lshlrev_b32 v112, 16, v113
v_mfma_f32_16x16x32_bf16 v[36:39], a[192:195], a[32:35], 0
v_lshlrev_b32 v114, 16, v115
v_lshlrev_b32 v116, 16, v117
v_mfma_f32_16x16x32_bf16 v[40:43], a[192:195], a[48:51], 0
ds_read_b64_tr_b16 a[174:175], v7 offset:5120
v_lshlrev_b32 v118, 16, v119
v_mfma_f32_16x16x32_bf16 v[20:23], a[196:199], a[4:7], v[20:23]
s_add_u32 m0, s30, 0x8000
s_add_u32 s21, s21, 0x2000
v_and_b32 v113, s25, v113
v_and_b32 v115, s25, v115
v_mfma_f32_16x16x32_bf16 v[24:27], a[196:199], a[20:23], v[24:27]
buffer_load_dwordx4 v11, s[8:11], s21 offen nt lds
v_mfma_f32_16x16x32_bf16 v[36:39], a[196:199], a[36:39], v[36:39]
ds_read_b64_tr_b16 a[176:177], v8 offset:0
v_and_b32 v117, s25, v117
v_mfma_f32_16x16x32_bf16 v[40:43], a[196:199], a[52:55], v[40:43]
v_and_b32 v119, s25, v119
v_mul_f32 v112, s26, v112
v_mfma_f32_16x16x32_bf16 v[20:23], a[200:203], a[8:11], v[20:23]
ds_read_b64_tr_b16 a[178:179], v8 offset:4096
v_mul_f32 v113, s26, v113
v_mfma_f32_16x16x32_bf16 v[24:27], a[200:203], a[24:27], v[24:27]
v_mul_f32 v114, s26, v114
v_mul_f32 v115, s26, v115
v_mfma_f32_16x16x32_bf16 v[36:39], a[200:203], a[40:43], v[36:39]
ds_read_b64_tr_b16 a[180:181], v8 offset:1024
v_mul_f32 v116, s26, v116
v_mfma_f32_16x16x32_bf16 v[40:43], a[200:203], a[56:59], v[40:43]
v_mul_f32 v117, s26, v117
v_mul_f32 v118, s26, v118
v_mfma_f32_16x16x32_bf16 v[20:23], a[204:207], a[12:15], v[20:23]
ds_read_b64_tr_b16 a[182:183], v8 offset:5120
v_mul_f32 v119, s26, v119
v_mfma_f32_16x16x32_bf16 v[24:27], a[204:207], a[28:31], v[24:27]
v_cvt_pk_bf16_f32 v112, v112, v113
v_cvt_pk_bf16_f32 v114, v114, v115
v_mfma_f32_16x16x32_bf16 v[36:39], a[204:207], a[44:47], v[36:39]
s_waitcnt lgkmcnt(4)
ds_read_b64_tr_b16 a[184:185], v5 offset:0
v_cvt_pk_bf16_f32 v116, v116, v117
v_mfma_f32_16x16x32_bf16 v[40:43], a[204:207], a[60:63], v[40:43]
v_exp_f32 v20, v20
v_mfma_f32_16x16x32_bf16 v[16:19], a[208:211], a[0:3], 0
ds_read_b64_tr_b16 a[186:187], v5 offset:4096
v_exp_f32 v21, v21
v_mfma_f32_16x16x32_bf16 v[28:31], a[208:211], a[16:19], 0
v_exp_f32 v22, v22
v_mfma_f32_16x16x32_bf16 v[32:35], a[208:211], a[32:35], 0
ds_read_b64_tr_b16 a[188:189], v5 offset:1024
v_exp_f32 v23, v23
v_mfma_f32_16x16x32_bf16 v[44:47], a[208:211], a[48:51], 0
v_exp_f32 v24, v24
v_mfma_f32_16x16x32_bf16 v[16:19], a[212:215], a[4:7], v[16:19]
ds_read_b64_tr_b16 a[190:191], v5 offset:5120
v_exp_f32 v25, v25
v_mfma_f32_16x16x32_bf16 v[28:31], a[212:215], a[20:23], v[28:31]
v_exp_f32 v26, v26
v_mfma_f32_16x16x32_bf16 v[32:35], a[212:215], a[36:39], v[32:35]
ds_read_b128 a[192:195], v1 offset:8192
v_exp_f32 v27, v27
v_mfma_f32_16x16x32_bf16 v[44:47], a[212:215], a[52:55], v[44:47]
v_exp_f32 v36, v36
v_mfma_f32_16x16x32_bf16 v[16:19], a[216:219], a[8:11], v[16:19]
buffer_load_dwordx4 v11, s[8:11], s21 offen offset:2048 nt lds
v_mfma_f32_16x16x32_bf16 v[28:31], a[216:219], a[24:27], v[28:31]
ds_read_b128 a[196:199], v2 offset:8192
v_exp_f32 v37, v37
v_mfma_f32_16x16x32_bf16 v[32:35], a[216:219], a[40:43], v[32:35]
v_exp_f32 v38, v38
v_mfma_f32_16x16x32_bf16 v[44:47], a[216:219], a[56:59], v[44:47]
ds_read_b128 a[200:203], v1 offset:9216
v_exp_f32 v39, v39
v_mfma_f32_16x16x32_bf16 v[16:19], a[220:223], a[12:15], v[16:19]
v_cvt_pk_bf16_f32 v20, v20, v21
v_cvt_pk_bf16_f32 v21, v22, v23
v_mfma_f32_16x16x32_bf16 v[28:31], a[220:223], a[28:31], v[28:31]
ds_read_b128 a[204:207], v2 offset:9216
v_exp_f32 v40, v40
v_mfma_f32_16x16x32_bf16 v[32:35], a[220:223], a[44:47], v[32:35]
v_exp_f32 v41, v41
v_mfma_f32_16x16x32_bf16 v[44:47], a[220:223], a[60:63], v[44:47]
ds_read_b128 a[208:211], v1 offset:12288
v_exp_f32 v42, v42
v_mfma_f32_16x16x32_bf16 v[80:83], a[232:235], a[64:67], 0
v_exp_f32 v43, v43
v_mfma_f32_16x16x32_bf16 v[84:87], a[232:235], a[80:83], 0
ds_read_b128 a[232:235], v10 offset:2048
v_exp_f32 v16, v16
v_mfma_f32_16x16x32_bf16 v[80:83], a[236:239], a[68:71], v[80:83]
v_cvt_pk_bf16_f32 v24, v24, v25
v_cvt_pk_bf16_f32 v25, v26, v27
v_mfma_f32_16x16x32_bf16 v[84:87], a[236:239], a[84:87], v[84:87]
ds_read_b128 a[236:239], v10 offset:3072
v_exp_f32 v17, v17
v_mfma_f32_16x16x32_bf16 v[80:83], a[224:227], a[72:75], v[80:83]
v_exp_f32 v18, v18
v_mfma_f32_16x16x32_bf16 v[84:87], a[224:227], a[88:91], v[84:87]
s_waitcnt lgkmcnt(4)
ds_read_b128 a[212:215], v2 offset:12288
v_exp_f32 v19, v19
v_mfma_f32_16x16x32_bf16 v[80:83], a[228:231], a[76:79], v[80:83]
v_cvt_pk_bf16_f32 v22, v16, v17
v_cvt_pk_bf16_f32 v23, v18, v19
v_mfma_f32_16x16x32_bf16 v[84:87], a[228:231], a[92:95], v[84:87]
ds_read_b128 a[216:219], v1 offset:13312
v_exp_f32 v28, v28
v_mfma_f32_16x16x32_bf16 v[132:135], a[160:163], v[52:55], v[132:135]
v_exp_f32 v29, v29
v_mfma_f32_16x16x32_bf16 v[164:167], a[160:163], v[56:59], v[164:167]
ds_read_b128 a[220:223], v2 offset:13312
v_exp_f32 v80, v80
v_mfma_f32_16x16x32_bf16 v[196:199], a[160:163], v[68:71], v[196:199]
s_add_u32 m0, s30, 0x1a000
s_add_u32 s37, s37, 0x2000
v_exp_f32 v81, v81
v_mfma_f32_16x16x32_bf16 v[228:231], a[160:163], v[72:75], v[228:231]
buffer_load_dwordx4 v11, s[12:15], s37 offen nt lds
v_mfma_f32_16x16x32_bf16 v[148:151], a[164:167], v[52:55], v[148:151]
ds_read_b64_tr_b16 a[160:161], v6 offset:8192
v_exp_f32 v82, v82
v_mfma_f32_16x16x32_bf16 v[180:183], a[164:167], v[56:59], v[180:183]
v_cvt_pk_bf16_f32 v80, v80, v81
v_cvt_pk_bf16_f32 v36, v36, v37
v_mfma_f32_16x16x32_bf16 v[212:215], a[164:167], v[68:71], v[212:215]
ds_read_b64_tr_b16 a[162:163], v6 offset:12288
v_exp_f32 v83, v83
v_mfma_f32_16x16x32_bf16 v[244:247], a[164:167], v[72:75], v[244:247]
v_exp_f32 v84, v84
v_smfmac_f32_16x16x64_bf16 a[244:247], a[240:243], v[52:59], v110
ds_read_b64_tr_b16 a[164:165], v6 offset:9216
v_cvt_pk_bf16_f32 v81, v82, v83
v_mfma_f32_16x16x32_bf16 v[136:139], a[168:171], v[52:55], v[136:139]
ds_write_b64 v9, v[80:81] offset:4096
v_exp_f32 v85, v85
v_mfma_f32_16x16x32_bf16 v[168:171], a[168:171], v[56:59], v[168:171]
ds_read_b64_tr_b16 a[166:167], v6 offset:13312
v_exp_f32 v86, v86
v_mfma_f32_16x16x32_bf16 v[200:203], a[168:171], v[68:71], v[200:203]
v_exp_f32 v87, v87
v_mfma_f32_16x16x32_bf16 v[232:235], a[168:171], v[72:75], v[232:235]
ds_read_b64_tr_b16 a[168:169], v7 offset:8192
v_cvt_pk_bf16_f32 v84, v84, v85
v_mfma_f32_16x16x32_bf16 v[152:155], a[172:175], v[52:55], v[152:155]
v_exp_f32 v30, v30
v_mfma_f32_16x16x32_bf16 v[184:187], a[172:175], v[56:59], v[184:187]
ds_read_b64_tr_b16 a[170:171], v7 offset:12288
v_cvt_pk_bf16_f32 v85, v86, v87
v_mfma_f32_16x16x32_bf16 v[216:219], a[172:175], v[68:71], v[216:219]
ds_write_b64 v9, v[84:85] offset:5120
v_exp_f32 v31, v31
v_mfma_f32_16x16x32_bf16 v[248:251], a[172:175], v[72:75], v[248:251]
s_waitcnt lgkmcnt(6)
ds_read_b64_tr_b16 a[172:173], v7 offset:9216
v_exp_f32 v32, v32
v_smfmac_f32_16x16x64_bf16 a[248:251], a[240:243], v[68:75], v110
ds_read_b64_tr_b16 a[174:175], v7 offset:13312
v_cvt_pk_bf16_f32 v37, v38, v39
v_mfma_f32_16x16x32_bf16 v[140:143], a[176:179], v[52:55], v[140:143]
v_exp_f32 v33, v33
v_mfma_f32_16x16x32_bf16 v[172:175], a[176:179], v[56:59], v[172:175]
v_exp_f32 v34, v34
v_mfma_f32_16x16x32_bf16 v[204:207], a[176:179], v[68:71], v[204:207]
v_exp_f32 v35, v35
v_mfma_f32_16x16x32_bf16 v[236:239], a[176:179], v[72:75], v[236:239]
ds_read_b64_tr_b16 a[176:177], v8 offset:8192
v_cvt_pk_bf16_f32 v26, v28, v29
v_mfma_f32_16x16x32_bf16 v[156:159], a[180:183], v[52:55], v[156:159]
buffer_load_dwordx4 v11, s[12:15], s37 offen offset:2048 nt lds
v_mfma_f32_16x16x32_bf16 v[188:191], a[180:183], v[56:59], v[188:191]
ds_read_b64_tr_b16 a[178:179], v8 offset:12288
v_cvt_pk_bf16_f32 v27, v30, v31
v_mfma_f32_16x16x32_bf16 v[220:223], a[180:183], v[68:71], v[220:223]
v_exp_f32 v44, v44
v_mfma_f32_16x16x32_bf16 v[252:255], a[180:183], v[72:75], v[252:255]
ds_read_b64_tr_b16 a[180:181], v8 offset:9216
v_exp_f32 v45, v45
v_mfma_f32_16x16x32_bf16 v[128:131], a[184:187], v[52:55], v[128:131]
v_exp_f32 v46, v46
v_mfma_f32_16x16x32_bf16 v[160:163], a[184:187], v[56:59], v[160:163]
ds_read_b64_tr_b16 a[182:183], v8 offset:13312
v_exp_f32 v47, v47
v_mfma_f32_16x16x32_bf16 v[192:195], a[184:187], v[68:71], v[192:195]
v_cvt_pk_bf16_f32 v40, v40, v41
v_cvt_pk_bf16_f32 v41, v42, v43
v_mfma_f32_16x16x32_bf16 v[224:227], a[184:187], v[72:75], v[224:227]
v_cvt_pk_bf16_f32 v38, v32, v33
v_cvt_pk_bf16_f32 v39, v34, v35
v_mfma_f32_16x16x32_bf16 v[88:91], a[184:187], a[232:235], v[88:91]
v_cvt_pk_bf16_f32 v42, v44, v45
v_cvt_pk_bf16_f32 v43, v46, v47
v_mfma_f32_16x16x32_bf16 v[96:99], a[184:187], a[236:239], v[96:99]
ds_read_b64_tr_b16 a[184:185], v5 offset:8192
v_cvt_pk_bf16_f32 v118, v118, v119
v_smfmac_f32_16x16x64_bf16 a[252:255], a[240:243], a[232:239], v110
ds_read_b64_tr_b16 a[186:187], v5 offset:12288
v_accvgpr_write_b32 a104, v112
v_mfma_f32_16x16x32_bf16 v[144:147], a[188:191], v[52:55], v[144:147]
v_accvgpr_write_b32 a105, v114
v_accvgpr_write_b32 a106, v116
v_mfma_f32_16x16x32_bf16 v[176:179], a[188:191], v[56:59], v[176:179]
v_accvgpr_write_b32 a107, v118
v_accvgpr_read_b32 v113, a108
v_mfma_f32_16x16x32_bf16 v[208:211], a[188:191], v[68:71], v[208:211]
v_accvgpr_read_b32 v115, a109
v_accvgpr_read_b32 v117, a110
v_mfma_f32_16x16x32_bf16 v[240:243], a[188:191], v[72:75], v[240:243]
v_accvgpr_read_b32 v119, a111
v_lshlrev_b32 v112, 16, v113
v_mfma_f32_16x16x32_bf16 v[92:95], a[188:191], a[232:235], v[92:95]
v_lshlrev_b32 v114, 16, v115
v_lshlrev_b32 v116, 16, v117
v_mfma_f32_16x16x32_bf16 v[100:103], a[188:191], a[236:239], v[100:103]
ds_read_b64_tr_b16 a[188:189], v5 offset:9216
v_lshlrev_b32 v118, 16, v119
v_mfma_f32_16x16x32_bf16 v[52:55], a[192:195], a[0:3], 0
v_and_b32 v113, s25, v113
v_and_b32 v115, s25, v115
v_mfma_f32_16x16x32_bf16 v[56:59], a[192:195], a[16:19], 0
s_add_u32 m0, s30, 0xa000
s_add_u32 s21, s21, 0x2000
s_waitcnt lgkmcnt(3)
ds_read_b64_tr_b16 a[190:191], v5 offset:13312
v_and_b32 v117, s25, v117
v_mfma_f32_16x16x32_bf16 v[68:71], a[192:195], a[32:35], 0
buffer_load_dwordx4 v11, s[8:11], s21 offen nt lds
v_mfma_f32_16x16x32_bf16 v[72:75], a[192:195], a[48:51], 0
v_and_b32 v119, s25, v119
v_mul_f32 v112, s26, v112
v_mfma_f32_16x16x32_bf16 v[52:55], a[196:199], a[4:7], v[52:55]
v_mul_f32 v113, s26, v113
v_mul_f32 v114, s26, v114
v_mfma_f32_16x16x32_bf16 v[56:59], a[196:199], a[20:23], v[56:59]
v_mul_f32 v115, s26, v115
v_mul_f32 v116, s26, v116
v_mfma_f32_16x16x32_bf16 v[68:71], a[196:199], a[36:39], v[68:71]
v_mul_f32 v117, s26, v117
v_mul_f32 v118, s26, v118
v_mfma_f32_16x16x32_bf16 v[72:75], a[196:199], a[52:55], v[72:75]
v_mul_f32 v119, s26, v119
v_cvt_pk_bf16_f32 v112, v112, v113
v_mfma_f32_16x16x32_bf16 v[52:55], a[200:203], a[8:11], v[52:55]
v_cvt_pk_bf16_f32 v114, v114, v115
v_cvt_pk_bf16_f32 v116, v116, v117
v_mfma_f32_16x16x32_bf16 v[56:59], a[200:203], a[24:27], v[56:59]
v_cvt_pk_bf16_f32 v118, v118, v119
v_accvgpr_write_b32 a108, v112
v_mfma_f32_16x16x32_bf16 v[68:71], a[200:203], a[40:43], v[68:71]
v_accvgpr_write_b32 a109, v114
v_accvgpr_write_b32 a110, v116
v_mfma_f32_16x16x32_bf16 v[72:75], a[200:203], a[56:59], v[72:75]
v_accvgpr_write_b32 a111, v118
v_mfma_f32_16x16x32_bf16 v[52:55], a[204:207], a[12:15], v[52:55]
v_mfma_f32_16x16x32_bf16 v[56:59], a[204:207], a[28:31], v[56:59]
v_mfma_f32_16x16x32_bf16 v[68:71], a[204:207], a[44:47], v[68:71]
v_mfma_f32_16x16x32_bf16 v[72:75], a[204:207], a[60:63], v[72:75]
v_mfma_f32_16x16x32_bf16 v[48:51], a[208:211], a[0:3], 0
v_mfma_f32_16x16x32_bf16 v[60:63], a[208:211], a[16:19], 0
v_mfma_f32_16x16x32_bf16 v[64:67], a[208:211], a[32:35], 0
v_mfma_f32_16x16x32_bf16 v[76:79], a[208:211], a[48:51], 0
v_mfma_f32_16x16x32_bf16 v[48:51], a[212:215], a[4:7], v[48:51]
buffer_load_dwordx4 v11, s[8:11], s21 offen offset:2048 nt lds
v_mfma_f32_16x16x32_bf16 v[60:63], a[212:215], a[20:23], v[60:63]
v_exp_f32 v52, v52
v_mfma_f32_16x16x32_bf16 v[64:67], a[212:215], a[36:39], v[64:67]
v_exp_f32 v53, v53
v_mfma_f32_16x16x32_bf16 v[76:79], a[212:215], a[52:55], v[76:79]
v_exp_f32 v54, v54
v_mfma_f32_16x16x32_bf16 v[48:51], a[216:219], a[8:11], v[48:51]
v_exp_f32 v55, v55
v_mfma_f32_16x16x32_bf16 v[60:63], a[216:219], a[24:27], v[60:63]
v_exp_f32 v56, v56
v_mfma_f32_16x16x32_bf16 v[64:67], a[216:219], a[40:43], v[64:67]
v_exp_f32 v57, v57
v_mfma_f32_16x16x32_bf16 v[76:79], a[216:219], a[56:59], v[76:79]
v_exp_f32 v58, v58
v_mfma_f32_16x16x32_bf16 v[48:51], a[220:223], a[12:15], v[48:51]
v_exp_f32 v59, v59
v_mfma_f32_16x16x32_bf16 v[60:63], a[220:223], a[28:31], v[60:63]
v_exp_f32 v68, v68
v_mfma_f32_16x16x32_bf16 v[64:67], a[220:223], a[44:47], v[64:67]
v_exp_f32 v69, v69
v_mfma_f32_16x16x32_bf16 v[76:79], a[220:223], a[60:63], v[76:79]
s_waitcnt vmcnt(10) lgkmcnt(0)
s_barrier
ds_read_b128 a[224:227], v10 offset:4096
v_cvt_pk_bf16_f32 v52, v52, v53
v_mfma_f32_16x16x32_bf16 v[132:135], a[160:163], v[20:23], v[132:135]
v_exp_f32 v70, v70
v_mfma_f32_16x16x32_bf16 v[164:167], a[160:163], v[24:27], v[164:167]
ds_read_b128 a[228:231], v10 offset:5120
v_cvt_pk_bf16_f32 v53, v54, v55
v_mfma_f32_16x16x32_bf16 v[196:199], a[160:163], v[36:39], v[196:199]
v_exp_f32 v71, v71
v_mfma_f32_16x16x32_bf16 v[228:231], a[160:163], v[40:43], v[228:231]
ds_read_b128 a[192:195], v1 offset:16384
v_cvt_pk_bf16_f32 v56, v56, v57
v_mfma_f32_16x16x32_bf16 v[148:151], a[164:167], v[20:23], v[148:151]
v_exp_f32 v72, v72
v_mfma_f32_16x16x32_bf16 v[180:183], a[164:167], v[24:27], v[180:183]
s_add_u32 m0, s30, 0x1c000
s_add_u32 s37, s37, 0x2000
ds_read_b128 a[196:199], v2 offset:16384
v_cvt_pk_bf16_f32 v57, v58, v59
v_mfma_f32_16x16x32_bf16 v[212:215], a[164:167], v[36:39], v[212:215]
buffer_load_dwordx4 v11, s[12:15], s37 offen nt lds
v_mfma_f32_16x16x32_bf16 v[244:247], a[164:167], v[40:43], v[244:247]
ds_read_b128 a[200:203], v1 offset:17408
v_cvt_pk_bf16_f32 v68, v68, v69
v_smfmac_f32_16x16x64_bf16 a[244:247], a[240:243], v[20:27], v110
ds_read_b128 a[204:207], v2 offset:17408
v_cvt_pk_bf16_f32 v69, v70, v71
v_mfma_f32_16x16x32_bf16 v[136:139], a[168:171], v[20:23], v[136:139]
v_exp_f32 v73, v73
v_mfma_f32_16x16x32_bf16 v[168:171], a[168:171], v[24:27], v[168:171]
ds_read_b128 a[208:211], v1 offset:20480
v_cvt_pk_bf16_f32 v72, v72, v73
v_mfma_f32_16x16x32_bf16 v[200:203], a[168:171], v[36:39], v[200:203]
v_exp_f32 v74, v74
v_mfma_f32_16x16x32_bf16 v[232:235], a[168:171], v[40:43], v[232:235]
ds_read_b128 a[212:215], v2 offset:20480
v_accvgpr_read_b32 v113, a112
v_mfma_f32_16x16x32_bf16 v[152:155], a[172:175], v[20:23], v[152:155]
v_exp_f32 v75, v75
v_mfma_f32_16x16x32_bf16 v[184:187], a[172:175], v[24:27], v[184:187]
buffer_load_dwordx4 a[128:131], v12, s[4:7], s76 offen offset:0 nt
v_mfma_f32_16x16x32_bf16 v[216:219], a[172:175], v[36:39], v[216:219]
buffer_load_dwordx4 a[132:135], v12, s[4:7], s76 offen offset:64 nt
v_mfma_f32_16x16x32_bf16 v[248:251], a[172:175], v[40:43], v[248:251]
ds_read_b128 a[216:219], v1 offset:21504
v_cvt_pk_bf16_f32 v73, v74, v75
v_smfmac_f32_16x16x64_bf16 a[248:251], a[240:243], v[36:43], v110
ds_read_b128 a[220:223], v2 offset:21504
v_accvgpr_read_b32 v115, a113
v_mfma_f32_16x16x32_bf16 v[140:143], a[176:179], v[20:23], v[140:143]
v_exp_f32 v48, v48
v_mfma_f32_16x16x32_bf16 v[172:175], a[176:179], v[24:27], v[172:175]
ds_read_b128 a[232:235], v3 offset:16384
v_accvgpr_read_b32 v117, a114
v_mfma_f32_16x16x32_bf16 v[204:207], a[176:179], v[36:39], v[204:207]
v_exp_f32 v49, v49
v_mfma_f32_16x16x32_bf16 v[236:239], a[176:179], v[40:43], v[236:239]
ds_read_b128 a[236:239], v4 offset:16384
v_cvt_pk_bf16_f32 v54, v48, v49
v_mfma_f32_16x16x32_bf16 v[156:159], a[180:183], v[20:23], v[156:159]
v_exp_f32 v50, v50
v_mfma_f32_16x16x32_bf16 v[188:191], a[180:183], v[24:27], v[188:191]
ds_read_b64_tr_b16 a[160:161], v6 offset:16384
v_accvgpr_read_b32 v119, a115
v_mfma_f32_16x16x32_bf16 v[220:223], a[180:183], v[36:39], v[220:223]
v_exp_f32 v51, v51
v_mfma_f32_16x16x32_bf16 v[252:255], a[180:183], v[40:43], v[252:255]
buffer_load_dwordx4 v11, s[12:15], s37 offen offset:2048 nt lds
v_mfma_f32_16x16x32_bf16 v[128:131], a[184:187], v[20:23], v[128:131]
ds_read_b64_tr_b16 a[162:163], v6 offset:20480
v_cvt_pk_bf16_f32 v55, v50, v51
v_mfma_f32_16x16x32_bf16 v[160:163], a[184:187], v[24:27], v[160:163]
v_exp_f32 v60, v60
v_mfma_f32_16x16x32_bf16 v[192:195], a[184:187], v[36:39], v[192:195]
ds_read_b64_tr_b16 a[164:165], v6 offset:17408
v_lshlrev_b32 v112, 16, v113
v_mfma_f32_16x16x32_bf16 v[224:227], a[184:187], v[40:43], v[224:227]
v_exp_f32 v61, v61
s_waitcnt lgkmcnt(4)
v_mfma_f32_16x16x32_bf16 v[88:91], a[184:187], a[224:227], v[88:91]
ds_read_b64_tr_b16 a[166:167], v6 offset:21504
v_cvt_pk_bf16_f32 v58, v60, v61
v_mfma_f32_16x16x32_bf16 v[96:99], a[184:187], a[228:231], v[96:99]
v_exp_f32 v62, v62
v_smfmac_f32_16x16x64_bf16 a[252:255], a[240:243], a[224:231], v110
ds_read_b64_tr_b16 a[168:169], v7 offset:16384
v_lshlrev_b32 v114, 16, v115
v_mfma_f32_16x16x32_bf16 v[144:147], a[188:191], v[20:23], v[144:147]
v_exp_f32 v63, v63
v_mfma_f32_16x16x32_bf16 v[176:179], a[188:191], v[24:27], v[176:179]
ds_read_b64_tr_b16 a[170:171], v7 offset:20480
v_cvt_pk_bf16_f32 v59, v62, v63
v_mfma_f32_16x16x32_bf16 v[208:211], a[188:191], v[36:39], v[208:211]
v_exp_f32 v64, v64
v_mfma_f32_16x16x32_bf16 v[240:243], a[188:191], v[40:43], v[240:243]
ds_read_b64_tr_b16 a[172:173], v7 offset:17408
v_lshlrev_b32 v116, 16, v117
v_mfma_f32_16x16x32_bf16 v[92:95], a[188:191], a[224:227], v[92:95]
v_exp_f32 v65, v65
v_mfma_f32_16x16x32_bf16 v[100:103], a[188:191], a[228:231], v[100:103]
ds_read_b128 a[224:227], v3 offset:17408
v_cvt_pk_bf16_f32 v70, v64, v65
v_mfma_f32_16x16x32_bf16 v[20:23], a[192:195], a[0:3], 0
v_exp_f32 v66, v66
v_mfma_f32_16x16x32_bf16 v[24:27], a[192:195], a[16:19], 0
ds_read_b128 a[228:231], v4 offset:17408
v_lshlrev_b32 v118, 16, v119
v_mfma_f32_16x16x32_bf16 v[36:39], a[192:195], a[32:35], 0
v_exp_f32 v67, v67
v_mfma_f32_16x16x32_bf16 v[40:43], a[192:195], a[48:51], 0
ds_read_b64_tr_b16 a[174:175], v7 offset:21504
v_cvt_pk_bf16_f32 v71, v66, v67
v_mfma_f32_16x16x32_bf16 v[20:23], a[196:199], a[4:7], v[20:23]
s_add_u32 m0, s30, 0xc000
s_add_u32 s21, s21, 0x2000
v_exp_f32 v76, v76
v_mfma_f32_16x16x32_bf16 v[24:27], a[196:199], a[20:23], v[24:27]
buffer_load_dwordx4 v11, s[8:11], s21 offen nt lds
v_mfma_f32_16x16x32_bf16 v[36:39], a[196:199], a[36:39], v[36:39]
ds_read_b64_tr_b16 a[176:177], v8 offset:16384
v_and_b32 v113, s25, v113
v_mfma_f32_16x16x32_bf16 v[40:43], a[196:199], a[52:55], v[40:43]
v_exp_f32 v77, v77
v_mfma_f32_16x16x32_bf16 v[20:23], a[200:203], a[8:11], v[20:23]
ds_read_b64_tr_b16 a[178:179], v8 offset:20480
v_cvt_pk_bf16_f32 v74, v76, v77
v_mfma_f32_16x16x32_bf16 v[24:27], a[200:203], a[24:27], v[24:27]
v_exp_f32 v78, v78
v_mfma_f32_16x16x32_bf16 v[36:39], a[200:203], a[40:43], v[36:39]
ds_read_b64_tr_b16 a[180:181], v8 offset:17408
v_and_b32 v115, s25, v115
v_mfma_f32_16x16x32_bf16 v[40:43], a[200:203], a[56:59], v[40:43]
v_exp_f32 v79, v79
v_mfma_f32_16x16x32_bf16 v[20:23], a[204:207], a[12:15], v[20:23]
ds_read_b64_tr_b16 a[182:183], v8 offset:21504
v_cvt_pk_bf16_f32 v75, v78, v79
v_mfma_f32_16x16x32_bf16 v[24:27], a[204:207], a[28:31], v[24:27]
v_and_b32 v117, s25, v117
v_and_b32 v119, s25, v119
v_mfma_f32_16x16x32_bf16 v[36:39], a[204:207], a[44:47], v[36:39]
s_waitcnt lgkmcnt(4)
ds_read_b64_tr_b16 a[184:185], v5 offset:16384
v_mul_f32 v112, s26, v112
v_mfma_f32_16x16x32_bf16 v[40:43], a[204:207], a[60:63], v[40:43]
v_exp_f32 v20, v20
v_mfma_f32_16x16x32_bf16 v[16:19], a[208:211], a[0:3], 0
ds_read_b64_tr_b16 a[186:187], v5 offset:20480
v_mul_f32 v113, s26, v113
v_mfma_f32_16x16x32_bf16 v[28:31], a[208:211], a[16:19], 0
v_exp_f32 v21, v21
v_mfma_f32_16x16x32_bf16 v[32:35], a[208:211], a[32:35], 0
ds_read_b64_tr_b16 a[188:189], v5 offset:17408
v_cvt_pk_bf16_f32 v20, v20, v21
v_mfma_f32_16x16x32_bf16 v[44:47], a[208:211], a[48:51], 0
v_exp_f32 v22, v22
v_mfma_f32_16x16x32_bf16 v[16:19], a[212:215], a[4:7], v[16:19]
ds_read_b64_tr_b16 a[190:191], v5 offset:21504
v_mul_f32 v114, s26, v114
v_mfma_f32_16x16x32_bf16 v[28:31], a[212:215], a[20:23], v[28:31]
v_exp_f32 v23, v23
v_mfma_f32_16x16x32_bf16 v[32:35], a[212:215], a[36:39], v[32:35]
ds_read_b128 a[192:195], v1 offset:24576
v_cvt_pk_bf16_f32 v21, v22, v23
v_mfma_f32_16x16x32_bf16 v[44:47], a[212:215], a[52:55], v[44:47]
v_exp_f32 v24, v24
v_mfma_f32_16x16x32_bf16 v[16:19], a[216:219], a[8:11], v[16:19]
buffer_load_dwordx4 v11, s[8:11], s21 offen offset:2048 nt lds
v_mfma_f32_16x16x32_bf16 v[28:31], a[216:219], a[24:27], v[28:31]
ds_read_b128 a[196:199], v2 offset:24576
v_mul_f32 v115, s26, v115
v_mfma_f32_16x16x32_bf16 v[32:35], a[216:219], a[40:43], v[32:35]
v_exp_f32 v25, v25
v_mfma_f32_16x16x32_bf16 v[44:47], a[216:219], a[56:59], v[44:47]
ds_read_b128 a[200:203], v1 offset:25600
v_cvt_pk_bf16_f32 v24, v24, v25
v_mfma_f32_16x16x32_bf16 v[16:19], a[220:223], a[12:15], v[16:19]
v_exp_f32 v26, v26
v_mfma_f32_16x16x32_bf16 v[28:31], a[220:223], a[28:31], v[28:31]
ds_read_b128 a[204:207], v2 offset:25600
v_mul_f32 v116, s26, v116
v_mfma_f32_16x16x32_bf16 v[32:35], a[220:223], a[44:47], v[32:35]
v_exp_f32 v27, v27
v_mfma_f32_16x16x32_bf16 v[44:47], a[220:223], a[60:63], v[44:47]
ds_read_b128 a[208:211], v1 offset:28672
v_cvt_pk_bf16_f32 v25, v26, v27
v_mfma_f32_16x16x32_bf16 v[80:83], a[232:235], a[64:67], 0
v_exp_f32 v36, v36
v_mfma_f32_16x16x32_bf16 v[84:87], a[232:235], a[80:83], 0
ds_read_b128 a[232:235], v10 offset:6144
v_mul_f32 v117, s26, v117
v_mfma_f32_16x16x32_bf16 v[80:83], a[236:239], a[68:71], v[80:83]
v_exp_f32 v37, v37
v_mfma_f32_16x16x32_bf16 v[84:87], a[236:239], a[84:87], v[84:87]
ds_read_b128 a[236:239], v10 offset:7168
v_cvt_pk_bf16_f32 v36, v36, v37
v_mfma_f32_16x16x32_bf16 v[80:83], a[224:227], a[72:75], v[80:83]
v_exp_f32 v38, v38
v_mfma_f32_16x16x32_bf16 v[84:87], a[224:227], a[88:91], v[84:87]
s_waitcnt lgkmcnt(5)
ds_read_b128 a[212:215], v2 offset:28672
v_mul_f32 v118, s26, v118
v_mfma_f32_16x16x32_bf16 v[80:83], a[228:231], a[76:79], v[80:83]
v_exp_f32 v39, v39
v_mfma_f32_16x16x32_bf16 v[84:87], a[228:231], a[92:95], v[84:87]
ds_read_b128 a[216:219], v1 offset:29696
v_cvt_pk_bf16_f32 v37, v38, v39
v_mfma_f32_16x16x32_bf16 v[132:135], a[160:163], v[52:55], v[132:135]
v_exp_f32 v40, v40
v_mfma_f32_16x16x32_bf16 v[164:167], a[160:163], v[56:59], v[164:167]
ds_read_b128 a[220:223], v2 offset:29696
v_mul_f32 v119, s26, v119
v_mfma_f32_16x16x32_bf16 v[196:199], a[160:163], v[68:71], v[196:199]
s_add_u32 m0, s30, 0x1e000
s_add_u32 s37, s37, 0x2000
v_exp_f32 v80, v80
v_mfma_f32_16x16x32_bf16 v[228:231], a[160:163], v[72:75], v[228:231]
buffer_load_dwordx4 v11, s[12:15], s37 offen nt lds
v_mfma_f32_16x16x32_bf16 v[148:151], a[164:167], v[52:55], v[148:151]
ds_read_b64_tr_b16 a[160:161], v6 offset:24576
v_cvt_pk_bf16_f32 v112, v112, v113
v_mfma_f32_16x16x32_bf16 v[180:183], a[164:167], v[56:59], v[180:183]
v_exp_f32 v81, v81
v_mfma_f32_16x16x32_bf16 v[212:215], a[164:167], v[68:71], v[212:215]
ds_read_b64_tr_b16 a[162:163], v6 offset:28672
v_cvt_pk_bf16_f32 v80, v80, v81
v_mfma_f32_16x16x32_bf16 v[244:247], a[164:167], v[72:75], v[244:247]
v_exp_f32 v82, v82
v_smfmac_f32_16x16x64_bf16 a[244:247], a[240:243], v[52:59], v110
ds_read_b64_tr_b16 a[164:165], v6 offset:25600
v_cvt_pk_bf16_f32 v114, v114, v115
v_mfma_f32_16x16x32_bf16 v[136:139], a[168:171], v[52:55], v[136:139]
v_exp_f32 v83, v83
v_mfma_f32_16x16x32_bf16 v[168:171], a[168:171], v[56:59], v[168:171]
ds_read_b64_tr_b16 a[166:167], v6 offset:29696
v_cvt_pk_bf16_f32 v81, v82, v83
v_mfma_f32_16x16x32_bf16 v[200:203], a[168:171], v[68:71], v[200:203]
ds_write_b64 v9, v[80:81] offset:0
v_cvt_pk_bf16_f32 v116, v116, v117
v_mfma_f32_16x16x32_bf16 v[232:235], a[168:171], v[72:75], v[232:235]
ds_read_b64_tr_b16 a[168:169], v7 offset:24576
v_cvt_pk_bf16_f32 v118, v118, v119
v_mfma_f32_16x16x32_bf16 v[152:155], a[172:175], v[52:55], v[152:155]
v_exp_f32 v84, v84
v_mfma_f32_16x16x32_bf16 v[184:187], a[172:175], v[56:59], v[184:187]
ds_read_b64_tr_b16 a[170:171], v7 offset:28672
v_accvgpr_write_b32 a112, v112
v_mfma_f32_16x16x32_bf16 v[216:219], a[172:175], v[68:71], v[216:219]
v_exp_f32 v85, v85
v_mfma_f32_16x16x32_bf16 v[248:251], a[172:175], v[72:75], v[248:251]
s_waitcnt lgkmcnt(5)
ds_read_b64_tr_b16 a[172:173], v7 offset:25600
v_cvt_pk_bf16_f32 v84, v84, v85
v_smfmac_f32_16x16x64_bf16 a[248:251], a[240:243], v[68:75], v110
ds_read_b64_tr_b16 a[174:175], v7 offset:29696
v_accvgpr_write_b32 a113, v114
v_mfma_f32_16x16x32_bf16 v[140:143], a[176:179], v[52:55], v[140:143]
v_exp_f32 v86, v86
v_mfma_f32_16x16x32_bf16 v[172:175], a[176:179], v[56:59], v[172:175]
v_exp_f32 v87, v87
v_mfma_f32_16x16x32_bf16 v[204:207], a[176:179], v[68:71], v[204:207]
v_exp_f32 v41, v41
v_mfma_f32_16x16x32_bf16 v[236:239], a[176:179], v[72:75], v[236:239]
ds_read_b64_tr_b16 a[176:177], v8 offset:24576
v_cvt_pk_bf16_f32 v85, v86, v87
v_mfma_f32_16x16x32_bf16 v[156:159], a[180:183], v[52:55], v[156:159]
buffer_load_dwordx4 v11, s[12:15], s37 offen offset:2048 nt lds
v_mfma_f32_16x16x32_bf16 v[188:191], a[180:183], v[56:59], v[188:191]
ds_read_b64_tr_b16 a[178:179], v8 offset:28672
v_cvt_pk_bf16_f32 v40, v40, v41
v_mfma_f32_16x16x32_bf16 v[220:223], a[180:183], v[68:71], v[220:223]
ds_write_b64 v9, v[84:85] offset:1024
v_accvgpr_write_b32 a114, v116
v_mfma_f32_16x16x32_bf16 v[252:255], a[180:183], v[72:75], v[252:255]
ds_read_b64_tr_b16 a[180:181], v8 offset:25600
v_accvgpr_write_b32 a115, v118
v_mfma_f32_16x16x32_bf16 v[128:131], a[184:187], v[52:55], v[128:131]
v_exp_f32 v42, v42
v_mfma_f32_16x16x32_bf16 v[160:163], a[184:187], v[56:59], v[160:163]
ds_read_b64_tr_b16 a[182:183], v8 offset:29696
v_accvgpr_read_b32 v113, a116
v_mfma_f32_16x16x32_bf16 v[192:195], a[184:187], v[68:71], v[192:195]
v_exp_f32 v43, v43
v_mfma_f32_16x16x32_bf16 v[224:227], a[184:187], v[72:75], v[224:227]
v_exp_f32 v16, v16
v_mfma_f32_16x16x32_bf16 v[88:91], a[184:187], a[232:235], v[88:91]
v_exp_f32 v17, v17
v_mfma_f32_16x16x32_bf16 v[96:99], a[184:187], a[236:239], v[96:99]
ds_read_b64_tr_b16 a[184:185], v5 offset:24576
v_cvt_pk_bf16_f32 v22, v16, v17
v_smfmac_f32_16x16x64_bf16 a[252:255], a[240:243], a[232:239], v110
ds_read_b64_tr_b16 a[186:187], v5 offset:28672
v_cvt_pk_bf16_f32 v41, v42, v43
v_mfma_f32_16x16x32_bf16 v[144:147], a[188:191], v[52:55], v[144:147]
v_exp_f32 v18, v18
v_mfma_f32_16x16x32_bf16 v[176:179], a[188:191], v[56:59], v[176:179]
v_exp_f32 v19, v19
v_mfma_f32_16x16x32_bf16 v[208:211], a[188:191], v[68:71], v[208:211]
v_exp_f32 v28, v28
v_mfma_f32_16x16x32_bf16 v[240:243], a[188:191], v[72:75], v[240:243]
v_exp_f32 v29, v29
v_mfma_f32_16x16x32_bf16 v[92:95], a[188:191], a[232:235], v[92:95]
v_exp_f32 v30, v30
v_mfma_f32_16x16x32_bf16 v[100:103], a[188:191], a[236:239], v[100:103]
ds_read_b64_tr_b16 a[188:189], v5 offset:25600
v_cvt_pk_bf16_f32 v23, v18, v19
v_mfma_f32_16x16x32_bf16 v[52:55], a[192:195], a[0:3], 0
v_exp_f32 v31, v31
v_mfma_f32_16x16x32_bf16 v[56:59], a[192:195], a[16:19], 0
s_add_u32 m0, s30, 0xe000
s_add_u32 s21, s21, 0x2000
s_waitcnt lgkmcnt(3)
ds_read_b64_tr_b16 a[190:191], v5 offset:29696
v_cvt_pk_bf16_f32 v26, v28, v29
v_mfma_f32_16x16x32_bf16 v[68:71], a[192:195], a[32:35], 0
buffer_load_dwordx4 v11, s[8:11], s21 offen nt lds
v_mfma_f32_16x16x32_bf16 v[72:75], a[192:195], a[48:51], 0
v_exp_f32 v32, v32
v_mfma_f32_16x16x32_bf16 v[52:55], a[196:199], a[4:7], v[52:55]
v_exp_f32 v33, v33
v_mfma_f32_16x16x32_bf16 v[56:59], a[196:199], a[20:23], v[56:59]
v_exp_f32 v34, v34
v_mfma_f32_16x16x32_bf16 v[68:71], a[196:199], a[36:39], v[68:71]
v_exp_f32 v35, v35
v_mfma_f32_16x16x32_bf16 v[72:75], a[196:199], a[52:55], v[72:75]
v_exp_f32 v44, v44
v_mfma_f32_16x16x32_bf16 v[52:55], a[200:203], a[8:11], v[52:55]
v_exp_f32 v45, v45
v_mfma_f32_16x16x32_bf16 v[56:59], a[200:203], a[24:27], v[56:59]
v_exp_f32 v46, v46
v_mfma_f32_16x16x32_bf16 v[68:71], a[200:203], a[40:43], v[68:71]
v_exp_f32 v47, v47
v_mfma_f32_16x16x32_bf16 v[72:75], a[200:203], a[56:59], v[72:75]
v_cvt_pk_bf16_f32 v27, v30, v31
v_cvt_pk_bf16_f32 v38, v32, v33
v_mfma_f32_16x16x32_bf16 v[52:55], a[204:207], a[12:15], v[52:55]
v_cvt_pk_bf16_f32 v39, v34, v35
v_cvt_pk_bf16_f32 v42, v44, v45
v_mfma_f32_16x16x32_bf16 v[56:59], a[204:207], a[28:31], v[56:59]
v_cvt_pk_bf16_f32 v43, v46, v47
v_accvgpr_read_b32 v115, a117
v_mfma_f32_16x16x32_bf16 v[68:71], a[204:207], a[44:47], v[68:71]
v_accvgpr_read_b32 v117, a118
v_accvgpr_read_b32 v119, a119
v_mfma_f32_16x16x32_bf16 v[72:75], a[204:207], a[60:63], v[72:75]
v_exp_f32 v52, v52
v_mfma_f32_16x16x32_bf16 v[48:51], a[208:211], a[0:3], 0
v_exp_f32 v53, v53
v_mfma_f32_16x16x32_bf16 v[60:63], a[208:211], a[16:19], 0
v_exp_f32 v54, v54
v_mfma_f32_16x16x32_bf16 v[64:67], a[208:211], a[32:35], 0
v_exp_f32 v55, v55
v_mfma_f32_16x16x32_bf16 v[76:79], a[208:211], a[48:51], 0
v_exp_f32 v56, v56
v_mfma_f32_16x16x32_bf16 v[48:51], a[212:215], a[4:7], v[48:51]
buffer_load_dwordx4 v11, s[8:11], s21 offen offset:2048 nt lds
v_mfma_f32_16x16x32_bf16 v[60:63], a[212:215], a[20:23], v[60:63]
v_exp_f32 v57, v57
v_mfma_f32_16x16x32_bf16 v[64:67], a[212:215], a[36:39], v[64:67]
v_exp_f32 v58, v58
v_mfma_f32_16x16x32_bf16 v[76:79], a[212:215], a[52:55], v[76:79]
v_exp_f32 v59, v59
v_mfma_f32_16x16x32_bf16 v[48:51], a[216:219], a[8:11], v[48:51]
v_exp_f32 v68, v68
v_mfma_f32_16x16x32_bf16 v[60:63], a[216:219], a[24:27], v[60:63]
v_exp_f32 v69, v69
v_mfma_f32_16x16x32_bf16 v[64:67], a[216:219], a[40:43], v[64:67]
v_exp_f32 v70, v70
v_mfma_f32_16x16x32_bf16 v[76:79], a[216:219], a[56:59], v[76:79]
v_exp_f32 v71, v71
v_mfma_f32_16x16x32_bf16 v[48:51], a[220:223], a[12:15], v[48:51]
v_cvt_pk_bf16_f32 v52, v52, v53
v_cvt_pk_bf16_f32 v53, v54, v55
v_mfma_f32_16x16x32_bf16 v[60:63], a[220:223], a[28:31], v[60:63]
v_exp_f32 v72, v72
v_mfma_f32_16x16x32_bf16 v[64:67], a[220:223], a[44:47], v[64:67]
v_exp_f32 v73, v73
v_mfma_f32_16x16x32_bf16 v[76:79], a[220:223], a[60:63], v[76:79]
s_waitcnt vmcnt(10) lgkmcnt(0)
s_barrier
ds_read_b128 a[224:227], v10 offset:0
v_mfma_f32_16x16x32_bf16 v[132:135], a[160:163], v[20:23], v[132:135]
v_exp_f32 v74, v74
v_mfma_f32_16x16x32_bf16 v[164:167], a[160:163], v[24:27], v[164:167]
ds_read_b128 a[228:231], v10 offset:1024
v_cvt_pk_bf16_f32 v56, v56, v57
v_mfma_f32_16x16x32_bf16 v[196:199], a[160:163], v[36:39], v[196:199]
v_exp_f32 v75, v75
v_mfma_f32_16x16x32_bf16 v[228:231], a[160:163], v[40:43], v[228:231]
ds_read_b128 a[192:195], v1 offset:32768
v_cvt_pk_bf16_f32 v57, v58, v59
v_mfma_f32_16x16x32_bf16 v[148:151], a[164:167], v[20:23], v[148:151]
v_exp_f32 v48, v48
v_mfma_f32_16x16x32_bf16 v[180:183], a[164:167], v[24:27], v[180:183]
s_add_u32 m0, s30, 0x10000
s_add_u32 s37, s37, 0x2000
ds_read_b128 a[196:199], v2 offset:32768
v_cvt_pk_bf16_f32 v68, v68, v69
v_mfma_f32_16x16x32_bf16 v[212:215], a[164:167], v[36:39], v[212:215]
buffer_load_dwordx4 v11, s[12:15], s37 offen nt lds
v_mfma_f32_16x16x32_bf16 v[244:247], a[164:167], v[40:43], v[244:247]
ds_read_b128 a[200:203], v1 offset:33792
v_cvt_pk_bf16_f32 v69, v70, v71
v_smfmac_f32_16x16x64_bf16 a[244:247], a[240:243], v[20:27], v110
ds_read_b128 a[204:207], v2 offset:33792
v_cvt_pk_bf16_f32 v72, v72, v73
v_mfma_f32_16x16x32_bf16 v[136:139], a[168:171], v[20:23], v[136:139]
v_exp_f32 v49, v49
v_mfma_f32_16x16x32_bf16 v[168:171], a[168:171], v[24:27], v[168:171]
ds_read_b128 a[208:211], v1 offset:36864
v_cvt_pk_bf16_f32 v54, v48, v49
v_mfma_f32_16x16x32_bf16 v[200:203], a[168:171], v[36:39], v[200:203]
v_exp_f32 v50, v50
v_mfma_f32_16x16x32_bf16 v[232:235], a[168:171], v[40:43], v[232:235]
ds_read_b128 a[212:215], v2 offset:36864
v_cvt_pk_bf16_f32 v73, v74, v75
v_mfma_f32_16x16x32_bf16 v[152:155], a[172:175], v[20:23], v[152:155]
v_exp_f32 v51, v51
v_mfma_f32_16x16x32_bf16 v[184:187], a[172:175], v[24:27], v[184:187]
buffer_load_dwordx4 a[136:139], v12, s[4:7], s76 offen offset:128 nt
v_mfma_f32_16x16x32_bf16 v[216:219], a[172:175], v[36:39], v[216:219]
buffer_load_dwordx4 a[140:143], v12, s[4:7], s76 offen offset:192 nt
v_mfma_f32_16x16x32_bf16 v[248:251], a[172:175], v[40:43], v[248:251]
ds_read_b128 a[216:219], v1 offset:37888
v_cvt_pk_bf16_f32 v55, v50, v51
v_smfmac_f32_16x16x64_bf16 a[248:251], a[240:243], v[36:43], v110
ds_read_b128 a[220:223], v2 offset:37888
v_lshlrev_b32 v112, 16, v113
v_mfma_f32_16x16x32_bf16 v[140:143], a[176:179], v[20:23], v[140:143]
v_exp_f32 v60, v60
v_mfma_f32_16x16x32_bf16 v[172:175], a[176:179], v[24:27], v[172:175]
ds_read_b128 a[232:235], v3 offset:32768
v_lshlrev_b32 v114, 16, v115
v_mfma_f32_16x16x32_bf16 v[204:207], a[176:179], v[36:39], v[204:207]
v_exp_f32 v61, v61
v_mfma_f32_16x16x32_bf16 v[236:239], a[176:179], v[40:43], v[236:239]
ds_read_b128 a[236:239], v4 offset:32768
v_cvt_pk_bf16_f32 v58, v60, v61
v_mfma_f32_16x16x32_bf16 v[156:159], a[180:183], v[20:23], v[156:159]
v_exp_f32 v62, v62
v_mfma_f32_16x16x32_bf16 v[188:191], a[180:183], v[24:27], v[188:191]
ds_read_b64_tr_b16 a[160:161], v6 offset:32768
v_lshlrev_b32 v116, 16, v117
v_mfma_f32_16x16x32_bf16 v[220:223], a[180:183], v[36:39], v[220:223]
v_exp_f32 v63, v63
v_mfma_f32_16x16x32_bf16 v[252:255], a[180:183], v[40:43], v[252:255]
buffer_load_dwordx4 v11, s[12:15], s37 offen offset:2048 nt lds
v_mfma_f32_16x16x32_bf16 v[128:131], a[184:187], v[20:23], v[128:131]
ds_read_b64_tr_b16 a[162:163], v6 offset:36864
v_cvt_pk_bf16_f32 v59, v62, v63
v_mfma_f32_16x16x32_bf16 v[160:163], a[184:187], v[24:27], v[160:163]
v_exp_f32 v64, v64
v_mfma_f32_16x16x32_bf16 v[192:195], a[184:187], v[36:39], v[192:195]
ds_read_b64_tr_b16 a[164:165], v6 offset:33792
v_lshlrev_b32 v118, 16, v119
v_mfma_f32_16x16x32_bf16 v[224:227], a[184:187], v[40:43], v[224:227]
v_exp_f32 v65, v65
s_waitcnt lgkmcnt(4)
v_mfma_f32_16x16x32_bf16 v[88:91], a[184:187], a[224:227], v[88:91]
ds_read_b64_tr_b16 a[166:167], v6 offset:37888
v_cvt_pk_bf16_f32 v70, v64, v65
v_mfma_f32_16x16x32_bf16 v[96:99], a[184:187], a[228:231], v[96:99]
v_exp_f32 v66, v66
v_smfmac_f32_16x16x64_bf16 a[252:255], a[240:243], a[224:231], v110
ds_read_b64_tr_b16 a[168:169], v7 offset:32768
v_and_b32 v113, s25, v113
v_mfma_f32_16x16x32_bf16 v[144:147], a[188:191], v[20:23], v[144:147]
v_exp_f32 v67, v67
v_mfma_f32_16x16x32_bf16 v[176:179], a[188:191], v[24:27], v[176:179]
ds_read_b64_tr_b16 a[170:171], v7 offset:36864
v_cvt_pk_bf16_f32 v71, v66, v67
v_mfma_f32_16x16x32_bf16 v[208:211], a[188:191], v[36:39], v[208:211]
v_exp_f32 v76, v76
v_mfma_f32_16x16x32_bf16 v[240:243], a[188:191], v[40:43], v[240:243]
ds_read_b64_tr_b16 a[172:173], v7 offset:33792
v_and_b32 v115, s25, v115
v_mfma_f32_16x16x32_bf16 v[92:95], a[188:191], a[224:227], v[92:95]
v_exp_f32 v77, v77
v_mfma_f32_16x16x32_bf16 v[100:103], a[188:191], a[228:231], v[100:103]
ds_read_b128 a[224:227], v3 offset:33792
v_cvt_pk_bf16_f32 v74, v76, v77
v_mfma_f32_16x16x32_bf16 v[20:23], a[192:195], a[0:3], 0
v_exp_f32 v78, v78
v_mfma_f32_16x16x32_bf16 v[24:27], a[192:195], a[16:19], 0
ds_read_b128 a[228:231], v4 offset:33792
v_and_b32 v117, s25, v117
v_mfma_f32_16x16x32_bf16 v[36:39], a[192:195], a[32:35], 0
v_exp_f32 v79, v79
v_mfma_f32_16x16x32_bf16 v[40:43], a[192:195], a[48:51], 0
ds_read_b64_tr_b16 a[174:175], v7 offset:37888
v_cvt_pk_bf16_f32 v75, v78, v79
v_mfma_f32_16x16x32_bf16 v[20:23], a[196:199], a[4:7], v[20:23]
s_add_u32 m0, s30, 0x0
s_add_u32 s21, s21, 0x2000
v_and_b32 v119, s25, v119
v_mfma_f32_16x16x32_bf16 v[24:27], a[196:199], a[20:23], v[24:27]
buffer_load_dwordx4 v11, s[8:11], s21 offen nt lds
v_mfma_f32_16x16x32_bf16 v[36:39], a[196:199], a[36:39], v[36:39]
ds_read_b64_tr_b16 a[176:177], v8 offset:32768
v_mul_f32 v112, s26, v112
v_mfma_f32_16x16x32_bf16 v[40:43], a[196:199], a[52:55], v[40:43]
v_mul_f32 v113, s26, v113
v_mul_f32 v114, s26, v114
v_mfma_f32_16x16x32_bf16 v[20:23], a[200:203], a[8:11], v[20:23]
ds_read_b64_tr_b16 a[178:179], v8 offset:36864
v_mul_f32 v115, s26, v115
v_mfma_f32_16x16x32_bf16 v[24:27], a[200:203], a[24:27], v[24:27]
v_mul_f32 v116, s26, v116
v_mul_f32 v117, s26, v117
v_mfma_f32_16x16x32_bf16 v[36:39], a[200:203], a[40:43], v[36:39]
ds_read_b64_tr_b16 a[180:181], v8 offset:33792
v_mul_f32 v118, s26, v118
v_mfma_f32_16x16x32_bf16 v[40:43], a[200:203], a[56:59], v[40:43]
v_mul_f32 v119, s26, v119
v_cvt_pk_bf16_f32 v112, v112, v113
v_mfma_f32_16x16x32_bf16 v[20:23], a[204:207], a[12:15], v[20:23]
ds_read_b64_tr_b16 a[182:183], v8 offset:37888
v_cvt_pk_bf16_f32 v114, v114, v115
v_mfma_f32_16x16x32_bf16 v[24:27], a[204:207], a[28:31], v[24:27]
v_cvt_pk_bf16_f32 v116, v116, v117
v_cvt_pk_bf16_f32 v118, v118, v119
v_mfma_f32_16x16x32_bf16 v[36:39], a[204:207], a[44:47], v[36:39]
s_waitcnt lgkmcnt(4)
ds_read_b64_tr_b16 a[184:185], v5 offset:32768
v_accvgpr_write_b32 a116, v112
v_mfma_f32_16x16x32_bf16 v[40:43], a[204:207], a[60:63], v[40:43]
v_exp_f32 v20, v20
v_mfma_f32_16x16x32_bf16 v[16:19], a[208:211], a[0:3], 0
ds_read_b64_tr_b16 a[186:187], v5 offset:36864
v_accvgpr_write_b32 a117, v114
v_mfma_f32_16x16x32_bf16 v[28:31], a[208:211], a[16:19], 0
v_exp_f32 v21, v21
v_mfma_f32_16x16x32_bf16 v[32:35], a[208:211], a[32:35], 0
ds_read_b64_tr_b16 a[188:189], v5 offset:33792
v_cvt_pk_bf16_f32 v20, v20, v21
v_mfma_f32_16x16x32_bf16 v[44:47], a[208:211], a[48:51], 0
v_exp_f32 v22, v22
v_mfma_f32_16x16x32_bf16 v[16:19], a[212:215], a[4:7], v[16:19]
ds_read_b64_tr_b16 a[190:191], v5 offset:37888
v_accvgpr_write_b32 a118, v116
v_mfma_f32_16x16x32_bf16 v[28:31], a[212:215], a[20:23], v[28:31]
v_exp_f32 v23, v23
v_mfma_f32_16x16x32_bf16 v[32:35], a[212:215], a[36:39], v[32:35]
ds_read_b128 a[192:195], v1 offset:40960
v_cvt_pk_bf16_f32 v21, v22, v23
v_mfma_f32_16x16x32_bf16 v[44:47], a[212:215], a[52:55], v[44:47]
v_exp_f32 v24, v24
v_mfma_f32_16x16x32_bf16 v[16:19], a[216:219], a[8:11], v[16:19]
buffer_load_dwordx4 v11, s[8:11], s21 offen offset:2048 nt lds
v_mfma_f32_16x16x32_bf16 v[28:31], a[216:219], a[24:27], v[28:31]
ds_read_b128 a[196:199], v2 offset:40960
v_accvgpr_write_b32 a119, v118
v_mfma_f32_16x16x32_bf16 v[32:35], a[216:219], a[40:43], v[32:35]
v_exp_f32 v25, v25
v_mfma_f32_16x16x32_bf16 v[44:47], a[216:219], a[56:59], v[44:47]
ds_read_b128 a[200:203], v1 offset:41984
v_cvt_pk_bf16_f32 v24, v24, v25
v_mfma_f32_16x16x32_bf16 v[16:19], a[220:223], a[12:15], v[16:19]
v_exp_f32 v26, v26
v_mfma_f32_16x16x32_bf16 v[28:31], a[220:223], a[28:31], v[28:31]
ds_read_b128 a[204:207], v2 offset:41984
v_accvgpr_read_b32 v113, a120
v_mfma_f32_16x16x32_bf16 v[32:35], a[220:223], a[44:47], v[32:35]
v_exp_f32 v27, v27
v_mfma_f32_16x16x32_bf16 v[44:47], a[220:223], a[60:63], v[44:47]
ds_read_b128 a[208:211], v1 offset:45056
v_cvt_pk_bf16_f32 v25, v26, v27
v_mfma_f32_16x16x32_bf16 v[80:83], a[232:235], a[64:67], 0
v_exp_f32 v36, v36
v_mfma_f32_16x16x32_bf16 v[84:87], a[232:235], a[80:83], 0
ds_read_b128 a[232:235], v10 offset:2048
v_accvgpr_read_b32 v115, a121
v_mfma_f32_16x16x32_bf16 v[80:83], a[236:239], a[68:71], v[80:83]
v_exp_f32 v37, v37
v_mfma_f32_16x16x32_bf16 v[84:87], a[236:239], a[84:87], v[84:87]
ds_read_b128 a[236:239], v10 offset:3072
v_cvt_pk_bf16_f32 v36, v36, v37
v_mfma_f32_16x16x32_bf16 v[80:83], a[224:227], a[72:75], v[80:83]
v_exp_f32 v38, v38
v_mfma_f32_16x16x32_bf16 v[84:87], a[224:227], a[88:91], v[84:87]
s_waitcnt lgkmcnt(5)
ds_read_b128 a[212:215], v2 offset:45056
v_accvgpr_read_b32 v117, a122
v_mfma_f32_16x16x32_bf16 v[80:83], a[228:231], a[76:79], v[80:83]
v_exp_f32 v39, v39
v_mfma_f32_16x16x32_bf16 v[84:87], a[228:231], a[92:95], v[84:87]
ds_read_b128 a[216:219], v1 offset:46080
v_cvt_pk_bf16_f32 v37, v38, v39
v_mfma_f32_16x16x32_bf16 v[132:135], a[160:163], v[52:55], v[132:135]
v_exp_f32 v40, v40
v_mfma_f32_16x16x32_bf16 v[164:167], a[160:163], v[56:59], v[164:167]
ds_read_b128 a[220:223], v2 offset:46080
v_accvgpr_read_b32 v119, a123
v_mfma_f32_16x16x32_bf16 v[196:199], a[160:163], v[68:71], v[196:199]
s_add_u32 m0, s30, 0x12000
s_add_u32 s37, s37, 0x2000
v_exp_f32 v80, v80
v_mfma_f32_16x16x32_bf16 v[228:231], a[160:163], v[72:75], v[228:231]
buffer_load_dwordx4 v11, s[12:15], s37 offen nt lds
v_mfma_f32_16x16x32_bf16 v[148:151], a[164:167], v[52:55], v[148:151]
ds_read_b64_tr_b16 a[160:161], v6 offset:40960
v_lshlrev_b32 v112, 16, v113
v_mfma_f32_16x16x32_bf16 v[180:183], a[164:167], v[56:59], v[180:183]
v_exp_f32 v81, v81
v_mfma_f32_16x16x32_bf16 v[212:215], a[164:167], v[68:71], v[212:215]
ds_read_b64_tr_b16 a[162:163], v6 offset:45056
v_cvt_pk_bf16_f32 v80, v80, v81
v_mfma_f32_16x16x32_bf16 v[244:247], a[164:167], v[72:75], v[244:247]
v_exp_f32 v82, v82
v_smfmac_f32_16x16x64_bf16 a[244:247], a[240:243], v[52:59], v110
ds_read_b64_tr_b16 a[164:165], v6 offset:41984
v_lshlrev_b32 v114, 16, v115
v_mfma_f32_16x16x32_bf16 v[136:139], a[168:171], v[52:55], v[136:139]
v_exp_f32 v83, v83
v_mfma_f32_16x16x32_bf16 v[168:171], a[168:171], v[56:59], v[168:171]
ds_read_b64_tr_b16 a[166:167], v6 offset:46080
v_cvt_pk_bf16_f32 v81, v82, v83
v_mfma_f32_16x16x32_bf16 v[200:203], a[168:171], v[68:71], v[200:203]
ds_write_b64 v9, v[80:81] offset:4096
v_lshlrev_b32 v116, 16, v117
v_mfma_f32_16x16x32_bf16 v[232:235], a[168:171], v[72:75], v[232:235]
ds_read_b64_tr_b16 a[168:169], v7 offset:40960
v_lshlrev_b32 v118, 16, v119
v_mfma_f32_16x16x32_bf16 v[152:155], a[172:175], v[52:55], v[152:155]
v_exp_f32 v84, v84
v_mfma_f32_16x16x32_bf16 v[184:187], a[172:175], v[56:59], v[184:187]
ds_read_b64_tr_b16 a[170:171], v7 offset:45056
v_and_b32 v113, s25, v113
v_mfma_f32_16x16x32_bf16 v[216:219], a[172:175], v[68:71], v[216:219]
v_exp_f32 v85, v85
v_mfma_f32_16x16x32_bf16 v[248:251], a[172:175], v[72:75], v[248:251]
s_waitcnt lgkmcnt(5)
ds_read_b64_tr_b16 a[172:173], v7 offset:41984
v_cvt_pk_bf16_f32 v84, v84, v85
v_smfmac_f32_16x16x64_bf16 a[248:251], a[240:243], v[68:75], v110
ds_read_b64_tr_b16 a[174:175], v7 offset:46080
v_and_b32 v115, s25, v115
v_mfma_f32_16x16x32_bf16 v[140:143], a[176:179], v[52:55], v[140:143]
v_exp_f32 v86, v86
v_mfma_f32_16x16x32_bf16 v[172:175], a[176:179], v[56:59], v[172:175]
v_exp_f32 v87, v87
v_mfma_f32_16x16x32_bf16 v[204:207], a[176:179], v[68:71], v[204:207]
v_exp_f32 v41, v41
v_mfma_f32_16x16x32_bf16 v[236:239], a[176:179], v[72:75], v[236:239]
ds_read_b64_tr_b16 a[176:177], v8 offset:40960
v_cvt_pk_bf16_f32 v85, v86, v87
v_mfma_f32_16x16x32_bf16 v[156:159], a[180:183], v[52:55], v[156:159]
buffer_load_dwordx4 v11, s[12:15], s37 offen offset:2048 nt lds
v_mfma_f32_16x16x32_bf16 v[188:191], a[180:183], v[56:59], v[188:191]
ds_read_b64_tr_b16 a[178:179], v8 offset:45056
v_cvt_pk_bf16_f32 v40, v40, v41
v_mfma_f32_16x16x32_bf16 v[220:223], a[180:183], v[68:71], v[220:223]
ds_write_b64 v9, v[84:85] offset:5120
v_and_b32 v117, s25, v117
v_mfma_f32_16x16x32_bf16 v[252:255], a[180:183], v[72:75], v[252:255]
ds_read_b64_tr_b16 a[180:181], v8 offset:41984
v_and_b32 v119, s25, v119
v_mfma_f32_16x16x32_bf16 v[128:131], a[184:187], v[52:55], v[128:131]
v_exp_f32 v42, v42
v_mfma_f32_16x16x32_bf16 v[160:163], a[184:187], v[56:59], v[160:163]
ds_read_b64_tr_b16 a[182:183], v8 offset:46080
v_mul_f32 v112, s26, v112
v_mfma_f32_16x16x32_bf16 v[192:195], a[184:187], v[68:71], v[192:195]
v_exp_f32 v43, v43
v_mfma_f32_16x16x32_bf16 v[224:227], a[184:187], v[72:75], v[224:227]
v_exp_f32 v16, v16
v_mfma_f32_16x16x32_bf16 v[88:91], a[184:187], a[232:235], v[88:91]
v_exp_f32 v17, v17
v_mfma_f32_16x16x32_bf16 v[96:99], a[184:187], a[236:239], v[96:99]
ds_read_b64_tr_b16 a[184:185], v5 offset:40960
v_cvt_pk_bf16_f32 v22, v16, v17
v_smfmac_f32_16x16x64_bf16 a[252:255], a[240:243], a[232:239], v110
ds_read_b64_tr_b16 a[186:187], v5 offset:45056
v_cvt_pk_bf16_f32 v41, v42, v43
v_mfma_f32_16x16x32_bf16 v[144:147], a[188:191], v[52:55], v[144:147]
v_exp_f32 v18, v18
v_mfma_f32_16x16x32_bf16 v[176:179], a[188:191], v[56:59], v[176:179]
v_exp_f32 v19, v19
v_mfma_f32_16x16x32_bf16 v[208:211], a[188:191], v[68:71], v[208:211]
v_exp_f32 v28, v28
v_mfma_f32_16x16x32_bf16 v[240:243], a[188:191], v[72:75], v[240:243]
v_exp_f32 v29, v29
v_mfma_f32_16x16x32_bf16 v[92:95], a[188:191], a[232:235], v[92:95]
v_exp_f32 v30, v30
v_mfma_f32_16x16x32_bf16 v[100:103], a[188:191], a[236:239], v[100:103]
ds_read_b64_tr_b16 a[188:189], v5 offset:41984
v_cvt_pk_bf16_f32 v23, v18, v19
v_mfma_f32_16x16x32_bf16 v[52:55], a[192:195], a[0:3], 0
v_exp_f32 v31, v31
v_mfma_f32_16x16x32_bf16 v[56:59], a[192:195], a[16:19], 0
s_add_u32 m0, s30, 0x2000
s_add_u32 s21, s21, 0x2000
s_waitcnt lgkmcnt(3)
ds_read_b64_tr_b16 a[190:191], v5 offset:46080
v_cvt_pk_bf16_f32 v26, v28, v29
v_mfma_f32_16x16x32_bf16 v[68:71], a[192:195], a[32:35], 0
buffer_load_dwordx4 v11, s[8:11], s21 offen nt lds
v_mfma_f32_16x16x32_bf16 v[72:75], a[192:195], a[48:51], 0
v_exp_f32 v32, v32
v_mfma_f32_16x16x32_bf16 v[52:55], a[196:199], a[4:7], v[52:55]
v_exp_f32 v33, v33
v_mfma_f32_16x16x32_bf16 v[56:59], a[196:199], a[20:23], v[56:59]
v_exp_f32 v34, v34
v_mfma_f32_16x16x32_bf16 v[68:71], a[196:199], a[36:39], v[68:71]
v_exp_f32 v35, v35
v_mfma_f32_16x16x32_bf16 v[72:75], a[196:199], a[52:55], v[72:75]
v_exp_f32 v44, v44
v_mfma_f32_16x16x32_bf16 v[52:55], a[200:203], a[8:11], v[52:55]
v_exp_f32 v45, v45
v_mfma_f32_16x16x32_bf16 v[56:59], a[200:203], a[24:27], v[56:59]
v_exp_f32 v46, v46
v_mfma_f32_16x16x32_bf16 v[68:71], a[200:203], a[40:43], v[68:71]
v_exp_f32 v47, v47
v_mfma_f32_16x16x32_bf16 v[72:75], a[200:203], a[56:59], v[72:75]
v_cvt_pk_bf16_f32 v27, v30, v31
v_cvt_pk_bf16_f32 v38, v32, v33
v_mfma_f32_16x16x32_bf16 v[52:55], a[204:207], a[12:15], v[52:55]
v_cvt_pk_bf16_f32 v39, v34, v35
v_cvt_pk_bf16_f32 v42, v44, v45
v_mfma_f32_16x16x32_bf16 v[56:59], a[204:207], a[28:31], v[56:59]
v_cvt_pk_bf16_f32 v43, v46, v47
v_mul_f32 v113, s26, v113
v_mfma_f32_16x16x32_bf16 v[68:71], a[204:207], a[44:47], v[68:71]
v_mul_f32 v114, s26, v114
v_mul_f32 v115, s26, v115
v_mfma_f32_16x16x32_bf16 v[72:75], a[204:207], a[60:63], v[72:75]
v_exp_f32 v52, v52
v_mfma_f32_16x16x32_bf16 v[48:51], a[208:211], a[0:3], 0
v_exp_f32 v53, v53
v_mfma_f32_16x16x32_bf16 v[60:63], a[208:211], a[16:19], 0
v_exp_f32 v54, v54
v_mfma_f32_16x16x32_bf16 v[64:67], a[208:211], a[32:35], 0
v_exp_f32 v55, v55
v_mfma_f32_16x16x32_bf16 v[76:79], a[208:211], a[48:51], 0
v_exp_f32 v56, v56
v_mfma_f32_16x16x32_bf16 v[48:51], a[212:215], a[4:7], v[48:51]
buffer_load_dwordx4 v11, s[8:11], s21 offen offset:2048 nt lds
v_mfma_f32_16x16x32_bf16 v[60:63], a[212:215], a[20:23], v[60:63]
v_exp_f32 v57, v57
v_mfma_f32_16x16x32_bf16 v[64:67], a[212:215], a[36:39], v[64:67]
v_exp_f32 v58, v58
v_mfma_f32_16x16x32_bf16 v[76:79], a[212:215], a[52:55], v[76:79]
v_exp_f32 v59, v59
v_mfma_f32_16x16x32_bf16 v[48:51], a[216:219], a[8:11], v[48:51]
v_exp_f32 v68, v68
v_mfma_f32_16x16x32_bf16 v[60:63], a[216:219], a[24:27], v[60:63]
v_exp_f32 v69, v69
v_mfma_f32_16x16x32_bf16 v[64:67], a[216:219], a[40:43], v[64:67]
v_exp_f32 v70, v70
v_mfma_f32_16x16x32_bf16 v[76:79], a[216:219], a[56:59], v[76:79]
v_exp_f32 v71, v71
v_mfma_f32_16x16x32_bf16 v[48:51], a[220:223], a[12:15], v[48:51]
v_cvt_pk_bf16_f32 v52, v52, v53
v_cvt_pk_bf16_f32 v53, v54, v55
v_mfma_f32_16x16x32_bf16 v[60:63], a[220:223], a[28:31], v[60:63]
v_exp_f32 v72, v72
v_mfma_f32_16x16x32_bf16 v[64:67], a[220:223], a[44:47], v[64:67]
v_exp_f32 v73, v73
v_mfma_f32_16x16x32_bf16 v[76:79], a[220:223], a[60:63], v[76:79]
s_waitcnt vmcnt(10) lgkmcnt(0)
s_barrier
ds_read_b128 a[224:227], v10 offset:4096
v_mfma_f32_16x16x32_bf16 v[132:135], a[160:163], v[20:23], v[132:135]
v_exp_f32 v74, v74
v_mfma_f32_16x16x32_bf16 v[164:167], a[160:163], v[24:27], v[164:167]
ds_read_b128 a[228:231], v10 offset:5120
v_cvt_pk_bf16_f32 v56, v56, v57
v_mfma_f32_16x16x32_bf16 v[196:199], a[160:163], v[36:39], v[196:199]
v_exp_f32 v75, v75
v_mfma_f32_16x16x32_bf16 v[228:231], a[160:163], v[40:43], v[228:231]
ds_read_b128 a[192:195], v1 offset:49152
v_cvt_pk_bf16_f32 v57, v58, v59
v_mfma_f32_16x16x32_bf16 v[148:151], a[164:167], v[20:23], v[148:151]
v_exp_f32 v48, v48
v_mfma_f32_16x16x32_bf16 v[180:183], a[164:167], v[24:27], v[180:183]
s_add_u32 m0, s30, 0x14000
s_add_u32 s37, s37, 0x2000
ds_read_b128 a[196:199], v2 offset:49152
v_cvt_pk_bf16_f32 v68, v68, v69
v_mfma_f32_16x16x32_bf16 v[212:215], a[164:167], v[36:39], v[212:215]
buffer_load_dwordx4 v11, s[12:15], s37 offen nt lds
v_mfma_f32_16x16x32_bf16 v[244:247], a[164:167], v[40:43], v[244:247]
ds_read_b128 a[200:203], v1 offset:50176
v_cvt_pk_bf16_f32 v69, v70, v71
v_smfmac_f32_16x16x64_bf16 a[244:247], a[240:243], v[20:27], v110
ds_read_b128 a[204:207], v2 offset:50176
v_cvt_pk_bf16_f32 v72, v72, v73
v_mfma_f32_16x16x32_bf16 v[136:139], a[168:171], v[20:23], v[136:139]
v_exp_f32 v49, v49
v_mfma_f32_16x16x32_bf16 v[168:171], a[168:171], v[24:27], v[168:171]
ds_read_b128 a[208:211], v1 offset:53248
v_cvt_pk_bf16_f32 v54, v48, v49
v_mfma_f32_16x16x32_bf16 v[200:203], a[168:171], v[36:39], v[200:203]
v_exp_f32 v50, v50
v_mfma_f32_16x16x32_bf16 v[232:235], a[168:171], v[40:43], v[232:235]
ds_read_b128 a[212:215], v2 offset:53248
v_cvt_pk_bf16_f32 v73, v74, v75
v_mfma_f32_16x16x32_bf16 v[152:155], a[172:175], v[20:23], v[152:155]
v_exp_f32 v51, v51
v_mfma_f32_16x16x32_bf16 v[184:187], a[172:175], v[24:27], v[184:187]
buffer_load_dwordx4 a[144:147], v12, s[4:7], s77 offen offset:0 nt
v_mfma_f32_16x16x32_bf16 v[216:219], a[172:175], v[36:39], v[216:219]
buffer_load_dwordx4 a[148:151], v12, s[4:7], s77 offen offset:64 nt
v_mfma_f32_16x16x32_bf16 v[248:251], a[172:175], v[40:43], v[248:251]
ds_read_b128 a[216:219], v1 offset:54272
v_cvt_pk_bf16_f32 v55, v50, v51
v_smfmac_f32_16x16x64_bf16 a[248:251], a[240:243], v[36:43], v110
ds_read_b128 a[220:223], v2 offset:54272
v_mul_f32 v116, s26, v116
v_mfma_f32_16x16x32_bf16 v[140:143], a[176:179], v[20:23], v[140:143]
v_exp_f32 v60, v60
v_mfma_f32_16x16x32_bf16 v[172:175], a[176:179], v[24:27], v[172:175]
ds_read_b128 a[232:235], v3 offset:49152
v_mul_f32 v117, s26, v117
v_mfma_f32_16x16x32_bf16 v[204:207], a[176:179], v[36:39], v[204:207]
v_exp_f32 v61, v61
v_mfma_f32_16x16x32_bf16 v[236:239], a[176:179], v[40:43], v[236:239]
ds_read_b128 a[236:239], v4 offset:49152
v_cvt_pk_bf16_f32 v58, v60, v61
v_mfma_f32_16x16x32_bf16 v[156:159], a[180:183], v[20:23], v[156:159]
v_exp_f32 v62, v62
v_mfma_f32_16x16x32_bf16 v[188:191], a[180:183], v[24:27], v[188:191]
ds_read_b64_tr_b16 a[160:161], v6 offset:49152
v_mul_f32 v118, s26, v118
v_mfma_f32_16x16x32_bf16 v[220:223], a[180:183], v[36:39], v[220:223]
v_exp_f32 v63, v63
v_mfma_f32_16x16x32_bf16 v[252:255], a[180:183], v[40:43], v[252:255]
buffer_load_dwordx4 v11, s[12:15], s37 offen offset:2048 nt lds
v_mfma_f32_16x16x32_bf16 v[128:131], a[184:187], v[20:23], v[128:131]
ds_read_b64_tr_b16 a[162:163], v6 offset:53248
v_cvt_pk_bf16_f32 v59, v62, v63
v_mfma_f32_16x16x32_bf16 v[160:163], a[184:187], v[24:27], v[160:163]
v_exp_f32 v64, v64
v_mfma_f32_16x16x32_bf16 v[192:195], a[184:187], v[36:39], v[192:195]
ds_read_b64_tr_b16 a[164:165], v6 offset:50176
v_mul_f32 v119, s26, v119
v_mfma_f32_16x16x32_bf16 v[224:227], a[184:187], v[40:43], v[224:227]
v_exp_f32 v65, v65
s_waitcnt lgkmcnt(4)
v_mfma_f32_16x16x32_bf16 v[88:91], a[184:187], a[224:227], v[88:91]
ds_read_b64_tr_b16 a[166:167], v6 offset:54272
v_cvt_pk_bf16_f32 v70, v64, v65
v_mfma_f32_16x16x32_bf16 v[96:99], a[184:187], a[228:231], v[96:99]
v_exp_f32 v66, v66
v_smfmac_f32_16x16x64_bf16 a[252:255], a[240:243], a[224:231], v110
ds_read_b64_tr_b16 a[168:169], v7 offset:49152
v_cvt_pk_bf16_f32 v112, v112, v113
v_mfma_f32_16x16x32_bf16 v[144:147], a[188:191], v[20:23], v[144:147]
v_exp_f32 v67, v67
v_mfma_f32_16x16x32_bf16 v[176:179], a[188:191], v[24:27], v[176:179]
ds_read_b64_tr_b16 a[170:171], v7 offset:53248
v_cvt_pk_bf16_f32 v71, v66, v67
v_mfma_f32_16x16x32_bf16 v[208:211], a[188:191], v[36:39], v[208:211]
v_exp_f32 v76, v76
v_mfma_f32_16x16x32_bf16 v[240:243], a[188:191], v[40:43], v[240:243]
ds_read_b64_tr_b16 a[172:173], v7 offset:50176
v_cvt_pk_bf16_f32 v114, v114, v115
v_mfma_f32_16x16x32_bf16 v[92:95], a[188:191], a[224:227], v[92:95]
v_exp_f32 v77, v77
v_mfma_f32_16x16x32_bf16 v[100:103], a[188:191], a[228:231], v[100:103]
ds_read_b128 a[224:227], v3 offset:50176
v_cvt_pk_bf16_f32 v74, v76, v77
v_mfma_f32_16x16x32_bf16 v[20:23], a[192:195], a[0:3], 0
v_exp_f32 v78, v78
v_mfma_f32_16x16x32_bf16 v[24:27], a[192:195], a[16:19], 0
ds_read_b128 a[228:231], v4 offset:50176
v_cvt_pk_bf16_f32 v116, v116, v117
v_mfma_f32_16x16x32_bf16 v[36:39], a[192:195], a[32:35], 0
v_exp_f32 v79, v79
v_mfma_f32_16x16x32_bf16 v[40:43], a[192:195], a[48:51], 0
ds_read_b64_tr_b16 a[174:175], v7 offset:54272
v_cvt_pk_bf16_f32 v75, v78, v79
v_mfma_f32_16x16x32_bf16 v[20:23], a[196:199], a[4:7], v[20:23]
s_add_u32 m0, s30, 0x4000
s_add_u32 s21, s21, 0x2000
v_cvt_pk_bf16_f32 v118, v118, v119
v_mfma_f32_16x16x32_bf16 v[24:27], a[196:199], a[20:23], v[24:27]
buffer_load_dwordx4 v11, s[8:11], s21 offen nt lds
v_mfma_f32_16x16x32_bf16 v[36:39], a[196:199], a[36:39], v[36:39]
ds_read_b64_tr_b16 a[176:177], v8 offset:49152
v_accvgpr_write_b32 a120, v112
v_mfma_f32_16x16x32_bf16 v[40:43], a[196:199], a[52:55], v[40:43]
v_accvgpr_write_b32 a121, v114
v_accvgpr_write_b32 a122, v116
v_mfma_f32_16x16x32_bf16 v[20:23], a[200:203], a[8:11], v[20:23]
ds_read_b64_tr_b16 a[178:179], v8 offset:53248
v_accvgpr_write_b32 a123, v118
v_mfma_f32_16x16x32_bf16 v[24:27], a[200:203], a[24:27], v[24:27]
v_accvgpr_read_b32 v113, a124
v_accvgpr_read_b32 v115, a125
v_mfma_f32_16x16x32_bf16 v[36:39], a[200:203], a[40:43], v[36:39]
ds_read_b64_tr_b16 a[180:181], v8 offset:50176
v_accvgpr_read_b32 v117, a126
v_mfma_f32_16x16x32_bf16 v[40:43], a[200:203], a[56:59], v[40:43]
v_accvgpr_read_b32 v119, a127
v_lshlrev_b32 v112, 16, v113
v_mfma_f32_16x16x32_bf16 v[20:23], a[204:207], a[12:15], v[20:23]
ds_read_b64_tr_b16 a[182:183], v8 offset:54272
v_lshlrev_b32 v114, 16, v115
v_mfma_f32_16x16x32_bf16 v[24:27], a[204:207], a[28:31], v[24:27]
v_lshlrev_b32 v116, 16, v117
v_lshlrev_b32 v118, 16, v119
v_mfma_f32_16x16x32_bf16 v[36:39], a[204:207], a[44:47], v[36:39]
s_waitcnt lgkmcnt(4)
ds_read_b64_tr_b16 a[184:185], v5 offset:49152
v_and_b32 v113, s25, v113
v_mfma_f32_16x16x32_bf16 v[40:43], a[204:207], a[60:63], v[40:43]
v_exp_f32 v20, v20
v_mfma_f32_16x16x32_bf16 v[16:19], a[208:211], a[0:3], 0
ds_read_b64_tr_b16 a[186:187], v5 offset:53248
v_and_b32 v115, s25, v115
v_mfma_f32_16x16x32_bf16 v[28:31], a[208:211], a[16:19], 0
v_exp_f32 v21, v21
v_mfma_f32_16x16x32_bf16 v[32:35], a[208:211], a[32:35], 0
ds_read_b64_tr_b16 a[188:189], v5 offset:50176
v_cvt_pk_bf16_f32 v20, v20, v21
v_mfma_f32_16x16x32_bf16 v[44:47], a[208:211], a[48:51], 0
v_exp_f32 v22, v22
v_mfma_f32_16x16x32_bf16 v[16:19], a[212:215], a[4:7], v[16:19]
ds_read_b64_tr_b16 a[190:191], v5 offset:54272
v_and_b32 v117, s25, v117
v_mfma_f32_16x16x32_bf16 v[28:31], a[212:215], a[20:23], v[28:31]
v_exp_f32 v23, v23
v_mfma_f32_16x16x32_bf16 v[32:35], a[212:215], a[36:39], v[32:35]
ds_read_b128 a[192:195], v1 offset:57344
v_cvt_pk_bf16_f32 v21, v22, v23
v_mfma_f32_16x16x32_bf16 v[44:47], a[212:215], a[52:55], v[44:47]
v_exp_f32 v24, v24
v_mfma_f32_16x16x32_bf16 v[16:19], a[216:219], a[8:11], v[16:19]
buffer_load_dwordx4 v11, s[8:11], s21 offen offset:2048 nt lds
v_mfma_f32_16x16x32_bf16 v[28:31], a[216:219], a[24:27], v[28:31]
ds_read_b128 a[196:199], v2 offset:57344
v_and_b32 v119, s25, v119
v_mfma_f32_16x16x32_bf16 v[32:35], a[216:219], a[40:43], v[32:35]
v_exp_f32 v25, v25
v_mfma_f32_16x16x32_bf16 v[44:47], a[216:219], a[56:59], v[44:47]
ds_read_b128 a[200:203], v1 offset:58368
v_cvt_pk_bf16_f32 v24, v24, v25
v_mfma_f32_16x16x32_bf16 v[16:19], a[220:223], a[12:15], v[16:19]
v_exp_f32 v26, v26
v_mfma_f32_16x16x32_bf16 v[28:31], a[220:223], a[28:31], v[28:31]
ds_read_b128 a[204:207], v2 offset:58368
v_mul_f32 v112, s26, v112
v_mfma_f32_16x16x32_bf16 v[32:35], a[220:223], a[44:47], v[32:35]
v_exp_f32 v27, v27
v_mfma_f32_16x16x32_bf16 v[44:47], a[220:223], a[60:63], v[44:47]
ds_read_b128 a[208:211], v1 offset:61440
v_cvt_pk_bf16_f32 v25, v26, v27
v_mfma_f32_16x16x32_bf16 v[80:83], a[232:235], a[64:67], 0
v_exp_f32 v36, v36
v_mfma_f32_16x16x32_bf16 v[84:87], a[232:235], a[80:83], 0
ds_read_b128 a[232:235], v10 offset:6144
v_mul_f32 v113, s26, v113
v_mfma_f32_16x16x32_bf16 v[80:83], a[236:239], a[68:71], v[80:83]
v_exp_f32 v37, v37
v_mfma_f32_16x16x32_bf16 v[84:87], a[236:239], a[84:87], v[84:87]
ds_read_b128 a[236:239], v10 offset:7168
v_cvt_pk_bf16_f32 v36, v36, v37
v_mfma_f32_16x16x32_bf16 v[80:83], a[224:227], a[72:75], v[80:83]
v_exp_f32 v38, v38
v_mfma_f32_16x16x32_bf16 v[84:87], a[224:227], a[88:91], v[84:87]
s_waitcnt lgkmcnt(5)
ds_read_b128 a[212:215], v2 offset:61440
v_mul_f32 v114, s26, v114
v_mfma_f32_16x16x32_bf16 v[80:83], a[228:231], a[76:79], v[80:83]
v_exp_f32 v39, v39
v_mfma_f32_16x16x32_bf16 v[84:87], a[228:231], a[92:95], v[84:87]
ds_read_b128 a[216:219], v1 offset:62464
v_cvt_pk_bf16_f32 v37, v38, v39
v_mfma_f32_16x16x32_bf16 v[132:135], a[160:163], v[52:55], v[132:135]
v_exp_f32 v40, v40
v_mfma_f32_16x16x32_bf16 v[164:167], a[160:163], v[56:59], v[164:167]
ds_read_b128 a[220:223], v2 offset:62464
v_mul_f32 v115, s26, v115
v_mfma_f32_16x16x32_bf16 v[196:199], a[160:163], v[68:71], v[196:199]
s_add_u32 m0, s30, 0x16000
s_add_u32 s37, s37, 0x2000
v_exp_f32 v80, v80
v_mfma_f32_16x16x32_bf16 v[228:231], a[160:163], v[72:75], v[228:231]
buffer_load_dwordx4 v11, s[12:15], s37 offen nt lds
v_mfma_f32_16x16x32_bf16 v[148:151], a[164:167], v[52:55], v[148:151]
ds_read_b64_tr_b16 a[160:161], v6 offset:57344
v_mul_f32 v116, s26, v116
v_mfma_f32_16x16x32_bf16 v[180:183], a[164:167], v[56:59], v[180:183]
v_exp_f32 v81, v81
v_mfma_f32_16x16x32_bf16 v[212:215], a[164:167], v[68:71], v[212:215]
ds_read_b64_tr_b16 a[162:163], v6 offset:61440
v_cvt_pk_bf16_f32 v80, v80, v81
v_mfma_f32_16x16x32_bf16 v[244:247], a[164:167], v[72:75], v[244:247]
v_exp_f32 v82, v82
v_smfmac_f32_16x16x64_bf16 a[244:247], a[240:243], v[52:59], v110
ds_read_b64_tr_b16 a[164:165], v6 offset:58368
v_mul_f32 v117, s26, v117
v_mfma_f32_16x16x32_bf16 v[136:139], a[168:171], v[52:55], v[136:139]
v_exp_f32 v83, v83
v_mfma_f32_16x16x32_bf16 v[168:171], a[168:171], v[56:59], v[168:171]
ds_read_b64_tr_b16 a[166:167], v6 offset:62464
v_cvt_pk_bf16_f32 v81, v82, v83
v_mfma_f32_16x16x32_bf16 v[200:203], a[168:171], v[68:71], v[200:203]
ds_write_b64 v9, v[80:81] offset:0
v_mul_f32 v118, s26, v118
v_mfma_f32_16x16x32_bf16 v[232:235], a[168:171], v[72:75], v[232:235]
ds_read_b64_tr_b16 a[168:169], v7 offset:57344
v_mul_f32 v119, s26, v119
v_mfma_f32_16x16x32_bf16 v[152:155], a[172:175], v[52:55], v[152:155]
v_exp_f32 v84, v84
v_mfma_f32_16x16x32_bf16 v[184:187], a[172:175], v[56:59], v[184:187]
ds_read_b64_tr_b16 a[170:171], v7 offset:61440
v_cvt_pk_bf16_f32 v112, v112, v113
v_mfma_f32_16x16x32_bf16 v[216:219], a[172:175], v[68:71], v[216:219]
v_exp_f32 v85, v85
v_mfma_f32_16x16x32_bf16 v[248:251], a[172:175], v[72:75], v[248:251]
s_waitcnt lgkmcnt(5)
ds_read_b64_tr_b16 a[172:173], v7 offset:58368
v_cvt_pk_bf16_f32 v84, v84, v85
v_smfmac_f32_16x16x64_bf16 a[248:251], a[240:243], v[68:75], v110
ds_read_b64_tr_b16 a[174:175], v7 offset:62464
v_cvt_pk_bf16_f32 v114, v114, v115
v_mfma_f32_16x16x32_bf16 v[140:143], a[176:179], v[52:55], v[140:143]
v_exp_f32 v86, v86
v_mfma_f32_16x16x32_bf16 v[172:175], a[176:179], v[56:59], v[172:175]
v_exp_f32 v87, v87
v_mfma_f32_16x16x32_bf16 v[204:207], a[176:179], v[68:71], v[204:207]
v_exp_f32 v41, v41
v_mfma_f32_16x16x32_bf16 v[236:239], a[176:179], v[72:75], v[236:239]
ds_read_b64_tr_b16 a[176:177], v8 offset:57344
v_cvt_pk_bf16_f32 v85, v86, v87
v_mfma_f32_16x16x32_bf16 v[156:159], a[180:183], v[52:55], v[156:159]
buffer_load_dwordx4 v11, s[12:15], s37 offen offset:2048 nt lds
v_mfma_f32_16x16x32_bf16 v[188:191], a[180:183], v[56:59], v[188:191]
ds_read_b64_tr_b16 a[178:179], v8 offset:61440
v_cvt_pk_bf16_f32 v40, v40, v41
v_mfma_f32_16x16x32_bf16 v[220:223], a[180:183], v[68:71], v[220:223]
ds_write_b64 v9, v[84:85] offset:1024
v_cvt_pk_bf16_f32 v116, v116, v117
v_mfma_f32_16x16x32_bf16 v[252:255], a[180:183], v[72:75], v[252:255]
ds_read_b64_tr_b16 a[180:181], v8 offset:58368
v_cvt_pk_bf16_f32 v118, v118, v119
v_mfma_f32_16x16x32_bf16 v[128:131], a[184:187], v[52:55], v[128:131]
v_exp_f32 v42, v42
v_mfma_f32_16x16x32_bf16 v[160:163], a[184:187], v[56:59], v[160:163]
ds_read_b64_tr_b16 a[182:183], v8 offset:62464
v_accvgpr_write_b32 a124, v112
v_mfma_f32_16x16x32_bf16 v[192:195], a[184:187], v[68:71], v[192:195]
v_exp_f32 v43, v43
v_mfma_f32_16x16x32_bf16 v[224:227], a[184:187], v[72:75], v[224:227]
v_exp_f32 v16, v16
v_mfma_f32_16x16x32_bf16 v[88:91], a[184:187], a[232:235], v[88:91]
v_exp_f32 v17, v17
v_mfma_f32_16x16x32_bf16 v[96:99], a[184:187], a[236:239], v[96:99]
ds_read_b64_tr_b16 a[184:185], v5 offset:57344
v_cvt_pk_bf16_f32 v22, v16, v17
v_smfmac_f32_16x16x64_bf16 a[252:255], a[240:243], a[232:239], v110
ds_read_b64_tr_b16 a[186:187], v5 offset:61440
v_cvt_pk_bf16_f32 v41, v42, v43
v_mfma_f32_16x16x32_bf16 v[144:147], a[188:191], v[52:55], v[144:147]
v_exp_f32 v18, v18
v_mfma_f32_16x16x32_bf16 v[176:179], a[188:191], v[56:59], v[176:179]
v_exp_f32 v19, v19
v_mfma_f32_16x16x32_bf16 v[208:211], a[188:191], v[68:71], v[208:211]
v_exp_f32 v28, v28
v_mfma_f32_16x16x32_bf16 v[240:243], a[188:191], v[72:75], v[240:243]
v_exp_f32 v29, v29
v_mfma_f32_16x16x32_bf16 v[92:95], a[188:191], a[232:235], v[92:95]
v_exp_f32 v30, v30
v_mfma_f32_16x16x32_bf16 v[100:103], a[188:191], a[236:239], v[100:103]
ds_read_b64_tr_b16 a[188:189], v5 offset:58368
v_cvt_pk_bf16_f32 v23, v18, v19
v_mfma_f32_16x16x32_bf16 v[52:55], a[192:195], a[0:3], 0
v_exp_f32 v31, v31
v_mfma_f32_16x16x32_bf16 v[56:59], a[192:195], a[16:19], 0
s_add_u32 m0, s30, 0x6000
s_add_u32 s21, s21, 0x2000
s_waitcnt lgkmcnt(3)
ds_read_b64_tr_b16 a[190:191], v5 offset:62464
v_cvt_pk_bf16_f32 v26, v28, v29
v_mfma_f32_16x16x32_bf16 v[68:71], a[192:195], a[32:35], 0
buffer_load_dwordx4 v11, s[8:11], s21 offen nt lds
v_mfma_f32_16x16x32_bf16 v[72:75], a[192:195], a[48:51], 0
v_exp_f32 v32, v32
v_mfma_f32_16x16x32_bf16 v[52:55], a[196:199], a[4:7], v[52:55]
v_exp_f32 v33, v33
v_mfma_f32_16x16x32_bf16 v[56:59], a[196:199], a[20:23], v[56:59]
v_exp_f32 v34, v34
v_mfma_f32_16x16x32_bf16 v[68:71], a[196:199], a[36:39], v[68:71]
v_exp_f32 v35, v35
v_mfma_f32_16x16x32_bf16 v[72:75], a[196:199], a[52:55], v[72:75]
v_exp_f32 v44, v44
v_mfma_f32_16x16x32_bf16 v[52:55], a[200:203], a[8:11], v[52:55]
v_exp_f32 v45, v45
v_mfma_f32_16x16x32_bf16 v[56:59], a[200:203], a[24:27], v[56:59]
v_exp_f32 v46, v46
v_mfma_f32_16x16x32_bf16 v[68:71], a[200:203], a[40:43], v[68:71]
v_exp_f32 v47, v47
v_mfma_f32_16x16x32_bf16 v[72:75], a[200:203], a[56:59], v[72:75]
v_cvt_pk_bf16_f32 v27, v30, v31
v_cvt_pk_bf16_f32 v38, v32, v33
v_mfma_f32_16x16x32_bf16 v[52:55], a[204:207], a[12:15], v[52:55]
v_cvt_pk_bf16_f32 v39, v34, v35
v_cvt_pk_bf16_f32 v42, v44, v45
v_mfma_f32_16x16x32_bf16 v[56:59], a[204:207], a[28:31], v[56:59]
v_cvt_pk_bf16_f32 v43, v46, v47
v_accvgpr_write_b32 a125, v114
v_mfma_f32_16x16x32_bf16 v[68:71], a[204:207], a[44:47], v[68:71]
v_accvgpr_write_b32 a126, v116
v_accvgpr_write_b32 a127, v118
v_mfma_f32_16x16x32_bf16 v[72:75], a[204:207], a[60:63], v[72:75]
v_exp_f32 v52, v52
v_mfma_f32_16x16x32_bf16 v[48:51], a[208:211], a[0:3], 0
v_exp_f32 v53, v53
v_mfma_f32_16x16x32_bf16 v[60:63], a[208:211], a[16:19], 0
v_exp_f32 v54, v54
v_mfma_f32_16x16x32_bf16 v[64:67], a[208:211], a[32:35], 0
v_exp_f32 v55, v55
v_mfma_f32_16x16x32_bf16 v[76:79], a[208:211], a[48:51], 0
v_exp_f32 v56, v56
v_mfma_f32_16x16x32_bf16 v[48:51], a[212:215], a[4:7], v[48:51]
buffer_load_dwordx4 v11, s[8:11], s21 offen offset:2048 nt lds
v_mfma_f32_16x16x32_bf16 v[60:63], a[212:215], a[20:23], v[60:63]
v_exp_f32 v57, v57
v_mfma_f32_16x16x32_bf16 v[64:67], a[212:215], a[36:39], v[64:67]
v_exp_f32 v58, v58
v_mfma_f32_16x16x32_bf16 v[76:79], a[212:215], a[52:55], v[76:79]
v_exp_f32 v59, v59
v_mfma_f32_16x16x32_bf16 v[48:51], a[216:219], a[8:11], v[48:51]
v_exp_f32 v68, v68
v_mfma_f32_16x16x32_bf16 v[60:63], a[216:219], a[24:27], v[60:63]
v_exp_f32 v69, v69
v_mfma_f32_16x16x32_bf16 v[64:67], a[216:219], a[40:43], v[64:67]
v_exp_f32 v70, v70
v_mfma_f32_16x16x32_bf16 v[76:79], a[216:219], a[56:59], v[76:79]
v_exp_f32 v71, v71
v_mfma_f32_16x16x32_bf16 v[48:51], a[220:223], a[12:15], v[48:51]
v_cvt_pk_bf16_f32 v52, v52, v53
v_cvt_pk_bf16_f32 v53, v54, v55
v_mfma_f32_16x16x32_bf16 v[60:63], a[220:223], a[28:31], v[60:63]
v_exp_f32 v72, v72
v_mfma_f32_16x16x32_bf16 v[64:67], a[220:223], a[44:47], v[64:67]
v_exp_f32 v73, v73
v_mfma_f32_16x16x32_bf16 v[76:79], a[220:223], a[60:63], v[76:79]
s_waitcnt vmcnt(10) lgkmcnt(0)
s_barrier
ds_read_b128 a[224:227], v10 offset:0
v_mfma_f32_16x16x32_bf16 v[132:135], a[160:163], v[20:23], v[132:135]
v_exp_f32 v74, v74
v_mfma_f32_16x16x32_bf16 v[164:167], a[160:163], v[24:27], v[164:167]
ds_read_b128 a[228:231], v10 offset:1024
v_cvt_pk_bf16_f32 v56, v56, v57
v_mfma_f32_16x16x32_bf16 v[196:199], a[160:163], v[36:39], v[196:199]
v_exp_f32 v75, v75
v_mfma_f32_16x16x32_bf16 v[228:231], a[160:163], v[40:43], v[228:231]
ds_read_b128 a[192:195], v1 offset:0
v_cvt_pk_bf16_f32 v57, v58, v59
v_mfma_f32_16x16x32_bf16 v[148:151], a[164:167], v[20:23], v[148:151]
v_exp_f32 v48, v48
v_mfma_f32_16x16x32_bf16 v[180:183], a[164:167], v[24:27], v[180:183]
s_add_u32 m0, s30, 0x18000
s_add_u32 s37, s37, 0x2000
ds_read_b128 a[196:199], v2 offset:0
v_cvt_pk_bf16_f32 v68, v68, v69
v_mfma_f32_16x16x32_bf16 v[212:215], a[164:167], v[36:39], v[212:215]
buffer_load_dwordx4 v11, s[12:15], s37 offen nt lds
v_mfma_f32_16x16x32_bf16 v[244:247], a[164:167], v[40:43], v[244:247]
ds_read_b128 a[200:203], v1 offset:1024
v_cvt_pk_bf16_f32 v69, v70, v71
v_smfmac_f32_16x16x64_bf16 a[244:247], a[240:243], v[20:27], v110
ds_read_b128 a[204:207], v2 offset:1024
v_cvt_pk_bf16_f32 v72, v72, v73
v_mfma_f32_16x16x32_bf16 v[136:139], a[168:171], v[20:23], v[136:139]
v_exp_f32 v49, v49
v_mfma_f32_16x16x32_bf16 v[168:171], a[168:171], v[24:27], v[168:171]
ds_read_b128 a[208:211], v1 offset:4096
v_cvt_pk_bf16_f32 v54, v48, v49
v_mfma_f32_16x16x32_bf16 v[200:203], a[168:171], v[36:39], v[200:203]
v_exp_f32 v50, v50
v_mfma_f32_16x16x32_bf16 v[232:235], a[168:171], v[40:43], v[232:235]
ds_read_b128 a[212:215], v2 offset:4096
v_cvt_pk_bf16_f32 v73, v74, v75
v_mfma_f32_16x16x32_bf16 v[152:155], a[172:175], v[20:23], v[152:155]
v_exp_f32 v51, v51
v_mfma_f32_16x16x32_bf16 v[184:187], a[172:175], v[24:27], v[184:187]
buffer_load_dwordx4 a[152:155], v12, s[4:7], s77 offen offset:128 nt
v_mfma_f32_16x16x32_bf16 v[216:219], a[172:175], v[36:39], v[216:219]
buffer_load_dwordx4 a[156:159], v12, s[4:7], s77 offen offset:192 nt
v_mfma_f32_16x16x32_bf16 v[248:251], a[172:175], v[40:43], v[248:251]
ds_read_b128 a[216:219], v1 offset:5120
v_cvt_pk_bf16_f32 v55, v50, v51
v_smfmac_f32_16x16x64_bf16 a[248:251], a[240:243], v[36:43], v110
ds_read_b128 a[220:223], v2 offset:5120
v_accvgpr_read_b32 v113, a128
v_mfma_f32_16x16x32_bf16 v[140:143], a[176:179], v[20:23], v[140:143]
v_exp_f32 v60, v60
v_mfma_f32_16x16x32_bf16 v[172:175], a[176:179], v[24:27], v[172:175]
ds_read_b128 a[232:235], v3 offset:0
v_accvgpr_read_b32 v115, a129
v_mfma_f32_16x16x32_bf16 v[204:207], a[176:179], v[36:39], v[204:207]
v_exp_f32 v61, v61
v_mfma_f32_16x16x32_bf16 v[236:239], a[176:179], v[40:43], v[236:239]
ds_read_b128 a[236:239], v4 offset:0
v_cvt_pk_bf16_f32 v58, v60, v61
v_mfma_f32_16x16x32_bf16 v[156:159], a[180:183], v[20:23], v[156:159]
v_exp_f32 v62, v62
v_mfma_f32_16x16x32_bf16 v[188:191], a[180:183], v[24:27], v[188:191]
ds_read_b64_tr_b16 a[160:161], v6 offset:0
v_accvgpr_read_b32 v117, a130
v_mfma_f32_16x16x32_bf16 v[220:223], a[180:183], v[36:39], v[220:223]
v_exp_f32 v63, v63
v_mfma_f32_16x16x32_bf16 v[252:255], a[180:183], v[40:43], v[252:255]
buffer_load_dwordx4 v11, s[12:15], s37 offen offset:2048 nt lds
v_mfma_f32_16x16x32_bf16 v[128:131], a[184:187], v[20:23], v[128:131]
ds_read_b64_tr_b16 a[162:163], v6 offset:4096
v_cvt_pk_bf16_f32 v59, v62, v63
v_mfma_f32_16x16x32_bf16 v[160:163], a[184:187], v[24:27], v[160:163]
v_exp_f32 v64, v64
v_mfma_f32_16x16x32_bf16 v[192:195], a[184:187], v[36:39], v[192:195]
ds_read_b64_tr_b16 a[164:165], v6 offset:1024
v_accvgpr_read_b32 v119, a131
v_mfma_f32_16x16x32_bf16 v[224:227], a[184:187], v[40:43], v[224:227]
v_exp_f32 v65, v65
s_waitcnt lgkmcnt(4)
v_mfma_f32_16x16x32_bf16 v[88:91], a[184:187], a[224:227], v[88:91]
ds_read_b64_tr_b16 a[166:167], v6 offset:5120
v_cvt_pk_bf16_f32 v70, v64, v65
v_mfma_f32_16x16x32_bf16 v[96:99], a[184:187], a[228:231], v[96:99]
v_exp_f32 v66, v66
v_smfmac_f32_16x16x64_bf16 a[252:255], a[240:243], a[224:231], v110
ds_read_b64_tr_b16 a[168:169], v7 offset:0
v_lshlrev_b32 v112, 16, v113
v_mfma_f32_16x16x32_bf16 v[144:147], a[188:191], v[20:23], v[144:147]
v_exp_f32 v67, v67
v_mfma_f32_16x16x32_bf16 v[176:179], a[188:191], v[24:27], v[176:179]
ds_read_b64_tr_b16 a[170:171], v7 offset:4096
v_cvt_pk_bf16_f32 v71, v66, v67
v_mfma_f32_16x16x32_bf16 v[208:211], a[188:191], v[36:39], v[208:211]
v_exp_f32 v76, v76
v_mfma_f32_16x16x32_bf16 v[240:243], a[188:191], v[40:43], v[240:243]
ds_read_b64_tr_b16 a[172:173], v7 offset:1024
v_lshlrev_b32 v114, 16, v115
v_mfma_f32_16x16x32_bf16 v[92:95], a[188:191], a[224:227], v[92:95]
v_exp_f32 v77, v77
v_mfma_f32_16x16x32_bf16 v[100:103], a[188:191], a[228:231], v[100:103]
ds_read_b128 a[224:227], v3 offset:1024
v_cvt_pk_bf16_f32 v74, v76, v77
v_mfma_f32_16x16x32_bf16 v[20:23], a[192:195], a[0:3], 0
v_exp_f32 v78, v78
v_mfma_f32_16x16x32_bf16 v[24:27], a[192:195], a[16:19], 0
ds_read_b128 a[228:231], v4 offset:1024
v_lshlrev_b32 v116, 16, v117
v_mfma_f32_16x16x32_bf16 v[36:39], a[192:195], a[32:35], 0
v_exp_f32 v79, v79
v_mfma_f32_16x16x32_bf16 v[40:43], a[192:195], a[48:51], 0
ds_read_b64_tr_b16 a[174:175], v7 offset:5120
v_cvt_pk_bf16_f32 v75, v78, v79
v_mfma_f32_16x16x32_bf16 v[20:23], a[196:199], a[4:7], v[20:23]
s_add_u32 m0, s30, 0x8000
s_add_u32 s21, s21, 0x2000
v_lshlrev_b32 v118, 16, v119
v_mfma_f32_16x16x32_bf16 v[24:27], a[196:199], a[20:23], v[24:27]
buffer_load_dwordx4 v11, s[8:11], s21 offen nt lds
v_mfma_f32_16x16x32_bf16 v[36:39], a[196:199], a[36:39], v[36:39]
ds_read_b64_tr_b16 a[176:177], v8 offset:0
v_and_b32 v113, s25, v113
v_mfma_f32_16x16x32_bf16 v[40:43], a[196:199], a[52:55], v[40:43]
v_and_b32 v115, s25, v115
v_and_b32 v117, s25, v117
v_mfma_f32_16x16x32_bf16 v[20:23], a[200:203], a[8:11], v[20:23]
ds_read_b64_tr_b16 a[178:179], v8 offset:4096
v_and_b32 v119, s25, v119
v_mfma_f32_16x16x32_bf16 v[24:27], a[200:203], a[24:27], v[24:27]
v_mul_f32 v112, s26, v112
v_mul_f32 v113, s26, v113
v_mfma_f32_16x16x32_bf16 v[36:39], a[200:203], a[40:43], v[36:39]
ds_read_b64_tr_b16 a[180:181], v8 offset:1024
v_mul_f32 v114, s26, v114
v_mfma_f32_16x16x32_bf16 v[40:43], a[200:203], a[56:59], v[40:43]
v_mul_f32 v115, s26, v115
v_mul_f32 v116, s26, v116
v_mfma_f32_16x16x32_bf16 v[20:23], a[204:207], a[12:15], v[20:23]
ds_read_b64_tr_b16 a[182:183], v8 offset:5120
v_mul_f32 v117, s26, v117
v_mfma_f32_16x16x32_bf16 v[24:27], a[204:207], a[28:31], v[24:27]
v_mul_f32 v118, s26, v118
v_mul_f32 v119, s26, v119
v_mfma_f32_16x16x32_bf16 v[36:39], a[204:207], a[44:47], v[36:39]
s_waitcnt lgkmcnt(4)
ds_read_b64_tr_b16 a[184:185], v5 offset:0
v_cvt_pk_bf16_f32 v112, v112, v113
v_mfma_f32_16x16x32_bf16 v[40:43], a[204:207], a[60:63], v[40:43]
v_exp_f32 v20, v20
v_mfma_f32_16x16x32_bf16 v[16:19], a[208:211], a[0:3], 0
ds_read_b64_tr_b16 a[186:187], v5 offset:4096
v_cvt_pk_bf16_f32 v114, v114, v115
v_mfma_f32_16x16x32_bf16 v[28:31], a[208:211], a[16:19], 0
v_exp_f32 v21, v21
v_mfma_f32_16x16x32_bf16 v[32:35], a[208:211], a[32:35], 0
ds_read_b64_tr_b16 a[188:189], v5 offset:1024
v_cvt_pk_bf16_f32 v20, v20, v21
v_mfma_f32_16x16x32_bf16 v[44:47], a[208:211], a[48:51], 0
v_exp_f32 v22, v22
v_mfma_f32_16x16x32_bf16 v[16:19], a[212:215], a[4:7], v[16:19]
ds_read_b64_tr_b16 a[190:191], v5 offset:5120
v_cvt_pk_bf16_f32 v116, v116, v117
v_mfma_f32_16x16x32_bf16 v[28:31], a[212:215], a[20:23], v[28:31]
v_exp_f32 v23, v23
v_mfma_f32_16x16x32_bf16 v[32:35], a[212:215], a[36:39], v[32:35]
ds_read_b128 a[192:195], v1 offset:8192
v_cvt_pk_bf16_f32 v21, v22, v23
v_mfma_f32_16x16x32_bf16 v[44:47], a[212:215], a[52:55], v[44:47]
v_exp_f32 v24, v24
v_mfma_f32_16x16x32_bf16 v[16:19], a[216:219], a[8:11], v[16:19]
buffer_load_dwordx4 v11, s[8:11], s21 offen offset:2048 nt lds
v_mfma_f32_16x16x32_bf16 v[28:31], a[216:219], a[24:27], v[28:31]
ds_read_b128 a[196:199], v2 offset:8192
v_cvt_pk_bf16_f32 v118, v118, v119
v_mfma_f32_16x16x32_bf16 v[32:35], a[216:219], a[40:43], v[32:35]
v_exp_f32 v25, v25
v_mfma_f32_16x16x32_bf16 v[44:47], a[216:219], a[56:59], v[44:47]
ds_read_b128 a[200:203], v1 offset:9216
v_cvt_pk_bf16_f32 v24, v24, v25
v_mfma_f32_16x16x32_bf16 v[16:19], a[220:223], a[12:15], v[16:19]
v_exp_f32 v26, v26
v_mfma_f32_16x16x32_bf16 v[28:31], a[220:223], a[28:31], v[28:31]
ds_read_b128 a[204:207], v2 offset:9216
v_accvgpr_write_b32 a128, v112
v_mfma_f32_16x16x32_bf16 v[32:35], a[220:223], a[44:47], v[32:35]
v_exp_f32 v27, v27
v_mfma_f32_16x16x32_bf16 v[44:47], a[220:223], a[60:63], v[44:47]
ds_read_b128 a[208:211], v1 offset:12288
v_cvt_pk_bf16_f32 v25, v26, v27
v_mfma_f32_16x16x32_bf16 v[80:83], a[232:235], a[64:67], 0
v_exp_f32 v36, v36
v_mfma_f32_16x16x32_bf16 v[84:87], a[232:235], a[80:83], 0
ds_read_b128 a[232:235], v10 offset:2048
v_accvgpr_write_b32 a129, v114
v_mfma_f32_16x16x32_bf16 v[80:83], a[236:239], a[68:71], v[80:83]
v_exp_f32 v37, v37
v_mfma_f32_16x16x32_bf16 v[84:87], a[236:239], a[84:87], v[84:87]
ds_read_b128 a[236:239], v10 offset:3072
v_cvt_pk_bf16_f32 v36, v36, v37
v_mfma_f32_16x16x32_bf16 v[80:83], a[224:227], a[72:75], v[80:83]
v_exp_f32 v38, v38
v_mfma_f32_16x16x32_bf16 v[84:87], a[224:227], a[88:91], v[84:87]
s_waitcnt lgkmcnt(5)
ds_read_b128 a[212:215], v2 offset:12288
v_accvgpr_write_b32 a130, v116
v_mfma_f32_16x16x32_bf16 v[80:83], a[228:231], a[76:79], v[80:83]
v_exp_f32 v39, v39
v_mfma_f32_16x16x32_bf16 v[84:87], a[228:231], a[92:95], v[84:87]
ds_read_b128 a[216:219], v1 offset:13312
v_cvt_pk_bf16_f32 v37, v38, v39
v_mfma_f32_16x16x32_bf16 v[132:135], a[160:163], v[52:55], v[132:135]
v_exp_f32 v40, v40
v_mfma_f32_16x16x32_bf16 v[164:167], a[160:163], v[56:59], v[164:167]
ds_read_b128 a[220:223], v2 offset:13312
v_accvgpr_write_b32 a131, v118
v_mfma_f32_16x16x32_bf16 v[196:199], a[160:163], v[68:71], v[196:199]
s_add_u32 m0, s30, 0x1a000
s_add_u32 s37, s37, 0x2000
v_exp_f32 v80, v80
v_mfma_f32_16x16x32_bf16 v[228:231], a[160:163], v[72:75], v[228:231]
buffer_load_dwordx4 v11, s[12:15], s37 offen nt lds
v_mfma_f32_16x16x32_bf16 v[148:151], a[164:167], v[52:55], v[148:151]
ds_read_b64_tr_b16 a[160:161], v6 offset:8192
v_accvgpr_read_b32 v113, a132
v_mfma_f32_16x16x32_bf16 v[180:183], a[164:167], v[56:59], v[180:183]
v_exp_f32 v81, v81
v_mfma_f32_16x16x32_bf16 v[212:215], a[164:167], v[68:71], v[212:215]
ds_read_b64_tr_b16 a[162:163], v6 offset:12288
v_cvt_pk_bf16_f32 v80, v80, v81
v_mfma_f32_16x16x32_bf16 v[244:247], a[164:167], v[72:75], v[244:247]
v_exp_f32 v82, v82
v_smfmac_f32_16x16x64_bf16 a[244:247], a[240:243], v[52:59], v110
ds_read_b64_tr_b16 a[164:165], v6 offset:9216
v_accvgpr_read_b32 v115, a133
v_mfma_f32_16x16x32_bf16 v[136:139], a[168:171], v[52:55], v[136:139]
v_exp_f32 v83, v83
v_mfma_f32_16x16x32_bf16 v[168:171], a[168:171], v[56:59], v[168:171]
ds_read_b64_tr_b16 a[166:167], v6 offset:13312
v_cvt_pk_bf16_f32 v81, v82, v83
v_mfma_f32_16x16x32_bf16 v[200:203], a[168:171], v[68:71], v[200:203]
ds_write_b64 v9, v[80:81] offset:4096
v_accvgpr_read_b32 v117, a134
v_mfma_f32_16x16x32_bf16 v[232:235], a[168:171], v[72:75], v[232:235]
ds_read_b64_tr_b16 a[168:169], v7 offset:8192
v_accvgpr_read_b32 v119, a135
v_mfma_f32_16x16x32_bf16 v[152:155], a[172:175], v[52:55], v[152:155]
v_exp_f32 v84, v84
v_mfma_f32_16x16x32_bf16 v[184:187], a[172:175], v[56:59], v[184:187]
ds_read_b64_tr_b16 a[170:171], v7 offset:12288
v_lshlrev_b32 v112, 16, v113
v_mfma_f32_16x16x32_bf16 v[216:219], a[172:175], v[68:71], v[216:219]
v_exp_f32 v85, v85
v_mfma_f32_16x16x32_bf16 v[248:251], a[172:175], v[72:75], v[248:251]
s_waitcnt lgkmcnt(5)
ds_read_b64_tr_b16 a[172:173], v7 offset:9216
v_cvt_pk_bf16_f32 v84, v84, v85
v_smfmac_f32_16x16x64_bf16 a[248:251], a[240:243], v[68:75], v110
ds_read_b64_tr_b16 a[174:175], v7 offset:13312
v_lshlrev_b32 v114, 16, v115
v_mfma_f32_16x16x32_bf16 v[140:143], a[176:179], v[52:55], v[140:143]
v_exp_f32 v86, v86
v_mfma_f32_16x16x32_bf16 v[172:175], a[176:179], v[56:59], v[172:175]
v_exp_f32 v87, v87
v_mfma_f32_16x16x32_bf16 v[204:207], a[176:179], v[68:71], v[204:207]
v_exp_f32 v41, v41
v_mfma_f32_16x16x32_bf16 v[236:239], a[176:179], v[72:75], v[236:239]
ds_read_b64_tr_b16 a[176:177], v8 offset:8192
v_cvt_pk_bf16_f32 v85, v86, v87
v_mfma_f32_16x16x32_bf16 v[156:159], a[180:183], v[52:55], v[156:159]
buffer_load_dwordx4 v11, s[12:15], s37 offen offset:2048 nt lds
v_mfma_f32_16x16x32_bf16 v[188:191], a[180:183], v[56:59], v[188:191]
ds_read_b64_tr_b16 a[178:179], v8 offset:12288
v_cvt_pk_bf16_f32 v40, v40, v41
v_mfma_f32_16x16x32_bf16 v[220:223], a[180:183], v[68:71], v[220:223]
ds_write_b64 v9, v[84:85] offset:5120
v_lshlrev_b32 v116, 16, v117
v_mfma_f32_16x16x32_bf16 v[252:255], a[180:183], v[72:75], v[252:255]
ds_read_b64_tr_b16 a[180:181], v8 offset:9216
v_lshlrev_b32 v118, 16, v119
v_mfma_f32_16x16x32_bf16 v[128:131], a[184:187], v[52:55], v[128:131]
v_exp_f32 v42, v42
v_mfma_f32_16x16x32_bf16 v[160:163], a[184:187], v[56:59], v[160:163]
ds_read_b64_tr_b16 a[182:183], v8 offset:13312
v_and_b32 v113, s25, v113
v_mfma_f32_16x16x32_bf16 v[192:195], a[184:187], v[68:71], v[192:195]
v_exp_f32 v43, v43
v_mfma_f32_16x16x32_bf16 v[224:227], a[184:187], v[72:75], v[224:227]
v_exp_f32 v16, v16
v_mfma_f32_16x16x32_bf16 v[88:91], a[184:187], a[232:235], v[88:91]
v_exp_f32 v17, v17
v_mfma_f32_16x16x32_bf16 v[96:99], a[184:187], a[236:239], v[96:99]
ds_read_b64_tr_b16 a[184:185], v5 offset:8192
v_cvt_pk_bf16_f32 v22, v16, v17
v_smfmac_f32_16x16x64_bf16 a[252:255], a[240:243], a[232:239], v110
ds_read_b64_tr_b16 a[186:187], v5 offset:12288
v_cvt_pk_bf16_f32 v41, v42, v43
v_mfma_f32_16x16x32_bf16 v[144:147], a[188:191], v[52:55], v[144:147]
v_exp_f32 v18, v18
v_mfma_f32_16x16x32_bf16 v[176:179], a[188:191], v[56:59], v[176:179]
v_exp_f32 v19, v19
v_mfma_f32_16x16x32_bf16 v[208:211], a[188:191], v[68:71], v[208:211]
v_exp_f32 v28, v28
v_mfma_f32_16x16x32_bf16 v[240:243], a[188:191], v[72:75], v[240:243]
v_exp_f32 v29, v29
v_mfma_f32_16x16x32_bf16 v[92:95], a[188:191], a[232:235], v[92:95]
v_exp_f32 v30, v30
v_mfma_f32_16x16x32_bf16 v[100:103], a[188:191], a[236:239], v[100:103]
ds_read_b64_tr_b16 a[188:189], v5 offset:9216
v_cvt_pk_bf16_f32 v23, v18, v19
v_mfma_f32_16x16x32_bf16 v[52:55], a[192:195], a[0:3], 0
v_exp_f32 v31, v31
v_mfma_f32_16x16x32_bf16 v[56:59], a[192:195], a[16:19], 0
s_add_u32 m0, s30, 0xa000
s_add_u32 s21, s21, 0x2000
s_waitcnt lgkmcnt(3)
ds_read_b64_tr_b16 a[190:191], v5 offset:13312
v_cvt_pk_bf16_f32 v26, v28, v29
v_mfma_f32_16x16x32_bf16 v[68:71], a[192:195], a[32:35], 0
buffer_load_dwordx4 v11, s[8:11], s21 offen nt lds
v_mfma_f32_16x16x32_bf16 v[72:75], a[192:195], a[48:51], 0
v_exp_f32 v32, v32
v_mfma_f32_16x16x32_bf16 v[52:55], a[196:199], a[4:7], v[52:55]
v_exp_f32 v33, v33
v_mfma_f32_16x16x32_bf16 v[56:59], a[196:199], a[20:23], v[56:59]
v_exp_f32 v34, v34
v_mfma_f32_16x16x32_bf16 v[68:71], a[196:199], a[36:39], v[68:71]
v_exp_f32 v35, v35
v_mfma_f32_16x16x32_bf16 v[72:75], a[196:199], a[52:55], v[72:75]
v_exp_f32 v44, v44
v_mfma_f32_16x16x32_bf16 v[52:55], a[200:203], a[8:11], v[52:55]
v_exp_f32 v45, v45
v_mfma_f32_16x16x32_bf16 v[56:59], a[200:203], a[24:27], v[56:59]
v_exp_f32 v46, v46
v_mfma_f32_16x16x32_bf16 v[68:71], a[200:203], a[40:43], v[68:71]
v_exp_f32 v47, v47
v_mfma_f32_16x16x32_bf16 v[72:75], a[200:203], a[56:59], v[72:75]
v_cvt_pk_bf16_f32 v27, v30, v31
v_cvt_pk_bf16_f32 v38, v32, v33
v_mfma_f32_16x16x32_bf16 v[52:55], a[204:207], a[12:15], v[52:55]
v_cvt_pk_bf16_f32 v39, v34, v35
v_cvt_pk_bf16_f32 v42, v44, v45
v_mfma_f32_16x16x32_bf16 v[56:59], a[204:207], a[28:31], v[56:59]
v_cvt_pk_bf16_f32 v43, v46, v47
v_and_b32 v115, s25, v115
v_mfma_f32_16x16x32_bf16 v[68:71], a[204:207], a[44:47], v[68:71]
v_and_b32 v117, s25, v117
v_and_b32 v119, s25, v119
v_mfma_f32_16x16x32_bf16 v[72:75], a[204:207], a[60:63], v[72:75]
v_exp_f32 v52, v52
v_mfma_f32_16x16x32_bf16 v[48:51], a[208:211], a[0:3], 0
v_exp_f32 v53, v53
v_mfma_f32_16x16x32_bf16 v[60:63], a[208:211], a[16:19], 0
v_exp_f32 v54, v54
v_mfma_f32_16x16x32_bf16 v[64:67], a[208:211], a[32:35], 0
v_exp_f32 v55, v55
v_mfma_f32_16x16x32_bf16 v[76:79], a[208:211], a[48:51], 0
v_exp_f32 v56, v56
v_mfma_f32_16x16x32_bf16 v[48:51], a[212:215], a[4:7], v[48:51]
buffer_load_dwordx4 v11, s[8:11], s21 offen offset:2048 nt lds
v_mfma_f32_16x16x32_bf16 v[60:63], a[212:215], a[20:23], v[60:63]
v_exp_f32 v57, v57
v_mfma_f32_16x16x32_bf16 v[64:67], a[212:215], a[36:39], v[64:67]
v_exp_f32 v58, v58
v_mfma_f32_16x16x32_bf16 v[76:79], a[212:215], a[52:55], v[76:79]
v_exp_f32 v59, v59
v_mfma_f32_16x16x32_bf16 v[48:51], a[216:219], a[8:11], v[48:51]
v_exp_f32 v68, v68
v_mfma_f32_16x16x32_bf16 v[60:63], a[216:219], a[24:27], v[60:63]
v_exp_f32 v69, v69
v_mfma_f32_16x16x32_bf16 v[64:67], a[216:219], a[40:43], v[64:67]
v_exp_f32 v70, v70
v_mfma_f32_16x16x32_bf16 v[76:79], a[216:219], a[56:59], v[76:79]
v_exp_f32 v71, v71
v_mfma_f32_16x16x32_bf16 v[48:51], a[220:223], a[12:15], v[48:51]
v_cvt_pk_bf16_f32 v52, v52, v53
v_cvt_pk_bf16_f32 v53, v54, v55
v_mfma_f32_16x16x32_bf16 v[60:63], a[220:223], a[28:31], v[60:63]
v_exp_f32 v72, v72
v_mfma_f32_16x16x32_bf16 v[64:67], a[220:223], a[44:47], v[64:67]
v_exp_f32 v73, v73
v_mfma_f32_16x16x32_bf16 v[76:79], a[220:223], a[60:63], v[76:79]
s_waitcnt vmcnt(10) lgkmcnt(0)
s_barrier
ds_read_b128 a[224:227], v10 offset:4096
v_mfma_f32_16x16x32_bf16 v[132:135], a[160:163], v[20:23], v[132:135]
v_exp_f32 v74, v74
v_mfma_f32_16x16x32_bf16 v[164:167], a[160:163], v[24:27], v[164:167]
ds_read_b128 a[228:231], v10 offset:5120
v_cvt_pk_bf16_f32 v56, v56, v57
v_mfma_f32_16x16x32_bf16 v[196:199], a[160:163], v[36:39], v[196:199]
v_exp_f32 v75, v75
v_mfma_f32_16x16x32_bf16 v[228:231], a[160:163], v[40:43], v[228:231]
ds_read_b128 a[192:195], v1 offset:16384
v_cvt_pk_bf16_f32 v57, v58, v59
v_mfma_f32_16x16x32_bf16 v[148:151], a[164:167], v[20:23], v[148:151]
v_exp_f32 v48, v48
v_mfma_f32_16x16x32_bf16 v[180:183], a[164:167], v[24:27], v[180:183]
s_add_u32 m0, s30, 0x1c000
s_add_u32 s37, s37, 0x2000
ds_read_b128 a[196:199], v2 offset:16384
v_cvt_pk_bf16_f32 v68, v68, v69
v_mfma_f32_16x16x32_bf16 v[212:215], a[164:167], v[36:39], v[212:215]
buffer_load_dwordx4 v11, s[12:15], s37 offen nt lds
v_mfma_f32_16x16x32_bf16 v[244:247], a[164:167], v[40:43], v[244:247]
ds_read_b128 a[200:203], v1 offset:17408
v_cvt_pk_bf16_f32 v69, v70, v71
v_smfmac_f32_16x16x64_bf16 a[244:247], a[240:243], v[20:27], v110
ds_read_b128 a[204:207], v2 offset:17408
v_cvt_pk_bf16_f32 v72, v72, v73
v_mfma_f32_16x16x32_bf16 v[136:139], a[168:171], v[20:23], v[136:139]
v_exp_f32 v49, v49
v_mfma_f32_16x16x32_bf16 v[168:171], a[168:171], v[24:27], v[168:171]
ds_read_b128 a[208:211], v1 offset:20480
v_cvt_pk_bf16_f32 v54, v48, v49
v_mfma_f32_16x16x32_bf16 v[200:203], a[168:171], v[36:39], v[200:203]
v_exp_f32 v50, v50
v_mfma_f32_16x16x32_bf16 v[232:235], a[168:171], v[40:43], v[232:235]
ds_read_b128 a[212:215], v2 offset:20480
v_cvt_pk_bf16_f32 v73, v74, v75
v_mfma_f32_16x16x32_bf16 v[152:155], a[172:175], v[20:23], v[152:155]
v_exp_f32 v51, v51
v_mfma_f32_16x16x32_bf16 v[184:187], a[172:175], v[24:27], v[184:187]
ds_read_b128 a[216:219], v1 offset:21504
v_cvt_pk_bf16_f32 v55, v50, v51
v_mfma_f32_16x16x32_bf16 v[216:219], a[172:175], v[36:39], v[216:219]
v_exp_f32 v60, v60
v_mfma_f32_16x16x32_bf16 v[248:251], a[172:175], v[40:43], v[248:251]
ds_read_b128 a[220:223], v2 offset:21504
v_mul_f32 v112, s26, v112
v_smfmac_f32_16x16x64_bf16 a[248:251], a[240:243], v[36:43], v110
ds_read_b128 a[232:235], v3 offset:16384
v_mul_f32 v113, s26, v113
v_mfma_f32_16x16x32_bf16 v[140:143], a[176:179], v[20:23], v[140:143]
v_exp_f32 v61, v61
v_mfma_f32_16x16x32_bf16 v[172:175], a[176:179], v[24:27], v[172:175]
ds_read_b128 a[236:239], v4 offset:16384
v_cvt_pk_bf16_f32 v58, v60, v61
v_mfma_f32_16x16x32_bf16 v[204:207], a[176:179], v[36:39], v[204:207]
v_exp_f32 v62, v62
v_mfma_f32_16x16x32_bf16 v[236:239], a[176:179], v[40:43], v[236:239]
ds_read_b64_tr_b16 a[160:161], v6 offset:16384
v_mul_f32 v114, s26, v114
v_mfma_f32_16x16x32_bf16 v[156:159], a[180:183], v[20:23], v[156:159]
v_exp_f32 v63, v63
v_mfma_f32_16x16x32_bf16 v[188:191], a[180:183], v[24:27], v[188:191]
ds_read_b64_tr_b16 a[162:163], v6 offset:20480
v_cvt_pk_bf16_f32 v59, v62, v63
v_mfma_f32_16x16x32_bf16 v[220:223], a[180:183], v[36:39], v[220:223]
v_exp_f32 v64, v64
v_mfma_f32_16x16x32_bf16 v[252:255], a[180:183], v[40:43], v[252:255]
buffer_load_dwordx4 v11, s[12:15], s37 offen offset:2048 nt lds
v_mfma_f32_16x16x32_bf16 v[128:131], a[184:187], v[20:23], v[128:131]
ds_read_b64_tr_b16 a[164:165], v6 offset:17408
v_mul_f32 v115, s26, v115
v_mfma_f32_16x16x32_bf16 v[160:163], a[184:187], v[24:27], v[160:163]
v_exp_f32 v65, v65
v_mfma_f32_16x16x32_bf16 v[192:195], a[184:187], v[36:39], v[192:195]
s_waitcnt lgkmcnt(4)
ds_read_b64_tr_b16 a[166:167], v6 offset:21504
v_cvt_pk_bf16_f32 v70, v64, v65
v_mfma_f32_16x16x32_bf16 v[224:227], a[184:187], v[40:43], v[224:227]
v_exp_f32 v66, v66
v_mfma_f32_16x16x32_bf16 v[88:91], a[184:187], a[224:227], v[88:91]
ds_read_b64_tr_b16 a[168:169], v7 offset:16384
v_mul_f32 v116, s26, v116
v_mfma_f32_16x16x32_bf16 v[96:99], a[184:187], a[228:231], v[96:99]
v_exp_f32 v67, v67
v_smfmac_f32_16x16x64_bf16 a[252:255], a[240:243], a[224:231], v110
ds_read_b64_tr_b16 a[170:171], v7 offset:20480
v_cvt_pk_bf16_f32 v71, v66, v67
v_mfma_f32_16x16x32_bf16 v[144:147], a[188:191], v[20:23], v[144:147]
v_exp_f32 v76, v76
v_mfma_f32_16x16x32_bf16 v[176:179], a[188:191], v[24:27], v[176:179]
ds_read_b64_tr_b16 a[172:173], v7 offset:17408
v_mul_f32 v117, s26, v117
v_mfma_f32_16x16x32_bf16 v[208:211], a[188:191], v[36:39], v[208:211]
v_exp_f32 v77, v77
v_mfma_f32_16x16x32_bf16 v[240:243], a[188:191], v[40:43], v[240:243]
ds_read_b64_tr_b16 a[174:175], v7 offset:21504
v_cvt_pk_bf16_f32 v74, v76, v77
v_mfma_f32_16x16x32_bf16 v[92:95], a[188:191], a[224:227], v[92:95]
v_exp_f32 v78, v78
v_mfma_f32_16x16x32_bf16 v[100:103], a[188:191], a[228:231], v[100:103]
ds_read_b128 a[224:227], v3 offset:17408
v_mul_f32 v118, s26, v118
v_mfma_f32_16x16x32_bf16 v[20:23], a[192:195], a[0:3], 0
v_exp_f32 v79, v79
v_mfma_f32_16x16x32_bf16 v[24:27], a[192:195], a[16:19], 0
ds_read_b128 a[228:231], v4 offset:17408
v_cvt_pk_bf16_f32 v75, v78, v79
v_mfma_f32_16x16x32_bf16 v[36:39], a[192:195], a[32:35], 0
v_mul_f32 v119, s26, v119
v_cvt_pk_bf16_f32 v112, v112, v113
v_mfma_f32_16x16x32_bf16 v[40:43], a[192:195], a[48:51], 0
ds_read_b64_tr_b16 a[176:177], v8 offset:16384
v_cvt_pk_bf16_f32 v114, v114, v115
v_mfma_f32_16x16x32_bf16 v[20:23], a[196:199], a[4:7], v[20:23]
s_add_u32 m0, s30, 0xc000
s_add_u32 s21, s21, 0x2000
v_cvt_pk_bf16_f32 v116, v116, v117
v_mfma_f32_16x16x32_bf16 v[24:27], a[196:199], a[20:23], v[24:27]
buffer_load_dwordx4 v11, s[8:11], s21 offen nt lds
v_mfma_f32_16x16x32_bf16 v[36:39], a[196:199], a[36:39], v[36:39]
ds_read_b64_tr_b16 a[178:179], v8 offset:20480
v_cvt_pk_bf16_f32 v118, v118, v119
v_mfma_f32_16x16x32_bf16 v[40:43], a[196:199], a[52:55], v[40:43]
v_accvgpr_write_b32 a132, v112
v_accvgpr_write_b32 a133, v114
v_mfma_f32_16x16x32_bf16 v[20:23], a[200:203], a[8:11], v[20:23]
ds_read_b64_tr_b16 a[180:181], v8 offset:17408
v_accvgpr_write_b32 a134, v116
v_mfma_f32_16x16x32_bf16 v[24:27], a[200:203], a[24:27], v[24:27]
v_accvgpr_write_b32 a135, v118
v_mfma_f32_16x16x32_bf16 v[36:39], a[200:203], a[40:43], v[36:39]
ds_read_b64_tr_b16 a[182:183], v8 offset:21504
v_accvgpr_read_b32 v113, a136
v_mfma_f32_16x16x32_bf16 v[40:43], a[200:203], a[56:59], v[40:43]
v_accvgpr_read_b32 v115, a137
v_accvgpr_read_b32 v117, a138
v_mfma_f32_16x16x32_bf16 v[20:23], a[204:207], a[12:15], v[20:23]
s_waitcnt lgkmcnt(4)
ds_read_b64_tr_b16 a[184:185], v5 offset:16384
v_accvgpr_read_b32 v119, a139
v_mfma_f32_16x16x32_bf16 v[24:27], a[204:207], a[28:31], v[24:27]
v_lshlrev_b32 v112, 16, v113
v_lshlrev_b32 v114, 16, v115
v_mfma_f32_16x16x32_bf16 v[36:39], a[204:207], a[44:47], v[36:39]
ds_read_b64_tr_b16 a[186:187], v5 offset:20480
v_lshlrev_b32 v116, 16, v117
v_mfma_f32_16x16x32_bf16 v[40:43], a[204:207], a[60:63], v[40:43]
v_exp_f32 v20, v20
v_mfma_f32_16x16x32_bf16 v[16:19], a[208:211], a[0:3], 0
ds_read_b64_tr_b16 a[188:189], v5 offset:17408
v_lshlrev_b32 v118, 16, v119
v_mfma_f32_16x16x32_bf16 v[28:31], a[208:211], a[16:19], 0
v_exp_f32 v21, v21
v_mfma_f32_16x16x32_bf16 v[32:35], a[208:211], a[32:35], 0
ds_read_b64_tr_b16 a[190:191], v5 offset:21504
v_cvt_pk_bf16_f32 v20, v20, v21
v_mfma_f32_16x16x32_bf16 v[44:47], a[208:211], a[48:51], 0
v_exp_f32 v22, v22
v_mfma_f32_16x16x32_bf16 v[16:19], a[212:215], a[4:7], v[16:19]
ds_read_b128 a[192:195], v1 offset:24576
v_and_b32 v113, s25, v113
v_mfma_f32_16x16x32_bf16 v[28:31], a[212:215], a[20:23], v[28:31]
v_exp_f32 v23, v23
v_mfma_f32_16x16x32_bf16 v[32:35], a[212:215], a[36:39], v[32:35]
ds_read_b128 a[196:199], v2 offset:24576
v_cvt_pk_bf16_f32 v21, v22, v23
v_mfma_f32_16x16x32_bf16 v[44:47], a[212:215], a[52:55], v[44:47]
v_exp_f32 v24, v24
v_mfma_f32_16x16x32_bf16 v[16:19], a[216:219], a[8:11], v[16:19]
buffer_load_dwordx4 v11, s[8:11], s21 offen offset:2048 nt lds
v_mfma_f32_16x16x32_bf16 v[28:31], a[216:219], a[24:27], v[28:31]
ds_read_b128 a[200:203], v1 offset:25600
v_and_b32 v115, s25, v115
v_mfma_f32_16x16x32_bf16 v[32:35], a[216:219], a[40:43], v[32:35]
v_exp_f32 v25, v25
v_mfma_f32_16x16x32_bf16 v[44:47], a[216:219], a[56:59], v[44:47]
ds_read_b128 a[204:207], v2 offset:25600
v_cvt_pk_bf16_f32 v24, v24, v25
v_mfma_f32_16x16x32_bf16 v[16:19], a[220:223], a[12:15], v[16:19]
v_exp_f32 v26, v26
v_mfma_f32_16x16x32_bf16 v[28:31], a[220:223], a[28:31], v[28:31]
ds_read_b128 a[208:211], v1 offset:28672
v_and_b32 v117, s25, v117
v_mfma_f32_16x16x32_bf16 v[32:35], a[220:223], a[44:47], v[32:35]
v_exp_f32 v27, v27
v_mfma_f32_16x16x32_bf16 v[44:47], a[220:223], a[60:63], v[44:47]
ds_read_b128 a[212:215], v2 offset:28672
v_cvt_pk_bf16_f32 v25, v26, v27
v_mfma_f32_16x16x32_bf16 v[80:83], a[232:235], a[64:67], 0
v_exp_f32 v36, v36
v_mfma_f32_16x16x32_bf16 v[84:87], a[232:235], a[80:83], 0
ds_read_b128 a[232:235], v10 offset:6144
v_and_b32 v119, s25, v119
v_mfma_f32_16x16x32_bf16 v[80:83], a[236:239], a[68:71], v[80:83]
v_exp_f32 v37, v37
v_mfma_f32_16x16x32_bf16 v[84:87], a[236:239], a[84:87], v[84:87]
s_waitcnt lgkmcnt(5)
ds_read_b128 a[236:239], v10 offset:7168
v_cvt_pk_bf16_f32 v36, v36, v37
v_mfma_f32_16x16x32_bf16 v[80:83], a[224:227], a[72:75], v[80:83]
v_exp_f32 v38, v38
v_mfma_f32_16x16x32_bf16 v[84:87], a[224:227], a[88:91], v[84:87]
ds_read_b128 a[216:219], v1 offset:29696
v_mul_f32 v112, s26, v112
v_mfma_f32_16x16x32_bf16 v[80:83], a[228:231], a[76:79], v[80:83]
v_exp_f32 v39, v39
v_mfma_f32_16x16x32_bf16 v[84:87], a[228:231], a[92:95], v[84:87]
ds_read_b128 a[220:223], v2 offset:29696
v_cvt_pk_bf16_f32 v37, v38, v39
v_mfma_f32_16x16x32_bf16 v[132:135], a[160:163], v[52:55], v[132:135]
v_exp_f32 v40, v40
v_mfma_f32_16x16x32_bf16 v[164:167], a[160:163], v[56:59], v[164:167]
v_exp_f32 v41, v41
v_mfma_f32_16x16x32_bf16 v[196:199], a[160:163], v[68:71], v[196:199]
s_add_u32 m0, s30, 0x1e000
s_add_u32 s37, s37, 0x2000
v_exp_f32 v80, v80
v_mfma_f32_16x16x32_bf16 v[228:231], a[160:163], v[72:75], v[228:231]
buffer_load_dwordx4 v11, s[12:15], s37 offen nt lds
v_mfma_f32_16x16x32_bf16 v[148:151], a[164:167], v[52:55], v[148:151]
ds_read_b64_tr_b16 a[160:161], v6 offset:24576
v_cvt_pk_bf16_f32 v40, v40, v41
v_mfma_f32_16x16x32_bf16 v[180:183], a[164:167], v[56:59], v[180:183]
v_exp_f32 v81, v81
v_mfma_f32_16x16x32_bf16 v[212:215], a[164:167], v[68:71], v[212:215]
ds_read_b64_tr_b16 a[162:163], v6 offset:28672
v_cvt_pk_bf16_f32 v80, v80, v81
v_mfma_f32_16x16x32_bf16 v[244:247], a[164:167], v[72:75], v[244:247]
v_exp_f32 v82, v82
v_smfmac_f32_16x16x64_bf16 a[244:247], a[240:243], v[52:59], v110
ds_read_b64_tr_b16 a[164:165], v6 offset:25600
v_mul_f32 v113, s26, v113
v_mfma_f32_16x16x32_bf16 v[136:139], a[168:171], v[52:55], v[136:139]
v_exp_f32 v83, v83
v_mfma_f32_16x16x32_bf16 v[168:171], a[168:171], v[56:59], v[168:171]
ds_read_b64_tr_b16 a[166:167], v6 offset:29696
v_cvt_pk_bf16_f32 v81, v82, v83
v_mfma_f32_16x16x32_bf16 v[200:203], a[168:171], v[68:71], v[200:203]
ds_write_b64 v9, v[80:81] offset:0
v_mul_f32 v114, s26, v114
v_mfma_f32_16x16x32_bf16 v[232:235], a[168:171], v[72:75], v[232:235]
ds_read_b64_tr_b16 a[168:169], v7 offset:24576
v_mul_f32 v115, s26, v115
v_mfma_f32_16x16x32_bf16 v[152:155], a[172:175], v[52:55], v[152:155]
v_exp_f32 v84, v84
v_mfma_f32_16x16x32_bf16 v[184:187], a[172:175], v[56:59], v[184:187]
ds_read_b64_tr_b16 a[170:171], v7 offset:28672
v_mul_f32 v116, s26, v116
v_mfma_f32_16x16x32_bf16 v[216:219], a[172:175], v[68:71], v[216:219]
v_exp_f32 v85, v85
v_mfma_f32_16x16x32_bf16 v[248:251], a[172:175], v[72:75], v[248:251]
s_waitcnt lgkmcnt(5)
ds_read_b64_tr_b16 a[172:173], v7 offset:25600
v_cvt_pk_bf16_f32 v84, v84, v85
v_smfmac_f32_16x16x64_bf16 a[248:251], a[240:243], v[68:75], v110
ds_read_b64_tr_b16 a[174:175], v7 offset:29696
v_mul_f32 v117, s26, v117
v_mfma_f32_16x16x32_bf16 v[140:143], a[176:179], v[52:55], v[140:143]
v_exp_f32 v86, v86
v_mfma_f32_16x16x32_bf16 v[172:175], a[176:179], v[56:59], v[172:175]
v_exp_f32 v87, v87
v_mfma_f32_16x16x32_bf16 v[204:207], a[176:179], v[68:71], v[204:207]
v_exp_f32 v42, v42
v_mfma_f32_16x16x32_bf16 v[236:239], a[176:179], v[72:75], v[236:239]
ds_read_b64_tr_b16 a[176:177], v8 offset:24576
v_cvt_pk_bf16_f32 v85, v86, v87
v_mfma_f32_16x16x32_bf16 v[156:159], a[180:183], v[52:55], v[156:159]
buffer_load_dwordx4 v11, s[12:15], s37 offen offset:2048 nt lds
v_mfma_f32_16x16x32_bf16 v[188:191], a[180:183], v[56:59], v[188:191]
ds_read_b64_tr_b16 a[178:179], v8 offset:28672
v_mul_f32 v118, s26, v118
v_mfma_f32_16x16x32_bf16 v[220:223], a[180:183], v[68:71], v[220:223]
ds_write_b64 v9, v[84:85] offset:1024
v_mul_f32 v119, s26, v119
v_mfma_f32_16x16x32_bf16 v[252:255], a[180:183], v[72:75], v[252:255]
ds_read_b64_tr_b16 a[180:181], v8 offset:25600
v_cvt_pk_bf16_f32 v112, v112, v113
v_mfma_f32_16x16x32_bf16 v[128:131], a[184:187], v[52:55], v[128:131]
v_exp_f32 v43, v43
v_mfma_f32_16x16x32_bf16 v[160:163], a[184:187], v[56:59], v[160:163]
ds_read_b64_tr_b16 a[182:183], v8 offset:29696
v_cvt_pk_bf16_f32 v41, v42, v43
v_mfma_f32_16x16x32_bf16 v[192:195], a[184:187], v[68:71], v[192:195]
v_exp_f32 v16, v16
v_mfma_f32_16x16x32_bf16 v[224:227], a[184:187], v[72:75], v[224:227]
v_exp_f32 v17, v17
v_mfma_f32_16x16x32_bf16 v[88:91], a[184:187], a[232:235], v[88:91]
v_exp_f32 v18, v18
v_mfma_f32_16x16x32_bf16 v[96:99], a[184:187], a[236:239], v[96:99]
ds_read_b64_tr_b16 a[184:185], v5 offset:24576
v_cvt_pk_bf16_f32 v22, v16, v17
v_smfmac_f32_16x16x64_bf16 a[252:255], a[240:243], a[232:239], v110
ds_read_b64_tr_b16 a[186:187], v5 offset:28672
v_cvt_pk_bf16_f32 v114, v114, v115
v_mfma_f32_16x16x32_bf16 v[144:147], a[188:191], v[52:55], v[144:147]
v_exp_f32 v19, v19
v_mfma_f32_16x16x32_bf16 v[176:179], a[188:191], v[56:59], v[176:179]
v_exp_f32 v28, v28
v_mfma_f32_16x16x32_bf16 v[208:211], a[188:191], v[68:71], v[208:211]
v_exp_f32 v29, v29
v_mfma_f32_16x16x32_bf16 v[240:243], a[188:191], v[72:75], v[240:243]
v_exp_f32 v30, v30
v_mfma_f32_16x16x32_bf16 v[92:95], a[188:191], a[232:235], v[92:95]
v_exp_f32 v31, v31
v_mfma_f32_16x16x32_bf16 v[100:103], a[188:191], a[236:239], v[100:103]
ds_read_b64_tr_b16 a[188:189], v5 offset:25600
v_cvt_pk_bf16_f32 v23, v18, v19
v_mfma_f32_16x16x32_bf16 v[52:55], a[192:195], a[0:3], 0
v_exp_f32 v32, v32
v_mfma_f32_16x16x32_bf16 v[56:59], a[192:195], a[16:19], 0
s_add_u32 m0, s30, 0xe000
s_add_u32 s21, s21, 0x2000
s_waitcnt lgkmcnt(3)
ds_read_b64_tr_b16 a[190:191], v5 offset:29696
v_cvt_pk_bf16_f32 v26, v28, v29
v_mfma_f32_16x16x32_bf16 v[68:71], a[192:195], a[32:35], 0
buffer_load_dwordx4 v11, s[8:11], s21 offen nt lds
v_mfma_f32_16x16x32_bf16 v[72:75], a[192:195], a[48:51], 0
v_exp_f32 v33, v33
v_mfma_f32_16x16x32_bf16 v[52:55], a[196:199], a[4:7], v[52:55]
v_exp_f32 v34, v34
v_mfma_f32_16x16x32_bf16 v[56:59], a[196:199], a[20:23], v[56:59]
v_exp_f32 v35, v35
v_mfma_f32_16x16x32_bf16 v[68:71], a[196:199], a[36:39], v[68:71]
v_exp_f32 v44, v44
v_mfma_f32_16x16x32_bf16 v[72:75], a[196:199], a[52:55], v[72:75]
v_exp_f32 v45, v45
v_mfma_f32_16x16x32_bf16 v[52:55], a[200:203], a[8:11], v[52:55]
v_exp_f32 v46, v46
v_mfma_f32_16x16x32_bf16 v[56:59], a[200:203], a[24:27], v[56:59]
v_exp_f32 v47, v47
v_mfma_f32_16x16x32_bf16 v[68:71], a[200:203], a[40:43], v[68:71]
v_cvt_pk_bf16_f32 v27, v30, v31
v_cvt_pk_bf16_f32 v38, v32, v33
v_mfma_f32_16x16x32_bf16 v[72:75], a[200:203], a[56:59], v[72:75]
v_cvt_pk_bf16_f32 v39, v34, v35
v_cvt_pk_bf16_f32 v42, v44, v45
v_mfma_f32_16x16x32_bf16 v[52:55], a[204:207], a[12:15], v[52:55]
v_cvt_pk_bf16_f32 v43, v46, v47
v_cvt_pk_bf16_f32 v116, v116, v117
v_mfma_f32_16x16x32_bf16 v[56:59], a[204:207], a[28:31], v[56:59]
v_cvt_pk_bf16_f32 v118, v118, v119
v_accvgpr_write_b32 a136, v112
v_mfma_f32_16x16x32_bf16 v[68:71], a[204:207], a[44:47], v[68:71]
v_accvgpr_write_b32 a137, v114
v_accvgpr_write_b32 a138, v116
v_mfma_f32_16x16x32_bf16 v[72:75], a[204:207], a[60:63], v[72:75]
v_exp_f32 v52, v52
v_mfma_f32_16x16x32_bf16 v[48:51], a[208:211], a[0:3], 0
v_exp_f32 v53, v53
v_mfma_f32_16x16x32_bf16 v[60:63], a[208:211], a[16:19], 0
v_exp_f32 v54, v54
v_mfma_f32_16x16x32_bf16 v[64:67], a[208:211], a[32:35], 0
v_exp_f32 v55, v55
v_mfma_f32_16x16x32_bf16 v[76:79], a[208:211], a[48:51], 0
v_exp_f32 v56, v56
v_mfma_f32_16x16x32_bf16 v[48:51], a[212:215], a[4:7], v[48:51]
buffer_load_dwordx4 v11, s[8:11], s21 offen offset:2048 nt lds
v_mfma_f32_16x16x32_bf16 v[60:63], a[212:215], a[20:23], v[60:63]
v_exp_f32 v57, v57
v_mfma_f32_16x16x32_bf16 v[64:67], a[212:215], a[36:39], v[64:67]
v_exp_f32 v58, v58
v_mfma_f32_16x16x32_bf16 v[76:79], a[212:215], a[52:55], v[76:79]
v_exp_f32 v59, v59
v_mfma_f32_16x16x32_bf16 v[48:51], a[216:219], a[8:11], v[48:51]
v_exp_f32 v68, v68
v_mfma_f32_16x16x32_bf16 v[60:63], a[216:219], a[24:27], v[60:63]
v_exp_f32 v69, v69
v_mfma_f32_16x16x32_bf16 v[64:67], a[216:219], a[40:43], v[64:67]
v_exp_f32 v70, v70
v_mfma_f32_16x16x32_bf16 v[76:79], a[216:219], a[56:59], v[76:79]
v_exp_f32 v71, v71
v_mfma_f32_16x16x32_bf16 v[48:51], a[220:223], a[12:15], v[48:51]
v_cvt_pk_bf16_f32 v52, v52, v53
v_cvt_pk_bf16_f32 v53, v54, v55
v_mfma_f32_16x16x32_bf16 v[60:63], a[220:223], a[28:31], v[60:63]
v_exp_f32 v72, v72
v_mfma_f32_16x16x32_bf16 v[64:67], a[220:223], a[44:47], v[64:67]
v_exp_f32 v73, v73
v_mfma_f32_16x16x32_bf16 v[76:79], a[220:223], a[60:63], v[76:79]
s_waitcnt vmcnt(8) lgkmcnt(0)
s_barrier
ds_read_b128 a[224:227], v10 offset:0
v_mfma_f32_16x16x32_bf16 v[132:135], a[160:163], v[20:23], v[132:135]
v_exp_f32 v74, v74
v_mfma_f32_16x16x32_bf16 v[164:167], a[160:163], v[24:27], v[164:167]
ds_read_b128 a[228:231], v10 offset:1024
v_cvt_pk_bf16_f32 v56, v56, v57
v_mfma_f32_16x16x32_bf16 v[196:199], a[160:163], v[36:39], v[196:199]
v_exp_f32 v75, v75
v_mfma_f32_16x16x32_bf16 v[228:231], a[160:163], v[40:43], v[228:231]
ds_read_b128 a[192:195], v1 offset:32768
v_cvt_pk_bf16_f32 v57, v58, v59
v_mfma_f32_16x16x32_bf16 v[148:151], a[164:167], v[20:23], v[148:151]
v_exp_f32 v48, v48
v_mfma_f32_16x16x32_bf16 v[180:183], a[164:167], v[24:27], v[180:183]
s_add_u32 m0, s30, 0x10000
s_add_u32 s37, s37, 0x2000
ds_read_b128 a[196:199], v2 offset:32768
v_cvt_pk_bf16_f32 v68, v68, v69
v_mfma_f32_16x16x32_bf16 v[212:215], a[164:167], v[36:39], v[212:215]
buffer_load_dwordx4 v11, s[12:15], s37 offen nt lds
v_mfma_f32_16x16x32_bf16 v[244:247], a[164:167], v[40:43], v[244:247]
ds_read_b128 a[200:203], v1 offset:33792
v_cvt_pk_bf16_f32 v69, v70, v71
v_smfmac_f32_16x16x64_bf16 a[244:247], a[240:243], v[20:27], v110
ds_read_b128 a[204:207], v2 offset:33792
v_cvt_pk_bf16_f32 v72, v72, v73
v_mfma_f32_16x16x32_bf16 v[136:139], a[168:171], v[20:23], v[136:139]
v_exp_f32 v49, v49
v_mfma_f32_16x16x32_bf16 v[168:171], a[168:171], v[24:27], v[168:171]
ds_read_b128 a[208:211], v1 offset:36864
v_cvt_pk_bf16_f32 v54, v48, v49
v_mfma_f32_16x16x32_bf16 v[200:203], a[168:171], v[36:39], v[200:203]
v_exp_f32 v50, v50
v_mfma_f32_16x16x32_bf16 v[232:235], a[168:171], v[40:43], v[232:235]
ds_read_b128 a[212:215], v2 offset:36864
v_cvt_pk_bf16_f32 v73, v74, v75
v_mfma_f32_16x16x32_bf16 v[152:155], a[172:175], v[20:23], v[152:155]
v_exp_f32 v51, v51
v_mfma_f32_16x16x32_bf16 v[184:187], a[172:175], v[24:27], v[184:187]
ds_read_b128 a[216:219], v1 offset:37888
v_cvt_pk_bf16_f32 v55, v50, v51
v_mfma_f32_16x16x32_bf16 v[216:219], a[172:175], v[36:39], v[216:219]
v_exp_f32 v60, v60
v_mfma_f32_16x16x32_bf16 v[248:251], a[172:175], v[40:43], v[248:251]
ds_read_b128 a[220:223], v2 offset:37888
v_accvgpr_write_b32 a139, v118
v_smfmac_f32_16x16x64_bf16 a[248:251], a[240:243], v[36:43], v110
ds_read_b128 a[232:235], v3 offset:32768
v_accvgpr_read_b32 v113, a140
v_mfma_f32_16x16x32_bf16 v[140:143], a[176:179], v[20:23], v[140:143]
v_exp_f32 v61, v61
v_mfma_f32_16x16x32_bf16 v[172:175], a[176:179], v[24:27], v[172:175]
ds_read_b128 a[236:239], v4 offset:32768
v_cvt_pk_bf16_f32 v58, v60, v61
v_mfma_f32_16x16x32_bf16 v[204:207], a[176:179], v[36:39], v[204:207]
v_exp_f32 v62, v62
v_mfma_f32_16x16x32_bf16 v[236:239], a[176:179], v[40:43], v[236:239]
ds_read_b64_tr_b16 a[160:161], v6 offset:32768
v_accvgpr_read_b32 v115, a141
v_mfma_f32_16x16x32_bf16 v[156:159], a[180:183], v[20:23], v[156:159]
v_exp_f32 v63, v63
v_mfma_f32_16x16x32_bf16 v[188:191], a[180:183], v[24:27], v[188:191]
ds_read_b64_tr_b16 a[162:163], v6 offset:36864
v_cvt_pk_bf16_f32 v59, v62, v63
v_mfma_f32_16x16x32_bf16 v[220:223], a[180:183], v[36:39], v[220:223]
v_exp_f32 v64, v64
v_mfma_f32_16x16x32_bf16 v[252:255], a[180:183], v[40:43], v[252:255]
buffer_load_dwordx4 v11, s[12:15], s37 offen offset:2048 nt lds
v_mfma_f32_16x16x32_bf16 v[128:131], a[184:187], v[20:23], v[128:131]
ds_read_b64_tr_b16 a[164:165], v6 offset:33792
v_accvgpr_read_b32 v117, a142
v_mfma_f32_16x16x32_bf16 v[160:163], a[184:187], v[24:27], v[160:163]
v_exp_f32 v65, v65
v_mfma_f32_16x16x32_bf16 v[192:195], a[184:187], v[36:39], v[192:195]
s_waitcnt lgkmcnt(4)
ds_read_b64_tr_b16 a[166:167], v6 offset:37888
v_cvt_pk_bf16_f32 v70, v64, v65
v_mfma_f32_16x16x32_bf16 v[224:227], a[184:187], v[40:43], v[224:227]
v_exp_f32 v66, v66
v_mfma_f32_16x16x32_bf16 v[88:91], a[184:187], a[224:227], v[88:91]
ds_read_b64_tr_b16 a[168:169], v7 offset:32768
v_accvgpr_read_b32 v119, a143
v_mfma_f32_16x16x32_bf16 v[96:99], a[184:187], a[228:231], v[96:99]
v_exp_f32 v67, v67
v_smfmac_f32_16x16x64_bf16 a[252:255], a[240:243], a[224:231], v110
ds_read_b64_tr_b16 a[170:171], v7 offset:36864
v_cvt_pk_bf16_f32 v71, v66, v67
v_mfma_f32_16x16x32_bf16 v[144:147], a[188:191], v[20:23], v[144:147]
v_exp_f32 v76, v76
v_mfma_f32_16x16x32_bf16 v[176:179], a[188:191], v[24:27], v[176:179]
ds_read_b64_tr_b16 a[172:173], v7 offset:33792
v_lshlrev_b32 v112, 16, v113
v_mfma_f32_16x16x32_bf16 v[208:211], a[188:191], v[36:39], v[208:211]
v_exp_f32 v77, v77
v_mfma_f32_16x16x32_bf16 v[240:243], a[188:191], v[40:43], v[240:243]
ds_read_b64_tr_b16 a[174:175], v7 offset:37888
v_cvt_pk_bf16_f32 v74, v76, v77
v_mfma_f32_16x16x32_bf16 v[92:95], a[188:191], a[224:227], v[92:95]
v_exp_f32 v78, v78
v_mfma_f32_16x16x32_bf16 v[100:103], a[188:191], a[228:231], v[100:103]
ds_read_b128 a[224:227], v3 offset:33792
v_lshlrev_b32 v114, 16, v115
v_mfma_f32_16x16x32_bf16 v[20:23], a[192:195], a[0:3], 0
v_exp_f32 v79, v79
v_mfma_f32_16x16x32_bf16 v[24:27], a[192:195], a[16:19], 0
ds_read_b128 a[228:231], v4 offset:33792
v_cvt_pk_bf16_f32 v75, v78, v79
v_mfma_f32_16x16x32_bf16 v[36:39], a[192:195], a[32:35], 0
v_lshlrev_b32 v116, 16, v117
v_lshlrev_b32 v118, 16, v119
v_mfma_f32_16x16x32_bf16 v[40:43], a[192:195], a[48:51], 0
ds_read_b64_tr_b16 a[176:177], v8 offset:32768
v_and_b32 v113, s25, v113
v_mfma_f32_16x16x32_bf16 v[20:23], a[196:199], a[4:7], v[20:23]
s_add_u32 m0, s30, 0x0
s_add_u32 s21, s21, 0x2000
v_and_b32 v115, s25, v115
v_mfma_f32_16x16x32_bf16 v[24:27], a[196:199], a[20:23], v[24:27]
buffer_load_dwordx4 v11, s[8:11], s21 offen nt lds
v_mfma_f32_16x16x32_bf16 v[36:39], a[196:199], a[36:39], v[36:39]
ds_read_b64_tr_b16 a[178:179], v8 offset:36864
v_and_b32 v117, s25, v117
v_mfma_f32_16x16x32_bf16 v[40:43], a[196:199], a[52:55], v[40:43]
v_and_b32 v119, s25, v119
v_mul_f32 v112, s26, v112
v_mfma_f32_16x16x32_bf16 v[20:23], a[200:203], a[8:11], v[20:23]
ds_read_b64_tr_b16 a[180:181], v8 offset:33792
v_mul_f32 v113, s26, v113
v_mfma_f32_16x16x32_bf16 v[24:27], a[200:203], a[24:27], v[24:27]
v_mul_f32 v114, s26, v114
v_mul_f32 v115, s26, v115
v_mfma_f32_16x16x32_bf16 v[36:39], a[200:203], a[40:43], v[36:39]
ds_read_b64_tr_b16 a[182:183], v8 offset:37888
v_mul_f32 v116, s26, v116
v_mfma_f32_16x16x32_bf16 v[40:43], a[200:203], a[56:59], v[40:43]
v_mul_f32 v117, s26, v117
v_mul_f32 v118, s26, v118
v_mfma_f32_16x16x32_bf16 v[20:23], a[204:207], a[12:15], v[20:23]
s_waitcnt lgkmcnt(4)
ds_read_b64_tr_b16 a[184:185], v5 offset:32768
v_mul_f32 v119, s26, v119
v_mfma_f32_16x16x32_bf16 v[24:27], a[204:207], a[28:31], v[24:27]
v_cvt_pk_bf16_f32 v112, v112, v113
v_cvt_pk_bf16_f32 v114, v114, v115
v_mfma_f32_16x16x32_bf16 v[36:39], a[204:207], a[44:47], v[36:39]
ds_read_b64_tr_b16 a[186:187], v5 offset:36864
v_cvt_pk_bf16_f32 v116, v116, v117
v_mfma_f32_16x16x32_bf16 v[40:43], a[204:207], a[60:63], v[40:43]
v_exp_f32 v20, v20
v_mfma_f32_16x16x32_bf16 v[16:19], a[208:211], a[0:3], 0
ds_read_b64_tr_b16 a[188:189], v5 offset:33792
v_cvt_pk_bf16_f32 v118, v118, v119
v_mfma_f32_16x16x32_bf16 v[28:31], a[208:211], a[16:19], 0
v_exp_f32 v21, v21
v_mfma_f32_16x16x32_bf16 v[32:35], a[208:211], a[32:35], 0
ds_read_b64_tr_b16 a[190:191], v5 offset:37888
v_cvt_pk_bf16_f32 v20, v20, v21
v_mfma_f32_16x16x32_bf16 v[44:47], a[208:211], a[48:51], 0
v_exp_f32 v22, v22
v_mfma_f32_16x16x32_bf16 v[16:19], a[212:215], a[4:7], v[16:19]
ds_read_b128 a[192:195], v1 offset:40960
v_accvgpr_write_b32 a140, v112
v_mfma_f32_16x16x32_bf16 v[28:31], a[212:215], a[20:23], v[28:31]
v_exp_f32 v23, v23
v_mfma_f32_16x16x32_bf16 v[32:35], a[212:215], a[36:39], v[32:35]
ds_read_b128 a[196:199], v2 offset:40960
v_cvt_pk_bf16_f32 v21, v22, v23
v_mfma_f32_16x16x32_bf16 v[44:47], a[212:215], a[52:55], v[44:47]
v_exp_f32 v24, v24
v_mfma_f32_16x16x32_bf16 v[16:19], a[216:219], a[8:11], v[16:19]
buffer_load_dwordx4 v11, s[8:11], s21 offen offset:2048 nt lds
v_mfma_f32_16x16x32_bf16 v[28:31], a[216:219], a[24:27], v[28:31]
ds_read_b128 a[200:203], v1 offset:41984
v_accvgpr_write_b32 a141, v114
v_mfma_f32_16x16x32_bf16 v[32:35], a[216:219], a[40:43], v[32:35]
v_exp_f32 v25, v25
v_mfma_f32_16x16x32_bf16 v[44:47], a[216:219], a[56:59], v[44:47]
ds_read_b128 a[204:207], v2 offset:41984
v_cvt_pk_bf16_f32 v24, v24, v25
v_mfma_f32_16x16x32_bf16 v[16:19], a[220:223], a[12:15], v[16:19]
v_exp_f32 v26, v26
v_mfma_f32_16x16x32_bf16 v[28:31], a[220:223], a[28:31], v[28:31]
ds_read_b128 a[208:211], v1 offset:45056
v_accvgpr_write_b32 a142, v116
v_mfma_f32_16x16x32_bf16 v[32:35], a[220:223], a[44:47], v[32:35]
v_exp_f32 v27, v27
v_mfma_f32_16x16x32_bf16 v[44:47], a[220:223], a[60:63], v[44:47]
ds_read_b128 a[212:215], v2 offset:45056
v_cvt_pk_bf16_f32 v25, v26, v27
v_mfma_f32_16x16x32_bf16 v[80:83], a[232:235], a[64:67], 0
v_exp_f32 v36, v36
v_mfma_f32_16x16x32_bf16 v[84:87], a[232:235], a[80:83], 0
ds_read_b128 a[232:235], v10 offset:2048
v_accvgpr_write_b32 a143, v118
v_mfma_f32_16x16x32_bf16 v[80:83], a[236:239], a[68:71], v[80:83]
v_exp_f32 v37, v37
v_mfma_f32_16x16x32_bf16 v[84:87], a[236:239], a[84:87], v[84:87]
s_waitcnt lgkmcnt(5)
ds_read_b128 a[236:239], v10 offset:3072
v_cvt_pk_bf16_f32 v36, v36, v37
v_mfma_f32_16x16x32_bf16 v[80:83], a[224:227], a[72:75], v[80:83]
v_exp_f32 v38, v38
v_mfma_f32_16x16x32_bf16 v[84:87], a[224:227], a[88:91], v[84:87]
ds_read_b128 a[216:219], v1 offset:46080
v_accvgpr_read_b32 v113, a144
v_mfma_f32_16x16x32_bf16 v[80:83], a[228:231], a[76:79], v[80:83]
v_exp_f32 v39, v39
v_mfma_f32_16x16x32_bf16 v[84:87], a[228:231], a[92:95], v[84:87]
ds_read_b128 a[220:223], v2 offset:46080
v_cvt_pk_bf16_f32 v37, v38, v39
v_mfma_f32_16x16x32_bf16 v[132:135], a[160:163], v[52:55], v[132:135]
v_exp_f32 v40, v40
v_mfma_f32_16x16x32_bf16 v[164:167], a[160:163], v[56:59], v[164:167]
v_exp_f32 v41, v41
v_mfma_f32_16x16x32_bf16 v[196:199], a[160:163], v[68:71], v[196:199]
s_add_u32 m0, s30, 0x12000
s_add_u32 s37, s37, 0x2000
v_exp_f32 v80, v80
v_mfma_f32_16x16x32_bf16 v[228:231], a[160:163], v[72:75], v[228:231]
buffer_load_dwordx4 v11, s[12:15], s37 offen nt lds
v_mfma_f32_16x16x32_bf16 v[148:151], a[164:167], v[52:55], v[148:151]
ds_read_b64_tr_b16 a[160:161], v6 offset:40960
v_cvt_pk_bf16_f32 v40, v40, v41
v_mfma_f32_16x16x32_bf16 v[180:183], a[164:167], v[56:59], v[180:183]
v_exp_f32 v81, v81
v_mfma_f32_16x16x32_bf16 v[212:215], a[164:167], v[68:71], v[212:215]
ds_read_b64_tr_b16 a[162:163], v6 offset:45056
v_cvt_pk_bf16_f32 v80, v80, v81
v_mfma_f32_16x16x32_bf16 v[244:247], a[164:167], v[72:75], v[244:247]
v_exp_f32 v82, v82
v_smfmac_f32_16x16x64_bf16 a[244:247], a[240:243], v[52:59], v110
ds_read_b64_tr_b16 a[164:165], v6 offset:41984
v_accvgpr_read_b32 v115, a145
v_mfma_f32_16x16x32_bf16 v[136:139], a[168:171], v[52:55], v[136:139]
v_exp_f32 v83, v83
v_mfma_f32_16x16x32_bf16 v[168:171], a[168:171], v[56:59], v[168:171]
ds_read_b64_tr_b16 a[166:167], v6 offset:46080
v_cvt_pk_bf16_f32 v81, v82, v83
v_mfma_f32_16x16x32_bf16 v[200:203], a[168:171], v[68:71], v[200:203]
ds_write_b64 v9, v[80:81] offset:4096
v_accvgpr_read_b32 v117, a146
v_mfma_f32_16x16x32_bf16 v[232:235], a[168:171], v[72:75], v[232:235]
ds_read_b64_tr_b16 a[168:169], v7 offset:40960
v_accvgpr_read_b32 v119, a147
v_mfma_f32_16x16x32_bf16 v[152:155], a[172:175], v[52:55], v[152:155]
v_exp_f32 v84, v84
v_mfma_f32_16x16x32_bf16 v[184:187], a[172:175], v[56:59], v[184:187]
ds_read_b64_tr_b16 a[170:171], v7 offset:45056
v_lshlrev_b32 v112, 16, v113
v_mfma_f32_16x16x32_bf16 v[216:219], a[172:175], v[68:71], v[216:219]
v_exp_f32 v85, v85
v_mfma_f32_16x16x32_bf16 v[248:251], a[172:175], v[72:75], v[248:251]
s_waitcnt lgkmcnt(5)
ds_read_b64_tr_b16 a[172:173], v7 offset:41984
v_cvt_pk_bf16_f32 v84, v84, v85
v_smfmac_f32_16x16x64_bf16 a[248:251], a[240:243], v[68:75], v110
ds_read_b64_tr_b16 a[174:175], v7 offset:46080
v_lshlrev_b32 v114, 16, v115
v_mfma_f32_16x16x32_bf16 v[140:143], a[176:179], v[52:55], v[140:143]
v_exp_f32 v86, v86
v_mfma_f32_16x16x32_bf16 v[172:175], a[176:179], v[56:59], v[172:175]
v_exp_f32 v87, v87
v_mfma_f32_16x16x32_bf16 v[204:207], a[176:179], v[68:71], v[204:207]
v_exp_f32 v42, v42
v_mfma_f32_16x16x32_bf16 v[236:239], a[176:179], v[72:75], v[236:239]
ds_read_b64_tr_b16 a[176:177], v8 offset:40960
v_cvt_pk_bf16_f32 v85, v86, v87
v_mfma_f32_16x16x32_bf16 v[156:159], a[180:183], v[52:55], v[156:159]
buffer_load_dwordx4 v11, s[12:15], s37 offen offset:2048 nt lds
v_mfma_f32_16x16x32_bf16 v[188:191], a[180:183], v[56:59], v[188:191]
ds_read_b64_tr_b16 a[178:179], v8 offset:45056
v_lshlrev_b32 v116, 16, v117
v_mfma_f32_16x16x32_bf16 v[220:223], a[180:183], v[68:71], v[220:223]
ds_write_b64 v9, v[84:85] offset:5120
v_lshlrev_b32 v118, 16, v119
v_mfma_f32_16x16x32_bf16 v[252:255], a[180:183], v[72:75], v[252:255]
ds_read_b64_tr_b16 a[180:181], v8 offset:41984
v_and_b32 v113, s25, v113
v_mfma_f32_16x16x32_bf16 v[128:131], a[184:187], v[52:55], v[128:131]
v_exp_f32 v43, v43
v_mfma_f32_16x16x32_bf16 v[160:163], a[184:187], v[56:59], v[160:163]
ds_read_b64_tr_b16 a[182:183], v8 offset:46080
v_cvt_pk_bf16_f32 v41, v42, v43
v_mfma_f32_16x16x32_bf16 v[192:195], a[184:187], v[68:71], v[192:195]
v_exp_f32 v16, v16
v_mfma_f32_16x16x32_bf16 v[224:227], a[184:187], v[72:75], v[224:227]
v_exp_f32 v17, v17
v_mfma_f32_16x16x32_bf16 v[88:91], a[184:187], a[232:235], v[88:91]
v_exp_f32 v18, v18
v_mfma_f32_16x16x32_bf16 v[96:99], a[184:187], a[236:239], v[96:99]
ds_read_b64_tr_b16 a[184:185], v5 offset:40960
v_cvt_pk_bf16_f32 v22, v16, v17
v_smfmac_f32_16x16x64_bf16 a[252:255], a[240:243], a[232:239], v110
ds_read_b64_tr_b16 a[186:187], v5 offset:45056
v_and_b32 v115, s25, v115
v_mfma_f32_16x16x32_bf16 v[144:147], a[188:191], v[52:55], v[144:147]
v_exp_f32 v19, v19
v_mfma_f32_16x16x32_bf16 v[176:179], a[188:191], v[56:59], v[176:179]
v_exp_f32 v28, v28
v_mfma_f32_16x16x32_bf16 v[208:211], a[188:191], v[68:71], v[208:211]
v_exp_f32 v29, v29
v_mfma_f32_16x16x32_bf16 v[240:243], a[188:191], v[72:75], v[240:243]
v_exp_f32 v30, v30
v_mfma_f32_16x16x32_bf16 v[92:95], a[188:191], a[232:235], v[92:95]
v_exp_f32 v31, v31
v_mfma_f32_16x16x32_bf16 v[100:103], a[188:191], a[236:239], v[100:103]
ds_read_b64_tr_b16 a[188:189], v5 offset:41984
v_cvt_pk_bf16_f32 v23, v18, v19
v_mfma_f32_16x16x32_bf16 v[52:55], a[192:195], a[0:3], 0
v_exp_f32 v32, v32
v_mfma_f32_16x16x32_bf16 v[56:59], a[192:195], a[16:19], 0
s_add_u32 m0, s30, 0x2000
s_add_u32 s21, s21, 0x2000
s_waitcnt lgkmcnt(3)
ds_read_b64_tr_b16 a[190:191], v5 offset:46080
v_cvt_pk_bf16_f32 v26, v28, v29
v_mfma_f32_16x16x32_bf16 v[68:71], a[192:195], a[32:35], 0
buffer_load_dwordx4 v11, s[8:11], s21 offen nt lds
v_mfma_f32_16x16x32_bf16 v[72:75], a[192:195], a[48:51], 0
v_exp_f32 v33, v33
v_mfma_f32_16x16x32_bf16 v[52:55], a[196:199], a[4:7], v[52:55]
v_exp_f32 v34, v34
v_mfma_f32_16x16x32_bf16 v[56:59], a[196:199], a[20:23], v[56:59]
v_exp_f32 v35, v35
v_mfma_f32_16x16x32_bf16 v[68:71], a[196:199], a[36:39], v[68:71]
v_exp_f32 v44, v44
v_mfma_f32_16x16x32_bf16 v[72:75], a[196:199], a[52:55], v[72:75]
v_exp_f32 v45, v45
v_mfma_f32_16x16x32_bf16 v[52:55], a[200:203], a[8:11], v[52:55]
v_exp_f32 v46, v46
v_mfma_f32_16x16x32_bf16 v[56:59], a[200:203], a[24:27], v[56:59]
v_exp_f32 v47, v47
v_mfma_f32_16x16x32_bf16 v[68:71], a[200:203], a[40:43], v[68:71]
v_cvt_pk_bf16_f32 v27, v30, v31
v_cvt_pk_bf16_f32 v38, v32, v33
v_mfma_f32_16x16x32_bf16 v[72:75], a[200:203], a[56:59], v[72:75]
v_cvt_pk_bf16_f32 v39, v34, v35
v_cvt_pk_bf16_f32 v42, v44, v45
v_mfma_f32_16x16x32_bf16 v[52:55], a[204:207], a[12:15], v[52:55]
v_cvt_pk_bf16_f32 v43, v46, v47
v_and_b32 v117, s25, v117
v_mfma_f32_16x16x32_bf16 v[56:59], a[204:207], a[28:31], v[56:59]
v_and_b32 v119, s25, v119
v_mul_f32 v112, s26, v112
v_mfma_f32_16x16x32_bf16 v[68:71], a[204:207], a[44:47], v[68:71]
v_mul_f32 v113, s26, v113
v_mul_f32 v114, s26, v114
v_mfma_f32_16x16x32_bf16 v[72:75], a[204:207], a[60:63], v[72:75]
v_exp_f32 v52, v52
v_mfma_f32_16x16x32_bf16 v[48:51], a[208:211], a[0:3], 0
v_exp_f32 v53, v53
v_mfma_f32_16x16x32_bf16 v[60:63], a[208:211], a[16:19], 0
v_exp_f32 v54, v54
v_mfma_f32_16x16x32_bf16 v[64:67], a[208:211], a[32:35], 0
v_exp_f32 v55, v55
v_mfma_f32_16x16x32_bf16 v[76:79], a[208:211], a[48:51], 0
v_exp_f32 v56, v56
v_mfma_f32_16x16x32_bf16 v[48:51], a[212:215], a[4:7], v[48:51]
buffer_load_dwordx4 v11, s[8:11], s21 offen offset:2048 nt lds
v_mfma_f32_16x16x32_bf16 v[60:63], a[212:215], a[20:23], v[60:63]
v_exp_f32 v57, v57
v_mfma_f32_16x16x32_bf16 v[64:67], a[212:215], a[36:39], v[64:67]
v_exp_f32 v58, v58
v_mfma_f32_16x16x32_bf16 v[76:79], a[212:215], a[52:55], v[76:79]
v_exp_f32 v59, v59
v_mfma_f32_16x16x32_bf16 v[48:51], a[216:219], a[8:11], v[48:51]
v_exp_f32 v68, v68
v_mfma_f32_16x16x32_bf16 v[60:63], a[216:219], a[24:27], v[60:63]
v_exp_f32 v69, v69
v_mfma_f32_16x16x32_bf16 v[64:67], a[216:219], a[40:43], v[64:67]
v_exp_f32 v70, v70
v_mfma_f32_16x16x32_bf16 v[76:79], a[216:219], a[56:59], v[76:79]
v_exp_f32 v71, v71
v_mfma_f32_16x16x32_bf16 v[48:51], a[220:223], a[12:15], v[48:51]
v_cvt_pk_bf16_f32 v52, v52, v53
v_cvt_pk_bf16_f32 v53, v54, v55
v_mfma_f32_16x16x32_bf16 v[60:63], a[220:223], a[28:31], v[60:63]
v_exp_f32 v72, v72
v_mfma_f32_16x16x32_bf16 v[64:67], a[220:223], a[44:47], v[64:67]
v_exp_f32 v73, v73
v_mfma_f32_16x16x32_bf16 v[76:79], a[220:223], a[60:63], v[76:79]
s_waitcnt vmcnt(8) lgkmcnt(0)
s_barrier
ds_read_b128 a[224:227], v10 offset:4096
v_mfma_f32_16x16x32_bf16 v[132:135], a[160:163], v[20:23], v[132:135]
v_exp_f32 v74, v74
v_mfma_f32_16x16x32_bf16 v[164:167], a[160:163], v[24:27], v[164:167]
ds_read_b128 a[228:231], v10 offset:5120
v_cvt_pk_bf16_f32 v56, v56, v57
v_mfma_f32_16x16x32_bf16 v[196:199], a[160:163], v[36:39], v[196:199]
v_exp_f32 v75, v75
v_mfma_f32_16x16x32_bf16 v[228:231], a[160:163], v[40:43], v[228:231]
ds_read_b128 a[192:195], v1 offset:49152
v_cvt_pk_bf16_f32 v57, v58, v59
v_mfma_f32_16x16x32_bf16 v[148:151], a[164:167], v[20:23], v[148:151]
v_exp_f32 v48, v48
v_mfma_f32_16x16x32_bf16 v[180:183], a[164:167], v[24:27], v[180:183]
s_add_u32 m0, s30, 0x14000
s_add_u32 s37, s37, 0x2000
ds_read_b128 a[196:199], v2 offset:49152
v_cvt_pk_bf16_f32 v68, v68, v69
v_mfma_f32_16x16x32_bf16 v[212:215], a[164:167], v[36:39], v[212:215]
buffer_load_dwordx4 v11, s[12:15], s37 offen nt lds
v_mfma_f32_16x16x32_bf16 v[244:247], a[164:167], v[40:43], v[244:247]
ds_read_b128 a[200:203], v1 offset:50176
v_cvt_pk_bf16_f32 v69, v70, v71
v_smfmac_f32_16x16x64_bf16 a[244:247], a[240:243], v[20:27], v110
ds_read_b128 a[204:207], v2 offset:50176
v_cvt_pk_bf16_f32 v72, v72, v73
v_mfma_f32_16x16x32_bf16 v[136:139], a[168:171], v[20:23], v[136:139]
v_exp_f32 v49, v49
v_mfma_f32_16x16x32_bf16 v[168:171], a[168:171], v[24:27], v[168:171]
ds_read_b128 a[208:211], v1 offset:53248
v_cvt_pk_bf16_f32 v54, v48, v49
v_mfma_f32_16x16x32_bf16 v[200:203], a[168:171], v[36:39], v[200:203]
v_exp_f32 v50, v50
v_mfma_f32_16x16x32_bf16 v[232:235], a[168:171], v[40:43], v[232:235]
ds_read_b128 a[212:215], v2 offset:53248
v_cvt_pk_bf16_f32 v73, v74, v75
v_mfma_f32_16x16x32_bf16 v[152:155], a[172:175], v[20:23], v[152:155]
v_exp_f32 v51, v51
v_mfma_f32_16x16x32_bf16 v[184:187], a[172:175], v[24:27], v[184:187]
ds_read_b128 a[216:219], v1 offset:54272
v_cvt_pk_bf16_f32 v55, v50, v51
v_mfma_f32_16x16x32_bf16 v[216:219], a[172:175], v[36:39], v[216:219]
v_exp_f32 v60, v60
v_mfma_f32_16x16x32_bf16 v[248:251], a[172:175], v[40:43], v[248:251]
ds_read_b128 a[220:223], v2 offset:54272
v_mul_f32 v115, s26, v115
v_smfmac_f32_16x16x64_bf16 a[248:251], a[240:243], v[36:43], v110
ds_read_b128 a[232:235], v3 offset:49152
v_mul_f32 v116, s26, v116
v_mfma_f32_16x16x32_bf16 v[140:143], a[176:179], v[20:23], v[140:143]
v_exp_f32 v61, v61
v_mfma_f32_16x16x32_bf16 v[172:175], a[176:179], v[24:27], v[172:175]
ds_read_b128 a[236:239], v4 offset:49152
v_cvt_pk_bf16_f32 v58, v60, v61
v_mfma_f32_16x16x32_bf16 v[204:207], a[176:179], v[36:39], v[204:207]
v_exp_f32 v62, v62
v_mfma_f32_16x16x32_bf16 v[236:239], a[176:179], v[40:43], v[236:239]
ds_read_b64_tr_b16 a[160:161], v6 offset:49152
v_mul_f32 v117, s26, v117
v_mfma_f32_16x16x32_bf16 v[156:159], a[180:183], v[20:23], v[156:159]
v_exp_f32 v63, v63
v_mfma_f32_16x16x32_bf16 v[188:191], a[180:183], v[24:27], v[188:191]
ds_read_b64_tr_b16 a[162:163], v6 offset:53248
v_cvt_pk_bf16_f32 v59, v62, v63
v_mfma_f32_16x16x32_bf16 v[220:223], a[180:183], v[36:39], v[220:223]
v_exp_f32 v64, v64
v_mfma_f32_16x16x32_bf16 v[252:255], a[180:183], v[40:43], v[252:255]
buffer_load_dwordx4 v11, s[12:15], s37 offen offset:2048 nt lds
v_mfma_f32_16x16x32_bf16 v[128:131], a[184:187], v[20:23], v[128:131]
ds_read_b64_tr_b16 a[164:165], v6 offset:50176
v_mul_f32 v118, s26, v118
v_mfma_f32_16x16x32_bf16 v[160:163], a[184:187], v[24:27], v[160:163]
v_exp_f32 v65, v65
v_mfma_f32_16x16x32_bf16 v[192:195], a[184:187], v[36:39], v[192:195]
s_waitcnt lgkmcnt(4)
ds_read_b64_tr_b16 a[166:167], v6 offset:54272
v_cvt_pk_bf16_f32 v70, v64, v65
v_mfma_f32_16x16x32_bf16 v[224:227], a[184:187], v[40:43], v[224:227]
v_exp_f32 v66, v66
v_mfma_f32_16x16x32_bf16 v[88:91], a[184:187], a[224:227], v[88:91]
ds_read_b64_tr_b16 a[168:169], v7 offset:49152
v_mul_f32 v119, s26, v119
v_mfma_f32_16x16x32_bf16 v[96:99], a[184:187], a[228:231], v[96:99]
v_exp_f32 v67, v67
v_smfmac_f32_16x16x64_bf16 a[252:255], a[240:243], a[224:231], v110
ds_read_b64_tr_b16 a[170:171], v7 offset:53248
v_cvt_pk_bf16_f32 v71, v66, v67
v_mfma_f32_16x16x32_bf16 v[144:147], a[188:191], v[20:23], v[144:147]
v_exp_f32 v76, v76
v_mfma_f32_16x16x32_bf16 v[176:179], a[188:191], v[24:27], v[176:179]
ds_read_b64_tr_b16 a[172:173], v7 offset:50176
v_cvt_pk_bf16_f32 v112, v112, v113
v_mfma_f32_16x16x32_bf16 v[208:211], a[188:191], v[36:39], v[208:211]
v_exp_f32 v77, v77
v_mfma_f32_16x16x32_bf16 v[240:243], a[188:191], v[40:43], v[240:243]
ds_read_b64_tr_b16 a[174:175], v7 offset:54272
v_cvt_pk_bf16_f32 v74, v76, v77
v_mfma_f32_16x16x32_bf16 v[92:95], a[188:191], a[224:227], v[92:95]
v_exp_f32 v78, v78
v_mfma_f32_16x16x32_bf16 v[100:103], a[188:191], a[228:231], v[100:103]
ds_read_b128 a[224:227], v3 offset:50176
v_cvt_pk_bf16_f32 v114, v114, v115
v_mfma_f32_16x16x32_bf16 v[20:23], a[192:195], a[0:3], 0
v_exp_f32 v79, v79
v_mfma_f32_16x16x32_bf16 v[24:27], a[192:195], a[16:19], 0
ds_read_b128 a[228:231], v4 offset:50176
v_cvt_pk_bf16_f32 v75, v78, v79
v_mfma_f32_16x16x32_bf16 v[36:39], a[192:195], a[32:35], 0
v_cvt_pk_bf16_f32 v116, v116, v117
v_cvt_pk_bf16_f32 v118, v118, v119
v_mfma_f32_16x16x32_bf16 v[40:43], a[192:195], a[48:51], 0
ds_read_b64_tr_b16 a[176:177], v8 offset:49152
v_accvgpr_write_b32 a144, v112
v_mfma_f32_16x16x32_bf16 v[20:23], a[196:199], a[4:7], v[20:23]
s_add_u32 m0, s30, 0x4000
s_add_u32 s21, s21, 0x2000
v_accvgpr_write_b32 a145, v114
v_mfma_f32_16x16x32_bf16 v[24:27], a[196:199], a[20:23], v[24:27]
buffer_load_dwordx4 v11, s[8:11], s21 offen nt lds
v_mfma_f32_16x16x32_bf16 v[36:39], a[196:199], a[36:39], v[36:39]
ds_read_b64_tr_b16 a[178:179], v8 offset:53248
v_accvgpr_write_b32 a146, v116
v_mfma_f32_16x16x32_bf16 v[40:43], a[196:199], a[52:55], v[40:43]
v_accvgpr_write_b32 a147, v118
v_mfma_f32_16x16x32_bf16 v[20:23], a[200:203], a[8:11], v[20:23]
ds_read_b64_tr_b16 a[180:181], v8 offset:50176
v_accvgpr_read_b32 v113, a148
v_mfma_f32_16x16x32_bf16 v[24:27], a[200:203], a[24:27], v[24:27]
v_accvgpr_read_b32 v115, a149
v_accvgpr_read_b32 v117, a150
v_mfma_f32_16x16x32_bf16 v[36:39], a[200:203], a[40:43], v[36:39]
ds_read_b64_tr_b16 a[182:183], v8 offset:54272
v_accvgpr_read_b32 v119, a151
v_mfma_f32_16x16x32_bf16 v[40:43], a[200:203], a[56:59], v[40:43]
v_lshlrev_b32 v112, 16, v113
v_lshlrev_b32 v114, 16, v115
v_mfma_f32_16x16x32_bf16 v[20:23], a[204:207], a[12:15], v[20:23]
s_waitcnt lgkmcnt(4)
ds_read_b64_tr_b16 a[184:185], v5 offset:49152
v_lshlrev_b32 v116, 16, v117
v_mfma_f32_16x16x32_bf16 v[24:27], a[204:207], a[28:31], v[24:27]
v_lshlrev_b32 v118, 16, v119
v_and_b32 v113, s25, v113
v_mfma_f32_16x16x32_bf16 v[36:39], a[204:207], a[44:47], v[36:39]
ds_read_b64_tr_b16 a[186:187], v5 offset:53248
v_and_b32 v115, s25, v115
v_mfma_f32_16x16x32_bf16 v[40:43], a[204:207], a[60:63], v[40:43]
v_exp_f32 v20, v20
v_mfma_f32_16x16x32_bf16 v[16:19], a[208:211], a[0:3], 0
ds_read_b64_tr_b16 a[188:189], v5 offset:50176
v_and_b32 v117, s25, v117
v_mfma_f32_16x16x32_bf16 v[28:31], a[208:211], a[16:19], 0
v_exp_f32 v21, v21
v_mfma_f32_16x16x32_bf16 v[32:35], a[208:211], a[32:35], 0
ds_read_b64_tr_b16 a[190:191], v5 offset:54272
v_cvt_pk_bf16_f32 v20, v20, v21
v_mfma_f32_16x16x32_bf16 v[44:47], a[208:211], a[48:51], 0
v_exp_f32 v22, v22
v_mfma_f32_16x16x32_bf16 v[16:19], a[212:215], a[4:7], v[16:19]
ds_read_b128 a[192:195], v1 offset:57344
v_and_b32 v119, s25, v119
v_mfma_f32_16x16x32_bf16 v[28:31], a[212:215], a[20:23], v[28:31]
v_exp_f32 v23, v23
v_mfma_f32_16x16x32_bf16 v[32:35], a[212:215], a[36:39], v[32:35]
ds_read_b128 a[196:199], v2 offset:57344
v_cvt_pk_bf16_f32 v21, v22, v23
v_mfma_f32_16x16x32_bf16 v[44:47], a[212:215], a[52:55], v[44:47]
v_exp_f32 v24, v24
v_mfma_f32_16x16x32_bf16 v[16:19], a[216:219], a[8:11], v[16:19]
buffer_load_dwordx4 v11, s[8:11], s21 offen offset:2048 nt lds
v_mfma_f32_16x16x32_bf16 v[28:31], a[216:219], a[24:27], v[28:31]
ds_read_b128 a[200:203], v1 offset:58368
v_mul_f32 v112, s26, v112
v_mfma_f32_16x16x32_bf16 v[32:35], a[216:219], a[40:43], v[32:35]
v_exp_f32 v25, v25
v_mfma_f32_16x16x32_bf16 v[44:47], a[216:219], a[56:59], v[44:47]
ds_read_b128 a[204:207], v2 offset:58368
v_cvt_pk_bf16_f32 v24, v24, v25
v_mfma_f32_16x16x32_bf16 v[16:19], a[220:223], a[12:15], v[16:19]
v_exp_f32 v26, v26
v_mfma_f32_16x16x32_bf16 v[28:31], a[220:223], a[28:31], v[28:31]
ds_read_b128 a[208:211], v1 offset:61440
v_mul_f32 v113, s26, v113
v_mfma_f32_16x16x32_bf16 v[32:35], a[220:223], a[44:47], v[32:35]
v_exp_f32 v27, v27
v_mfma_f32_16x16x32_bf16 v[44:47], a[220:223], a[60:63], v[44:47]
ds_read_b128 a[212:215], v2 offset:61440
v_cvt_pk_bf16_f32 v25, v26, v27
v_mfma_f32_16x16x32_bf16 v[80:83], a[232:235], a[64:67], 0
v_exp_f32 v36, v36
v_mfma_f32_16x16x32_bf16 v[84:87], a[232:235], a[80:83], 0
ds_read_b128 a[232:235], v10 offset:6144
v_mul_f32 v114, s26, v114
v_mfma_f32_16x16x32_bf16 v[80:83], a[236:239], a[68:71], v[80:83]
v_exp_f32 v37, v37
v_mfma_f32_16x16x32_bf16 v[84:87], a[236:239], a[84:87], v[84:87]
s_waitcnt lgkmcnt(5)
ds_read_b128 a[236:239], v10 offset:7168
v_cvt_pk_bf16_f32 v36, v36, v37
v_mfma_f32_16x16x32_bf16 v[80:83], a[224:227], a[72:75], v[80:83]
v_exp_f32 v38, v38
v_mfma_f32_16x16x32_bf16 v[84:87], a[224:227], a[88:91], v[84:87]
ds_read_b128 a[216:219], v1 offset:62464
v_mul_f32 v115, s26, v115
v_mfma_f32_16x16x32_bf16 v[80:83], a[228:231], a[76:79], v[80:83]
v_exp_f32 v39, v39
v_mfma_f32_16x16x32_bf16 v[84:87], a[228:231], a[92:95], v[84:87]
ds_read_b128 a[220:223], v2 offset:62464
v_cvt_pk_bf16_f32 v37, v38, v39
v_mfma_f32_16x16x32_bf16 v[132:135], a[160:163], v[52:55], v[132:135]
v_exp_f32 v40, v40
v_mfma_f32_16x16x32_bf16 v[164:167], a[160:163], v[56:59], v[164:167]
v_exp_f32 v41, v41
v_mfma_f32_16x16x32_bf16 v[196:199], a[160:163], v[68:71], v[196:199]
s_add_u32 m0, s30, 0x16000
s_add_u32 s37, s37, 0x2000
v_exp_f32 v80, v80
v_mfma_f32_16x16x32_bf16 v[228:231], a[160:163], v[72:75], v[228:231]
buffer_load_dwordx4 v11, s[12:15], s37 offen nt lds
v_mfma_f32_16x16x32_bf16 v[148:151], a[164:167], v[52:55], v[148:151]
ds_read_b64_tr_b16 a[160:161], v6 offset:57344
v_cvt_pk_bf16_f32 v40, v40, v41
v_mfma_f32_16x16x32_bf16 v[180:183], a[164:167], v[56:59], v[180:183]
v_exp_f32 v81, v81
v_mfma_f32_16x16x32_bf16 v[212:215], a[164:167], v[68:71], v[212:215]
ds_read_b64_tr_b16 a[162:163], v6 offset:61440
v_cvt_pk_bf16_f32 v80, v80, v81
v_mfma_f32_16x16x32_bf16 v[244:247], a[164:167], v[72:75], v[244:247]
v_exp_f32 v82, v82
v_smfmac_f32_16x16x64_bf16 a[244:247], a[240:243], v[52:59], v110
ds_read_b64_tr_b16 a[164:165], v6 offset:58368
v_mul_f32 v116, s26, v116
v_mfma_f32_16x16x32_bf16 v[136:139], a[168:171], v[52:55], v[136:139]
v_exp_f32 v83, v83
v_mfma_f32_16x16x32_bf16 v[168:171], a[168:171], v[56:59], v[168:171]
ds_read_b64_tr_b16 a[166:167], v6 offset:62464
v_cvt_pk_bf16_f32 v81, v82, v83
v_mfma_f32_16x16x32_bf16 v[200:203], a[168:171], v[68:71], v[200:203]
ds_write_b64 v9, v[80:81] offset:0
v_mul_f32 v117, s26, v117
v_mfma_f32_16x16x32_bf16 v[232:235], a[168:171], v[72:75], v[232:235]
ds_read_b64_tr_b16 a[168:169], v7 offset:57344
v_mul_f32 v118, s26, v118
v_mfma_f32_16x16x32_bf16 v[152:155], a[172:175], v[52:55], v[152:155]
v_exp_f32 v84, v84
v_mfma_f32_16x16x32_bf16 v[184:187], a[172:175], v[56:59], v[184:187]
ds_read_b64_tr_b16 a[170:171], v7 offset:61440
v_mul_f32 v119, s26, v119
v_mfma_f32_16x16x32_bf16 v[216:219], a[172:175], v[68:71], v[216:219]
v_exp_f32 v85, v85
v_mfma_f32_16x16x32_bf16 v[248:251], a[172:175], v[72:75], v[248:251]
s_waitcnt lgkmcnt(5)
ds_read_b64_tr_b16 a[172:173], v7 offset:58368
v_cvt_pk_bf16_f32 v84, v84, v85
v_smfmac_f32_16x16x64_bf16 a[248:251], a[240:243], v[68:75], v110
ds_read_b64_tr_b16 a[174:175], v7 offset:62464
v_cvt_pk_bf16_f32 v112, v112, v113
v_mfma_f32_16x16x32_bf16 v[140:143], a[176:179], v[52:55], v[140:143]
v_exp_f32 v86, v86
v_mfma_f32_16x16x32_bf16 v[172:175], a[176:179], v[56:59], v[172:175]
v_exp_f32 v87, v87
v_mfma_f32_16x16x32_bf16 v[204:207], a[176:179], v[68:71], v[204:207]
v_exp_f32 v42, v42
v_mfma_f32_16x16x32_bf16 v[236:239], a[176:179], v[72:75], v[236:239]
ds_read_b64_tr_b16 a[176:177], v8 offset:57344
v_cvt_pk_bf16_f32 v85, v86, v87
v_mfma_f32_16x16x32_bf16 v[156:159], a[180:183], v[52:55], v[156:159]
buffer_load_dwordx4 v11, s[12:15], s37 offen offset:2048 nt lds
v_mfma_f32_16x16x32_bf16 v[188:191], a[180:183], v[56:59], v[188:191]
ds_read_b64_tr_b16 a[178:179], v8 offset:61440
v_cvt_pk_bf16_f32 v114, v114, v115
v_mfma_f32_16x16x32_bf16 v[220:223], a[180:183], v[68:71], v[220:223]
ds_write_b64 v9, v[84:85] offset:1024
v_cvt_pk_bf16_f32 v116, v116, v117
v_mfma_f32_16x16x32_bf16 v[252:255], a[180:183], v[72:75], v[252:255]
ds_read_b64_tr_b16 a[180:181], v8 offset:58368
v_cvt_pk_bf16_f32 v118, v118, v119
v_mfma_f32_16x16x32_bf16 v[128:131], a[184:187], v[52:55], v[128:131]
v_exp_f32 v43, v43
v_mfma_f32_16x16x32_bf16 v[160:163], a[184:187], v[56:59], v[160:163]
ds_read_b64_tr_b16 a[182:183], v8 offset:62464
v_cvt_pk_bf16_f32 v41, v42, v43
v_mfma_f32_16x16x32_bf16 v[192:195], a[184:187], v[68:71], v[192:195]
v_exp_f32 v16, v16
v_mfma_f32_16x16x32_bf16 v[224:227], a[184:187], v[72:75], v[224:227]
v_exp_f32 v17, v17
v_mfma_f32_16x16x32_bf16 v[88:91], a[184:187], a[232:235], v[88:91]
v_exp_f32 v18, v18
v_mfma_f32_16x16x32_bf16 v[96:99], a[184:187], a[236:239], v[96:99]
ds_read_b64_tr_b16 a[184:185], v5 offset:57344
v_cvt_pk_bf16_f32 v22, v16, v17
v_smfmac_f32_16x16x64_bf16 a[252:255], a[240:243], a[232:239], v110
ds_read_b64_tr_b16 a[186:187], v5 offset:61440
v_accvgpr_write_b32 a148, v112
v_mfma_f32_16x16x32_bf16 v[144:147], a[188:191], v[52:55], v[144:147]
v_exp_f32 v19, v19
v_mfma_f32_16x16x32_bf16 v[176:179], a[188:191], v[56:59], v[176:179]
v_exp_f32 v28, v28
v_mfma_f32_16x16x32_bf16 v[208:211], a[188:191], v[68:71], v[208:211]
v_exp_f32 v29, v29
v_mfma_f32_16x16x32_bf16 v[240:243], a[188:191], v[72:75], v[240:243]
v_exp_f32 v30, v30
v_mfma_f32_16x16x32_bf16 v[92:95], a[188:191], a[232:235], v[92:95]
v_exp_f32 v31, v31
v_mfma_f32_16x16x32_bf16 v[100:103], a[188:191], a[236:239], v[100:103]
ds_read_b64_tr_b16 a[188:189], v5 offset:58368
v_cvt_pk_bf16_f32 v23, v18, v19
v_mfma_f32_16x16x32_bf16 v[52:55], a[192:195], a[0:3], 0
v_exp_f32 v32, v32
v_mfma_f32_16x16x32_bf16 v[56:59], a[192:195], a[16:19], 0
s_add_u32 m0, s30, 0x6000
s_add_u32 s21, s21, 0x2000
s_waitcnt lgkmcnt(3)
ds_read_b64_tr_b16 a[190:191], v5 offset:62464
v_cvt_pk_bf16_f32 v26, v28, v29
v_mfma_f32_16x16x32_bf16 v[68:71], a[192:195], a[32:35], 0
buffer_load_dwordx4 v11, s[8:11], s21 offen nt lds
v_mfma_f32_16x16x32_bf16 v[72:75], a[192:195], a[48:51], 0
v_exp_f32 v33, v33
v_mfma_f32_16x16x32_bf16 v[52:55], a[196:199], a[4:7], v[52:55]
v_exp_f32 v34, v34
v_mfma_f32_16x16x32_bf16 v[56:59], a[196:199], a[20:23], v[56:59]
v_exp_f32 v35, v35
v_mfma_f32_16x16x32_bf16 v[68:71], a[196:199], a[36:39], v[68:71]
v_exp_f32 v44, v44
v_mfma_f32_16x16x32_bf16 v[72:75], a[196:199], a[52:55], v[72:75]
v_exp_f32 v45, v45
v_mfma_f32_16x16x32_bf16 v[52:55], a[200:203], a[8:11], v[52:55]
v_exp_f32 v46, v46
v_mfma_f32_16x16x32_bf16 v[56:59], a[200:203], a[24:27], v[56:59]
v_exp_f32 v47, v47
v_mfma_f32_16x16x32_bf16 v[68:71], a[200:203], a[40:43], v[68:71]
v_cvt_pk_bf16_f32 v27, v30, v31
v_cvt_pk_bf16_f32 v38, v32, v33
v_mfma_f32_16x16x32_bf16 v[72:75], a[200:203], a[56:59], v[72:75]
v_cvt_pk_bf16_f32 v39, v34, v35
v_cvt_pk_bf16_f32 v42, v44, v45
v_mfma_f32_16x16x32_bf16 v[52:55], a[204:207], a[12:15], v[52:55]
v_cvt_pk_bf16_f32 v43, v46, v47
v_accvgpr_write_b32 a149, v114
v_mfma_f32_16x16x32_bf16 v[56:59], a[204:207], a[28:31], v[56:59]
v_accvgpr_write_b32 a150, v116
v_accvgpr_write_b32 a151, v118
v_mfma_f32_16x16x32_bf16 v[68:71], a[204:207], a[44:47], v[68:71]
v_accvgpr_read_b32 v113, a152
v_mfma_f32_16x16x32_bf16 v[72:75], a[204:207], a[60:63], v[72:75]
v_exp_f32 v52, v52
v_mfma_f32_16x16x32_bf16 v[48:51], a[208:211], a[0:3], 0
v_exp_f32 v53, v53
v_mfma_f32_16x16x32_bf16 v[60:63], a[208:211], a[16:19], 0
v_exp_f32 v54, v54
v_mfma_f32_16x16x32_bf16 v[64:67], a[208:211], a[32:35], 0
v_exp_f32 v55, v55
v_mfma_f32_16x16x32_bf16 v[76:79], a[208:211], a[48:51], 0
v_exp_f32 v56, v56
v_mfma_f32_16x16x32_bf16 v[48:51], a[212:215], a[4:7], v[48:51]
buffer_load_dwordx4 v11, s[8:11], s21 offen offset:2048 nt lds
v_mfma_f32_16x16x32_bf16 v[60:63], a[212:215], a[20:23], v[60:63]
v_exp_f32 v57, v57
v_mfma_f32_16x16x32_bf16 v[64:67], a[212:215], a[36:39], v[64:67]
v_exp_f32 v58, v58
v_mfma_f32_16x16x32_bf16 v[76:79], a[212:215], a[52:55], v[76:79]
v_exp_f32 v59, v59
v_mfma_f32_16x16x32_bf16 v[48:51], a[216:219], a[8:11], v[48:51]
v_exp_f32 v68, v68
v_mfma_f32_16x16x32_bf16 v[60:63], a[216:219], a[24:27], v[60:63]
v_exp_f32 v69, v69
v_mfma_f32_16x16x32_bf16 v[64:67], a[216:219], a[40:43], v[64:67]
v_exp_f32 v70, v70
v_mfma_f32_16x16x32_bf16 v[76:79], a[216:219], a[56:59], v[76:79]
v_exp_f32 v71, v71
v_mfma_f32_16x16x32_bf16 v[48:51], a[220:223], a[12:15], v[48:51]
v_cvt_pk_bf16_f32 v52, v52, v53
v_cvt_pk_bf16_f32 v53, v54, v55
v_mfma_f32_16x16x32_bf16 v[60:63], a[220:223], a[28:31], v[60:63]
v_exp_f32 v72, v72
v_mfma_f32_16x16x32_bf16 v[64:67], a[220:223], a[44:47], v[64:67]
v_exp_f32 v73, v73
v_mfma_f32_16x16x32_bf16 v[76:79], a[220:223], a[60:63], v[76:79]
s_waitcnt vmcnt(8) lgkmcnt(0)
s_barrier
ds_read_b128 a[224:227], v10 offset:0
v_mfma_f32_16x16x32_bf16 v[132:135], a[160:163], v[20:23], v[132:135]
v_exp_f32 v74, v74
v_mfma_f32_16x16x32_bf16 v[164:167], a[160:163], v[24:27], v[164:167]
ds_read_b128 a[228:231], v10 offset:1024
v_cvt_pk_bf16_f32 v56, v56, v57
v_mfma_f32_16x16x32_bf16 v[196:199], a[160:163], v[36:39], v[196:199]
v_exp_f32 v75, v75
v_mfma_f32_16x16x32_bf16 v[228:231], a[160:163], v[40:43], v[228:231]
ds_read_b128 a[192:195], v1 offset:0
v_cvt_pk_bf16_f32 v57, v58, v59
v_mfma_f32_16x16x32_bf16 v[148:151], a[164:167], v[20:23], v[148:151]
v_exp_f32 v48, v48
v_mfma_f32_16x16x32_bf16 v[180:183], a[164:167], v[24:27], v[180:183]
s_add_u32 m0, s30, 0x18000
s_add_u32 s37, s37, 0x2000
ds_read_b128 a[196:199], v2 offset:0
v_cvt_pk_bf16_f32 v68, v68, v69
v_mfma_f32_16x16x32_bf16 v[212:215], a[164:167], v[36:39], v[212:215]
buffer_load_dwordx4 v11, s[12:15], s37 offen nt lds
v_mfma_f32_16x16x32_bf16 v[244:247], a[164:167], v[40:43], v[244:247]
ds_read_b128 a[200:203], v1 offset:1024
v_cvt_pk_bf16_f32 v69, v70, v71
v_smfmac_f32_16x16x64_bf16 a[244:247], a[240:243], v[20:27], v110
ds_read_b128 a[204:207], v2 offset:1024
v_cvt_pk_bf16_f32 v72, v72, v73
v_mfma_f32_16x16x32_bf16 v[136:139], a[168:171], v[20:23], v[136:139]
v_exp_f32 v49, v49
v_mfma_f32_16x16x32_bf16 v[168:171], a[168:171], v[24:27], v[168:171]
ds_read_b128 a[208:211], v1 offset:4096
v_cvt_pk_bf16_f32 v54, v48, v49
v_mfma_f32_16x16x32_bf16 v[200:203], a[168:171], v[36:39], v[200:203]
v_exp_f32 v50, v50
v_mfma_f32_16x16x32_bf16 v[232:235], a[168:171], v[40:43], v[232:235]
ds_read_b128 a[212:215], v2 offset:4096
v_cvt_pk_bf16_f32 v73, v74, v75
v_mfma_f32_16x16x32_bf16 v[152:155], a[172:175], v[20:23], v[152:155]
v_exp_f32 v51, v51
v_mfma_f32_16x16x32_bf16 v[184:187], a[172:175], v[24:27], v[184:187]
ds_read_b128 a[216:219], v1 offset:5120
v_cvt_pk_bf16_f32 v55, v50, v51
v_mfma_f32_16x16x32_bf16 v[216:219], a[172:175], v[36:39], v[216:219]
v_exp_f32 v60, v60
v_mfma_f32_16x16x32_bf16 v[248:251], a[172:175], v[40:43], v[248:251]
ds_read_b128 a[220:223], v2 offset:5120
v_accvgpr_read_b32 v115, a153
v_smfmac_f32_16x16x64_bf16 a[248:251], a[240:243], v[36:43], v110
ds_read_b128 a[232:235], v3 offset:0
v_accvgpr_read_b32 v117, a154
v_mfma_f32_16x16x32_bf16 v[140:143], a[176:179], v[20:23], v[140:143]
v_exp_f32 v61, v61
v_mfma_f32_16x16x32_bf16 v[172:175], a[176:179], v[24:27], v[172:175]
ds_read_b128 a[236:239], v4 offset:0
v_cvt_pk_bf16_f32 v58, v60, v61
v_mfma_f32_16x16x32_bf16 v[204:207], a[176:179], v[36:39], v[204:207]
v_exp_f32 v62, v62
v_mfma_f32_16x16x32_bf16 v[236:239], a[176:179], v[40:43], v[236:239]
ds_read_b64_tr_b16 a[160:161], v6 offset:0
v_accvgpr_read_b32 v119, a155
v_mfma_f32_16x16x32_bf16 v[156:159], a[180:183], v[20:23], v[156:159]
v_exp_f32 v63, v63
v_mfma_f32_16x16x32_bf16 v[188:191], a[180:183], v[24:27], v[188:191]
ds_read_b64_tr_b16 a[162:163], v6 offset:4096
v_cvt_pk_bf16_f32 v59, v62, v63
v_mfma_f32_16x16x32_bf16 v[220:223], a[180:183], v[36:39], v[220:223]
v_exp_f32 v64, v64
v_mfma_f32_16x16x32_bf16 v[252:255], a[180:183], v[40:43], v[252:255]
buffer_load_dwordx4 v11, s[12:15], s37 offen offset:2048 nt lds
v_mfma_f32_16x16x32_bf16 v[128:131], a[184:187], v[20:23], v[128:131]
ds_read_b64_tr_b16 a[164:165], v6 offset:1024
v_lshlrev_b32 v112, 16, v113
v_mfma_f32_16x16x32_bf16 v[160:163], a[184:187], v[24:27], v[160:163]
v_exp_f32 v65, v65
v_mfma_f32_16x16x32_bf16 v[192:195], a[184:187], v[36:39], v[192:195]
s_waitcnt lgkmcnt(4)
ds_read_b64_tr_b16 a[166:167], v6 offset:5120
v_cvt_pk_bf16_f32 v70, v64, v65
v_mfma_f32_16x16x32_bf16 v[224:227], a[184:187], v[40:43], v[224:227]
v_exp_f32 v66, v66
v_mfma_f32_16x16x32_bf16 v[88:91], a[184:187], a[224:227], v[88:91]
ds_read_b64_tr_b16 a[168:169], v7 offset:0
v_lshlrev_b32 v114, 16, v115
v_mfma_f32_16x16x32_bf16 v[96:99], a[184:187], a[228:231], v[96:99]
v_exp_f32 v67, v67
v_smfmac_f32_16x16x64_bf16 a[252:255], a[240:243], a[224:231], v110
ds_read_b64_tr_b16 a[170:171], v7 offset:4096
v_cvt_pk_bf16_f32 v71, v66, v67
v_mfma_f32_16x16x32_bf16 v[144:147], a[188:191], v[20:23], v[144:147]
v_exp_f32 v76, v76
v_mfma_f32_16x16x32_bf16 v[176:179], a[188:191], v[24:27], v[176:179]
ds_read_b64_tr_b16 a[172:173], v7 offset:1024
v_lshlrev_b32 v116, 16, v117
v_mfma_f32_16x16x32_bf16 v[208:211], a[188:191], v[36:39], v[208:211]
v_exp_f32 v77, v77
v_mfma_f32_16x16x32_bf16 v[240:243], a[188:191], v[40:43], v[240:243]
ds_read_b64_tr_b16 a[174:175], v7 offset:5120
v_cvt_pk_bf16_f32 v74, v76, v77
v_mfma_f32_16x16x32_bf16 v[92:95], a[188:191], a[224:227], v[92:95]
v_exp_f32 v78, v78
v_mfma_f32_16x16x32_bf16 v[100:103], a[188:191], a[228:231], v[100:103]
ds_read_b128 a[224:227], v3 offset:1024
v_lshlrev_b32 v118, 16, v119
v_mfma_f32_16x16x32_bf16 v[20:23], a[192:195], a[0:3], 0
v_exp_f32 v79, v79
v_mfma_f32_16x16x32_bf16 v[24:27], a[192:195], a[16:19], 0
ds_read_b128 a[228:231], v4 offset:1024
v_cvt_pk_bf16_f32 v75, v78, v79
v_mfma_f32_16x16x32_bf16 v[36:39], a[192:195], a[32:35], 0
v_and_b32 v113, s25, v113
v_and_b32 v115, s25, v115
v_mfma_f32_16x16x32_bf16 v[40:43], a[192:195], a[48:51], 0
ds_read_b64_tr_b16 a[176:177], v8 offset:0
v_and_b32 v117, s25, v117
v_mfma_f32_16x16x32_bf16 v[20:23], a[196:199], a[4:7], v[20:23]
s_add_u32 m0, s30, 0x8000
s_add_u32 s21, s21, 0x2000
v_and_b32 v119, s25, v119
v_mfma_f32_16x16x32_bf16 v[24:27], a[196:199], a[20:23], v[24:27]
buffer_load_dwordx4 v11, s[8:11], s21 offen nt lds
v_mfma_f32_16x16x32_bf16 v[36:39], a[196:199], a[36:39], v[36:39]
ds_read_b64_tr_b16 a[178:179], v8 offset:4096
v_mul_f32 v112, s26, v112
v_mfma_f32_16x16x32_bf16 v[40:43], a[196:199], a[52:55], v[40:43]
v_mul_f32 v113, s26, v113
v_mul_f32 v114, s26, v114
v_mfma_f32_16x16x32_bf16 v[20:23], a[200:203], a[8:11], v[20:23]
ds_read_b64_tr_b16 a[180:181], v8 offset:1024
v_mul_f32 v115, s26, v115
v_mfma_f32_16x16x32_bf16 v[24:27], a[200:203], a[24:27], v[24:27]
v_mul_f32 v116, s26, v116
v_mul_f32 v117, s26, v117
v_mfma_f32_16x16x32_bf16 v[36:39], a[200:203], a[40:43], v[36:39]
ds_read_b64_tr_b16 a[182:183], v8 offset:5120
v_mul_f32 v118, s26, v118
v_mfma_f32_16x16x32_bf16 v[40:43], a[200:203], a[56:59], v[40:43]
v_mul_f32 v119, s26, v119
v_cvt_pk_bf16_f32 v112, v112, v113
v_mfma_f32_16x16x32_bf16 v[20:23], a[204:207], a[12:15], v[20:23]
s_waitcnt lgkmcnt(4)
ds_read_b64_tr_b16 a[184:185], v5 offset:0
v_cvt_pk_bf16_f32 v114, v114, v115
v_mfma_f32_16x16x32_bf16 v[24:27], a[204:207], a[28:31], v[24:27]
v_cvt_pk_bf16_f32 v116, v116, v117
v_cvt_pk_bf16_f32 v118, v118, v119
v_mfma_f32_16x16x32_bf16 v[36:39], a[204:207], a[44:47], v[36:39]
ds_read_b64_tr_b16 a[186:187], v5 offset:4096
v_accvgpr_write_b32 a152, v112
v_mfma_f32_16x16x32_bf16 v[40:43], a[204:207], a[60:63], v[40:43]
v_exp_f32 v20, v20
v_mfma_f32_16x16x32_bf16 v[16:19], a[208:211], a[0:3], 0
ds_read_b64_tr_b16 a[188:189], v5 offset:1024
v_accvgpr_write_b32 a153, v114
v_mfma_f32_16x16x32_bf16 v[28:31], a[208:211], a[16:19], 0
v_exp_f32 v21, v21
v_mfma_f32_16x16x32_bf16 v[32:35], a[208:211], a[32:35], 0
ds_read_b64_tr_b16 a[190:191], v5 offset:5120
v_cvt_pk_bf16_f32 v20, v20, v21
v_mfma_f32_16x16x32_bf16 v[44:47], a[208:211], a[48:51], 0
v_exp_f32 v22, v22
v_mfma_f32_16x16x32_bf16 v[16:19], a[212:215], a[4:7], v[16:19]
ds_read_b128 a[192:195], v1 offset:8192
v_accvgpr_write_b32 a154, v116
v_mfma_f32_16x16x32_bf16 v[28:31], a[212:215], a[20:23], v[28:31]
v_exp_f32 v23, v23
v_mfma_f32_16x16x32_bf16 v[32:35], a[212:215], a[36:39], v[32:35]
ds_read_b128 a[196:199], v2 offset:8192
v_cvt_pk_bf16_f32 v21, v22, v23
v_mfma_f32_16x16x32_bf16 v[44:47], a[212:215], a[52:55], v[44:47]
v_exp_f32 v24, v24
v_mfma_f32_16x16x32_bf16 v[16:19], a[216:219], a[8:11], v[16:19]
buffer_load_dwordx4 v11, s[8:11], s21 offen offset:2048 nt lds
v_mfma_f32_16x16x32_bf16 v[28:31], a[216:219], a[24:27], v[28:31]
ds_read_b128 a[200:203], v1 offset:9216
v_accvgpr_write_b32 a155, v118
v_mfma_f32_16x16x32_bf16 v[32:35], a[216:219], a[40:43], v[32:35]
v_exp_f32 v25, v25
v_mfma_f32_16x16x32_bf16 v[44:47], a[216:219], a[56:59], v[44:47]
ds_read_b128 a[204:207], v2 offset:9216
v_cvt_pk_bf16_f32 v24, v24, v25
v_mfma_f32_16x16x32_bf16 v[16:19], a[220:223], a[12:15], v[16:19]
v_exp_f32 v26, v26
v_mfma_f32_16x16x32_bf16 v[28:31], a[220:223], a[28:31], v[28:31]
ds_read_b128 a[208:211], v1 offset:12288
v_accvgpr_read_b32 v113, a156
v_mfma_f32_16x16x32_bf16 v[32:35], a[220:223], a[44:47], v[32:35]
v_exp_f32 v27, v27
v_mfma_f32_16x16x32_bf16 v[44:47], a[220:223], a[60:63], v[44:47]
ds_read_b128 a[212:215], v2 offset:12288
v_cvt_pk_bf16_f32 v25, v26, v27
v_mfma_f32_16x16x32_bf16 v[80:83], a[232:235], a[64:67], 0
v_exp_f32 v36, v36
v_mfma_f32_16x16x32_bf16 v[84:87], a[232:235], a[80:83], 0
ds_read_b128 a[232:235], v10 offset:2048
v_accvgpr_read_b32 v115, a157
v_mfma_f32_16x16x32_bf16 v[80:83], a[236:239], a[68:71], v[80:83]
v_exp_f32 v37, v37
v_mfma_f32_16x16x32_bf16 v[84:87], a[236:239], a[84:87], v[84:87]
s_waitcnt lgkmcnt(5)
ds_read_b128 a[236:239], v10 offset:3072
v_cvt_pk_bf16_f32 v36, v36, v37
v_mfma_f32_16x16x32_bf16 v[80:83], a[224:227], a[72:75], v[80:83]
v_exp_f32 v38, v38
v_mfma_f32_16x16x32_bf16 v[84:87], a[224:227], a[88:91], v[84:87]
ds_read_b128 a[216:219], v1 offset:13312
v_accvgpr_read_b32 v117, a158
v_mfma_f32_16x16x32_bf16 v[80:83], a[228:231], a[76:79], v[80:83]
v_exp_f32 v39, v39
v_mfma_f32_16x16x32_bf16 v[84:87], a[228:231], a[92:95], v[84:87]
ds_read_b128 a[220:223], v2 offset:13312
v_cvt_pk_bf16_f32 v37, v38, v39
v_mfma_f32_16x16x32_bf16 v[132:135], a[160:163], v[52:55], v[132:135]
v_exp_f32 v40, v40
v_mfma_f32_16x16x32_bf16 v[164:167], a[160:163], v[56:59], v[164:167]
v_exp_f32 v41, v41
v_mfma_f32_16x16x32_bf16 v[196:199], a[160:163], v[68:71], v[196:199]
s_add_u32 m0, s30, 0x1a000
s_add_u32 s37, s37, 0x2000
v_exp_f32 v80, v80
v_mfma_f32_16x16x32_bf16 v[228:231], a[160:163], v[72:75], v[228:231]
buffer_load_dwordx4 v11, s[12:15], s37 offen nt lds
v_mfma_f32_16x16x32_bf16 v[148:151], a[164:167], v[52:55], v[148:151]
ds_read_b64_tr_b16 a[160:161], v6 offset:8192
v_cvt_pk_bf16_f32 v40, v40, v41
v_mfma_f32_16x16x32_bf16 v[180:183], a[164:167], v[56:59], v[180:183]
v_exp_f32 v81, v81
v_mfma_f32_16x16x32_bf16 v[212:215], a[164:167], v[68:71], v[212:215]
ds_read_b64_tr_b16 a[162:163], v6 offset:12288
v_cvt_pk_bf16_f32 v80, v80, v81
v_mfma_f32_16x16x32_bf16 v[244:247], a[164:167], v[72:75], v[244:247]
v_exp_f32 v82, v82
v_smfmac_f32_16x16x64_bf16 a[244:247], a[240:243], v[52:59], v110
ds_read_b64_tr_b16 a[164:165], v6 offset:9216
v_accvgpr_read_b32 v119, a159
v_mfma_f32_16x16x32_bf16 v[136:139], a[168:171], v[52:55], v[136:139]
v_exp_f32 v83, v83
v_mfma_f32_16x16x32_bf16 v[168:171], a[168:171], v[56:59], v[168:171]
ds_read_b64_tr_b16 a[166:167], v6 offset:13312
v_cvt_pk_bf16_f32 v81, v82, v83
v_mfma_f32_16x16x32_bf16 v[200:203], a[168:171], v[68:71], v[200:203]
ds_write_b64 v9, v[80:81] offset:4096
v_lshlrev_b32 v112, 16, v113
v_mfma_f32_16x16x32_bf16 v[232:235], a[168:171], v[72:75], v[232:235]
ds_read_b64_tr_b16 a[168:169], v7 offset:8192
v_lshlrev_b32 v114, 16, v115
v_mfma_f32_16x16x32_bf16 v[152:155], a[172:175], v[52:55], v[152:155]
v_exp_f32 v84, v84
v_mfma_f32_16x16x32_bf16 v[184:187], a[172:175], v[56:59], v[184:187]
ds_read_b64_tr_b16 a[170:171], v7 offset:12288
v_lshlrev_b32 v116, 16, v117
v_mfma_f32_16x16x32_bf16 v[216:219], a[172:175], v[68:71], v[216:219]
v_exp_f32 v85, v85
v_mfma_f32_16x16x32_bf16 v[248:251], a[172:175], v[72:75], v[248:251]
s_waitcnt lgkmcnt(5)
ds_read_b64_tr_b16 a[172:173], v7 offset:9216
v_cvt_pk_bf16_f32 v84, v84, v85
v_smfmac_f32_16x16x64_bf16 a[248:251], a[240:243], v[68:75], v110
ds_read_b64_tr_b16 a[174:175], v7 offset:13312
v_lshlrev_b32 v118, 16, v119
v_mfma_f32_16x16x32_bf16 v[140:143], a[176:179], v[52:55], v[140:143]
v_exp_f32 v86, v86
v_mfma_f32_16x16x32_bf16 v[172:175], a[176:179], v[56:59], v[172:175]
v_exp_f32 v87, v87
v_mfma_f32_16x16x32_bf16 v[204:207], a[176:179], v[68:71], v[204:207]
v_exp_f32 v42, v42
v_mfma_f32_16x16x32_bf16 v[236:239], a[176:179], v[72:75], v[236:239]
ds_read_b64_tr_b16 a[176:177], v8 offset:8192
v_cvt_pk_bf16_f32 v85, v86, v87
v_mfma_f32_16x16x32_bf16 v[156:159], a[180:183], v[52:55], v[156:159]
buffer_load_dwordx4 v11, s[12:15], s37 offen offset:2048 nt lds
v_mfma_f32_16x16x32_bf16 v[188:191], a[180:183], v[56:59], v[188:191]
ds_read_b64_tr_b16 a[178:179], v8 offset:12288
v_and_b32 v113, s25, v113
v_mfma_f32_16x16x32_bf16 v[220:223], a[180:183], v[68:71], v[220:223]
ds_write_b64 v9, v[84:85] offset:5120
v_and_b32 v115, s25, v115
v_mfma_f32_16x16x32_bf16 v[252:255], a[180:183], v[72:75], v[252:255]
ds_read_b64_tr_b16 a[180:181], v8 offset:9216
v_and_b32 v117, s25, v117
v_mfma_f32_16x16x32_bf16 v[128:131], a[184:187], v[52:55], v[128:131]
v_exp_f32 v43, v43
v_mfma_f32_16x16x32_bf16 v[160:163], a[184:187], v[56:59], v[160:163]
ds_read_b64_tr_b16 a[182:183], v8 offset:13312
v_cvt_pk_bf16_f32 v41, v42, v43
v_mfma_f32_16x16x32_bf16 v[192:195], a[184:187], v[68:71], v[192:195]
v_exp_f32 v16, v16
v_mfma_f32_16x16x32_bf16 v[224:227], a[184:187], v[72:75], v[224:227]
v_exp_f32 v17, v17
v_mfma_f32_16x16x32_bf16 v[88:91], a[184:187], a[232:235], v[88:91]
v_exp_f32 v18, v18
v_mfma_f32_16x16x32_bf16 v[96:99], a[184:187], a[236:239], v[96:99]
ds_read_b64_tr_b16 a[184:185], v5 offset:8192
v_cvt_pk_bf16_f32 v22, v16, v17
v_smfmac_f32_16x16x64_bf16 a[252:255], a[240:243], a[232:239], v110
ds_read_b64_tr_b16 a[186:187], v5 offset:12288
v_and_b32 v119, s25, v119
v_mfma_f32_16x16x32_bf16 v[144:147], a[188:191], v[52:55], v[144:147]
v_exp_f32 v19, v19
v_mfma_f32_16x16x32_bf16 v[176:179], a[188:191], v[56:59], v[176:179]
v_exp_f32 v28, v28
v_mfma_f32_16x16x32_bf16 v[208:211], a[188:191], v[68:71], v[208:211]
v_exp_f32 v29, v29
v_mfma_f32_16x16x32_bf16 v[240:243], a[188:191], v[72:75], v[240:243]
v_exp_f32 v30, v30
v_mfma_f32_16x16x32_bf16 v[92:95], a[188:191], a[232:235], v[92:95]
v_exp_f32 v31, v31
v_mfma_f32_16x16x32_bf16 v[100:103], a[188:191], a[236:239], v[100:103]
ds_read_b64_tr_b16 a[188:189], v5 offset:9216
v_cvt_pk_bf16_f32 v23, v18, v19
v_mfma_f32_16x16x32_bf16 v[52:55], a[192:195], a[0:3], 0
v_exp_f32 v32, v32
v_mfma_f32_16x16x32_bf16 v[56:59], a[192:195], a[16:19], 0
s_add_u32 m0, s30, 0xa000
s_add_u32 s21, s21, 0x2000
s_waitcnt lgkmcnt(3)
ds_read_b64_tr_b16 a[190:191], v5 offset:13312
v_cvt_pk_bf16_f32 v26, v28, v29
v_mfma_f32_16x16x32_bf16 v[68:71], a[192:195], a[32:35], 0
buffer_load_dwordx4 v11, s[8:11], s21 offen nt lds
v_mfma_f32_16x16x32_bf16 v[72:75], a[192:195], a[48:51], 0
v_exp_f32 v33, v33
v_mfma_f32_16x16x32_bf16 v[52:55], a[196:199], a[4:7], v[52:55]
v_exp_f32 v34, v34
v_mfma_f32_16x16x32_bf16 v[56:59], a[196:199], a[20:23], v[56:59]
v_exp_f32 v35, v35
v_mfma_f32_16x16x32_bf16 v[68:71], a[196:199], a[36:39], v[68:71]
v_exp_f32 v44, v44
v_mfma_f32_16x16x32_bf16 v[72:75], a[196:199], a[52:55], v[72:75]
v_exp_f32 v45, v45
v_mfma_f32_16x16x32_bf16 v[52:55], a[200:203], a[8:11], v[52:55]
v_exp_f32 v46, v46
v_mfma_f32_16x16x32_bf16 v[56:59], a[200:203], a[24:27], v[56:59]
v_exp_f32 v47, v47
v_mfma_f32_16x16x32_bf16 v[68:71], a[200:203], a[40:43], v[68:71]
v_cvt_pk_bf16_f32 v27, v30, v31
v_cvt_pk_bf16_f32 v38, v32, v33
v_mfma_f32_16x16x32_bf16 v[72:75], a[200:203], a[56:59], v[72:75]
v_cvt_pk_bf16_f32 v39, v34, v35
v_cvt_pk_bf16_f32 v42, v44, v45
v_mfma_f32_16x16x32_bf16 v[52:55], a[204:207], a[12:15], v[52:55]
v_cvt_pk_bf16_f32 v43, v46, v47
v_mul_f32 v112, s26, v112
v_mfma_f32_16x16x32_bf16 v[56:59], a[204:207], a[28:31], v[56:59]
v_mul_f32 v113, s26, v113
v_mul_f32 v114, s26, v114
v_mfma_f32_16x16x32_bf16 v[68:71], a[204:207], a[44:47], v[68:71]
v_mul_f32 v115, s26, v115
v_mul_f32 v116, s26, v116
v_mfma_f32_16x16x32_bf16 v[72:75], a[204:207], a[60:63], v[72:75]
v_exp_f32 v52, v52
v_mfma_f32_16x16x32_bf16 v[48:51], a[208:211], a[0:3], 0
v_exp_f32 v53, v53
v_mfma_f32_16x16x32_bf16 v[60:63], a[208:211], a[16:19], 0
v_exp_f32 v54, v54
v_mfma_f32_16x16x32_bf16 v[64:67], a[208:211], a[32:35], 0
v_exp_f32 v55, v55
v_mfma_f32_16x16x32_bf16 v[76:79], a[208:211], a[48:51], 0
v_exp_f32 v56, v56
v_mfma_f32_16x16x32_bf16 v[48:51], a[212:215], a[4:7], v[48:51]
buffer_load_dwordx4 v11, s[8:11], s21 offen offset:2048 nt lds
v_mfma_f32_16x16x32_bf16 v[60:63], a[212:215], a[20:23], v[60:63]
v_exp_f32 v57, v57
v_mfma_f32_16x16x32_bf16 v[64:67], a[212:215], a[36:39], v[64:67]
v_exp_f32 v58, v58
v_mfma_f32_16x16x32_bf16 v[76:79], a[212:215], a[52:55], v[76:79]
v_exp_f32 v59, v59
v_mfma_f32_16x16x32_bf16 v[48:51], a[216:219], a[8:11], v[48:51]
v_exp_f32 v68, v68
v_mfma_f32_16x16x32_bf16 v[60:63], a[216:219], a[24:27], v[60:63]
v_exp_f32 v69, v69
v_mfma_f32_16x16x32_bf16 v[64:67], a[216:219], a[40:43], v[64:67]
v_exp_f32 v70, v70
v_mfma_f32_16x16x32_bf16 v[76:79], a[216:219], a[56:59], v[76:79]
v_exp_f32 v71, v71
v_mfma_f32_16x16x32_bf16 v[48:51], a[220:223], a[12:15], v[48:51]
v_cvt_pk_bf16_f32 v52, v52, v53
v_cvt_pk_bf16_f32 v53, v54, v55
v_mfma_f32_16x16x32_bf16 v[60:63], a[220:223], a[28:31], v[60:63]
v_exp_f32 v72, v72
v_mfma_f32_16x16x32_bf16 v[64:67], a[220:223], a[44:47], v[64:67]
v_exp_f32 v73, v73
v_mfma_f32_16x16x32_bf16 v[76:79], a[220:223], a[60:63], v[76:79]
s_waitcnt vmcnt(8) lgkmcnt(0)
s_barrier
ds_read_b128 a[224:227], v10 offset:4096
v_mfma_f32_16x16x32_bf16 v[132:135], a[160:163], v[20:23], v[132:135]
v_exp_f32 v74, v74
v_mfma_f32_16x16x32_bf16 v[164:167], a[160:163], v[24:27], v[164:167]
ds_read_b128 a[228:231], v10 offset:5120
v_cvt_pk_bf16_f32 v56, v56, v57
v_mfma_f32_16x16x32_bf16 v[196:199], a[160:163], v[36:39], v[196:199]
v_exp_f32 v75, v75
v_mfma_f32_16x16x32_bf16 v[228:231], a[160:163], v[40:43], v[228:231]
ds_read_b128 a[192:195], v1 offset:16384
v_cvt_pk_bf16_f32 v57, v58, v59
v_mfma_f32_16x16x32_bf16 v[148:151], a[164:167], v[20:23], v[148:151]
v_exp_f32 v48, v48
v_mfma_f32_16x16x32_bf16 v[180:183], a[164:167], v[24:27], v[180:183]
s_add_u32 m0, s30, 0x1c000
s_add_u32 s37, s37, 0x2000
ds_read_b128 a[196:199], v2 offset:16384
v_cvt_pk_bf16_f32 v68, v68, v69
v_mfma_f32_16x16x32_bf16 v[212:215], a[164:167], v[36:39], v[212:215]
buffer_load_dwordx4 v11, s[12:15], s37 offen nt lds
v_mfma_f32_16x16x32_bf16 v[244:247], a[164:167], v[40:43], v[244:247]
ds_read_b128 a[200:203], v1 offset:17408
v_cvt_pk_bf16_f32 v69, v70, v71
v_smfmac_f32_16x16x64_bf16 a[244:247], a[240:243], v[20:27], v110
ds_read_b128 a[204:207], v2 offset:17408
v_cvt_pk_bf16_f32 v72, v72, v73
v_mfma_f32_16x16x32_bf16 v[136:139], a[168:171], v[20:23], v[136:139]
v_exp_f32 v49, v49
v_mfma_f32_16x16x32_bf16 v[168:171], a[168:171], v[24:27], v[168:171]
ds_read_b128 a[208:211], v1 offset:20480
v_cvt_pk_bf16_f32 v54, v48, v49
v_mfma_f32_16x16x32_bf16 v[200:203], a[168:171], v[36:39], v[200:203]
v_exp_f32 v50, v50
v_mfma_f32_16x16x32_bf16 v[232:235], a[168:171], v[40:43], v[232:235]
ds_read_b128 a[212:215], v2 offset:20480
v_cvt_pk_bf16_f32 v73, v74, v75
v_mfma_f32_16x16x32_bf16 v[152:155], a[172:175], v[20:23], v[152:155]
v_exp_f32 v51, v51
v_mfma_f32_16x16x32_bf16 v[184:187], a[172:175], v[24:27], v[184:187]
ds_read_b128 a[216:219], v1 offset:21504
v_cvt_pk_bf16_f32 v55, v50, v51
v_mfma_f32_16x16x32_bf16 v[216:219], a[172:175], v[36:39], v[216:219]
v_exp_f32 v60, v60
v_mfma_f32_16x16x32_bf16 v[248:251], a[172:175], v[40:43], v[248:251]
ds_read_b128 a[220:223], v2 offset:21504
v_mul_f32 v117, s26, v117
v_smfmac_f32_16x16x64_bf16 a[248:251], a[240:243], v[36:43], v110
ds_read_b128 a[232:235], v3 offset:16384
v_mul_f32 v118, s26, v118
v_mfma_f32_16x16x32_bf16 v[140:143], a[176:179], v[20:23], v[140:143]
v_exp_f32 v61, v61
v_mfma_f32_16x16x32_bf16 v[172:175], a[176:179], v[24:27], v[172:175]
ds_read_b128 a[236:239], v4 offset:16384
v_cvt_pk_bf16_f32 v58, v60, v61
v_mfma_f32_16x16x32_bf16 v[204:207], a[176:179], v[36:39], v[204:207]
v_exp_f32 v62, v62
v_mfma_f32_16x16x32_bf16 v[236:239], a[176:179], v[40:43], v[236:239]
ds_read_b64_tr_b16 a[160:161], v6 offset:16384
v_mul_f32 v119, s26, v119
v_mfma_f32_16x16x32_bf16 v[156:159], a[180:183], v[20:23], v[156:159]
v_exp_f32 v63, v63
v_mfma_f32_16x16x32_bf16 v[188:191], a[180:183], v[24:27], v[188:191]
ds_read_b64_tr_b16 a[162:163], v6 offset:20480
v_cvt_pk_bf16_f32 v59, v62, v63
v_mfma_f32_16x16x32_bf16 v[220:223], a[180:183], v[36:39], v[220:223]
v_exp_f32 v64, v64
v_mfma_f32_16x16x32_bf16 v[252:255], a[180:183], v[40:43], v[252:255]
buffer_load_dwordx4 v11, s[12:15], s37 offen offset:2048 nt lds
v_mfma_f32_16x16x32_bf16 v[128:131], a[184:187], v[20:23], v[128:131]
ds_read_b64_tr_b16 a[164:165], v6 offset:17408
v_cvt_pk_bf16_f32 v112, v112, v113
v_mfma_f32_16x16x32_bf16 v[160:163], a[184:187], v[24:27], v[160:163]
v_exp_f32 v65, v65
v_mfma_f32_16x16x32_bf16 v[192:195], a[184:187], v[36:39], v[192:195]
s_waitcnt lgkmcnt(4)
ds_read_b64_tr_b16 a[166:167], v6 offset:21504
v_cvt_pk_bf16_f32 v70, v64, v65
v_mfma_f32_16x16x32_bf16 v[224:227], a[184:187], v[40:43], v[224:227]
v_exp_f32 v66, v66
v_mfma_f32_16x16x32_bf16 v[88:91], a[184:187], a[224:227], v[88:91]
ds_read_b64_tr_b16 a[168:169], v7 offset:16384
v_cvt_pk_bf16_f32 v114, v114, v115
v_mfma_f32_16x16x32_bf16 v[96:99], a[184:187], a[228:231], v[96:99]
v_exp_f32 v67, v67
v_smfmac_f32_16x16x64_bf16 a[252:255], a[240:243], a[224:231], v110
ds_read_b64_tr_b16 a[170:171], v7 offset:20480
v_cvt_pk_bf16_f32 v71, v66, v67
v_mfma_f32_16x16x32_bf16 v[144:147], a[188:191], v[20:23], v[144:147]
v_exp_f32 v76, v76
v_mfma_f32_16x16x32_bf16 v[176:179], a[188:191], v[24:27], v[176:179]
ds_read_b64_tr_b16 a[172:173], v7 offset:17408
v_cvt_pk_bf16_f32 v116, v116, v117
v_mfma_f32_16x16x32_bf16 v[208:211], a[188:191], v[36:39], v[208:211]
v_exp_f32 v77, v77
v_mfma_f32_16x16x32_bf16 v[240:243], a[188:191], v[40:43], v[240:243]
ds_read_b64_tr_b16 a[174:175], v7 offset:21504
v_cvt_pk_bf16_f32 v74, v76, v77
v_mfma_f32_16x16x32_bf16 v[92:95], a[188:191], a[224:227], v[92:95]
v_exp_f32 v78, v78
v_mfma_f32_16x16x32_bf16 v[100:103], a[188:191], a[228:231], v[100:103]
ds_read_b128 a[224:227], v3 offset:17408
v_cvt_pk_bf16_f32 v118, v118, v119
v_mfma_f32_16x16x32_bf16 v[20:23], a[192:195], a[0:3], 0
v_exp_f32 v79, v79
v_mfma_f32_16x16x32_bf16 v[24:27], a[192:195], a[16:19], 0
ds_read_b128 a[228:231], v4 offset:17408
v_cvt_pk_bf16_f32 v75, v78, v79
v_mfma_f32_16x16x32_bf16 v[36:39], a[192:195], a[32:35], 0
v_accvgpr_write_b32 a156, v112
v_accvgpr_write_b32 a157, v114
v_mfma_f32_16x16x32_bf16 v[40:43], a[192:195], a[48:51], 0
ds_read_b64_tr_b16 a[176:177], v8 offset:16384
v_accvgpr_write_b32 a158, v116
v_mfma_f32_16x16x32_bf16 v[20:23], a[196:199], a[4:7], v[20:23]
s_add_u32 m0, s30, 0xc000
s_add_u32 s21, s21, 0x2000
v_accvgpr_write_b32 a159, v118
v_mfma_f32_16x16x32_bf16 v[24:27], a[196:199], a[20:23], v[24:27]
buffer_load_dwordx4 v11, s[8:11], s21 offen nt lds
v_mfma_f32_16x16x32_bf16 v[36:39], a[196:199], a[36:39], v[36:39]
ds_read_b64_tr_b16 a[178:179], v8 offset:20480
v_mfma_f32_16x16x32_bf16 v[40:43], a[196:199], a[52:55], v[40:43]
v_mfma_f32_16x16x32_bf16 v[20:23], a[200:203], a[8:11], v[20:23]
ds_read_b64_tr_b16 a[180:181], v8 offset:17408
v_mfma_f32_16x16x32_bf16 v[24:27], a[200:203], a[24:27], v[24:27]
v_mfma_f32_16x16x32_bf16 v[36:39], a[200:203], a[40:43], v[36:39]
ds_read_b64_tr_b16 a[182:183], v8 offset:21504
v_mfma_f32_16x16x32_bf16 v[40:43], a[200:203], a[56:59], v[40:43]
v_mfma_f32_16x16x32_bf16 v[20:23], a[204:207], a[12:15], v[20:23]
s_waitcnt lgkmcnt(4)
ds_read_b64_tr_b16 a[184:185], v5 offset:16384
v_mfma_f32_16x16x32_bf16 v[24:27], a[204:207], a[28:31], v[24:27]
v_mfma_f32_16x16x32_bf16 v[36:39], a[204:207], a[44:47], v[36:39]
ds_read_b64_tr_b16 a[186:187], v5 offset:20480
v_mfma_f32_16x16x32_bf16 v[40:43], a[204:207], a[60:63], v[40:43]
v_mfma_f32_16x16x32_bf16 v[16:19], a[208:211], a[0:3], 0
ds_read_b64_tr_b16 a[188:189], v5 offset:17408
v_mfma_f32_16x16x32_bf16 v[28:31], a[208:211], a[16:19], 0
v_exp_f32 v20, v20
v_mfma_f32_16x16x32_bf16 v[32:35], a[208:211], a[32:35], 0
ds_read_b64_tr_b16 a[190:191], v5 offset:21504
v_mfma_f32_16x16x32_bf16 v[44:47], a[208:211], a[48:51], 0
v_exp_f32 v21, v21
v_mfma_f32_16x16x32_bf16 v[16:19], a[212:215], a[4:7], v[16:19]
ds_read_b128 a[192:195], v1 offset:24576
v_cvt_pk_bf16_f32 v20, v20, v21
v_mfma_f32_16x16x32_bf16 v[28:31], a[212:215], a[20:23], v[28:31]
v_exp_f32 v22, v22
v_mfma_f32_16x16x32_bf16 v[32:35], a[212:215], a[36:39], v[32:35]
ds_read_b128 a[196:199], v2 offset:24576
v_mfma_f32_16x16x32_bf16 v[44:47], a[212:215], a[52:55], v[44:47]
v_exp_f32 v23, v23
v_mfma_f32_16x16x32_bf16 v[16:19], a[216:219], a[8:11], v[16:19]
buffer_load_dwordx4 v11, s[8:11], s21 offen offset:2048 nt lds
v_mfma_f32_16x16x32_bf16 v[28:31], a[216:219], a[24:27], v[28:31]
ds_read_b128 a[200:203], v1 offset:25600
v_cvt_pk_bf16_f32 v21, v22, v23
v_mfma_f32_16x16x32_bf16 v[32:35], a[216:219], a[40:43], v[32:35]
v_exp_f32 v24, v24
v_mfma_f32_16x16x32_bf16 v[44:47], a[216:219], a[56:59], v[44:47]
ds_read_b128 a[204:207], v2 offset:25600
v_mfma_f32_16x16x32_bf16 v[16:19], a[220:223], a[12:15], v[16:19]
v_exp_f32 v25, v25
v_mfma_f32_16x16x32_bf16 v[28:31], a[220:223], a[28:31], v[28:31]
ds_read_b128 a[208:211], v1 offset:28672
v_cvt_pk_bf16_f32 v24, v24, v25
v_mfma_f32_16x16x32_bf16 v[32:35], a[220:223], a[44:47], v[32:35]
v_exp_f32 v26, v26
v_mfma_f32_16x16x32_bf16 v[44:47], a[220:223], a[60:63], v[44:47]
ds_read_b128 a[212:215], v2 offset:28672
v_mfma_f32_16x16x32_bf16 v[80:83], a[232:235], a[64:67], 0
v_exp_f32 v27, v27
v_mfma_f32_16x16x32_bf16 v[84:87], a[232:235], a[80:83], 0
ds_read_b128 a[232:235], v10 offset:6144
v_cvt_pk_bf16_f32 v25, v26, v27
v_mfma_f32_16x16x32_bf16 v[80:83], a[236:239], a[68:71], v[80:83]
v_exp_f32 v36, v36
v_mfma_f32_16x16x32_bf16 v[84:87], a[236:239], a[84:87], v[84:87]
s_waitcnt lgkmcnt(5)
ds_read_b128 a[236:239], v10 offset:7168
v_mfma_f32_16x16x32_bf16 v[80:83], a[224:227], a[72:75], v[80:83]
v_exp_f32 v37, v37
v_mfma_f32_16x16x32_bf16 v[84:87], a[224:227], a[88:91], v[84:87]
ds_read_b128 a[216:219], v1 offset:29696
v_cvt_pk_bf16_f32 v36, v36, v37
v_mfma_f32_16x16x32_bf16 v[80:83], a[228:231], a[76:79], v[80:83]
v_exp_f32 v38, v38
v_mfma_f32_16x16x32_bf16 v[84:87], a[228:231], a[92:95], v[84:87]
ds_read_b128 a[220:223], v2 offset:29696
v_mfma_f32_16x16x32_bf16 v[132:135], a[160:163], v[52:55], v[132:135]
v_exp_f32 v39, v39
v_mfma_f32_16x16x32_bf16 v[164:167], a[160:163], v[56:59], v[164:167]
v_exp_f32 v40, v40
v_mfma_f32_16x16x32_bf16 v[196:199], a[160:163], v[68:71], v[196:199]
s_add_u32 m0, s30, 0x1e000
s_add_u32 s37, s37, 0x2000
v_exp_f32 v80, v80
v_mfma_f32_16x16x32_bf16 v[228:231], a[160:163], v[72:75], v[228:231]
buffer_load_dwordx4 v11, s[12:15], s37 offen nt lds
v_mfma_f32_16x16x32_bf16 v[148:151], a[164:167], v[52:55], v[148:151]
ds_read_b64_tr_b16 a[160:161], v6 offset:24576
v_cvt_pk_bf16_f32 v37, v38, v39
v_mfma_f32_16x16x32_bf16 v[180:183], a[164:167], v[56:59], v[180:183]
v_exp_f32 v81, v81
v_mfma_f32_16x16x32_bf16 v[212:215], a[164:167], v[68:71], v[212:215]
ds_read_b64_tr_b16 a[162:163], v6 offset:28672
v_cvt_pk_bf16_f32 v80, v80, v81
v_mfma_f32_16x16x32_bf16 v[244:247], a[164:167], v[72:75], v[244:247]
v_exp_f32 v82, v82
v_smfmac_f32_16x16x64_bf16 a[244:247], a[240:243], v[52:59], v110
ds_read_b64_tr_b16 a[164:165], v6 offset:25600
v_mfma_f32_16x16x32_bf16 v[136:139], a[168:171], v[52:55], v[136:139]
v_exp_f32 v83, v83
v_mfma_f32_16x16x32_bf16 v[168:171], a[168:171], v[56:59], v[168:171]
ds_read_b64_tr_b16 a[166:167], v6 offset:29696
v_cvt_pk_bf16_f32 v81, v82, v83
v_mfma_f32_16x16x32_bf16 v[200:203], a[168:171], v[68:71], v[200:203]
ds_write_b64 v9, v[80:81] offset:0
v_mfma_f32_16x16x32_bf16 v[232:235], a[168:171], v[72:75], v[232:235]
ds_read_b64_tr_b16 a[168:169], v7 offset:24576
v_mfma_f32_16x16x32_bf16 v[152:155], a[172:175], v[52:55], v[152:155]
v_exp_f32 v84, v84
v_mfma_f32_16x16x32_bf16 v[184:187], a[172:175], v[56:59], v[184:187]
ds_read_b64_tr_b16 a[170:171], v7 offset:28672
v_mfma_f32_16x16x32_bf16 v[216:219], a[172:175], v[68:71], v[216:219]
v_exp_f32 v85, v85
v_mfma_f32_16x16x32_bf16 v[248:251], a[172:175], v[72:75], v[248:251]
s_waitcnt lgkmcnt(6)
ds_read_b64_tr_b16 a[172:173], v7 offset:25600
v_cvt_pk_bf16_f32 v84, v84, v85
v_smfmac_f32_16x16x64_bf16 a[248:251], a[240:243], v[68:75], v110
ds_read_b64_tr_b16 a[174:175], v7 offset:29696
v_mfma_f32_16x16x32_bf16 v[140:143], a[176:179], v[52:55], v[140:143]
v_exp_f32 v86, v86
v_mfma_f32_16x16x32_bf16 v[172:175], a[176:179], v[56:59], v[172:175]
v_exp_f32 v87, v87
v_mfma_f32_16x16x32_bf16 v[204:207], a[176:179], v[68:71], v[204:207]
v_exp_f32 v41, v41
v_mfma_f32_16x16x32_bf16 v[236:239], a[176:179], v[72:75], v[236:239]
ds_read_b64_tr_b16 a[176:177], v8 offset:24576
v_cvt_pk_bf16_f32 v85, v86, v87
v_mfma_f32_16x16x32_bf16 v[156:159], a[180:183], v[52:55], v[156:159]
buffer_load_dwordx4 v11, s[12:15], s37 offen offset:2048 nt lds
v_mfma_f32_16x16x32_bf16 v[188:191], a[180:183], v[56:59], v[188:191]
ds_read_b64_tr_b16 a[178:179], v8 offset:28672
v_cvt_pk_bf16_f32 v40, v40, v41
v_mfma_f32_16x16x32_bf16 v[220:223], a[180:183], v[68:71], v[220:223]
ds_write_b64 v9, v[84:85] offset:1024
v_mfma_f32_16x16x32_bf16 v[252:255], a[180:183], v[72:75], v[252:255]
ds_read_b64_tr_b16 a[180:181], v8 offset:25600
v_mfma_f32_16x16x32_bf16 v[128:131], a[184:187], v[52:55], v[128:131]
v_exp_f32 v42, v42
v_mfma_f32_16x16x32_bf16 v[160:163], a[184:187], v[56:59], v[160:163]
ds_read_b64_tr_b16 a[182:183], v8 offset:29696
v_mfma_f32_16x16x32_bf16 v[192:195], a[184:187], v[68:71], v[192:195]
v_exp_f32 v43, v43
v_mfma_f32_16x16x32_bf16 v[224:227], a[184:187], v[72:75], v[224:227]
v_exp_f32 v16, v16
v_mfma_f32_16x16x32_bf16 v[88:91], a[184:187], a[232:235], v[88:91]
v_exp_f32 v17, v17
v_mfma_f32_16x16x32_bf16 v[96:99], a[184:187], a[236:239], v[96:99]
ds_read_b64_tr_b16 a[184:185], v5 offset:24576
v_cvt_pk_bf16_f32 v22, v16, v17
v_smfmac_f32_16x16x64_bf16 a[252:255], a[240:243], a[232:239], v110
ds_read_b64_tr_b16 a[186:187], v5 offset:28672
v_cvt_pk_bf16_f32 v41, v42, v43
v_mfma_f32_16x16x32_bf16 v[144:147], a[188:191], v[52:55], v[144:147]
v_exp_f32 v18, v18
v_mfma_f32_16x16x32_bf16 v[176:179], a[188:191], v[56:59], v[176:179]
v_exp_f32 v19, v19
v_mfma_f32_16x16x32_bf16 v[208:211], a[188:191], v[68:71], v[208:211]
v_exp_f32 v28, v28
v_mfma_f32_16x16x32_bf16 v[240:243], a[188:191], v[72:75], v[240:243]
v_exp_f32 v29, v29
v_mfma_f32_16x16x32_bf16 v[92:95], a[188:191], a[232:235], v[92:95]
v_exp_f32 v30, v30
v_mfma_f32_16x16x32_bf16 v[100:103], a[188:191], a[236:239], v[100:103]
s_waitcnt lgkmcnt(2)
ds_read_b64_tr_b16 a[188:189], v5 offset:25600
v_cvt_pk_bf16_f32 v23, v18, v19
v_mfma_f32_16x16x32_bf16 v[52:55], a[192:195], a[0:3], 0
v_exp_f32 v31, v31
v_mfma_f32_16x16x32_bf16 v[56:59], a[192:195], a[16:19], 0
s_add_u32 m0, s30, 0xe000
s_add_u32 s21, s21, 0x2000
ds_read_b64_tr_b16 a[190:191], v5 offset:29696
v_cvt_pk_bf16_f32 v26, v28, v29
v_mfma_f32_16x16x32_bf16 v[68:71], a[192:195], a[32:35], 0
buffer_load_dwordx4 v11, s[8:11], s21 offen nt lds
v_mfma_f32_16x16x32_bf16 v[72:75], a[192:195], a[48:51], 0
v_exp_f32 v32, v32
v_mfma_f32_16x16x32_bf16 v[52:55], a[196:199], a[4:7], v[52:55]
v_exp_f32 v33, v33
v_mfma_f32_16x16x32_bf16 v[56:59], a[196:199], a[20:23], v[56:59]
v_exp_f32 v34, v34
v_mfma_f32_16x16x32_bf16 v[68:71], a[196:199], a[36:39], v[68:71]
v_exp_f32 v35, v35
v_mfma_f32_16x16x32_bf16 v[72:75], a[196:199], a[52:55], v[72:75]
v_exp_f32 v44, v44
v_mfma_f32_16x16x32_bf16 v[52:55], a[200:203], a[8:11], v[52:55]
v_exp_f32 v45, v45
v_mfma_f32_16x16x32_bf16 v[56:59], a[200:203], a[24:27], v[56:59]
v_exp_f32 v46, v46
v_mfma_f32_16x16x32_bf16 v[68:71], a[200:203], a[40:43], v[68:71]
v_exp_f32 v47, v47
v_mfma_f32_16x16x32_bf16 v[72:75], a[200:203], a[56:59], v[72:75]
v_cvt_pk_bf16_f32 v27, v30, v31
v_cvt_pk_bf16_f32 v38, v32, v33
v_mfma_f32_16x16x32_bf16 v[52:55], a[204:207], a[12:15], v[52:55]
v_cvt_pk_bf16_f32 v39, v34, v35
v_cvt_pk_bf16_f32 v42, v44, v45
v_mfma_f32_16x16x32_bf16 v[56:59], a[204:207], a[28:31], v[56:59]
v_cvt_pk_bf16_f32 v43, v46, v47
v_mfma_f32_16x16x32_bf16 v[68:71], a[204:207], a[44:47], v[68:71]
v_mfma_f32_16x16x32_bf16 v[72:75], a[204:207], a[60:63], v[72:75]
v_mfma_f32_16x16x32_bf16 v[48:51], a[208:211], a[0:3], 0
v_mfma_f32_16x16x32_bf16 v[60:63], a[208:211], a[16:19], 0
v_exp_f32 v52, v52
v_mfma_f32_16x16x32_bf16 v[64:67], a[208:211], a[32:35], 0
v_exp_f32 v53, v53
v_mfma_f32_16x16x32_bf16 v[76:79], a[208:211], a[48:51], 0
v_exp_f32 v54, v54
v_mfma_f32_16x16x32_bf16 v[48:51], a[212:215], a[4:7], v[48:51]
buffer_load_dwordx4 v11, s[8:11], s21 offen offset:2048 nt lds
v_mfma_f32_16x16x32_bf16 v[60:63], a[212:215], a[20:23], v[60:63]
v_exp_f32 v55, v55
v_mfma_f32_16x16x32_bf16 v[64:67], a[212:215], a[36:39], v[64:67]
v_exp_f32 v56, v56
v_mfma_f32_16x16x32_bf16 v[76:79], a[212:215], a[52:55], v[76:79]
v_exp_f32 v57, v57
v_mfma_f32_16x16x32_bf16 v[48:51], a[216:219], a[8:11], v[48:51]
v_exp_f32 v58, v58
v_mfma_f32_16x16x32_bf16 v[60:63], a[216:219], a[24:27], v[60:63]
v_exp_f32 v59, v59
v_mfma_f32_16x16x32_bf16 v[64:67], a[216:219], a[40:43], v[64:67]
v_exp_f32 v68, v68
v_mfma_f32_16x16x32_bf16 v[76:79], a[216:219], a[56:59], v[76:79]
v_exp_f32 v69, v69
v_mfma_f32_16x16x32_bf16 v[48:51], a[220:223], a[12:15], v[48:51]
v_exp_f32 v70, v70
v_mfma_f32_16x16x32_bf16 v[60:63], a[220:223], a[28:31], v[60:63]
v_exp_f32 v71, v71
v_mfma_f32_16x16x32_bf16 v[64:67], a[220:223], a[44:47], v[64:67]
v_cvt_pk_bf16_f32 v52, v52, v53
v_cvt_pk_bf16_f32 v53, v54, v55
v_mfma_f32_16x16x32_bf16 v[76:79], a[220:223], a[60:63], v[76:79]
s_waitcnt vmcnt(8) lgkmcnt(0)
s_barrier
ds_read_b128 a[224:227], v10 offset:0
v_mfma_f32_16x16x32_bf16 v[132:135], a[160:163], v[20:23], v[132:135]
v_add_u32 v126, 139264, v1
v_cvt_pk_bf16_f32 v56, v56, v57
v_mfma_f32_16x16x32_bf16 v[164:167], a[160:163], v[24:27], v[164:167]
v_add_u32 v127, 139264, v2
ds_read_b128 a[228:231], v10 offset:1024
v_mfma_f32_16x16x32_bf16 v[196:199], a[160:163], v[36:39], v[196:199]
v_exp_f32 v72, v72
v_mfma_f32_16x16x32_bf16 v[228:231], a[160:163], v[40:43], v[228:231]
ds_read_b128 a[192:195], v1 offset:32768
v_cvt_pk_bf16_f32 v57, v58, v59
v_mfma_f32_16x16x32_bf16 v[148:151], a[164:167], v[20:23], v[148:151]
v_exp_f32 v73, v73
v_mfma_f32_16x16x32_bf16 v[180:183], a[164:167], v[24:27], v[180:183]
s_add_u32 m0, s30, 0x10000
s_add_u32 s37, s37, 0x2000
ds_read_b128 a[196:199], v2 offset:32768
v_cvt_pk_bf16_f32 v68, v68, v69
v_mfma_f32_16x16x32_bf16 v[212:215], a[164:167], v[36:39], v[212:215]
buffer_load_dwordx4 v11, s[12:15], s37 offen nt lds
v_mfma_f32_16x16x32_bf16 v[244:247], a[164:167], v[40:43], v[244:247]
ds_read_b128 a[200:203], v1 offset:33792
v_cvt_pk_bf16_f32 v69, v70, v71
v_smfmac_f32_16x16x64_bf16 a[244:247], a[240:243], v[20:27], v110
ds_read_b128 a[204:207], v2 offset:33792
v_cvt_pk_bf16_f32 v72, v72, v73
v_mfma_f32_16x16x32_bf16 v[136:139], a[168:171], v[20:23], v[136:139]
v_exp_f32 v74, v74
v_mfma_f32_16x16x32_bf16 v[168:171], a[168:171], v[24:27], v[168:171]
ds_read_b128 a[208:211], v1 offset:36864
v_mfma_f32_16x16x32_bf16 v[200:203], a[168:171], v[36:39], v[200:203]
v_exp_f32 v75, v75
v_mfma_f32_16x16x32_bf16 v[232:235], a[168:171], v[40:43], v[232:235]
ds_read_b128 a[212:215], v2 offset:36864
v_cvt_pk_bf16_f32 v73, v74, v75
v_mfma_f32_16x16x32_bf16 v[152:155], a[172:175], v[20:23], v[152:155]
v_exp_f32 v48, v48
v_mfma_f32_16x16x32_bf16 v[184:187], a[172:175], v[24:27], v[184:187]
ds_read_b128 a[216:219], v1 offset:37888
v_mfma_f32_16x16x32_bf16 v[216:219], a[172:175], v[36:39], v[216:219]
v_exp_f32 v49, v49
v_mfma_f32_16x16x32_bf16 v[248:251], a[172:175], v[40:43], v[248:251]
ds_read_b128 a[220:223], v2 offset:37888
v_cvt_pk_bf16_f32 v54, v48, v49
v_smfmac_f32_16x16x64_bf16 a[248:251], a[240:243], v[36:43], v110
ds_read_b128 a[232:235], v3 offset:32768
v_mfma_f32_16x16x32_bf16 v[140:143], a[176:179], v[20:23], v[140:143]
v_exp_f32 v50, v50
v_mfma_f32_16x16x32_bf16 v[172:175], a[176:179], v[24:27], v[172:175]
ds_read_b128 a[236:239], v4 offset:32768
v_mfma_f32_16x16x32_bf16 v[204:207], a[176:179], v[36:39], v[204:207]
v_exp_f32 v51, v51
v_mfma_f32_16x16x32_bf16 v[236:239], a[176:179], v[40:43], v[236:239]
ds_read_b64_tr_b16 a[160:161], v6 offset:32768
v_cvt_pk_bf16_f32 v55, v50, v51
v_mfma_f32_16x16x32_bf16 v[156:159], a[180:183], v[20:23], v[156:159]
v_exp_f32 v60, v60
v_mfma_f32_16x16x32_bf16 v[188:191], a[180:183], v[24:27], v[188:191]
ds_read_b64_tr_b16 a[162:163], v6 offset:36864
v_mfma_f32_16x16x32_bf16 v[220:223], a[180:183], v[36:39], v[220:223]
v_exp_f32 v61, v61
v_mfma_f32_16x16x32_bf16 v[252:255], a[180:183], v[40:43], v[252:255]
buffer_load_dwordx4 v11, s[12:15], s37 offen offset:2048 nt lds
v_mfma_f32_16x16x32_bf16 v[128:131], a[184:187], v[20:23], v[128:131]
ds_read_b64_tr_b16 a[164:165], v6 offset:33792
v_cvt_pk_bf16_f32 v58, v60, v61
v_mfma_f32_16x16x32_bf16 v[160:163], a[184:187], v[24:27], v[160:163]
v_exp_f32 v62, v62
v_mfma_f32_16x16x32_bf16 v[192:195], a[184:187], v[36:39], v[192:195]
s_waitcnt lgkmcnt(4)
ds_read_b64_tr_b16 a[166:167], v6 offset:37888
v_mfma_f32_16x16x32_bf16 v[224:227], a[184:187], v[40:43], v[224:227]
v_exp_f32 v63, v63
v_mfma_f32_16x16x32_bf16 v[88:91], a[184:187], a[224:227], v[88:91]
ds_read_b64_tr_b16 a[168:169], v7 offset:32768
v_cvt_pk_bf16_f32 v59, v62, v63
v_mfma_f32_16x16x32_bf16 v[96:99], a[184:187], a[228:231], v[96:99]
v_exp_f32 v64, v64
v_smfmac_f32_16x16x64_bf16 a[252:255], a[240:243], a[224:231], v110
ds_read_b64_tr_b16 a[170:171], v7 offset:36864
v_mfma_f32_16x16x32_bf16 v[144:147], a[188:191], v[20:23], v[144:147]
v_exp_f32 v65, v65
v_mfma_f32_16x16x32_bf16 v[176:179], a[188:191], v[24:27], v[176:179]
ds_read_b64_tr_b16 a[172:173], v7 offset:33792
v_cvt_pk_bf16_f32 v70, v64, v65
v_mfma_f32_16x16x32_bf16 v[208:211], a[188:191], v[36:39], v[208:211]
v_exp_f32 v66, v66
v_mfma_f32_16x16x32_bf16 v[240:243], a[188:191], v[40:43], v[240:243]
ds_read_b64_tr_b16 a[174:175], v7 offset:37888
v_mfma_f32_16x16x32_bf16 v[92:95], a[188:191], a[224:227], v[92:95]
v_exp_f32 v67, v67
v_mfma_f32_16x16x32_bf16 v[100:103], a[188:191], a[228:231], v[100:103]
ds_read_b128 a[224:227], v3 offset:33792
v_cvt_pk_bf16_f32 v71, v66, v67
v_mfma_f32_16x16x32_bf16 v[20:23], a[192:195], a[0:3], 0
v_exp_f32 v76, v76
v_mfma_f32_16x16x32_bf16 v[24:27], a[192:195], a[16:19], 0
ds_read_b128 a[228:231], v4 offset:33792
v_mfma_f32_16x16x32_bf16 v[36:39], a[192:195], a[32:35], 0
v_exp_f32 v77, v77
v_mfma_f32_16x16x32_bf16 v[40:43], a[192:195], a[48:51], 0
ds_read_b64_tr_b16 a[176:177], v8 offset:32768
v_cvt_pk_bf16_f32 v74, v76, v77
v_mfma_f32_16x16x32_bf16 v[20:23], a[196:199], a[4:7], v[20:23]
s_add_u32 m0, s30, 0x0
s_add_u32 s21, s21, 0x2000
v_exp_f32 v78, v78
v_mfma_f32_16x16x32_bf16 v[24:27], a[196:199], a[20:23], v[24:27]
buffer_load_dwordx4 v11, s[8:11], s21 offen nt lds
v_mfma_f32_16x16x32_bf16 v[36:39], a[196:199], a[36:39], v[36:39]
ds_read_b64_tr_b16 a[178:179], v8 offset:36864
v_mfma_f32_16x16x32_bf16 v[40:43], a[196:199], a[52:55], v[40:43]
v_exp_f32 v79, v79
v_mfma_f32_16x16x32_bf16 v[20:23], a[200:203], a[8:11], v[20:23]
ds_read_b64_tr_b16 a[180:181], v8 offset:33792
v_cvt_pk_bf16_f32 v75, v78, v79
v_mfma_f32_16x16x32_bf16 v[24:27], a[200:203], a[24:27], v[24:27]
v_mfma_f32_16x16x32_bf16 v[36:39], a[200:203], a[40:43], v[36:39]
ds_read_b64_tr_b16 a[182:183], v8 offset:37888
v_mfma_f32_16x16x32_bf16 v[40:43], a[200:203], a[56:59], v[40:43]
v_mfma_f32_16x16x32_bf16 v[20:23], a[204:207], a[12:15], v[20:23]
s_waitcnt lgkmcnt(4)
ds_read_b64_tr_b16 a[184:185], v5 offset:32768
v_mfma_f32_16x16x32_bf16 v[24:27], a[204:207], a[28:31], v[24:27]
v_mfma_f32_16x16x32_bf16 v[36:39], a[204:207], a[44:47], v[36:39]
ds_read_b64_tr_b16 a[186:187], v5 offset:36864
v_mfma_f32_16x16x32_bf16 v[40:43], a[204:207], a[60:63], v[40:43]
v_mfma_f32_16x16x32_bf16 v[16:19], a[208:211], a[0:3], 0
ds_read_b64_tr_b16 a[188:189], v5 offset:33792
v_mfma_f32_16x16x32_bf16 v[28:31], a[208:211], a[16:19], 0
v_exp_f32 v20, v20
v_mfma_f32_16x16x32_bf16 v[32:35], a[208:211], a[32:35], 0
ds_read_b64_tr_b16 a[190:191], v5 offset:37888
v_mfma_f32_16x16x32_bf16 v[44:47], a[208:211], a[48:51], 0
v_exp_f32 v21, v21
v_mfma_f32_16x16x32_bf16 v[16:19], a[212:215], a[4:7], v[16:19]
ds_read_b128 a[192:195], v1 offset:40960
v_cvt_pk_bf16_f32 v20, v20, v21
v_mfma_f32_16x16x32_bf16 v[28:31], a[212:215], a[20:23], v[28:31]
v_exp_f32 v22, v22
v_mfma_f32_16x16x32_bf16 v[32:35], a[212:215], a[36:39], v[32:35]
ds_read_b128 a[196:199], v2 offset:40960
v_mfma_f32_16x16x32_bf16 v[44:47], a[212:215], a[52:55], v[44:47]
v_exp_f32 v23, v23
v_mfma_f32_16x16x32_bf16 v[16:19], a[216:219], a[8:11], v[16:19]
buffer_load_dwordx4 v11, s[8:11], s21 offen offset:2048 nt lds
v_mfma_f32_16x16x32_bf16 v[28:31], a[216:219], a[24:27], v[28:31]
ds_read_b128 a[200:203], v1 offset:41984
v_cvt_pk_bf16_f32 v21, v22, v23
v_mfma_f32_16x16x32_bf16 v[32:35], a[216:219], a[40:43], v[32:35]
v_exp_f32 v24, v24
v_mfma_f32_16x16x32_bf16 v[44:47], a[216:219], a[56:59], v[44:47]
ds_read_b128 a[204:207], v2 offset:41984
v_mfma_f32_16x16x32_bf16 v[16:19], a[220:223], a[12:15], v[16:19]
v_exp_f32 v25, v25
v_mfma_f32_16x16x32_bf16 v[28:31], a[220:223], a[28:31], v[28:31]
ds_read_b128 a[208:211], v1 offset:45056
v_cvt_pk_bf16_f32 v24, v24, v25
v_mfma_f32_16x16x32_bf16 v[32:35], a[220:223], a[44:47], v[32:35]
v_exp_f32 v26, v26
v_mfma_f32_16x16x32_bf16 v[44:47], a[220:223], a[60:63], v[44:47]
ds_read_b128 a[212:215], v2 offset:45056
v_mfma_f32_16x16x32_bf16 v[80:83], a[232:235], a[64:67], 0
v_exp_f32 v27, v27
v_mfma_f32_16x16x32_bf16 v[84:87], a[232:235], a[80:83], 0
ds_read_b128 a[232:235], v10 offset:2048
v_cvt_pk_bf16_f32 v25, v26, v27
v_mfma_f32_16x16x32_bf16 v[80:83], a[236:239], a[68:71], v[80:83]
v_exp_f32 v36, v36
v_mfma_f32_16x16x32_bf16 v[84:87], a[236:239], a[84:87], v[84:87]
s_waitcnt lgkmcnt(5)
ds_read_b128 a[236:239], v10 offset:3072
v_mfma_f32_16x16x32_bf16 v[80:83], a[224:227], a[72:75], v[80:83]
v_exp_f32 v37, v37
v_mfma_f32_16x16x32_bf16 v[84:87], a[224:227], a[88:91], v[84:87]
ds_read_b128 a[216:219], v1 offset:46080
v_cvt_pk_bf16_f32 v36, v36, v37
v_mfma_f32_16x16x32_bf16 v[80:83], a[228:231], a[76:79], v[80:83]
v_exp_f32 v38, v38
v_mfma_f32_16x16x32_bf16 v[84:87], a[228:231], a[92:95], v[84:87]
ds_read_b128 a[220:223], v2 offset:46080
v_mfma_f32_16x16x32_bf16 v[132:135], a[160:163], v[52:55], v[132:135]
v_exp_f32 v39, v39
v_mfma_f32_16x16x32_bf16 v[164:167], a[160:163], v[56:59], v[164:167]
ds_read_b128 a[64:67], v126 offset:0
v_cvt_pk_bf16_f32 v37, v38, v39
v_mfma_f32_16x16x32_bf16 v[196:199], a[160:163], v[68:71], v[196:199]
s_add_u32 m0, s30, 0x12000
s_add_u32 s37, s37, 0x2000
v_exp_f32 v80, v80
v_mfma_f32_16x16x32_bf16 v[228:231], a[160:163], v[72:75], v[228:231]
buffer_load_dwordx4 v11, s[12:15], s37 offen nt lds
v_mfma_f32_16x16x32_bf16 v[148:151], a[164:167], v[52:55], v[148:151]
ds_read_b64_tr_b16 a[160:161], v6 offset:40960
v_mfma_f32_16x16x32_bf16 v[180:183], a[164:167], v[56:59], v[180:183]
v_exp_f32 v81, v81
v_mfma_f32_16x16x32_bf16 v[212:215], a[164:167], v[68:71], v[212:215]
ds_read_b64_tr_b16 a[162:163], v6 offset:45056
v_cvt_pk_bf16_f32 v80, v80, v81
v_mfma_f32_16x16x32_bf16 v[244:247], a[164:167], v[72:75], v[244:247]
v_exp_f32 v82, v82
v_smfmac_f32_16x16x64_bf16 a[244:247], a[240:243], v[52:59], v110
ds_read_b128 a[80:83], v126 offset:4096
v_mfma_f32_16x16x32_bf16 v[136:139], a[168:171], v[52:55], v[136:139]
v_exp_f32 v83, v83
v_mfma_f32_16x16x32_bf16 v[168:171], a[168:171], v[56:59], v[168:171]
ds_read_b128 a[68:71], v127 offset:0
v_cvt_pk_bf16_f32 v81, v82, v83
v_mfma_f32_16x16x32_bf16 v[200:203], a[168:171], v[68:71], v[200:203]
ds_write_b64 v9, v[80:81] offset:4096
v_mfma_f32_16x16x32_bf16 v[232:235], a[168:171], v[72:75], v[232:235]
ds_read_b128 a[84:87], v127 offset:4096
v_mfma_f32_16x16x32_bf16 v[152:155], a[172:175], v[52:55], v[152:155]
v_exp_f32 v84, v84
v_mfma_f32_16x16x32_bf16 v[184:187], a[172:175], v[56:59], v[184:187]
s_waitcnt lgkmcnt(6)
ds_read_b128 a[72:75], v126 offset:1024
v_mfma_f32_16x16x32_bf16 v[216:219], a[172:175], v[68:71], v[216:219]
v_exp_f32 v85, v85
v_mfma_f32_16x16x32_bf16 v[248:251], a[172:175], v[72:75], v[248:251]
ds_read_b128 a[88:91], v126 offset:5120
v_cvt_pk_bf16_f32 v84, v84, v85
v_smfmac_f32_16x16x64_bf16 a[248:251], a[240:243], v[68:75], v110
ds_read_b128 a[76:79], v127 offset:1024
v_mfma_f32_16x16x32_bf16 v[140:143], a[176:179], v[52:55], v[140:143]
v_exp_f32 v86, v86
v_mfma_f32_16x16x32_bf16 v[172:175], a[176:179], v[56:59], v[172:175]
ds_read_b128 a[92:95], v127 offset:5120
v_mfma_f32_16x16x32_bf16 v[204:207], a[176:179], v[68:71], v[204:207]
v_exp_f32 v87, v87
v_mfma_f32_16x16x32_bf16 v[236:239], a[176:179], v[72:75], v[236:239]
ds_read_b64_tr_b16 a[164:165], v6 offset:41984
v_cvt_pk_bf16_f32 v85, v86, v87
v_mfma_f32_16x16x32_bf16 v[156:159], a[180:183], v[52:55], v[156:159]
buffer_load_dwordx4 v11, s[12:15], s37 offen offset:2048 nt lds
v_mfma_f32_16x16x32_bf16 v[188:191], a[180:183], v[56:59], v[188:191]
ds_read_b64_tr_b16 a[166:167], v6 offset:46080
v_mfma_f32_16x16x32_bf16 v[220:223], a[180:183], v[68:71], v[220:223]
ds_write_b64 v9, v[84:85] offset:5120
v_mfma_f32_16x16x32_bf16 v[252:255], a[180:183], v[72:75], v[252:255]
ds_read_b64_tr_b16 a[168:169], v7 offset:40960
v_mfma_f32_16x16x32_bf16 v[128:131], a[184:187], v[52:55], v[128:131]
v_exp_f32 v40, v40
v_mfma_f32_16x16x32_bf16 v[160:163], a[184:187], v[56:59], v[160:163]
ds_read_b64_tr_b16 a[170:171], v7 offset:45056
v_mfma_f32_16x16x32_bf16 v[192:195], a[184:187], v[68:71], v[192:195]
v_exp_f32 v41, v41
v_mfma_f32_16x16x32_bf16 v[224:227], a[184:187], v[72:75], v[224:227]
s_waitcnt lgkmcnt(6)
ds_read_b64_tr_b16 a[172:173], v7 offset:41984
v_cvt_pk_bf16_f32 v40, v40, v41
v_mfma_f32_16x16x32_bf16 v[88:91], a[184:187], a[232:235], v[88:91]
v_exp_f32 v42, v42
v_mfma_f32_16x16x32_bf16 v[96:99], a[184:187], a[236:239], v[96:99]
ds_read_b64_tr_b16 a[174:175], v7 offset:46080
v_smfmac_f32_16x16x64_bf16 a[252:255], a[240:243], a[232:239], v110
ds_read_b64_tr_b16 a[176:177], v8 offset:40960
v_mfma_f32_16x16x32_bf16 v[144:147], a[188:191], v[52:55], v[144:147]
v_exp_f32 v43, v43
v_mfma_f32_16x16x32_bf16 v[176:179], a[188:191], v[56:59], v[176:179]
ds_read_b64_tr_b16 a[178:179], v8 offset:45056
v_cvt_pk_bf16_f32 v41, v42, v43
v_mfma_f32_16x16x32_bf16 v[208:211], a[188:191], v[68:71], v[208:211]
v_exp_f32 v16, v16
v_mfma_f32_16x16x32_bf16 v[240:243], a[188:191], v[72:75], v[240:243]
ds_read_b64_tr_b16 a[180:181], v8 offset:41984
v_mfma_f32_16x16x32_bf16 v[92:95], a[188:191], a[232:235], v[92:95]
v_exp_f32 v17, v17
v_mfma_f32_16x16x32_bf16 v[100:103], a[188:191], a[236:239], v[100:103]
ds_read_b64_tr_b16 a[182:183], v8 offset:46080
v_cvt_pk_bf16_f32 v22, v16, v17
v_mfma_f32_16x16x32_bf16 v[52:55], a[192:195], a[0:3], 0
v_exp_f32 v18, v18
v_mfma_f32_16x16x32_bf16 v[56:59], a[192:195], a[16:19], 0
s_add_u32 m0, s30, 0x2000
s_add_u32 s21, s21, 0x2000
ds_read_b64_tr_b16 a[184:185], v5 offset:40960
v_mfma_f32_16x16x32_bf16 v[68:71], a[192:195], a[32:35], 0
buffer_load_dwordx4 v11, s[8:11], s21 offen nt lds
v_mfma_f32_16x16x32_bf16 v[72:75], a[192:195], a[48:51], 0
ds_read_b64_tr_b16 a[186:187], v5 offset:45056
v_mfma_f32_16x16x32_bf16 v[52:55], a[196:199], a[4:7], v[52:55]
v_exp_f32 v19, v19
v_mfma_f32_16x16x32_bf16 v[56:59], a[196:199], a[20:23], v[56:59]
ds_read_b64_tr_b16 a[188:189], v5 offset:41984
v_cvt_pk_bf16_f32 v23, v18, v19
v_mfma_f32_16x16x32_bf16 v[68:71], a[196:199], a[36:39], v[68:71]
v_exp_f32 v28, v28
v_mfma_f32_16x16x32_bf16 v[72:75], a[196:199], a[52:55], v[72:75]
s_waitcnt lgkmcnt(5)
ds_read_b64_tr_b16 a[190:191], v5 offset:46080
v_mfma_f32_16x16x32_bf16 v[52:55], a[200:203], a[8:11], v[52:55]
v_exp_f32 v29, v29
v_mfma_f32_16x16x32_bf16 v[56:59], a[200:203], a[24:27], v[56:59]
v_exp_f32 v30, v30
v_mfma_f32_16x16x32_bf16 v[68:71], a[200:203], a[40:43], v[68:71]
v_exp_f32 v31, v31
v_mfma_f32_16x16x32_bf16 v[72:75], a[200:203], a[56:59], v[72:75]
v_exp_f32 v32, v32
v_mfma_f32_16x16x32_bf16 v[52:55], a[204:207], a[12:15], v[52:55]
v_exp_f32 v33, v33
v_mfma_f32_16x16x32_bf16 v[56:59], a[204:207], a[28:31], v[56:59]
v_exp_f32 v34, v34
v_mfma_f32_16x16x32_bf16 v[68:71], a[204:207], a[44:47], v[68:71]
v_exp_f32 v35, v35
v_mfma_f32_16x16x32_bf16 v[72:75], a[204:207], a[60:63], v[72:75]
v_exp_f32 v44, v44
v_mfma_f32_16x16x32_bf16 v[48:51], a[208:211], a[0:3], 0
v_exp_f32 v45, v45
v_mfma_f32_16x16x32_bf16 v[60:63], a[208:211], a[16:19], 0
v_exp_f32 v46, v46
v_mfma_f32_16x16x32_bf16 v[64:67], a[208:211], a[32:35], 0
v_exp_f32 v47, v47
v_mfma_f32_16x16x32_bf16 v[76:79], a[208:211], a[48:51], 0
v_cvt_pk_bf16_f32 v26, v28, v29
v_cvt_pk_bf16_f32 v27, v30, v31
v_mfma_f32_16x16x32_bf16 v[48:51], a[212:215], a[4:7], v[48:51]
buffer_load_dwordx4 v11, s[8:11], s21 offen offset:2048 nt lds
v_mfma_f32_16x16x32_bf16 v[60:63], a[212:215], a[20:23], v[60:63]
v_exp_f32 v52, v52
v_mfma_f32_16x16x32_bf16 v[64:67], a[212:215], a[36:39], v[64:67]
v_exp_f32 v53, v53
v_mfma_f32_16x16x32_bf16 v[76:79], a[212:215], a[52:55], v[76:79]
v_exp_f32 v54, v54
v_mfma_f32_16x16x32_bf16 v[48:51], a[216:219], a[8:11], v[48:51]
v_exp_f32 v55, v55
v_mfma_f32_16x16x32_bf16 v[60:63], a[216:219], a[24:27], v[60:63]
v_cvt_pk_bf16_f32 v38, v32, v33
v_cvt_pk_bf16_f32 v39, v34, v35
v_mfma_f32_16x16x32_bf16 v[64:67], a[216:219], a[40:43], v[64:67]
v_exp_f32 v56, v56
v_mfma_f32_16x16x32_bf16 v[76:79], a[216:219], a[56:59], v[76:79]
v_exp_f32 v57, v57
v_mfma_f32_16x16x32_bf16 v[48:51], a[220:223], a[12:15], v[48:51]
v_exp_f32 v58, v58
v_mfma_f32_16x16x32_bf16 v[60:63], a[220:223], a[28:31], v[60:63]
v_exp_f32 v59, v59
v_mfma_f32_16x16x32_bf16 v[64:67], a[220:223], a[44:47], v[64:67]
v_cvt_pk_bf16_f32 v42, v44, v45
v_cvt_pk_bf16_f32 v43, v46, v47
v_mfma_f32_16x16x32_bf16 v[76:79], a[220:223], a[60:63], v[76:79]
s_waitcnt vmcnt(8) lgkmcnt(0)
s_barrier
ds_read_b128 a[224:227], v10 offset:4096
v_mfma_f32_16x16x32_bf16 v[132:135], a[160:163], v[20:23], v[132:135]
v_exp_f32 v48, v48
v_mfma_f32_16x16x32_bf16 v[164:167], a[160:163], v[24:27], v[164:167]
ds_read_b128 a[228:231], v10 offset:5120
v_cvt_pk_bf16_f32 v52, v52, v53
v_mfma_f32_16x16x32_bf16 v[196:199], a[160:163], v[36:39], v[196:199]
v_exp_f32 v49, v49
v_mfma_f32_16x16x32_bf16 v[228:231], a[160:163], v[40:43], v[228:231]
ds_read_b128 a[192:195], v1 offset:49152
v_cvt_pk_bf16_f32 v53, v54, v55
v_mfma_f32_16x16x32_bf16 v[148:151], a[164:167], v[20:23], v[148:151]
v_exp_f32 v50, v50
v_mfma_f32_16x16x32_bf16 v[180:183], a[164:167], v[24:27], v[180:183]
s_add_u32 m0, s30, 0x14000
s_add_u32 s37, s37, 0x2000
ds_read_b128 a[196:199], v2 offset:49152
v_cvt_pk_bf16_f32 v56, v56, v57
v_mfma_f32_16x16x32_bf16 v[212:215], a[164:167], v[36:39], v[212:215]
buffer_load_dwordx4 v11, s[12:15], s37 offen nt lds
v_mfma_f32_16x16x32_bf16 v[244:247], a[164:167], v[40:43], v[244:247]
ds_read_b128 a[200:203], v1 offset:50176
v_cvt_pk_bf16_f32 v57, v58, v59
v_smfmac_f32_16x16x64_bf16 a[244:247], a[240:243], v[20:27], v110
ds_read_b128 a[204:207], v2 offset:50176
v_cvt_pk_bf16_f32 v54, v48, v49
v_mfma_f32_16x16x32_bf16 v[136:139], a[168:171], v[20:23], v[136:139]
v_exp_f32 v51, v51
v_mfma_f32_16x16x32_bf16 v[168:171], a[168:171], v[24:27], v[168:171]
ds_read_b128 a[208:211], v1 offset:53248
v_cvt_pk_bf16_f32 v55, v50, v51
v_mfma_f32_16x16x32_bf16 v[200:203], a[168:171], v[36:39], v[200:203]
v_exp_f32 v60, v60
v_mfma_f32_16x16x32_bf16 v[232:235], a[168:171], v[40:43], v[232:235]
ds_read_b128 a[212:215], v2 offset:53248
v_mfma_f32_16x16x32_bf16 v[152:155], a[172:175], v[20:23], v[152:155]
v_exp_f32 v61, v61
v_mfma_f32_16x16x32_bf16 v[184:187], a[172:175], v[24:27], v[184:187]
ds_read_b128 a[216:219], v1 offset:54272
v_cvt_pk_bf16_f32 v58, v60, v61
v_mfma_f32_16x16x32_bf16 v[216:219], a[172:175], v[36:39], v[216:219]
v_exp_f32 v62, v62
v_mfma_f32_16x16x32_bf16 v[248:251], a[172:175], v[40:43], v[248:251]
ds_read_b128 a[220:223], v2 offset:54272
v_smfmac_f32_16x16x64_bf16 a[248:251], a[240:243], v[36:43], v110
ds_read_b128 a[232:235], v3 offset:49152
v_mfma_f32_16x16x32_bf16 v[140:143], a[176:179], v[20:23], v[140:143]
v_exp_f32 v63, v63
v_mfma_f32_16x16x32_bf16 v[172:175], a[176:179], v[24:27], v[172:175]
ds_read_b128 a[236:239], v4 offset:49152
v_cvt_pk_bf16_f32 v59, v62, v63
v_mfma_f32_16x16x32_bf16 v[204:207], a[176:179], v[36:39], v[204:207]
v_exp_f32 v68, v68
v_mfma_f32_16x16x32_bf16 v[236:239], a[176:179], v[40:43], v[236:239]
ds_read_b64_tr_b16 a[160:161], v6 offset:49152
v_mfma_f32_16x16x32_bf16 v[156:159], a[180:183], v[20:23], v[156:159]
v_exp_f32 v69, v69
v_mfma_f32_16x16x32_bf16 v[188:191], a[180:183], v[24:27], v[188:191]
ds_read_b64_tr_b16 a[162:163], v6 offset:53248
v_cvt_pk_bf16_f32 v68, v68, v69
v_mfma_f32_16x16x32_bf16 v[220:223], a[180:183], v[36:39], v[220:223]
v_exp_f32 v70, v70
v_mfma_f32_16x16x32_bf16 v[252:255], a[180:183], v[40:43], v[252:255]
buffer_load_dwordx4 v11, s[12:15], s37 offen offset:2048 nt lds
v_mfma_f32_16x16x32_bf16 v[128:131], a[184:187], v[20:23], v[128:131]
ds_read_b64_tr_b16 a[168:169], v7 offset:49152
v_mfma_f32_16x16x32_bf16 v[160:163], a[184:187], v[24:27], v[160:163]
v_exp_f32 v71, v71
v_mfma_f32_16x16x32_bf16 v[192:195], a[184:187], v[36:39], v[192:195]
s_waitcnt lgkmcnt(4)
ds_read_b64_tr_b16 a[170:171], v7 offset:53248
v_cvt_pk_bf16_f32 v69, v70, v71
v_mfma_f32_16x16x32_bf16 v[224:227], a[184:187], v[40:43], v[224:227]
v_exp_f32 v72, v72
v_mfma_f32_16x16x32_bf16 v[88:91], a[184:187], a[224:227], v[88:91]
ds_read_b64_tr_b16 a[176:177], v8 offset:49152
v_mfma_f32_16x16x32_bf16 v[96:99], a[184:187], a[228:231], v[96:99]
v_exp_f32 v73, v73
v_smfmac_f32_16x16x64_bf16 a[252:255], a[240:243], a[224:231], v110
ds_read_b64_tr_b16 a[184:185], v5 offset:49152
v_cvt_pk_bf16_f32 v72, v72, v73
v_mfma_f32_16x16x32_bf16 v[144:147], a[188:191], v[20:23], v[144:147]
v_exp_f32 v74, v74
v_mfma_f32_16x16x32_bf16 v[176:179], a[188:191], v[24:27], v[176:179]
ds_read_b64_tr_b16 a[186:187], v5 offset:53248
v_mfma_f32_16x16x32_bf16 v[208:211], a[188:191], v[36:39], v[208:211]
v_exp_f32 v75, v75
v_mfma_f32_16x16x32_bf16 v[240:243], a[188:191], v[40:43], v[240:243]
ds_read_b64_tr_b16 a[178:179], v8 offset:53248
v_cvt_pk_bf16_f32 v73, v74, v75
v_mfma_f32_16x16x32_bf16 v[92:95], a[188:191], a[224:227], v[92:95]
v_exp_f32 v64, v64
v_mfma_f32_16x16x32_bf16 v[100:103], a[188:191], a[228:231], v[100:103]
ds_read_b128 a[224:227], v3 offset:50176
v_mfma_f32_16x16x32_bf16 v[20:23], a[192:195], a[96:99], 0
v_exp_f32 v65, v65
v_mfma_f32_16x16x32_bf16 v[24:27], a[192:195], a[112:115], 0
ds_read_b128 a[228:231], v4 offset:50176
v_cvt_pk_bf16_f32 v70, v64, v65
v_mfma_f32_16x16x32_bf16 v[36:39], a[192:195], a[128:131], 0
v_exp_f32 v66, v66
v_mfma_f32_16x16x32_bf16 v[40:43], a[192:195], a[144:147], 0
ds_read_b64_tr_b16 a[188:189], v5 offset:50176
v_lshrrev_b32 v116, 1, v12
v_mfma_f32_16x16x32_bf16 v[20:23], a[196:199], a[100:103], v[20:23]
s_add_u32 m0, s30, 0x4000
s_add_u32 s21, s21, 0x2000
v_exp_f32 v67, v67
v_mfma_f32_16x16x32_bf16 v[24:27], a[196:199], a[116:119], v[24:27]
buffer_load_dwordx4 v11, s[8:11], s21 offen nt lds
v_mfma_f32_16x16x32_bf16 v[36:39], a[196:199], a[132:135], v[36:39]
ds_read_b64_tr_b16 a[190:191], v5 offset:54272
v_cvt_pk_bf16_f32 v71, v66, v67
v_mfma_f32_16x16x32_bf16 v[40:43], a[196:199], a[148:151], v[40:43]
v_exp_f32 v76, v76
v_mfma_f32_16x16x32_bf16 v[20:23], a[200:203], a[104:107], v[20:23]
ds_read_b64_tr_b16 a[164:165], v6 offset:50176
v_and_b32 v117, 0x30, v12
v_mfma_f32_16x16x32_bf16 v[24:27], a[200:203], a[120:123], v[24:27]
v_exp_f32 v77, v77
v_mfma_f32_16x16x32_bf16 v[36:39], a[200:203], a[136:139], v[36:39]
ds_read_b64_tr_b16 a[166:167], v6 offset:54272
v_cvt_pk_bf16_f32 v74, v76, v77
v_mfma_f32_16x16x32_bf16 v[40:43], a[200:203], a[152:155], v[40:43]
v_exp_f32 v78, v78
v_mfma_f32_16x16x32_bf16 v[20:23], a[204:207], a[108:111], v[20:23]
s_waitcnt lgkmcnt(4)
ds_read_b64_tr_b16 a[172:173], v7 offset:50176
v_and_b32 v116, 0x780, v116
v_mfma_f32_16x16x32_bf16 v[24:27], a[204:207], a[124:127], v[24:27]
v_exp_f32 v79, v79
v_mfma_f32_16x16x32_bf16 v[36:39], a[204:207], a[140:143], v[36:39]
ds_read_b64_tr_b16 a[174:175], v7 offset:54272
v_cvt_pk_bf16_f32 v75, v78, v79
v_mfma_f32_16x16x32_bf16 v[40:43], a[204:207], a[156:159], v[40:43]
v_exp_f32 v20, v20
v_mfma_f32_16x16x32_bf16 v[16:19], a[208:211], a[96:99], 0
ds_read_b64_tr_b16 a[180:181], v8 offset:50176
v_add3_u32 v117, v10, v117, s45
v_mfma_f32_16x16x32_bf16 v[28:31], a[208:211], a[112:115], 0
v_exp_f32 v21, v21
v_mfma_f32_16x16x32_bf16 v[32:35], a[208:211], a[128:131], 0
ds_read_b64_tr_b16 a[182:183], v8 offset:54272
v_cvt_pk_bf16_f32 v20, v20, v21
v_mfma_f32_16x16x32_bf16 v[44:47], a[208:211], a[144:147], 0
v_exp_f32 v22, v22
v_mfma_f32_16x16x32_bf16 v[16:19], a[212:215], a[100:103], v[16:19]
ds_read_b128 a[192:195], v1 offset:57344
v_add3_u32 v116, v13, v116, s44
v_mfma_f32_16x16x32_bf16 v[28:31], a[212:215], a[116:119], v[28:31]
v_exp_f32 v23, v23
v_mfma_f32_16x16x32_bf16 v[32:35], a[212:215], a[132:135], v[32:35]
ds_read_b128 a[196:199], v2 offset:57344
v_cvt_pk_bf16_f32 v21, v22, v23
v_mfma_f32_16x16x32_bf16 v[44:47], a[212:215], a[148:151], v[44:47]
v_exp_f32 v24, v24
v_mfma_f32_16x16x32_bf16 v[16:19], a[216:219], a[104:107], v[16:19]
buffer_load_dwordx4 v11, s[8:11], s21 offen offset:2048 nt lds
v_mfma_f32_16x16x32_bf16 v[28:31], a[216:219], a[120:123], v[28:31]
ds_read_b128 a[200:203], v1 offset:58368
v_add_u32 v12, s46, v10
v_mfma_f32_16x16x32_bf16 v[32:35], a[216:219], a[136:139], v[32:35]
v_exp_f32 v25, v25
v_mfma_f32_16x16x32_bf16 v[44:47], a[216:219], a[152:155], v[44:47]
ds_read_b128 a[204:207], v2 offset:58368
v_cvt_pk_bf16_f32 v24, v24, v25
v_mfma_f32_16x16x32_bf16 v[16:19], a[220:223], a[108:111], v[16:19]
v_exp_f32 v26, v26
v_mfma_f32_16x16x32_bf16 v[28:31], a[220:223], a[124:127], v[28:31]
ds_read_b128 a[208:211], v1 offset:61440
v_mfma_f32_16x16x32_bf16 v[32:35], a[220:223], a[140:143], v[32:35]
v_exp_f32 v27, v27
v_mfma_f32_16x16x32_bf16 v[44:47], a[220:223], a[156:159], v[44:47]
ds_read_b128 a[212:215], v2 offset:61440
v_cvt_pk_bf16_f32 v25, v26, v27
v_mfma_f32_16x16x32_bf16 v[80:83], a[232:235], a[64:67], 0
v_exp_f32 v16, v16
v_mfma_f32_16x16x32_bf16 v[84:87], a[232:235], a[80:83], 0
ds_read_b128 a[232:235], v10 offset:6144
v_mfma_f32_16x16x32_bf16 v[80:83], a[236:239], a[68:71], v[80:83]
v_exp_f32 v17, v17
v_mfma_f32_16x16x32_bf16 v[84:87], a[236:239], a[84:87], v[84:87]
s_waitcnt lgkmcnt(5)
ds_read_b128 a[236:239], v10 offset:7168
v_cvt_pk_bf16_f32 v22, v16, v17
v_mfma_f32_16x16x32_bf16 v[80:83], a[224:227], a[72:75], v[80:83]
v_exp_f32 v18, v18
v_mfma_f32_16x16x32_bf16 v[84:87], a[224:227], a[88:91], v[84:87]
ds_read_b128 a[216:219], v1 offset:62464
v_mfma_f32_16x16x32_bf16 v[80:83], a[228:231], a[76:79], v[80:83]
v_exp_f32 v19, v19
v_mfma_f32_16x16x32_bf16 v[84:87], a[228:231], a[92:95], v[84:87]
ds_read_b128 a[220:223], v2 offset:62464
v_cvt_pk_bf16_f32 v23, v18, v19
v_smfmac_f32_16x16x64_bf16 a[244:247], a[240:243], v[52:59], v110
v_mfma_f32_16x16x32_bf16 v[128:131], a[184:187], v[52:55], v[128:131]
v_exp_f32 v28, v28
v_mfma_f32_16x16x32_bf16 v[132:135], a[160:163], v[52:55], v[132:135]
s_add_u32 m0, s30, 0x16000
s_add_u32 s37, s37, 0x2000
v_exp_f32 v80, v80
v_mfma_f32_16x16x32_bf16 v[136:139], a[168:171], v[52:55], v[136:139]
buffer_load_dwordx4 v11, s[12:15], s37 offen nt lds
v_mfma_f32_16x16x32_bf16 v[140:143], a[176:179], v[52:55], v[140:143]
v_accvgpr_read_b32 v104, a244
v_accvgpr_read_b32 v111, a245
v_mfma_f32_16x16x32_bf16 v[144:147], a[188:191], v[52:55], v[144:147]
v_add_f32 v104, v104, v111
v_accvgpr_read_b32 v105, a246
v_mfma_f32_16x16x32_bf16 v[148:151], a[164:167], v[52:55], v[148:151]
v_rcp_f32 v114, v104
v_mfma_f32_16x16x32_bf16 v[152:155], a[172:175], v[52:55], v[152:155]
v_rcp_f32 v115, v104
v_mfma_f32_16x16x32_bf16 v[156:159], a[180:183], v[52:55], v[156:159]
v_accvgpr_read_b32 v111, a247
v_add_f32 v105, v105, v111
v_pk_mul_f32 v[128:129], v[128:129], v[114:115]
v_pk_mul_f32 v[130:131], v[130:131], v[114:115]
v_pk_mul_f32 v[132:133], v[132:133], v[114:115]
v_pk_mul_f32 v[134:135], v[134:135], v[114:115]
v_mfma_f32_16x16x32_bf16 v[160:163], a[184:187], v[56:59], v[160:163]
v_rcp_f32 v112, v105
v_mfma_f32_16x16x32_bf16 v[164:167], a[160:163], v[56:59], v[164:167]
v_rcp_f32 v113, v105
v_mfma_f32_16x16x32_bf16 v[168:171], a[168:171], v[56:59], v[168:171]
v_exp_f32 v81, v81
v_mfma_f32_16x16x32_bf16 v[172:175], a[176:179], v[56:59], v[172:175]
v_exp_f32 v82, v82
v_mfma_f32_16x16x32_bf16 v[176:179], a[188:191], v[56:59], v[176:179]
v_exp_f32 v83, v83
v_cvt_pk_bf16_f32 v128, v128, v129
v_cvt_pk_bf16_f32 v129, v130, v131
v_cvt_pk_bf16_f32 v130, v132, v133
v_cvt_pk_bf16_f32 v131, v134, v135
v_pk_mul_f32 v[136:137], v[136:137], v[114:115]
v_pk_mul_f32 v[138:139], v[138:139], v[114:115]
v_pk_mul_f32 v[140:141], v[140:141], v[114:115]
v_pk_mul_f32 v[142:143], v[142:143], v[114:115]
v_mfma_f32_16x16x32_bf16 v[180:183], a[164:167], v[56:59], v[180:183]
ds_write2_b64 v13, v[128:129], v[130:131] offset0:0 offset1:4
v_mfma_f32_16x16x32_bf16 v[184:187], a[172:175], v[56:59], v[184:187]
v_exp_f32 v84, v84
v_mfma_f32_16x16x32_bf16 v[188:191], a[180:183], v[56:59], v[188:191]
v_exp_f32 v85, v85
v_smfmac_f32_16x16x64_bf16 a[248:251], a[240:243], v[68:75], v110
v_cvt_pk_bf16_f32 v80, v80, v81
v_mfma_f32_16x16x32_bf16 v[192:195], a[184:187], v[68:71], v[192:195]
v_exp_f32 v86, v86
v_cvt_pk_bf16_f32 v136, v136, v137
v_cvt_pk_bf16_f32 v137, v138, v139
v_cvt_pk_bf16_f32 v138, v140, v141
v_cvt_pk_bf16_f32 v139, v142, v143
v_pk_mul_f32 v[144:145], v[144:145], v[114:115]
v_pk_mul_f32 v[146:147], v[146:147], v[114:115]
v_pk_mul_f32 v[148:149], v[148:149], v[114:115]
v_pk_mul_f32 v[150:151], v[150:151], v[114:115]
v_mfma_f32_16x16x32_bf16 v[196:199], a[160:163], v[68:71], v[196:199]
ds_write2_b64 v13, v[136:137], v[138:139] offset0:8 offset1:12
v_mfma_f32_16x16x32_bf16 v[200:203], a[168:171], v[68:71], v[200:203]
ds_read_b128 a[0:3], v14 offset:0
ds_read_b128 a[4:7], v14 offset:1152
v_mfma_f32_16x16x32_bf16 v[204:207], a[176:179], v[68:71], v[204:207]
v_accvgpr_read_b32 v106, a248
v_accvgpr_read_b32 v111, a249
v_mfma_f32_16x16x32_bf16 v[208:211], a[188:191], v[68:71], v[208:211]
buffer_load_dwordx4 v11, s[12:15], s37 offen offset:2048 nt lds
v_mfma_f32_16x16x32_bf16 v[212:215], a[164:167], v[68:71], v[212:215]
v_add_f32 v106, v106, v111
v_cvt_pk_bf16_f32 v81, v82, v83
v_cvt_pk_bf16_f32 v144, v144, v145
v_cvt_pk_bf16_f32 v145, v146, v147
v_cvt_pk_bf16_f32 v146, v148, v149
v_cvt_pk_bf16_f32 v147, v150, v151
v_pk_mul_f32 v[152:153], v[152:153], v[114:115]
v_pk_mul_f32 v[154:155], v[154:155], v[114:115]
v_pk_mul_f32 v[156:157], v[156:157], v[114:115]
v_pk_mul_f32 v[158:159], v[158:159], v[114:115]
v_mfma_f32_16x16x32_bf16 v[216:219], a[172:175], v[68:71], v[216:219]
ds_write_b64 v9, v[80:81] offset:0
v_cvt_pk_bf16_f32 v84, v84, v85
v_mfma_f32_16x16x32_bf16 v[220:223], a[180:183], v[68:71], v[220:223]
ds_write2_b64 v13, v[144:145], v[146:147] offset0:0 offset1:4
v_mfma_f32_16x16x32_bf16 v[224:227], a[184:187], v[72:75], v[224:227]
v_rcp_f32 v114, v106
v_mfma_f32_16x16x32_bf16 v[228:231], a[160:163], v[72:75], v[228:231]
ds_read_b64_tr_b16 a[160:161], v6 offset:57344
v_accvgpr_read_b32 v107, a250
v_mfma_f32_16x16x32_bf16 v[232:235], a[168:171], v[72:75], v[232:235]
v_rcp_f32 v115, v106
v_mfma_f32_16x16x32_bf16 v[236:239], a[176:179], v[72:75], v[236:239]
s_waitcnt lgkmcnt(3)
ds_read_b64_tr_b16 a[162:163], v6 offset:61440
v_accvgpr_read_b32 v111, a251
v_cvt_pk_bf16_f32 v152, v152, v153
v_cvt_pk_bf16_f32 v153, v154, v155
v_cvt_pk_bf16_f32 v154, v156, v157
v_cvt_pk_bf16_f32 v155, v158, v159
v_pk_mul_f32 v[160:161], v[160:161], v[112:113]
v_pk_mul_f32 v[162:163], v[162:163], v[112:113]
v_pk_mul_f32 v[164:165], v[164:165], v[112:113]
v_pk_mul_f32 v[166:167], v[166:167], v[112:113]
v_mfma_f32_16x16x32_bf16 v[240:243], a[188:191], v[72:75], v[240:243]
ds_write2_b64 v13, v[152:153], v[154:155] offset0:8 offset1:12
v_mfma_f32_16x16x32_bf16 v[244:247], a[164:167], v[72:75], v[244:247]
ds_read_b64_tr_b16 a[168:169], v7 offset:57344
ds_read_b128 a[8:11], v14 offset:0
v_mfma_f32_16x16x32_bf16 v[248:251], a[172:175], v[72:75], v[248:251]
ds_read_b128 a[12:15], v14 offset:1152
v_add_f32 v107, v107, v111
v_mfma_f32_16x16x32_bf16 v[252:255], a[180:183], v[72:75], v[252:255]
ds_read_b64_tr_b16 a[170:171], v7 offset:61440
v_accvgpr_write_b32 a244, 0
v_mfma_f32_16x16x32_bf16 v[88:91], a[184:187], a[232:235], v[88:91]
v_exp_f32 v87, v87
v_cvt_pk_bf16_f32 v160, v160, v161
v_cvt_pk_bf16_f32 v161, v162, v163
v_cvt_pk_bf16_f32 v162, v164, v165
v_cvt_pk_bf16_f32 v163, v166, v167
v_pk_mul_f32 v[168:169], v[168:169], v[112:113]
v_pk_mul_f32 v[170:171], v[170:171], v[112:113]
v_pk_mul_f32 v[172:173], v[172:173], v[112:113]
v_pk_mul_f32 v[174:175], v[174:175], v[112:113]
v_mfma_f32_16x16x32_bf16 v[96:99], a[184:187], a[236:239], v[96:99]
ds_read_b64_tr_b16 a[184:185], v5 offset:57344
v_cvt_pk_bf16_f32 v85, v86, v87
v_smfmac_f32_16x16x64_bf16 a[252:255], a[240:243], a[232:239], v110
ds_read_b64_tr_b16 a[186:187], v5 offset:61440
v_accvgpr_write_b32 a245, 0
v_mfma_f32_16x16x32_bf16 v[92:95], a[188:191], a[232:235], v[92:95]
ds_write_b64 v9, v[84:85] offset:1024
v_accvgpr_write_b32 a246, 0
v_mfma_f32_16x16x32_bf16 v[100:103], a[188:191], a[236:239], v[100:103]
ds_read_b64_tr_b16 a[164:165], v6 offset:58368
v_accvgpr_write_b32 a247, 0
v_mfma_f32_16x16x32_bf16 v[52:55], a[192:195], a[96:99], 0
ds_write2_b64 v13, v[160:161], v[162:163] offset0:0 offset1:4
v_cvt_pk_bf16_f32 v168, v168, v169
v_cvt_pk_bf16_f32 v169, v170, v171
v_cvt_pk_bf16_f32 v170, v172, v173
v_cvt_pk_bf16_f32 v171, v174, v175
v_pk_mul_f32 v[176:177], v[176:177], v[112:113]
v_pk_mul_f32 v[178:179], v[178:179], v[112:113]
v_pk_mul_f32 v[180:181], v[180:181], v[112:113]
v_pk_mul_f32 v[182:183], v[182:183], v[112:113]
v_mfma_f32_16x16x32_bf16 v[56:59], a[192:195], a[112:115], 0
s_add_u32 m0, s30, 0x6000
s_add_u32 s21, s21, 0x2000
ds_read_b64_tr_b16 a[166:167], v6 offset:62464
v_accvgpr_read_b32 v108, a252
v_mfma_f32_16x16x32_bf16 v[68:71], a[192:195], a[128:131], 0
buffer_load_dwordx4 v11, s[8:11], s21 offen nt lds
v_mfma_f32_16x16x32_bf16 v[72:75], a[192:195], a[144:147], 0
s_waitcnt lgkmcnt(6)
ds_read_b64_tr_b16 a[172:173], v7 offset:58368
v_accvgpr_read_b32 v111, a253
v_mfma_f32_16x16x32_bf16 v[52:55], a[196:199], a[100:103], v[52:55]
ds_write2_b64 v13, v[168:169], v[170:171] offset0:8 offset1:12
v_mfma_f32_16x16x32_bf16 v[56:59], a[196:199], a[116:119], v[56:59]
ds_read_b64_tr_b16 a[174:175], v7 offset:62464
ds_read_b128 a[16:19], v14 offset:0
v_mfma_f32_16x16x32_bf16 v[68:71], a[196:199], a[132:135], v[68:71]
ds_read_b128 a[20:23], v14 offset:1152
v_add_f32 v108, v108, v111
v_cvt_pk_bf16_f32 v176, v176, v177
v_cvt_pk_bf16_f32 v177, v178, v179
v_cvt_pk_bf16_f32 v178, v180, v181
v_cvt_pk_bf16_f32 v179, v182, v183
v_pk_mul_f32 v[184:185], v[184:185], v[112:113]
v_pk_mul_f32 v[186:187], v[186:187], v[112:113]
v_pk_mul_f32 v[188:189], v[188:189], v[112:113]
v_pk_mul_f32 v[190:191], v[190:191], v[112:113]
v_mfma_f32_16x16x32_bf16 v[72:75], a[196:199], a[148:151], v[72:75]
ds_read_b64_tr_b16 a[176:177], v8 offset:57344
v_accvgpr_read_b32 v109, a254
v_mfma_f32_16x16x32_bf16 v[52:55], a[200:203], a[104:107], v[52:55]
ds_write2_b64 v13, v[176:177], v[178:179] offset0:0 offset1:4
v_mfma_f32_16x16x32_bf16 v[56:59], a[200:203], a[120:123], v[56:59]
ds_read_b64_tr_b16 a[178:179], v8 offset:61440
v_accvgpr_read_b32 v111, a255
v_mfma_f32_16x16x32_bf16 v[68:71], a[200:203], a[136:139], v[68:71]
v_rcp_f32 v112, v107
v_mfma_f32_16x16x32_bf16 v[72:75], a[200:203], a[152:155], v[72:75]
ds_read_b64_tr_b16 a[180:181], v8 offset:58368
v_add_f32 v109, v109, v111
v_cvt_pk_bf16_f32 v184, v184, v185
v_cvt_pk_bf16_f32 v185, v186, v187
v_cvt_pk_bf16_f32 v186, v188, v189
v_cvt_pk_bf16_f32 v187, v190, v191
v_pk_mul_f32 v[192:193], v[192:193], v[114:115]
v_pk_mul_f32 v[194:195], v[194:195], v[114:115]
v_pk_mul_f32 v[196:197], v[196:197], v[114:115]
v_pk_mul_f32 v[198:199], v[198:199], v[114:115]
v_mfma_f32_16x16x32_bf16 v[52:55], a[204:207], a[108:111], v[52:55]
s_waitcnt lgkmcnt(4)
ds_write2_b64 v13, v[184:185], v[186:187] offset0:8 offset1:12
v_mfma_f32_16x16x32_bf16 v[56:59], a[204:207], a[124:127], v[56:59]
ds_read_b64_tr_b16 a[182:183], v8 offset:62464
ds_read_b128 a[24:27], v14 offset:0
v_mfma_f32_16x16x32_bf16 v[68:71], a[204:207], a[140:143], v[68:71]
ds_read_b128 a[28:31], v14 offset:1152
v_accvgpr_write_b32 a248, 0
v_mfma_f32_16x16x32_bf16 v[72:75], a[204:207], a[156:159], v[72:75]
ds_read_b64_tr_b16 a[188:189], v5 offset:58368
v_accvgpr_write_b32 a249, 0
v_mfma_f32_16x16x32_bf16 v[48:51], a[208:211], a[96:99], 0
v_rcp_f32 v113, v107
v_cvt_pk_bf16_f32 v192, v192, v193
v_cvt_pk_bf16_f32 v193, v194, v195
v_cvt_pk_bf16_f32 v194, v196, v197
v_cvt_pk_bf16_f32 v195, v198, v199
v_pk_mul_f32 v[200:201], v[200:201], v[114:115]
v_pk_mul_f32 v[202:203], v[202:203], v[114:115]
v_pk_mul_f32 v[204:205], v[204:205], v[114:115]
v_pk_mul_f32 v[206:207], v[206:207], v[114:115]
v_mfma_f32_16x16x32_bf16 v[60:63], a[208:211], a[112:115], 0
ds_read_b64_tr_b16 a[190:191], v5 offset:62464
v_accvgpr_write_b32 a250, 0
v_mfma_f32_16x16x32_bf16 v[64:67], a[208:211], a[128:131], 0
ds_write2_b64 v13, v[192:193], v[194:195] offset0:0 offset1:4
v_mfma_f32_16x16x32_bf16 v[76:79], a[208:211], a[144:147], 0
v_exp_f32 v29, v29
v_mfma_f32_16x16x32_bf16 v[48:51], a[212:215], a[100:103], v[48:51]
buffer_load_dwordx4 v11, s[8:11], s21 offen offset:2048 nt lds
v_mfma_f32_16x16x32_bf16 v[60:63], a[212:215], a[116:119], v[60:63]
v_exp_f32 v30, v30
v_mfma_f32_16x16x32_bf16 v[64:67], a[212:215], a[132:135], v[64:67]
v_exp_f32 v31, v31
v_cvt_pk_bf16_f32 v200, v200, v201
v_cvt_pk_bf16_f32 v201, v202, v203
v_cvt_pk_bf16_f32 v202, v204, v205
v_cvt_pk_bf16_f32 v203, v206, v207
v_pk_mul_f32 v[208:209], v[208:209], v[114:115]
v_pk_mul_f32 v[210:211], v[210:211], v[114:115]
v_pk_mul_f32 v[212:213], v[212:213], v[114:115]
v_pk_mul_f32 v[214:215], v[214:215], v[114:115]
v_mfma_f32_16x16x32_bf16 v[76:79], a[212:215], a[148:151], v[76:79]
ds_write2_b64 v13, v[200:201], v[202:203] offset0:8 offset1:12
v_mfma_f32_16x16x32_bf16 v[48:51], a[216:219], a[104:107], v[48:51]
ds_read_b128 a[32:35], v14 offset:0
ds_read_b128 a[36:39], v14 offset:1152
v_mfma_f32_16x16x32_bf16 v[60:63], a[216:219], a[120:123], v[60:63]
v_exp_f32 v36, v36
v_mfma_f32_16x16x32_bf16 v[64:67], a[216:219], a[136:139], v[64:67]
v_exp_f32 v37, v37
v_mfma_f32_16x16x32_bf16 v[76:79], a[216:219], a[152:155], v[76:79]
v_exp_f32 v38, v38
v_cvt_pk_bf16_f32 v208, v208, v209
v_cvt_pk_bf16_f32 v209, v210, v211
v_cvt_pk_bf16_f32 v210, v212, v213
v_cvt_pk_bf16_f32 v211, v214, v215
v_pk_mul_f32 v[216:217], v[216:217], v[114:115]
v_pk_mul_f32 v[218:219], v[218:219], v[114:115]
v_pk_mul_f32 v[220:221], v[220:221], v[114:115]
v_pk_mul_f32 v[222:223], v[222:223], v[114:115]
v_mfma_f32_16x16x32_bf16 v[48:51], a[220:223], a[108:111], v[48:51]
ds_write2_b64 v13, v[208:209], v[210:211] offset0:0 offset1:4
v_mfma_f32_16x16x32_bf16 v[60:63], a[220:223], a[124:127], v[60:63]
v_exp_f32 v39, v39
v_mfma_f32_16x16x32_bf16 v[64:67], a[220:223], a[140:143], v[64:67]
v_exp_f32 v32, v32
v_mfma_f32_16x16x32_bf16 v[76:79], a[220:223], a[156:159], v[76:79]
s_waitcnt vmcnt(8) lgkmcnt(0)
s_barrier
ds_read_b128 a[224:227], v10 offset:0
v_mfma_f32_16x16x32_bf16 v[128:131], a[184:187], v[20:23], 0
v_exp_f32 v33, v33
v_cvt_pk_bf16_f32 v216, v216, v217
v_cvt_pk_bf16_f32 v217, v218, v219
v_cvt_pk_bf16_f32 v218, v220, v221
v_cvt_pk_bf16_f32 v219, v222, v223
v_pk_mul_f32 v[224:225], v[224:225], v[112:113]
v_pk_mul_f32 v[226:227], v[226:227], v[112:113]
v_pk_mul_f32 v[228:229], v[228:229], v[112:113]
v_pk_mul_f32 v[230:231], v[230:231], v[112:113]
v_mfma_f32_16x16x32_bf16 v[132:135], a[160:163], v[20:23], 0
ds_read_b128 a[228:231], v10 offset:1024
v_cvt_pk_bf16_f32 v26, v28, v29
v_mfma_f32_16x16x32_bf16 v[136:139], a[168:171], v[20:23], 0
ds_write2_b64 v13, v[216:217], v[218:219] offset0:8 offset1:12
v_mfma_f32_16x16x32_bf16 v[140:143], a[176:179], v[20:23], 0
ds_read_b128 a[192:195], v1 offset:0
ds_read_b128 a[40:43], v14 offset:0
v_mfma_f32_16x16x32_bf16 v[144:147], a[188:191], v[20:23], 0
ds_read_b128 a[44:47], v14 offset:1152
v_cvt_pk_bf16_f32 v27, v30, v31
v_mfma_f32_16x16x32_bf16 v[148:151], a[164:167], v[20:23], 0
s_add_u32 m0, s30, 0x18000
s_add_u32 s37, s37, 0x2000
ds_read_b128 a[196:199], v2 offset:0
v_cvt_pk_bf16_f32 v36, v36, v37
v_cvt_pk_bf16_f32 v224, v224, v225
v_cvt_pk_bf16_f32 v225, v226, v227
v_cvt_pk_bf16_f32 v226, v228, v229
v_cvt_pk_bf16_f32 v227, v230, v231
v_pk_mul_f32 v[232:233], v[232:233], v[112:113]
v_pk_mul_f32 v[234:235], v[234:235], v[112:113]
v_pk_mul_f32 v[236:237], v[236:237], v[112:113]
v_pk_mul_f32 v[238:239], v[238:239], v[112:113]
v_mfma_f32_16x16x32_bf16 v[152:155], a[172:175], v[20:23], 0
buffer_load_dwordx4 v11, s[12:15], s37 offen nt lds
v_mfma_f32_16x16x32_bf16 v[156:159], a[180:183], v[20:23], 0
ds_read_b128 a[200:203], v1 offset:1024
v_cvt_pk_bf16_f32 v37, v38, v39
v_mfma_f32_16x16x32_bf16 v[160:163], a[184:187], v[24:27], 0
ds_write2_b64 v13, v[224:225], v[226:227] offset0:0 offset1:4
v_mfma_f32_16x16x32_bf16 v[164:167], a[160:163], v[24:27], 0
ds_read_b128 a[204:207], v2 offset:1024
v_cvt_pk_bf16_f32 v38, v32, v33
v_mfma_f32_16x16x32_bf16 v[168:171], a[168:171], v[24:27], 0
v_exp_f32 v34, v34
v_mfma_f32_16x16x32_bf16 v[172:175], a[176:179], v[24:27], 0
ds_read_b128 a[208:211], v1 offset:4096
v_accvgpr_write_b32 a251, 0
v_cvt_pk_bf16_f32 v232, v232, v233
v_cvt_pk_bf16_f32 v233, v234, v235
v_cvt_pk_bf16_f32 v234, v236, v237
v_cvt_pk_bf16_f32 v235, v238, v239
v_pk_mul_f32 v[240:241], v[240:241], v[112:113]
v_pk_mul_f32 v[242:243], v[242:243], v[112:113]
v_pk_mul_f32 v[244:245], v[244:245], v[112:113]
v_pk_mul_f32 v[246:247], v[246:247], v[112:113]
v_mfma_f32_16x16x32_bf16 v[176:179], a[188:191], v[24:27], 0
ds_write2_b64 v13, v[232:233], v[234:235] offset0:8 offset1:12
v_exp_f32 v35, v35
v_mfma_f32_16x16x32_bf16 v[180:183], a[164:167], v[24:27], 0
ds_read_b128 a[212:215], v2 offset:4096
ds_read_b128 a[48:51], v14 offset:0
v_mfma_f32_16x16x32_bf16 v[184:187], a[172:175], v[24:27], 0
ds_read_b128 a[52:55], v14 offset:1152
v_cvt_pk_bf16_f32 v39, v34, v35
v_mfma_f32_16x16x32_bf16 v[188:191], a[180:183], v[24:27], 0
s_waitcnt lgkmcnt(7)
ds_read_b128 a[216:219], v1 offset:5120
v_accvgpr_write_b32 a252, 0
v_mfma_f32_16x16x32_bf16 v[192:195], a[184:187], v[36:39], 0
v_exp_f32 v40, v40
v_exp_f32 v41, v41
v_exp_f32 v42, v42
v_exp_f32 v43, v43
v_cvt_pk_bf16_f32 v240, v240, v241
v_cvt_pk_bf16_f32 v241, v242, v243
v_cvt_pk_bf16_f32 v242, v244, v245
v_cvt_pk_bf16_f32 v243, v246, v247
v_pk_mul_f32 v[248:249], v[248:249], v[112:113]
v_pk_mul_f32 v[250:251], v[250:251], v[112:113]
v_pk_mul_f32 v[252:253], v[252:253], v[112:113]
v_pk_mul_f32 v[254:255], v[254:255], v[112:113]
v_mfma_f32_16x16x32_bf16 v[196:199], a[160:163], v[36:39], 0
ds_read_b128 a[220:223], v2 offset:5120
v_cvt_pk_bf16_f32 v40, v40, v41
v_mfma_f32_16x16x32_bf16 v[200:203], a[168:171], v[36:39], 0
ds_write2_b64 v13, v[240:241], v[242:243] offset0:0 offset1:4
v_mfma_f32_16x16x32_bf16 v[204:207], a[176:179], v[36:39], 0
ds_read_b128 a[232:235], v3 offset:0
v_cvt_pk_bf16_f32 v41, v42, v43
v_mfma_f32_16x16x32_bf16 v[208:211], a[188:191], v[36:39], 0
v_exp_f32 v44, v44
v_exp_f32 v45, v45
v_exp_f32 v46, v46
v_exp_f32 v47, v47
v_mfma_f32_16x16x32_bf16 v[212:215], a[164:167], v[36:39], 0
ds_read_b128 a[236:239], v4 offset:0
v_rcp_f32 v114, v108
v_rcp_f32 v115, v108
v_cvt_pk_bf16_f32 v248, v248, v249
v_cvt_pk_bf16_f32 v249, v250, v251
v_cvt_pk_bf16_f32 v250, v252, v253
v_cvt_pk_bf16_f32 v251, v254, v255
v_pk_mul_f32 v[88:89], v[88:89], v[114:115]
v_pk_mul_f32 v[90:91], v[90:91], v[114:115]
v_pk_mul_f32 v[92:93], v[92:93], v[114:115]
v_pk_mul_f32 v[94:95], v[94:95], v[114:115]
v_mfma_f32_16x16x32_bf16 v[216:219], a[172:175], v[36:39], 0
ds_write2_b64 v13, v[248:249], v[250:251] offset0:8 offset1:12
v_cvt_pk_bf16_f32 v42, v44, v45
v_cvt_pk_bf16_f32 v43, v46, v47
v_mfma_f32_16x16x32_bf16 v[220:223], a[180:183], v[36:39], 0
ds_read_b128 a[56:59], v14 offset:0
ds_read_b128 a[60:63], v14 offset:1152
v_mfma_f32_16x16x32_bf16 v[224:227], a[184:187], v[40:43], 0
v_rcp_f32 v112, v109
v_mfma_f32_16x16x32_bf16 v[228:231], a[160:163], v[40:43], 0
buffer_load_dwordx4 v11, s[12:15], s37 offen offset:2048 nt lds
v_mfma_f32_16x16x32_bf16 v[232:235], a[168:171], v[40:43], 0
s_waitcnt lgkmcnt(4)
ds_read_b64_tr_b16 a[160:161], v6 offset:0
v_accvgpr_write_b32 a253, 0
v_mfma_f32_16x16x32_bf16 v[236:239], a[176:179], v[40:43], 0
v_rcp_f32 v113, v109
v_cvt_pk_bf16_f32 v88, v88, v89
v_cvt_pk_bf16_f32 v89, v90, v91
v_cvt_pk_bf16_f32 v90, v92, v93
v_cvt_pk_bf16_f32 v91, v94, v95
v_pk_mul_f32 v[96:97], v[96:97], v[112:113]
v_pk_mul_f32 v[98:99], v[98:99], v[112:113]
v_pk_mul_f32 v[100:101], v[100:101], v[112:113]
v_pk_mul_f32 v[102:103], v[102:103], v[112:113]
v_smfmac_f32_16x16x64_bf16 a[244:247], a[240:243], v[20:27], v110
ds_read_b64_tr_b16 a[162:163], v6 offset:4096
v_accvgpr_write_b32 a254, 0
v_mfma_f32_16x16x32_bf16 v[240:243], a[188:191], v[40:43], 0
ds_write_b64 v116, v[88:89] offset:0
v_mfma_f32_16x16x32_bf16 v[244:247], a[164:167], v[40:43], 0
ds_read_b64_tr_b16 a[164:165], v6 offset:1024
v_accvgpr_write_b32 a255, 0
v_mfma_f32_16x16x32_bf16 v[248:251], a[172:175], v[40:43], 0
ds_write_b64 v116, v[90:91] offset:128
v_mfma_f32_16x16x32_bf16 v[252:255], a[180:183], v[40:43], 0
ds_read_b64_tr_b16 a[166:167], v6 offset:5120
v_subrev_u32 v118, s28, v104
v_cvt_pk_bf16_f32 v96, v96, v97
v_cvt_pk_bf16_f32 v97, v98, v99
v_cvt_pk_bf16_f32 v98, v100, v101
v_cvt_pk_bf16_f32 v99, v102, v103
v_smfmac_f32_16x16x64_bf16 a[248:251], a[240:243], v[36:43], v110
ds_read_b64_tr_b16 a[168:169], v7 offset:0
ds_write_b64 v116, v[96:97] offset:4352
ds_write_b64 v116, v[98:99] offset:4480
v_mfma_f32_16x16x32_bf16 v[88:91], a[184:187], a[224:227], 0
v_exp_f32 v52, v52
v_mfma_f32_16x16x32_bf16 v[96:99], a[184:187], a[228:231], 0
ds_read_b64_tr_b16 a[170:171], v7 offset:4096
v_subrev_u32 v119, s28, v105
v_mfma_f32_16x16x32_bf16 v[92:95], a[188:191], a[224:227], 0
v_exp_f32 v53, v53
v_mfma_f32_16x16x32_bf16 v[100:103], a[188:191], a[228:231], 0
ds_read_b64_tr_b16 a[172:173], v7 offset:1024
v_cvt_pk_bf16_f32 v52, v52, v53
v_smfmac_f32_16x16x64_bf16 a[252:255], a[240:243], a[224:231], v110
s_waitcnt lgkmcnt(7)
ds_read_b128 a[224:227], v3 offset:1024
v_max_u32 v118, v118, v119
v_mfma_f32_16x16x32_bf16 v[20:23], a[192:195], a[96:99], 0
v_exp_f32 v54, v54
v_mfma_f32_16x16x32_bf16 v[24:27], a[192:195], a[112:115], 0
ds_read_b128 a[228:231], v4 offset:1024
v_subrev_u32 v119, s28, v106
v_mfma_f32_16x16x32_bf16 v[36:39], a[192:195], a[128:131], 0
v_exp_f32 v55, v55
v_mfma_f32_16x16x32_bf16 v[40:43], a[192:195], a[144:147], 0
ds_read_b64_tr_b16 a[174:175], v7 offset:5120
v_cvt_pk_bf16_f32 v53, v54, v55
v_mfma_f32_16x16x32_bf16 v[20:23], a[196:199], a[100:103], v[20:23]
s_add_u32 m0, s30, 0x8000
s_add_u32 s21, s21, 0x2000
v_exp_f32 v56, v56
v_mfma_f32_16x16x32_bf16 v[24:27], a[196:199], a[116:119], v[24:27]
buffer_load_dwordx4 v11, s[8:11], s21 offen nt lds
v_mfma_f32_16x16x32_bf16 v[36:39], a[196:199], a[132:135], v[36:39]
ds_read_b64_tr_b16 a[176:177], v8 offset:0
v_cmp_lt_u32 s[48:49], s29, v118
v_mfma_f32_16x16x32_bf16 v[40:43], a[196:199], a[148:151], v[40:43]
v_exp_f32 v57, v57
v_mfma_f32_16x16x32_bf16 v[20:23], a[200:203], a[104:107], v[20:23]
ds_read_b64_tr_b16 a[178:179], v8 offset:4096
v_cvt_pk_bf16_f32 v56, v56, v57
v_mfma_f32_16x16x32_bf16 v[24:27], a[200:203], a[120:123], v[24:27]
v_exp_f32 v58, v58
v_mfma_f32_16x16x32_bf16 v[36:39], a[200:203], a[136:139], v[36:39]
ds_read_b64_tr_b16 a[180:181], v8 offset:1024
v_subrev_u32 v118, s28, v107
v_mfma_f32_16x16x32_bf16 v[40:43], a[200:203], a[152:155], v[40:43]
v_exp_f32 v59, v59
v_mfma_f32_16x16x32_bf16 v[20:23], a[204:207], a[108:111], v[20:23]
ds_read_b64_tr_b16 a[182:183], v8 offset:5120
v_cvt_pk_bf16_f32 v57, v58, v59
v_mfma_f32_16x16x32_bf16 v[24:27], a[204:207], a[124:127], v[24:27]
v_exp_f32 v68, v68
v_mfma_f32_16x16x32_bf16 v[36:39], a[204:207], a[140:143], v[36:39]
ds_read_b64_tr_b16 a[184:185], v5 offset:0
v_max_u32 v118, v118, v119
v_mfma_f32_16x16x32_bf16 v[40:43], a[204:207], a[156:159], v[40:43]
v_exp_f32 v69, v69
v_mfma_f32_16x16x32_bf16 v[16:19], a[208:211], a[96:99], 0
s_waitcnt lgkmcnt(5)
ds_read_b64_tr_b16 a[186:187], v5 offset:4096
v_cvt_pk_bf16_f32 v68, v68, v69
v_mfma_f32_16x16x32_bf16 v[28:31], a[208:211], a[112:115], 0
v_exp_f32 v70, v70
v_mfma_f32_16x16x32_bf16 v[32:35], a[208:211], a[128:131], 0
ds_read_b64_tr_b16 a[188:189], v5 offset:1024
v_subrev_u32 v119, s28, v108
v_mfma_f32_16x16x32_bf16 v[44:47], a[208:211], a[144:147], 0
v_exp_f32 v71, v71
v_mfma_f32_16x16x32_bf16 v[16:19], a[212:215], a[100:103], v[16:19]
ds_read_b64_tr_b16 a[190:191], v5 offset:5120
v_cvt_pk_bf16_f32 v69, v70, v71
v_mfma_f32_16x16x32_bf16 v[28:31], a[212:215], a[116:119], v[28:31]
v_exp_f32 v72, v72
v_mfma_f32_16x16x32_bf16 v[32:35], a[212:215], a[132:135], v[32:35]
ds_read_b128 a[192:195], v1 offset:8192
v_cmp_lt_u32 s[50:51], s29, v118
v_mfma_f32_16x16x32_bf16 v[44:47], a[212:215], a[148:151], v[44:47]
v_exp_f32 v73, v73
v_mfma_f32_16x16x32_bf16 v[16:19], a[216:219], a[104:107], v[16:19]
buffer_load_dwordx4 v11, s[8:11], s21 offen offset:2048 nt lds
v_mfma_f32_16x16x32_bf16 v[28:31], a[216:219], a[120:123], v[28:31]
ds_read_b128 a[196:199], v2 offset:8192
v_cvt_pk_bf16_f32 v72, v72, v73
v_mfma_f32_16x16x32_bf16 v[32:35], a[216:219], a[136:139], v[32:35]
v_exp_f32 v74, v74
v_mfma_f32_16x16x32_bf16 v[44:47], a[216:219], a[152:155], v[44:47]
ds_read_b128 a[200:203], v1 offset:9216
v_subrev_u32 v118, s28, v109
v_mfma_f32_16x16x32_bf16 v[16:19], a[220:223], a[108:111], v[16:19]
v_exp_f32 v75, v75
v_mfma_f32_16x16x32_bf16 v[28:31], a[220:223], a[124:127], v[28:31]
ds_read_b128 a[204:207], v2 offset:9216
v_cvt_pk_bf16_f32 v73, v74, v75
v_mfma_f32_16x16x32_bf16 v[32:35], a[220:223], a[140:143], v[32:35]
v_exp_f32 v48, v48
v_mfma_f32_16x16x32_bf16 v[44:47], a[220:223], a[156:159], v[44:47]
ds_read_b128 a[208:211], v1 offset:12288
v_max_u32 v118, v118, v119
s_lshl_b32 s34, s34, 3
v_mfma_f32_16x16x32_bf16 v[80:83], a[232:235], a[64:67], 0
v_exp_f32 v49, v49
v_mfma_f32_16x16x32_bf16 v[84:87], a[232:235], a[80:83], 0
ds_read_b128 a[232:235], v10 offset:2048
v_cvt_pk_bf16_f32 v54, v48, v49
v_mfma_f32_16x16x32_bf16 v[80:83], a[236:239], a[68:71], v[80:83]
v_exp_f32 v50, v50
v_mfma_f32_16x16x32_bf16 v[84:87], a[236:239], a[84:87], v[84:87]
ds_read_b128 a[236:239], v10 offset:3072
v_cmp_lt_u32 s[52:53], s29, v118
s_cmp_lg_u64 s[48:49], 0
s_cselect_b32 s55, 1, 0
s_or_b32 s34, s34, s55
s_cmp_lg_u64 s[50:51], 0
s_cselect_b32 s55, 2, 0
s_or_b32 s34, s34, s55
v_mfma_f32_16x16x32_bf16 v[80:83], a[224:227], a[72:75], v[80:83]
v_exp_f32 v51, v51
s_cmp_lg_u64 s[52:53], 0
s_cselect_b32 s55, 4, 0
s_or_b32 s34, s34, s55
v_mfma_f32_16x16x32_bf16 v[84:87], a[224:227], a[88:91], v[84:87]
s_waitcnt lgkmcnt(5)
ds_read_b128 a[212:215], v2 offset:12288
v_exp_f32 v60, v60
v_exp_f32 v61, v61
v_exp_f32 v62, v62
v_exp_f32 v63, v63
v_mfma_f32_16x16x32_bf16 v[80:83], a[228:231], a[76:79], v[80:83]
v_cvt_pk_bf16_f32 v55, v50, v51
v_exp_f32 v64, v64
v_exp_f32 v65, v65
v_exp_f32 v66, v66
v_exp_f32 v67, v67
v_mfma_f32_16x16x32_bf16 v[84:87], a[228:231], a[92:95], v[84:87]
ds_read_b128 a[216:219], v1 offset:13312
v_cvt_pk_bf16_f32 v58, v60, v61
v_cvt_pk_bf16_f32 v59, v62, v63
v_exp_f32 v76, v76
v_exp_f32 v77, v77
v_exp_f32 v78, v78
v_exp_f32 v79, v79
v_mfma_f32_16x16x32_bf16 v[132:135], a[160:163], v[52:55], v[132:135]
v_cvt_pk_bf16_f32 v70, v64, v65
v_cvt_pk_bf16_f32 v71, v66, v67
v_mfma_f32_16x16x32_bf16 v[164:167], a[160:163], v[56:59], v[164:167]
ds_read_b128 a[220:223], v2 offset:13312
v_cvt_pk_bf16_f32 v74, v76, v77
v_cvt_pk_bf16_f32 v75, v78, v79
v_mfma_f32_16x16x32_bf16 v[196:199], a[160:163], v[68:71], v[196:199]
s_add_u32 m0, s30, 0x1a000
s_add_u32 s37, s37, 0x2000
v_exp_f32 v80, v80
v_mfma_f32_16x16x32_bf16 v[228:231], a[160:163], v[72:75], v[228:231]
buffer_load_dwordx4 v11, s[12:15], s37 offen nt lds
v_mfma_f32_16x16x32_bf16 v[148:151], a[164:167], v[52:55], v[148:151]
ds_read_b64_tr_b16 a[160:161], v6 offset:8192
v_mfma_f32_16x16x32_bf16 v[180:183], a[164:167], v[56:59], v[180:183]
v_exp_f32 v81, v81
v_mfma_f32_16x16x32_bf16 v[212:215], a[164:167], v[68:71], v[212:215]
ds_read_b64_tr_b16 a[162:163], v6 offset:12288
v_cvt_pk_bf16_f32 v80, v80, v81
v_mfma_f32_16x16x32_bf16 v[244:247], a[164:167], v[72:75], v[244:247]
v_exp_f32 v82, v82
v_smfmac_f32_16x16x64_bf16 a[244:247], a[240:243], v[52:59], v110
ds_read_b64_tr_b16 a[164:165], v6 offset:9216
v_mfma_f32_16x16x32_bf16 v[136:139], a[168:171], v[52:55], v[136:139]
v_exp_f32 v83, v83
v_mfma_f32_16x16x32_bf16 v[168:171], a[168:171], v[56:59], v[168:171]
ds_read_b64_tr_b16 a[166:167], v6 offset:13312
v_cvt_pk_bf16_f32 v81, v82, v83
v_mfma_f32_16x16x32_bf16 v[200:203], a[168:171], v[68:71], v[200:203]
ds_write_b64 v9, v[80:81] offset:4096
v_mfma_f32_16x16x32_bf16 v[232:235], a[168:171], v[72:75], v[232:235]
ds_read_b64_tr_b16 a[168:169], v7 offset:8192
v_mfma_f32_16x16x32_bf16 v[152:155], a[172:175], v[52:55], v[152:155]
v_exp_f32 v84, v84
v_mfma_f32_16x16x32_bf16 v[184:187], a[172:175], v[56:59], v[184:187]
ds_read_b64_tr_b16 a[170:171], v7 offset:12288
v_mfma_f32_16x16x32_bf16 v[216:219], a[172:175], v[68:71], v[216:219]
v_exp_f32 v85, v85
v_mfma_f32_16x16x32_bf16 v[248:251], a[172:175], v[72:75], v[248:251]
s_waitcnt lgkmcnt(6)
ds_read_b64_tr_b16 a[172:173], v7 offset:9216
v_cvt_pk_bf16_f32 v84, v84, v85
v_smfmac_f32_16x16x64_bf16 a[248:251], a[240:243], v[68:75], v110
ds_read_b64_tr_b16 a[174:175], v7 offset:13312
v_mfma_f32_16x16x32_bf16 v[140:143], a[176:179], v[52:55], v[140:143]
v_exp_f32 v86, v86
v_mfma_f32_16x16x32_bf16 v[172:175], a[176:179], v[56:59], v[172:175]
v_exp_f32 v87, v87
v_mfma_f32_16x16x32_bf16 v[204:207], a[176:179], v[68:71], v[204:207]
v_exp_f32 v20, v20
v_mfma_f32_16x16x32_bf16 v[236:239], a[176:179], v[72:75], v[236:239]
ds_read_b64_tr_b16 a[176:177], v8 offset:8192
v_cvt_pk_bf16_f32 v85, v86, v87
v_mfma_f32_16x16x32_bf16 v[156:159], a[180:183], v[52:55], v[156:159]
buffer_load_dwordx4 v11, s[12:15], s37 offen offset:2048 nt lds
v_mfma_f32_16x16x32_bf16 v[188:191], a[180:183], v[56:59], v[188:191]
ds_read_b64_tr_b16 a[178:179], v8 offset:12288
v_mfma_f32_16x16x32_bf16 v[220:223], a[180:183], v[68:71], v[220:223]
ds_write_b64 v9, v[84:85] offset:5120
v_mfma_f32_16x16x32_bf16 v[252:255], a[180:183], v[72:75], v[252:255]
ds_read_b64_tr_b16 a[180:181], v8 offset:9216
v_mfma_f32_16x16x32_bf16 v[128:131], a[184:187], v[52:55], v[128:131]
v_exp_f32 v21, v21
v_mfma_f32_16x16x32_bf16 v[160:163], a[184:187], v[56:59], v[160:163]
ds_read_b64_tr_b16 a[182:183], v8 offset:13312
v_cvt_pk_bf16_f32 v20, v20, v21
v_mfma_f32_16x16x32_bf16 v[192:195], a[184:187], v[68:71], v[192:195]
v_exp_f32 v22, v22
v_mfma_f32_16x16x32_bf16 v[224:227], a[184:187], v[72:75], v[224:227]
v_exp_f32 v23, v23
v_mfma_f32_16x16x32_bf16 v[88:91], a[184:187], a[232:235], v[88:91]
v_exp_f32 v24, v24
v_mfma_f32_16x16x32_bf16 v[96:99], a[184:187], a[236:239], v[96:99]
ds_read_b64_tr_b16 a[184:185], v5 offset:8192
v_cvt_pk_bf16_f32 v21, v22, v23
v_smfmac_f32_16x16x64_bf16 a[252:255], a[240:243], a[232:239], v110
ds_read_b64_tr_b16 a[186:187], v5 offset:12288
v_mfma_f32_16x16x32_bf16 v[144:147], a[188:191], v[52:55], v[144:147]
v_exp_f32 v25, v25
v_mfma_f32_16x16x32_bf16 v[176:179], a[188:191], v[56:59], v[176:179]
v_exp_f32 v26, v26
v_mfma_f32_16x16x32_bf16 v[208:211], a[188:191], v[68:71], v[208:211]
v_exp_f32 v27, v27
v_mfma_f32_16x16x32_bf16 v[240:243], a[188:191], v[72:75], v[240:243]
v_exp_f32 v36, v36
v_mfma_f32_16x16x32_bf16 v[92:95], a[188:191], a[232:235], v[92:95]
v_exp_f32 v37, v37
v_mfma_f32_16x16x32_bf16 v[100:103], a[188:191], a[236:239], v[100:103]
s_waitcnt lgkmcnt(2)
ds_read_b64_tr_b16 a[188:189], v5 offset:9216
v_cvt_pk_bf16_f32 v24, v24, v25
v_mfma_f32_16x16x32_bf16 v[52:55], a[192:195], a[96:99], 0
v_exp_f32 v38, v38
v_mfma_f32_16x16x32_bf16 v[56:59], a[192:195], a[112:115], 0
s_add_u32 m0, s30, 0xa000
s_add_u32 s21, s21, 0x2000
ds_read_b64_tr_b16 a[190:191], v5 offset:13312
v_cvt_pk_bf16_f32 v25, v26, v27
v_mfma_f32_16x16x32_bf16 v[68:71], a[192:195], a[128:131], 0
buffer_load_dwordx4 v11, s[8:11], s21 offen nt lds
v_mfma_f32_16x16x32_bf16 v[72:75], a[192:195], a[144:147], 0
v_exp_f32 v39, v39
v_mfma_f32_16x16x32_bf16 v[52:55], a[196:199], a[100:103], v[52:55]
v_exp_f32 v40, v40
v_mfma_f32_16x16x32_bf16 v[56:59], a[196:199], a[116:119], v[56:59]
v_exp_f32 v41, v41
v_mfma_f32_16x16x32_bf16 v[68:71], a[196:199], a[132:135], v[68:71]
v_exp_f32 v42, v42
v_mfma_f32_16x16x32_bf16 v[72:75], a[196:199], a[148:151], v[72:75]
v_exp_f32 v43, v43
v_mfma_f32_16x16x32_bf16 v[52:55], a[200:203], a[104:107], v[52:55]
v_exp_f32 v16, v16
v_mfma_f32_16x16x32_bf16 v[56:59], a[200:203], a[120:123], v[56:59]
v_exp_f32 v17, v17
v_mfma_f32_16x16x32_bf16 v[68:71], a[200:203], a[136:139], v[68:71]
v_exp_f32 v18, v18
v_mfma_f32_16x16x32_bf16 v[72:75], a[200:203], a[152:155], v[72:75]
v_exp_f32 v19, v19
v_mfma_f32_16x16x32_bf16 v[52:55], a[204:207], a[108:111], v[52:55]
v_cvt_pk_bf16_f32 v22, v16, v17
v_cvt_pk_bf16_f32 v23, v18, v19
v_mfma_f32_16x16x32_bf16 v[56:59], a[204:207], a[124:127], v[56:59]
v_exp_f32 v28, v28
v_mfma_f32_16x16x32_bf16 v[68:71], a[204:207], a[140:143], v[68:71]
v_exp_f32 v29, v29
v_mfma_f32_16x16x32_bf16 v[72:75], a[204:207], a[156:159], v[72:75]
v_exp_f32 v30, v30
v_mfma_f32_16x16x32_bf16 v[48:51], a[208:211], a[96:99], 0
v_exp_f32 v31, v31
v_mfma_f32_16x16x32_bf16 v[60:63], a[208:211], a[112:115], 0
v_cvt_pk_bf16_f32 v36, v36, v37
v_cvt_pk_bf16_f32 v37, v38, v39
v_mfma_f32_16x16x32_bf16 v[64:67], a[208:211], a[128:131], 0
v_exp_f32 v32, v32
v_mfma_f32_16x16x32_bf16 v[76:79], a[208:211], a[144:147], 0
v_exp_f32 v33, v33
v_mfma_f32_16x16x32_bf16 v[48:51], a[212:215], a[100:103], v[48:51]
buffer_load_dwordx4 v11, s[8:11], s21 offen offset:2048 nt lds
v_mfma_f32_16x16x32_bf16 v[60:63], a[212:215], a[116:119], v[60:63]
v_exp_f32 v34, v34
v_mfma_f32_16x16x32_bf16 v[64:67], a[212:215], a[132:135], v[64:67]
v_exp_f32 v35, v35
v_mfma_f32_16x16x32_bf16 v[76:79], a[212:215], a[148:151], v[76:79]
v_cvt_pk_bf16_f32 v26, v28, v29
v_cvt_pk_bf16_f32 v27, v30, v31
v_mfma_f32_16x16x32_bf16 v[48:51], a[216:219], a[104:107], v[48:51]
v_exp_f32 v44, v44
v_mfma_f32_16x16x32_bf16 v[60:63], a[216:219], a[120:123], v[60:63]
v_exp_f32 v45, v45
v_mfma_f32_16x16x32_bf16 v[64:67], a[216:219], a[136:139], v[64:67]
v_exp_f32 v46, v46
v_mfma_f32_16x16x32_bf16 v[76:79], a[216:219], a[152:155], v[76:79]
v_exp_f32 v47, v47
v_mfma_f32_16x16x32_bf16 v[48:51], a[220:223], a[108:111], v[48:51]
v_cvt_pk_bf16_f32 v40, v40, v41
v_cvt_pk_bf16_f32 v41, v42, v43
v_mfma_f32_16x16x32_bf16 v[60:63], a[220:223], a[124:127], v[60:63]
v_cvt_pk_bf16_f32 v38, v32, v33
v_cvt_pk_bf16_f32 v39, v34, v35
v_mfma_f32_16x16x32_bf16 v[64:67], a[220:223], a[140:143], v[64:67]
v_cvt_pk_bf16_f32 v42, v44, v45
v_cvt_pk_bf16_f32 v43, v46, v47
v_mfma_f32_16x16x32_bf16 v[76:79], a[220:223], a[156:159], v[76:79]
s_waitcnt vmcnt(8) lgkmcnt(0)
s_barrier
ds_read_b128 a[224:227], v10 offset:4096
v_mfma_f32_16x16x32_bf16 v[132:135], a[160:163], v[20:23], v[132:135]
v_exp_f32 v52, v52
v_mfma_f32_16x16x32_bf16 v[164:167], a[160:163], v[24:27], v[164:167]
ds_read_b128 a[228:231], v10 offset:5120
v_mfma_f32_16x16x32_bf16 v[196:199], a[160:163], v[36:39], v[196:199]
v_exp_f32 v53, v53
v_mfma_f32_16x16x32_bf16 v[228:231], a[160:163], v[40:43], v[228:231]
ds_read_b128 a[192:195], v1 offset:16384
v_cvt_pk_bf16_f32 v52, v52, v53
v_mfma_f32_16x16x32_bf16 v[148:151], a[164:167], v[20:23], v[148:151]
v_exp_f32 v54, v54
v_mfma_f32_16x16x32_bf16 v[180:183], a[164:167], v[24:27], v[180:183]
s_add_u32 m0, s30, 0x1c000
s_add_u32 s37, s37, 0x2000
ds_read_b128 a[196:199], v2 offset:16384
v_mfma_f32_16x16x32_bf16 v[212:215], a[164:167], v[36:39], v[212:215]
buffer_load_dwordx4 v11, s[12:15], s37 offen nt lds
v_mfma_f32_16x16x32_bf16 v[244:247], a[164:167], v[40:43], v[244:247]
ds_read_b128 a[200:203], v1 offset:17408
v_smfmac_f32_16x16x64_bf16 a[244:247], a[240:243], v[20:27], v110
ds_read_b128 a[204:207], v2 offset:17408
v_mfma_f32_16x16x32_bf16 v[136:139], a[168:171], v[20:23], v[136:139]
v_exp_f32 v55, v55
v_mfma_f32_16x16x32_bf16 v[168:171], a[168:171], v[24:27], v[168:171]
ds_read_b128 a[208:211], v1 offset:20480
v_cvt_pk_bf16_f32 v53, v54, v55
v_mfma_f32_16x16x32_bf16 v[200:203], a[168:171], v[36:39], v[200:203]
v_exp_f32 v56, v56
v_mfma_f32_16x16x32_bf16 v[232:235], a[168:171], v[40:43], v[232:235]
ds_read_b128 a[212:215], v2 offset:20480
v_mfma_f32_16x16x32_bf16 v[152:155], a[172:175], v[20:23], v[152:155]
v_exp_f32 v57, v57
v_mfma_f32_16x16x32_bf16 v[184:187], a[172:175], v[24:27], v[184:187]
ds_read_b128 a[216:219], v1 offset:21504
v_cvt_pk_bf16_f32 v56, v56, v57
v_mfma_f32_16x16x32_bf16 v[216:219], a[172:175], v[36:39], v[216:219]
v_exp_f32 v58, v58
v_mfma_f32_16x16x32_bf16 v[248:251], a[172:175], v[40:43], v[248:251]
ds_read_b128 a[220:223], v2 offset:21504
v_smfmac_f32_16x16x64_bf16 a[248:251], a[240:243], v[36:43], v110
ds_read_b128 a[232:235], v3 offset:16384
v_mfma_f32_16x16x32_bf16 v[140:143], a[176:179], v[20:23], v[140:143]
v_exp_f32 v59, v59
v_mfma_f32_16x16x32_bf16 v[172:175], a[176:179], v[24:27], v[172:175]
ds_read_b128 a[236:239], v4 offset:16384
v_cvt_pk_bf16_f32 v57, v58, v59
v_mfma_f32_16x16x32_bf16 v[204:207], a[176:179], v[36:39], v[204:207]
v_exp_f32 v68, v68
v_mfma_f32_16x16x32_bf16 v[236:239], a[176:179], v[40:43], v[236:239]
ds_read_b64_tr_b16 a[160:161], v6 offset:16384
v_mfma_f32_16x16x32_bf16 v[156:159], a[180:183], v[20:23], v[156:159]
v_exp_f32 v69, v69
v_mfma_f32_16x16x32_bf16 v[188:191], a[180:183], v[24:27], v[188:191]
ds_read_b64_tr_b16 a[162:163], v6 offset:20480
v_cvt_pk_bf16_f32 v68, v68, v69
v_mfma_f32_16x16x32_bf16 v[220:223], a[180:183], v[36:39], v[220:223]
v_exp_f32 v70, v70
v_mfma_f32_16x16x32_bf16 v[252:255], a[180:183], v[40:43], v[252:255]
buffer_load_dwordx4 v11, s[12:15], s37 offen offset:2048 nt lds
v_mfma_f32_16x16x32_bf16 v[128:131], a[184:187], v[20:23], v[128:131]
ds_read_b64_tr_b16 a[164:165], v6 offset:17408
v_mfma_f32_16x16x32_bf16 v[160:163], a[184:187], v[24:27], v[160:163]
v_exp_f32 v71, v71
v_mfma_f32_16x16x32_bf16 v[192:195], a[184:187], v[36:39], v[192:195]
s_waitcnt lgkmcnt(4)
ds_read_b64_tr_b16 a[166:167], v6 offset:21504
v_cvt_pk_bf16_f32 v69, v70, v71
v_mfma_f32_16x16x32_bf16 v[224:227], a[184:187], v[40:43], v[224:227]
v_exp_f32 v72, v72
v_mfma_f32_16x16x32_bf16 v[88:91], a[184:187], a[224:227], v[88:91]
ds_read_b64_tr_b16 a[168:169], v7 offset:16384
v_mfma_f32_16x16x32_bf16 v[96:99], a[184:187], a[228:231], v[96:99]
v_exp_f32 v73, v73
v_smfmac_f32_16x16x64_bf16 a[252:255], a[240:243], a[224:231], v110
ds_read_b64_tr_b16 a[170:171], v7 offset:20480
v_cvt_pk_bf16_f32 v72, v72, v73
v_mfma_f32_16x16x32_bf16 v[144:147], a[188:191], v[20:23], v[144:147]
v_exp_f32 v74, v74
v_mfma_f32_16x16x32_bf16 v[176:179], a[188:191], v[24:27], v[176:179]
ds_read_b64_tr_b16 a[172:173], v7 offset:17408
v_mfma_f32_16x16x32_bf16 v[208:211], a[188:191], v[36:39], v[208:211]
v_exp_f32 v75, v75
v_mfma_f32_16x16x32_bf16 v[240:243], a[188:191], v[40:43], v[240:243]
ds_read_b64_tr_b16 a[174:175], v7 offset:21504
v_cvt_pk_bf16_f32 v73, v74, v75
v_mfma_f32_16x16x32_bf16 v[92:95], a[188:191], a[224:227], v[92:95]
v_exp_f32 v48, v48
v_mfma_f32_16x16x32_bf16 v[100:103], a[188:191], a[228:231], v[100:103]
ds_read_b128 a[224:227], v3 offset:17408
v_mfma_f32_16x16x32_bf16 v[20:23], a[192:195], a[96:99], 0
v_exp_f32 v49, v49
v_mfma_f32_16x16x32_bf16 v[24:27], a[192:195], a[112:115], 0
ds_read_b128 a[228:231], v4 offset:17408
v_cvt_pk_bf16_f32 v54, v48, v49
v_mfma_f32_16x16x32_bf16 v[36:39], a[192:195], a[128:131], 0
v_exp_f32 v50, v50
v_mfma_f32_16x16x32_bf16 v[40:43], a[192:195], a[144:147], 0
ds_read_b64_tr_b16 a[176:177], v8 offset:16384
v_mfma_f32_16x16x32_bf16 v[20:23], a[196:199], a[100:103], v[20:23]
s_add_u32 m0, s30, 0xc000
s_add_u32 s21, s21, 0x2000
v_exp_f32 v51, v51
v_mfma_f32_16x16x32_bf16 v[24:27], a[196:199], a[116:119], v[24:27]
buffer_load_dwordx4 v11, s[8:11], s21 offen nt lds
v_mfma_f32_16x16x32_bf16 v[36:39], a[196:199], a[132:135], v[36:39]
ds_read_b64_tr_b16 a[178:179], v8 offset:20480
v_cvt_pk_bf16_f32 v55, v50, v51
v_mfma_f32_16x16x32_bf16 v[40:43], a[196:199], a[148:151], v[40:43]
v_exp_f32 v60, v60
v_mfma_f32_16x16x32_bf16 v[20:23], a[200:203], a[104:107], v[20:23]
ds_read_b64_tr_b16 a[180:181], v8 offset:17408
v_mfma_f32_16x16x32_bf16 v[24:27], a[200:203], a[120:123], v[24:27]
v_exp_f32 v61, v61
v_mfma_f32_16x16x32_bf16 v[36:39], a[200:203], a[136:139], v[36:39]
ds_read_b64_tr_b16 a[182:183], v8 offset:21504
v_cvt_pk_bf16_f32 v58, v60, v61
v_mfma_f32_16x16x32_bf16 v[40:43], a[200:203], a[152:155], v[40:43]
v_exp_f32 v62, v62
v_mfma_f32_16x16x32_bf16 v[20:23], a[204:207], a[108:111], v[20:23]
s_waitcnt lgkmcnt(4)
ds_read_b64_tr_b16 a[184:185], v5 offset:16384
v_mfma_f32_16x16x32_bf16 v[24:27], a[204:207], a[124:127], v[24:27]
v_exp_f32 v63, v63
v_mfma_f32_16x16x32_bf16 v[36:39], a[204:207], a[140:143], v[36:39]
ds_read_b64_tr_b16 a[186:187], v5 offset:20480
v_cvt_pk_bf16_f32 v59, v62, v63
v_mfma_f32_16x16x32_bf16 v[40:43], a[204:207], a[156:159], v[40:43]
v_exp_f32 v64, v64
v_mfma_f32_16x16x32_bf16 v[16:19], a[208:211], a[96:99], 0
ds_read_b64_tr_b16 a[188:189], v5 offset:17408
v_mfma_f32_16x16x32_bf16 v[28:31], a[208:211], a[112:115], 0
v_exp_f32 v65, v65
v_mfma_f32_16x16x32_bf16 v[32:35], a[208:211], a[128:131], 0
ds_read_b64_tr_b16 a[190:191], v5 offset:21504
v_cvt_pk_bf16_f32 v70, v64, v65
v_mfma_f32_16x16x32_bf16 v[44:47], a[208:211], a[144:147], 0
v_exp_f32 v66, v66
v_mfma_f32_16x16x32_bf16 v[16:19], a[212:215], a[100:103], v[16:19]
ds_read_b128 a[192:195], v1 offset:24576
v_mfma_f32_16x16x32_bf16 v[28:31], a[212:215], a[116:119], v[28:31]
v_exp_f32 v67, v67
v_mfma_f32_16x16x32_bf16 v[32:35], a[212:215], a[132:135], v[32:35]
ds_read_b128 a[196:199], v2 offset:24576
v_cvt_pk_bf16_f32 v71, v66, v67
v_mfma_f32_16x16x32_bf16 v[44:47], a[212:215], a[148:151], v[44:47]
v_exp_f32 v76, v76
v_mfma_f32_16x16x32_bf16 v[16:19], a[216:219], a[104:107], v[16:19]
buffer_load_dwordx4 v11, s[8:11], s21 offen offset:2048 nt lds
v_mfma_f32_16x16x32_bf16 v[28:31], a[216:219], a[120:123], v[28:31]
ds_read_b128 a[200:203], v1 offset:25600
v_mfma_f32_16x16x32_bf16 v[32:35], a[216:219], a[136:139], v[32:35]
v_exp_f32 v77, v77
v_mfma_f32_16x16x32_bf16 v[44:47], a[216:219], a[152:155], v[44:47]
ds_read_b128 a[204:207], v2 offset:25600
v_cvt_pk_bf16_f32 v74, v76, v77
v_mfma_f32_16x16x32_bf16 v[16:19], a[220:223], a[108:111], v[16:19]
v_exp_f32 v78, v78
v_mfma_f32_16x16x32_bf16 v[28:31], a[220:223], a[124:127], v[28:31]
ds_read_b128 a[208:211], v1 offset:28672
v_mfma_f32_16x16x32_bf16 v[32:35], a[220:223], a[140:143], v[32:35]
v_exp_f32 v79, v79
v_mfma_f32_16x16x32_bf16 v[44:47], a[220:223], a[156:159], v[44:47]
ds_read_b128 a[212:215], v2 offset:28672
v_cvt_pk_bf16_f32 v75, v78, v79
v_mfma_f32_16x16x32_bf16 v[80:83], a[232:235], a[64:67], 0
v_exp_f32 v20, v20
v_mfma_f32_16x16x32_bf16 v[84:87], a[232:235], a[80:83], 0
ds_read_b128 a[232:235], v10 offset:6144
v_mfma_f32_16x16x32_bf16 v[80:83], a[236:239], a[68:71], v[80:83]
v_exp_f32 v21, v21
v_mfma_f32_16x16x32_bf16 v[84:87], a[236:239], a[84:87], v[84:87]
s_waitcnt lgkmcnt(5)
ds_read_b128 a[236:239], v10 offset:7168
v_cvt_pk_bf16_f32 v20, v20, v21
v_mfma_f32_16x16x32_bf16 v[80:83], a[224:227], a[72:75], v[80:83]
v_exp_f32 v22, v22
v_mfma_f32_16x16x32_bf16 v[84:87], a[224:227], a[88:91], v[84:87]
ds_read_b128 a[216:219], v1 offset:29696
v_mfma_f32_16x16x32_bf16 v[80:83], a[228:231], a[76:79], v[80:83]
v_exp_f32 v23, v23
v_mfma_f32_16x16x32_bf16 v[84:87], a[228:231], a[92:95], v[84:87]
ds_read_b128 a[220:223], v2 offset:29696
v_cvt_pk_bf16_f32 v21, v22, v23
v_mfma_f32_16x16x32_bf16 v[132:135], a[160:163], v[52:55], v[132:135]
v_exp_f32 v24, v24
v_mfma_f32_16x16x32_bf16 v[164:167], a[160:163], v[56:59], v[164:167]
v_exp_f32 v25, v25
v_mfma_f32_16x16x32_bf16 v[196:199], a[160:163], v[68:71], v[196:199]
s_add_u32 m0, s30, 0x1e000
s_add_u32 s37, s37, 0x2000
v_exp_f32 v80, v80
v_mfma_f32_16x16x32_bf16 v[228:231], a[160:163], v[72:75], v[228:231]
buffer_load_dwordx4 v11, s[12:15], s37 offen nt lds
v_mfma_f32_16x16x32_bf16 v[148:151], a[164:167], v[52:55], v[148:151]
ds_read_b64_tr_b16 a[160:161], v6 offset:24576
v_cvt_pk_bf16_f32 v24, v24, v25
v_mfma_f32_16x16x32_bf16 v[180:183], a[164:167], v[56:59], v[180:183]
v_exp_f32 v81, v81
v_mfma_f32_16x16x32_bf16 v[212:215], a[164:167], v[68:71], v[212:215]
ds_read_b64_tr_b16 a[162:163], v6 offset:28672
v_cvt_pk_bf16_f32 v80, v80, v81
v_mfma_f32_16x16x32_bf16 v[244:247], a[164:167], v[72:75], v[244:247]
v_exp_f32 v82, v82
v_smfmac_f32_16x16x64_bf16 a[244:247], a[240:243], v[52:59], v110
ds_read_b64_tr_b16 a[164:165], v6 offset:25600
v_mfma_f32_16x16x32_bf16 v[136:139], a[168:171], v[52:55], v[136:139]
v_exp_f32 v83, v83
v_mfma_f32_16x16x32_bf16 v[168:171], a[168:171], v[56:59], v[168:171]
ds_read_b64_tr_b16 a[166:167], v6 offset:29696
v_cvt_pk_bf16_f32 v81, v82, v83
v_mfma_f32_16x16x32_bf16 v[200:203], a[168:171], v[68:71], v[200:203]
ds_write_b64 v9, v[80:81] offset:0
v_mfma_f32_16x16x32_bf16 v[232:235], a[168:171], v[72:75], v[232:235]
ds_read_b64_tr_b16 a[168:169], v7 offset:24576
v_mfma_f32_16x16x32_bf16 v[152:155], a[172:175], v[52:55], v[152:155]
v_exp_f32 v84, v84
v_mfma_f32_16x16x32_bf16 v[184:187], a[172:175], v[56:59], v[184:187]
ds_read_b64_tr_b16 a[170:171], v7 offset:28672
v_mfma_f32_16x16x32_bf16 v[216:219], a[172:175], v[68:71], v[216:219]
v_exp_f32 v85, v85
v_mfma_f32_16x16x32_bf16 v[248:251], a[172:175], v[72:75], v[248:251]
s_waitcnt lgkmcnt(6)
ds_read_b64_tr_b16 a[172:173], v7 offset:25600
v_cvt_pk_bf16_f32 v84, v84, v85
v_smfmac_f32_16x16x64_bf16 a[248:251], a[240:243], v[68:75], v110
ds_read_b64_tr_b16 a[174:175], v7 offset:29696
v_mfma_f32_16x16x32_bf16 v[140:143], a[176:179], v[52:55], v[140:143]
v_exp_f32 v86, v86
v_mfma_f32_16x16x32_bf16 v[172:175], a[176:179], v[56:59], v[172:175]
v_exp_f32 v87, v87
v_mfma_f32_16x16x32_bf16 v[204:207], a[176:179], v[68:71], v[204:207]
v_exp_f32 v26, v26
v_mfma_f32_16x16x32_bf16 v[236:239], a[176:179], v[72:75], v[236:239]
ds_read_b64_tr_b16 a[176:177], v8 offset:24576
v_cvt_pk_bf16_f32 v85, v86, v87
v_mfma_f32_16x16x32_bf16 v[156:159], a[180:183], v[52:55], v[156:159]
buffer_load_dwordx4 v11, s[12:15], s37 offen offset:2048 nt lds
v_mfma_f32_16x16x32_bf16 v[188:191], a[180:183], v[56:59], v[188:191]
ds_read_b64_tr_b16 a[178:179], v8 offset:28672
v_mfma_f32_16x16x32_bf16 v[220:223], a[180:183], v[68:71], v[220:223]
ds_write_b64 v9, v[84:85] offset:1024
v_mfma_f32_16x16x32_bf16 v[252:255], a[180:183], v[72:75], v[252:255]
ds_read_b64_tr_b16 a[180:181], v8 offset:25600
v_mfma_f32_16x16x32_bf16 v[128:131], a[184:187], v[52:55], v[128:131]
v_exp_f32 v27, v27
v_mfma_f32_16x16x32_bf16 v[160:163], a[184:187], v[56:59], v[160:163]
ds_read_b64_tr_b16 a[182:183], v8 offset:29696
v_cvt_pk_bf16_f32 v25, v26, v27
v_mfma_f32_16x16x32_bf16 v[192:195], a[184:187], v[68:71], v[192:195]
v_exp_f32 v36, v36
v_mfma_f32_16x16x32_bf16 v[224:227], a[184:187], v[72:75], v[224:227]
v_exp_f32 v37, v37
v_mfma_f32_16x16x32_bf16 v[88:91], a[184:187], a[232:235], v[88:91]
v_exp_f32 v38, v38
v_mfma_f32_16x16x32_bf16 v[96:99], a[184:187], a[236:239], v[96:99]
ds_read_b64_tr_b16 a[184:185], v5 offset:24576
v_cvt_pk_bf16_f32 v36, v36, v37
v_smfmac_f32_16x16x64_bf16 a[252:255], a[240:243], a[232:239], v110
ds_read_b64_tr_b16 a[186:187], v5 offset:28672
v_mfma_f32_16x16x32_bf16 v[144:147], a[188:191], v[52:55], v[144:147]
v_exp_f32 v39, v39
v_mfma_f32_16x16x32_bf16 v[176:179], a[188:191], v[56:59], v[176:179]
v_exp_f32 v40, v40
v_mfma_f32_16x16x32_bf16 v[208:211], a[188:191], v[68:71], v[208:211]
v_exp_f32 v41, v41
v_mfma_f32_16x16x32_bf16 v[240:243], a[188:191], v[72:75], v[240:243]
v_exp_f32 v42, v42
v_mfma_f32_16x16x32_bf16 v[92:95], a[188:191], a[232:235], v[92:95]
v_exp_f32 v43, v43
v_mfma_f32_16x16x32_bf16 v[100:103], a[188:191], a[236:239], v[100:103]
s_waitcnt lgkmcnt(2)
ds_read_b64_tr_b16 a[188:189], v5 offset:25600
v_cvt_pk_bf16_f32 v37, v38, v39
v_mfma_f32_16x16x32_bf16 v[52:55], a[192:195], a[96:99], 0
v_exp_f32 v16, v16
v_mfma_f32_16x16x32_bf16 v[56:59], a[192:195], a[112:115], 0
s_add_u32 m0, s30, 0xe000
s_add_u32 s21, s21, 0x2000
ds_read_b64_tr_b16 a[190:191], v5 offset:29696
v_cvt_pk_bf16_f32 v40, v40, v41
v_mfma_f32_16x16x32_bf16 v[68:71], a[192:195], a[128:131], 0
buffer_load_dwordx4 v11, s[8:11], s21 offen nt lds
v_mfma_f32_16x16x32_bf16 v[72:75], a[192:195], a[144:147], 0
v_exp_f32 v17, v17
v_mfma_f32_16x16x32_bf16 v[52:55], a[196:199], a[100:103], v[52:55]
v_exp_f32 v18, v18
v_mfma_f32_16x16x32_bf16 v[56:59], a[196:199], a[116:119], v[56:59]
v_exp_f32 v19, v19
v_mfma_f32_16x16x32_bf16 v[68:71], a[196:199], a[132:135], v[68:71]
v_exp_f32 v28, v28
v_mfma_f32_16x16x32_bf16 v[72:75], a[196:199], a[148:151], v[72:75]
v_exp_f32 v29, v29
v_mfma_f32_16x16x32_bf16 v[52:55], a[200:203], a[104:107], v[52:55]
v_exp_f32 v30, v30
v_mfma_f32_16x16x32_bf16 v[56:59], a[200:203], a[120:123], v[56:59]
v_exp_f32 v31, v31
v_mfma_f32_16x16x32_bf16 v[68:71], a[200:203], a[136:139], v[68:71]
v_exp_f32 v32, v32
v_mfma_f32_16x16x32_bf16 v[72:75], a[200:203], a[152:155], v[72:75]
v_exp_f32 v33, v33
v_mfma_f32_16x16x32_bf16 v[52:55], a[204:207], a[108:111], v[52:55]
v_cvt_pk_bf16_f32 v22, v16, v17
v_cvt_pk_bf16_f32 v23, v18, v19
v_mfma_f32_16x16x32_bf16 v[56:59], a[204:207], a[124:127], v[56:59]
v_exp_f32 v34, v34
v_mfma_f32_16x16x32_bf16 v[68:71], a[204:207], a[140:143], v[68:71]
v_exp_f32 v35, v35
v_mfma_f32_16x16x32_bf16 v[72:75], a[204:207], a[156:159], v[72:75]
v_exp_f32 v44, v44
v_mfma_f32_16x16x32_bf16 v[48:51], a[208:211], a[96:99], 0
v_exp_f32 v45, v45
v_mfma_f32_16x16x32_bf16 v[60:63], a[208:211], a[112:115], 0
v_cvt_pk_bf16_f32 v26, v28, v29
v_cvt_pk_bf16_f32 v27, v30, v31
v_mfma_f32_16x16x32_bf16 v[64:67], a[208:211], a[128:131], 0
v_exp_f32 v46, v46
v_mfma_f32_16x16x32_bf16 v[76:79], a[208:211], a[144:147], 0
v_exp_f32 v47, v47
v_mfma_f32_16x16x32_bf16 v[48:51], a[212:215], a[100:103], v[48:51]
buffer_load_dwordx4 v11, s[8:11], s21 offen offset:2048 nt lds
v_mfma_f32_16x16x32_bf16 v[60:63], a[212:215], a[116:119], v[60:63]
v_exp_f32 v52, v52
v_mfma_f32_16x16x32_bf16 v[64:67], a[212:215], a[132:135], v[64:67]
v_exp_f32 v53, v53
v_mfma_f32_16x16x32_bf16 v[76:79], a[212:215], a[148:151], v[76:79]
v_cvt_pk_bf16_f32 v41, v42, v43
v_cvt_pk_bf16_f32 v38, v32, v33
v_mfma_f32_16x16x32_bf16 v[48:51], a[216:219], a[104:107], v[48:51]
v_exp_f32 v54, v54
v_mfma_f32_16x16x32_bf16 v[60:63], a[216:219], a[120:123], v[60:63]
v_exp_f32 v55, v55
v_mfma_f32_16x16x32_bf16 v[64:67], a[216:219], a[136:139], v[64:67]
v_exp_f32 v56, v56
v_mfma_f32_16x16x32_bf16 v[76:79], a[216:219], a[152:155], v[76:79]
v_exp_f32 v57, v57
v_mfma_f32_16x16x32_bf16 v[48:51], a[220:223], a[108:111], v[48:51]
v_cvt_pk_bf16_f32 v39, v34, v35
v_cvt_pk_bf16_f32 v42, v44, v45
v_mfma_f32_16x16x32_bf16 v[60:63], a[220:223], a[124:127], v[60:63]
v_exp_f32 v58, v58
v_mfma_f32_16x16x32_bf16 v[64:67], a[220:223], a[140:143], v[64:67]
v_cvt_pk_bf16_f32 v43, v46, v47
v_cvt_pk_bf16_f32 v52, v52, v53
v_mfma_f32_16x16x32_bf16 v[76:79], a[220:223], a[156:159], v[76:79]
s_waitcnt vmcnt(8) lgkmcnt(0)
s_barrier
ds_read_b128 a[224:227], v10 offset:0
v_mfma_f32_16x16x32_bf16 v[132:135], a[160:163], v[20:23], v[132:135]
v_exp_f32 v59, v59
v_mfma_f32_16x16x32_bf16 v[164:167], a[160:163], v[24:27], v[164:167]
ds_read_b128 a[228:231], v10 offset:1024
v_cvt_pk_bf16_f32 v53, v54, v55
v_mfma_f32_16x16x32_bf16 v[196:199], a[160:163], v[36:39], v[196:199]
v_exp_f32 v68, v68
v_mfma_f32_16x16x32_bf16 v[228:231], a[160:163], v[40:43], v[228:231]
ds_read_b128 a[192:195], v1 offset:32768
v_cvt_pk_bf16_f32 v56, v56, v57
v_mfma_f32_16x16x32_bf16 v[148:151], a[164:167], v[20:23], v[148:151]
v_exp_f32 v69, v69
v_mfma_f32_16x16x32_bf16 v[180:183], a[164:167], v[24:27], v[180:183]
s_add_u32 m0, s30, 0x10000
s_add_u32 s37, s37, 0x2000
ds_read_b128 a[196:199], v2 offset:32768
v_cvt_pk_bf16_f32 v57, v58, v59
v_mfma_f32_16x16x32_bf16 v[212:215], a[164:167], v[36:39], v[212:215]
buffer_load_dwordx4 v11, s[12:15], s37 offen nt lds
v_mfma_f32_16x16x32_bf16 v[244:247], a[164:167], v[40:43], v[244:247]
ds_read_b128 a[200:203], v1 offset:33792
v_cvt_pk_bf16_f32 v68, v68, v69
v_smfmac_f32_16x16x64_bf16 a[244:247], a[240:243], v[20:27], v110
ds_read_b128 a[204:207], v2 offset:33792
v_mfma_f32_16x16x32_bf16 v[136:139], a[168:171], v[20:23], v[136:139]
v_exp_f32 v70, v70
v_mfma_f32_16x16x32_bf16 v[168:171], a[168:171], v[24:27], v[168:171]
ds_read_b128 a[208:211], v1 offset:36864
v_mfma_f32_16x16x32_bf16 v[200:203], a[168:171], v[36:39], v[200:203]
v_exp_f32 v71, v71
v_mfma_f32_16x16x32_bf16 v[232:235], a[168:171], v[40:43], v[232:235]
ds_read_b128 a[212:215], v2 offset:36864
v_cvt_pk_bf16_f32 v69, v70, v71
v_mfma_f32_16x16x32_bf16 v[152:155], a[172:175], v[20:23], v[152:155]
v_exp_f32 v72, v72
v_mfma_f32_16x16x32_bf16 v[184:187], a[172:175], v[24:27], v[184:187]
ds_read_b128 a[216:219], v1 offset:37888
v_mfma_f32_16x16x32_bf16 v[216:219], a[172:175], v[36:39], v[216:219]
v_exp_f32 v73, v73
v_mfma_f32_16x16x32_bf16 v[248:251], a[172:175], v[40:43], v[248:251]
ds_read_b128 a[220:223], v2 offset:37888
v_cvt_pk_bf16_f32 v72, v72, v73
v_smfmac_f32_16x16x64_bf16 a[248:251], a[240:243], v[36:43], v110
ds_read_b128 a[232:235], v3 offset:32768
v_mfma_f32_16x16x32_bf16 v[140:143], a[176:179], v[20:23], v[140:143]
v_exp_f32 v74, v74
v_mfma_f32_16x16x32_bf16 v[172:175], a[176:179], v[24:27], v[172:175]
ds_read_b128 a[236:239], v4 offset:32768
v_mfma_f32_16x16x32_bf16 v[204:207], a[176:179], v[36:39], v[204:207]
v_exp_f32 v75, v75
v_mfma_f32_16x16x32_bf16 v[236:239], a[176:179], v[40:43], v[236:239]
ds_read_b64_tr_b16 a[160:161], v6 offset:32768
v_cvt_pk_bf16_f32 v73, v74, v75
v_mfma_f32_16x16x32_bf16 v[156:159], a[180:183], v[20:23], v[156:159]
v_exp_f32 v48, v48
v_mfma_f32_16x16x32_bf16 v[188:191], a[180:183], v[24:27], v[188:191]
ds_read_b64_tr_b16 a[162:163], v6 offset:36864
v_mfma_f32_16x16x32_bf16 v[220:223], a[180:183], v[36:39], v[220:223]
v_exp_f32 v49, v49
v_mfma_f32_16x16x32_bf16 v[252:255], a[180:183], v[40:43], v[252:255]
buffer_load_dwordx4 v11, s[12:15], s37 offen offset:2048 nt lds
v_mfma_f32_16x16x32_bf16 v[128:131], a[184:187], v[20:23], v[128:131]
ds_read_b64_tr_b16 a[164:165], v6 offset:33792
v_cvt_pk_bf16_f32 v54, v48, v49
v_mfma_f32_16x16x32_bf16 v[160:163], a[184:187], v[24:27], v[160:163]
v_exp_f32 v50, v50
v_mfma_f32_16x16x32_bf16 v[192:195], a[184:187], v[36:39], v[192:195]
s_waitcnt lgkmcnt(4)
ds_read_b64_tr_b16 a[166:167], v6 offset:37888
v_mfma_f32_16x16x32_bf16 v[224:227], a[184:187], v[40:43], v[224:227]
v_exp_f32 v51, v51
v_mfma_f32_16x16x32_bf16 v[88:91], a[184:187], a[224:227], v[88:91]
ds_read_b64_tr_b16 a[168:169], v7 offset:32768
v_cvt_pk_bf16_f32 v55, v50, v51
v_mfma_f32_16x16x32_bf16 v[96:99], a[184:187], a[228:231], v[96:99]
v_exp_f32 v60, v60
v_smfmac_f32_16x16x64_bf16 a[252:255], a[240:243], a[224:231], v110
ds_read_b64_tr_b16 a[170:171], v7 offset:36864
v_mfma_f32_16x16x32_bf16 v[144:147], a[188:191], v[20:23], v[144:147]
v_exp_f32 v61, v61
v_mfma_f32_16x16x32_bf16 v[176:179], a[188:191], v[24:27], v[176:179]
ds_read_b64_tr_b16 a[172:173], v7 offset:33792
v_cvt_pk_bf16_f32 v58, v60, v61
v_mfma_f32_16x16x32_bf16 v[208:211], a[188:191], v[36:39], v[208:211]
v_exp_f32 v62, v62
v_mfma_f32_16x16x32_bf16 v[240:243], a[188:191], v[40:43], v[240:243]
ds_read_b64_tr_b16 a[174:175], v7 offset:37888
v_mfma_f32_16x16x32_bf16 v[92:95], a[188:191], a[224:227], v[92:95]
v_exp_f32 v63, v63
v_mfma_f32_16x16x32_bf16 v[100:103], a[188:191], a[228:231], v[100:103]
ds_read_b128 a[224:227], v3 offset:33792
v_cvt_pk_bf16_f32 v59, v62, v63
v_mfma_f32_16x16x32_bf16 v[20:23], a[192:195], a[96:99], 0
v_exp_f32 v64, v64
v_mfma_f32_16x16x32_bf16 v[24:27], a[192:195], a[112:115], 0
ds_read_b128 a[228:231], v4 offset:33792
v_mfma_f32_16x16x32_bf16 v[36:39], a[192:195], a[128:131], 0
v_exp_f32 v65, v65
v_mfma_f32_16x16x32_bf16 v[40:43], a[192:195], a[144:147], 0
ds_read_b64_tr_b16 a[176:177], v8 offset:32768
v_cvt_pk_bf16_f32 v70, v64, v65
v_mfma_f32_16x16x32_bf16 v[20:23], a[196:199], a[100:103], v[20:23]
s_add_u32 m0, s30, 0x0
s_add_u32 s21, s21, 0x2000
v_exp_f32 v66, v66
v_mfma_f32_16x16x32_bf16 v[24:27], a[196:199], a[116:119], v[24:27]
buffer_load_dwordx4 v11, s[8:11], s21 offen nt lds
v_mfma_f32_16x16x32_bf16 v[36:39], a[196:199], a[132:135], v[36:39]
ds_read_b64_tr_b16 a[178:179], v8 offset:36864
v_mfma_f32_16x16x32_bf16 v[40:43], a[196:199], a[148:151], v[40:43]
v_exp_f32 v67, v67
v_mfma_f32_16x16x32_bf16 v[20:23], a[200:203], a[104:107], v[20:23]
ds_read_b64_tr_b16 a[180:181], v8 offset:33792
v_cvt_pk_bf16_f32 v71, v66, v67
v_mfma_f32_16x16x32_bf16 v[24:27], a[200:203], a[120:123], v[24:27]
v_exp_f32 v76, v76
v_mfma_f32_16x16x32_bf16 v[36:39], a[200:203], a[136:139], v[36:39]
ds_read_b64_tr_b16 a[182:183], v8 offset:37888
v_mfma_f32_16x16x32_bf16 v[40:43], a[200:203], a[152:155], v[40:43]
v_exp_f32 v77, v77
v_mfma_f32_16x16x32_bf16 v[20:23], a[204:207], a[108:111], v[20:23]
s_waitcnt lgkmcnt(4)
ds_read_b64_tr_b16 a[184:185], v5 offset:32768
v_cvt_pk_bf16_f32 v74, v76, v77
v_mfma_f32_16x16x32_bf16 v[24:27], a[204:207], a[124:127], v[24:27]
v_exp_f32 v78, v78
v_mfma_f32_16x16x32_bf16 v[36:39], a[204:207], a[140:143], v[36:39]
ds_read_b64_tr_b16 a[186:187], v5 offset:36864
v_mfma_f32_16x16x32_bf16 v[40:43], a[204:207], a[156:159], v[40:43]
v_exp_f32 v79, v79
v_mfma_f32_16x16x32_bf16 v[16:19], a[208:211], a[96:99], 0
ds_read_b64_tr_b16 a[188:189], v5 offset:33792
v_cvt_pk_bf16_f32 v75, v78, v79
v_mfma_f32_16x16x32_bf16 v[28:31], a[208:211], a[112:115], 0
v_exp_f32 v20, v20
v_mfma_f32_16x16x32_bf16 v[32:35], a[208:211], a[128:131], 0
ds_read_b64_tr_b16 a[190:191], v5 offset:37888
v_mfma_f32_16x16x32_bf16 v[44:47], a[208:211], a[144:147], 0
v_exp_f32 v21, v21
v_mfma_f32_16x16x32_bf16 v[16:19], a[212:215], a[100:103], v[16:19]
ds_read_b128 a[192:195], v1 offset:40960
v_cvt_pk_bf16_f32 v20, v20, v21
v_mfma_f32_16x16x32_bf16 v[28:31], a[212:215], a[116:119], v[28:31]
v_exp_f32 v22, v22
v_mfma_f32_16x16x32_bf16 v[32:35], a[212:215], a[132:135], v[32:35]
ds_read_b128 a[196:199], v2 offset:40960
v_mfma_f32_16x16x32_bf16 v[44:47], a[212:215], a[148:151], v[44:47]
v_exp_f32 v23, v23
v_mfma_f32_16x16x32_bf16 v[16:19], a[216:219], a[104:107], v[16:19]
buffer_load_dwordx4 v11, s[8:11], s21 offen offset:2048 nt lds
v_mfma_f32_16x16x32_bf16 v[28:31], a[216:219], a[120:123], v[28:31]
ds_read_b128 a[200:203], v1 offset:41984
v_cvt_pk_bf16_f32 v21, v22, v23
v_mfma_f32_16x16x32_bf16 v[32:35], a[216:219], a[136:139], v[32:35]
v_exp_f32 v24, v24
v_mfma_f32_16x16x32_bf16 v[44:47], a[216:219], a[152:155], v[44:47]
ds_read_b128 a[204:207], v2 offset:41984
v_mfma_f32_16x16x32_bf16 v[16:19], a[220:223], a[108:111], v[16:19]
v_exp_f32 v25, v25
v_mfma_f32_16x16x32_bf16 v[28:31], a[220:223], a[124:127], v[28:31]
ds_read_b128 a[208:211], v1 offset:45056
v_cvt_pk_bf16_f32 v24, v24, v25
v_mfma_f32_16x16x32_bf16 v[32:35], a[220:223], a[140:143], v[32:35]
v_exp_f32 v26, v26
v_mfma_f32_16x16x32_bf16 v[44:47], a[220:223], a[156:159], v[44:47]
ds_read_b128 a[212:215], v2 offset:45056
v_mfma_f32_16x16x32_bf16 v[80:83], a[232:235], a[64:67], 0
v_exp_f32 v27, v27
v_mfma_f32_16x16x32_bf16 v[84:87], a[232:235], a[80:83], 0
ds_read_b128 a[232:235], v10 offset:2048
v_cvt_pk_bf16_f32 v25, v26, v27
v_mfma_f32_16x16x32_bf16 v[80:83], a[236:239], a[68:71], v[80:83]
v_exp_f32 v36, v36
v_mfma_f32_16x16x32_bf16 v[84:87], a[236:239], a[84:87], v[84:87]
s_waitcnt lgkmcnt(5)
ds_read_b128 a[236:239], v10 offset:3072
v_mfma_f32_16x16x32_bf16 v[80:83], a[224:227], a[72:75], v[80:83]
v_exp_f32 v37, v37
v_mfma_f32_16x16x32_bf16 v[84:87], a[224:227], a[88:91], v[84:87]
ds_read_b128 a[216:219], v1 offset:46080
v_cvt_pk_bf16_f32 v36, v36, v37
v_mfma_f32_16x16x32_bf16 v[80:83], a[228:231], a[76:79], v[80:83]
v_exp_f32 v38, v38
v_mfma_f32_16x16x32_bf16 v[84:87], a[228:231], a[92:95], v[84:87]
ds_read_b128 a[220:223], v2 offset:46080
v_mfma_f32_16x16x32_bf16 v[132:135], a[160:163], v[52:55], v[132:135]
v_exp_f32 v39, v39
v_mfma_f32_16x16x32_bf16 v[164:167], a[160:163], v[56:59], v[164:167]
v_exp_f32 v40, v40
v_mfma_f32_16x16x32_bf16 v[196:199], a[160:163], v[68:71], v[196:199]
s_add_u32 m0, s30, 0x12000
s_add_u32 s37, s37, 0x2000
v_exp_f32 v80, v80
v_mfma_f32_16x16x32_bf16 v[228:231], a[160:163], v[72:75], v[228:231]
buffer_load_dwordx4 v11, s[12:15], s37 offen nt lds
v_mfma_f32_16x16x32_bf16 v[148:151], a[164:167], v[52:55], v[148:151]
ds_read_b64_tr_b16 a[160:161], v6 offset:40960
v_cvt_pk_bf16_f32 v37, v38, v39
v_mfma_f32_16x16x32_bf16 v[180:183], a[164:167], v[56:59], v[180:183]
v_exp_f32 v81, v81
v_mfma_f32_16x16x32_bf16 v[212:215], a[164:167], v[68:71], v[212:215]
ds_read_b64_tr_b16 a[162:163], v6 offset:45056
v_cvt_pk_bf16_f32 v80, v80, v81
v_mfma_f32_16x16x32_bf16 v[244:247], a[164:167], v[72:75], v[244:247]
v_exp_f32 v82, v82
v_smfmac_f32_16x16x64_bf16 a[244:247], a[240:243], v[52:59], v110
ds_read_b64_tr_b16 a[164:165], v6 offset:41984
v_mfma_f32_16x16x32_bf16 v[136:139], a[168:171], v[52:55], v[136:139]
v_exp_f32 v83, v83
v_mfma_f32_16x16x32_bf16 v[168:171], a[168:171], v[56:59], v[168:171]
ds_read_b64_tr_b16 a[166:167], v6 offset:46080
v_cvt_pk_bf16_f32 v81, v82, v83
v_mfma_f32_16x16x32_bf16 v[200:203], a[168:171], v[68:71], v[200:203]
ds_write_b64 v9, v[80:81] offset:4096
v_mfma_f32_16x16x32_bf16 v[232:235], a[168:171], v[72:75], v[232:235]
ds_read_b64_tr_b16 a[168:169], v7 offset:40960
v_mfma_f32_16x16x32_bf16 v[152:155], a[172:175], v[52:55], v[152:155]
v_exp_f32 v84, v84
v_mfma_f32_16x16x32_bf16 v[184:187], a[172:175], v[56:59], v[184:187]
ds_read_b64_tr_b16 a[170:171], v7 offset:45056
v_mfma_f32_16x16x32_bf16 v[216:219], a[172:175], v[68:71], v[216:219]
v_exp_f32 v85, v85
v_mfma_f32_16x16x32_bf16 v[248:251], a[172:175], v[72:75], v[248:251]
s_waitcnt lgkmcnt(6)
ds_read_b64_tr_b16 a[172:173], v7 offset:41984
v_cvt_pk_bf16_f32 v84, v84, v85
v_smfmac_f32_16x16x64_bf16 a[248:251], a[240:243], v[68:75], v110
ds_read_b64_tr_b16 a[174:175], v7 offset:46080
v_mfma_f32_16x16x32_bf16 v[140:143], a[176:179], v[52:55], v[140:143]
v_exp_f32 v86, v86
v_mfma_f32_16x16x32_bf16 v[172:175], a[176:179], v[56:59], v[172:175]
v_exp_f32 v87, v87
v_mfma_f32_16x16x32_bf16 v[204:207], a[176:179], v[68:71], v[204:207]
v_exp_f32 v41, v41
v_mfma_f32_16x16x32_bf16 v[236:239], a[176:179], v[72:75], v[236:239]
ds_read_b64_tr_b16 a[176:177], v8 offset:40960
v_cvt_pk_bf16_f32 v85, v86, v87
v_mfma_f32_16x16x32_bf16 v[156:159], a[180:183], v[52:55], v[156:159]
buffer_load_dwordx4 v11, s[12:15], s37 offen offset:2048 nt lds
v_mfma_f32_16x16x32_bf16 v[188:191], a[180:183], v[56:59], v[188:191]
ds_read_b64_tr_b16 a[178:179], v8 offset:45056
v_cvt_pk_bf16_f32 v40, v40, v41
v_mfma_f32_16x16x32_bf16 v[220:223], a[180:183], v[68:71], v[220:223]
ds_write_b64 v9, v[84:85] offset:5120
v_mfma_f32_16x16x32_bf16 v[252:255], a[180:183], v[72:75], v[252:255]
ds_read_b64_tr_b16 a[180:181], v8 offset:41984
v_mfma_f32_16x16x32_bf16 v[128:131], a[184:187], v[52:55], v[128:131]
v_exp_f32 v42, v42
v_mfma_f32_16x16x32_bf16 v[160:163], a[184:187], v[56:59], v[160:163]
ds_read_b64_tr_b16 a[182:183], v8 offset:46080
v_mfma_f32_16x16x32_bf16 v[192:195], a[184:187], v[68:71], v[192:195]
v_exp_f32 v43, v43
v_mfma_f32_16x16x32_bf16 v[224:227], a[184:187], v[72:75], v[224:227]
v_exp_f32 v16, v16
v_mfma_f32_16x16x32_bf16 v[88:91], a[184:187], a[232:235], v[88:91]
v_exp_f32 v17, v17
v_mfma_f32_16x16x32_bf16 v[96:99], a[184:187], a[236:239], v[96:99]
ds_read_b64_tr_b16 a[184:185], v5 offset:40960
v_cvt_pk_bf16_f32 v22, v16, v17
v_smfmac_f32_16x16x64_bf16 a[252:255], a[240:243], a[232:239], v110
ds_read_b64_tr_b16 a[186:187], v5 offset:45056
v_cvt_pk_bf16_f32 v41, v42, v43
v_mfma_f32_16x16x32_bf16 v[144:147], a[188:191], v[52:55], v[144:147]
v_exp_f32 v18, v18
v_mfma_f32_16x16x32_bf16 v[176:179], a[188:191], v[56:59], v[176:179]
v_exp_f32 v19, v19
v_mfma_f32_16x16x32_bf16 v[208:211], a[188:191], v[68:71], v[208:211]
v_exp_f32 v28, v28
v_mfma_f32_16x16x32_bf16 v[240:243], a[188:191], v[72:75], v[240:243]
v_exp_f32 v29, v29
v_mfma_f32_16x16x32_bf16 v[92:95], a[188:191], a[232:235], v[92:95]
v_exp_f32 v30, v30
v_mfma_f32_16x16x32_bf16 v[100:103], a[188:191], a[236:239], v[100:103]
s_waitcnt lgkmcnt(2)
ds_read_b64_tr_b16 a[188:189], v5 offset:41984
v_cvt_pk_bf16_f32 v23, v18, v19
v_mfma_f32_16x16x32_bf16 v[52:55], a[192:195], a[96:99], 0
v_exp_f32 v31, v31
v_mfma_f32_16x16x32_bf16 v[56:59], a[192:195], a[112:115], 0
s_add_u32 m0, s30, 0x2000
s_add_u32 s21, s21, 0x2000
ds_read_b64_tr_b16 a[190:191], v5 offset:46080
v_cvt_pk_bf16_f32 v26, v28, v29
v_mfma_f32_16x16x32_bf16 v[68:71], a[192:195], a[128:131], 0
buffer_load_dwordx4 v11, s[8:11], s21 offen nt lds
v_mfma_f32_16x16x32_bf16 v[72:75], a[192:195], a[144:147], 0
v_exp_f32 v32, v32
v_mfma_f32_16x16x32_bf16 v[52:55], a[196:199], a[100:103], v[52:55]
v_exp_f32 v33, v33
v_mfma_f32_16x16x32_bf16 v[56:59], a[196:199], a[116:119], v[56:59]
v_exp_f32 v34, v34
v_mfma_f32_16x16x32_bf16 v[68:71], a[196:199], a[132:135], v[68:71]
v_exp_f32 v35, v35
v_mfma_f32_16x16x32_bf16 v[72:75], a[196:199], a[148:151], v[72:75]
v_exp_f32 v44, v44
v_mfma_f32_16x16x32_bf16 v[52:55], a[200:203], a[104:107], v[52:55]
v_exp_f32 v45, v45
v_mfma_f32_16x16x32_bf16 v[56:59], a[200:203], a[120:123], v[56:59]
v_exp_f32 v46, v46
v_mfma_f32_16x16x32_bf16 v[68:71], a[200:203], a[136:139], v[68:71]
v_exp_f32 v47, v47
v_mfma_f32_16x16x32_bf16 v[72:75], a[200:203], a[152:155], v[72:75]
v_cvt_pk_bf16_f32 v27, v30, v31
v_cvt_pk_bf16_f32 v38, v32, v33
v_mfma_f32_16x16x32_bf16 v[52:55], a[204:207], a[108:111], v[52:55]
v_cvt_pk_bf16_f32 v39, v34, v35
v_cvt_pk_bf16_f32 v42, v44, v45
v_mfma_f32_16x16x32_bf16 v[56:59], a[204:207], a[124:127], v[56:59]
v_cvt_pk_bf16_f32 v43, v46, v47
v_mfma_f32_16x16x32_bf16 v[68:71], a[204:207], a[140:143], v[68:71]
v_mfma_f32_16x16x32_bf16 v[72:75], a[204:207], a[156:159], v[72:75]
v_mfma_f32_16x16x32_bf16 v[48:51], a[208:211], a[96:99], 0
v_mfma_f32_16x16x32_bf16 v[60:63], a[208:211], a[112:115], 0
v_exp_f32 v52, v52
v_mfma_f32_16x16x32_bf16 v[64:67], a[208:211], a[128:131], 0
v_exp_f32 v53, v53
v_mfma_f32_16x16x32_bf16 v[76:79], a[208:211], a[144:147], 0
v_exp_f32 v54, v54
v_mfma_f32_16x16x32_bf16 v[48:51], a[212:215], a[100:103], v[48:51]
buffer_load_dwordx4 v11, s[8:11], s21 offen offset:2048 nt lds
v_mfma_f32_16x16x32_bf16 v[60:63], a[212:215], a[116:119], v[60:63]
v_exp_f32 v55, v55
v_mfma_f32_16x16x32_bf16 v[64:67], a[212:215], a[132:135], v[64:67]
v_exp_f32 v56, v56
v_mfma_f32_16x16x32_bf16 v[76:79], a[212:215], a[148:151], v[76:79]
v_exp_f32 v57, v57
v_mfma_f32_16x16x32_bf16 v[48:51], a[216:219], a[104:107], v[48:51]
v_exp_f32 v58, v58
v_mfma_f32_16x16x32_bf16 v[60:63], a[216:219], a[120:123], v[60:63]
v_exp_f32 v59, v59
v_mfma_f32_16x16x32_bf16 v[64:67], a[216:219], a[136:139], v[64:67]
v_exp_f32 v68, v68
v_mfma_f32_16x16x32_bf16 v[76:79], a[216:219], a[152:155], v[76:79]
v_exp_f32 v69, v69
v_mfma_f32_16x16x32_bf16 v[48:51], a[220:223], a[108:111], v[48:51]
v_exp_f32 v70, v70
v_mfma_f32_16x16x32_bf16 v[60:63], a[220:223], a[124:127], v[60:63]
v_exp_f32 v71, v71
v_mfma_f32_16x16x32_bf16 v[64:67], a[220:223], a[140:143], v[64:67]
v_cvt_pk_bf16_f32 v52, v52, v53
v_cvt_pk_bf16_f32 v53, v54, v55
v_mfma_f32_16x16x32_bf16 v[76:79], a[220:223], a[156:159], v[76:79]
s_waitcnt vmcnt(8) lgkmcnt(0)
s_barrier
ds_read_b128 a[224:227], v10 offset:4096
v_mfma_f32_16x16x32_bf16 v[132:135], a[160:163], v[20:23], v[132:135]
v_exp_f32 v72, v72
v_mfma_f32_16x16x32_bf16 v[164:167], a[160:163], v[24:27], v[164:167]
ds_read_b128 a[228:231], v10 offset:5120
v_cvt_pk_bf16_f32 v56, v56, v57
v_mfma_f32_16x16x32_bf16 v[196:199], a[160:163], v[36:39], v[196:199]
v_exp_f32 v73, v73
v_mfma_f32_16x16x32_bf16 v[228:231], a[160:163], v[40:43], v[228:231]
ds_read_b128 a[192:195], v1 offset:49152
v_cvt_pk_bf16_f32 v57, v58, v59
v_mfma_f32_16x16x32_bf16 v[148:151], a[164:167], v[20:23], v[148:151]
v_exp_f32 v74, v74
v_mfma_f32_16x16x32_bf16 v[180:183], a[164:167], v[24:27], v[180:183]
s_add_u32 m0, s30, 0x14000
s_add_u32 s37, s37, 0x2000
ds_read_b128 a[196:199], v2 offset:49152
v_cvt_pk_bf16_f32 v68, v68, v69
v_mfma_f32_16x16x32_bf16 v[212:215], a[164:167], v[36:39], v[212:215]
buffer_load_dwordx4 v11, s[12:15], s37 offen nt lds
v_mfma_f32_16x16x32_bf16 v[244:247], a[164:167], v[40:43], v[244:247]
ds_read_b128 a[200:203], v1 offset:50176
v_cvt_pk_bf16_f32 v69, v70, v71
v_smfmac_f32_16x16x64_bf16 a[244:247], a[240:243], v[20:27], v110
ds_read_b128 a[204:207], v2 offset:50176
v_cvt_pk_bf16_f32 v72, v72, v73
v_mfma_f32_16x16x32_bf16 v[136:139], a[168:171], v[20:23], v[136:139]
v_exp_f32 v75, v75
v_mfma_f32_16x16x32_bf16 v[168:171], a[168:171], v[24:27], v[168:171]
ds_read_b128 a[208:211], v1 offset:53248
v_cvt_pk_bf16_f32 v73, v74, v75
v_mfma_f32_16x16x32_bf16 v[200:203], a[168:171], v[36:39], v[200:203]
v_exp_f32 v48, v48
v_mfma_f32_16x16x32_bf16 v[232:235], a[168:171], v[40:43], v[232:235]
ds_read_b128 a[212:215], v2 offset:53248
v_mfma_f32_16x16x32_bf16 v[152:155], a[172:175], v[20:23], v[152:155]
v_exp_f32 v49, v49
v_mfma_f32_16x16x32_bf16 v[184:187], a[172:175], v[24:27], v[184:187]
ds_read_b128 a[216:219], v1 offset:54272
v_cvt_pk_bf16_f32 v54, v48, v49
v_mfma_f32_16x16x32_bf16 v[216:219], a[172:175], v[36:39], v[216:219]
v_exp_f32 v50, v50
v_mfma_f32_16x16x32_bf16 v[248:251], a[172:175], v[40:43], v[248:251]
ds_read_b128 a[220:223], v2 offset:54272
v_smfmac_f32_16x16x64_bf16 a[248:251], a[240:243], v[36:43], v110
ds_read_b128 a[232:235], v3 offset:49152
v_mfma_f32_16x16x32_bf16 v[140:143], a[176:179], v[20:23], v[140:143]
v_exp_f32 v51, v51
v_mfma_f32_16x16x32_bf16 v[172:175], a[176:179], v[24:27], v[172:175]
ds_read_b128 a[236:239], v4 offset:49152
v_cvt_pk_bf16_f32 v55, v50, v51
v_mfma_f32_16x16x32_bf16 v[204:207], a[176:179], v[36:39], v[204:207]
v_exp_f32 v60, v60
v_mfma_f32_16x16x32_bf16 v[236:239], a[176:179], v[40:43], v[236:239]
ds_read_b64_tr_b16 a[160:161], v6 offset:49152
v_mfma_f32_16x16x32_bf16 v[156:159], a[180:183], v[20:23], v[156:159]
v_exp_f32 v61, v61
v_mfma_f32_16x16x32_bf16 v[188:191], a[180:183], v[24:27], v[188:191]
ds_read_b64_tr_b16 a[162:163], v6 offset:53248
v_cvt_pk_bf16_f32 v58, v60, v61
v_mfma_f32_16x16x32_bf16 v[220:223], a[180:183], v[36:39], v[220:223]
v_exp_f32 v62, v62
v_mfma_f32_16x16x32_bf16 v[252:255], a[180:183], v[40:43], v[252:255]
buffer_load_dwordx4 v11, s[12:15], s37 offen offset:2048 nt lds
v_mfma_f32_16x16x32_bf16 v[128:131], a[184:187], v[20:23], v[128:131]
ds_read_b64_tr_b16 a[164:165], v6 offset:50176
v_mfma_f32_16x16x32_bf16 v[160:163], a[184:187], v[24:27], v[160:163]
v_exp_f32 v63, v63
v_mfma_f32_16x16x32_bf16 v[192:195], a[184:187], v[36:39], v[192:195]
s_waitcnt lgkmcnt(4)
ds_read_b64_tr_b16 a[166:167], v6 offset:54272
v_cvt_pk_bf16_f32 v59, v62, v63
v_mfma_f32_16x16x32_bf16 v[224:227], a[184:187], v[40:43], v[224:227]
v_exp_f32 v64, v64
v_mfma_f32_16x16x32_bf16 v[88:91], a[184:187], a[224:227], v[88:91]
ds_read_b64_tr_b16 a[168:169], v7 offset:49152
v_mfma_f32_16x16x32_bf16 v[96:99], a[184:187], a[228:231], v[96:99]
v_exp_f32 v65, v65
v_smfmac_f32_16x16x64_bf16 a[252:255], a[240:243], a[224:231], v110
ds_read_b64_tr_b16 a[170:171], v7 offset:53248
v_cvt_pk_bf16_f32 v70, v64, v65
v_mfma_f32_16x16x32_bf16 v[144:147], a[188:191], v[20:23], v[144:147]
v_exp_f32 v66, v66
v_mfma_f32_16x16x32_bf16 v[176:179], a[188:191], v[24:27], v[176:179]
ds_read_b64_tr_b16 a[172:173], v7 offset:50176
v_mfma_f32_16x16x32_bf16 v[208:211], a[188:191], v[36:39], v[208:211]
v_exp_f32 v67, v67
v_mfma_f32_16x16x32_bf16 v[240:243], a[188:191], v[40:43], v[240:243]
ds_read_b64_tr_b16 a[174:175], v7 offset:54272
v_cvt_pk_bf16_f32 v71, v66, v67
v_mfma_f32_16x16x32_bf16 v[92:95], a[188:191], a[224:227], v[92:95]
v_exp_f32 v76, v76
v_mfma_f32_16x16x32_bf16 v[100:103], a[188:191], a[228:231], v[100:103]
ds_read_b128 a[224:227], v3 offset:50176
v_mfma_f32_16x16x32_bf16 v[20:23], a[192:195], a[96:99], 0
v_exp_f32 v77, v77
v_mfma_f32_16x16x32_bf16 v[24:27], a[192:195], a[112:115], 0
ds_read_b128 a[228:231], v4 offset:50176
v_cvt_pk_bf16_f32 v74, v76, v77
v_mfma_f32_16x16x32_bf16 v[36:39], a[192:195], a[128:131], 0
v_exp_f32 v78, v78
v_mfma_f32_16x16x32_bf16 v[40:43], a[192:195], a[144:147], 0
ds_read_b64_tr_b16 a[176:177], v8 offset:49152
v_mfma_f32_16x16x32_bf16 v[20:23], a[196:199], a[100:103], v[20:23]
s_add_u32 m0, s30, 0x4000
s_add_u32 s21, s21, 0x2000
v_exp_f32 v79, v79
v_mfma_f32_16x16x32_bf16 v[24:27], a[196:199], a[116:119], v[24:27]
buffer_load_dwordx4 v11, s[8:11], s21 offen nt lds
v_mfma_f32_16x16x32_bf16 v[36:39], a[196:199], a[132:135], v[36:39]
ds_read_b64_tr_b16 a[178:179], v8 offset:53248
v_cvt_pk_bf16_f32 v75, v78, v79
v_mfma_f32_16x16x32_bf16 v[40:43], a[196:199], a[148:151], v[40:43]
v_mfma_f32_16x16x32_bf16 v[20:23], a[200:203], a[104:107], v[20:23]
ds_read_b64_tr_b16 a[180:181], v8 offset:50176
v_mfma_f32_16x16x32_bf16 v[24:27], a[200:203], a[120:123], v[24:27]
v_mfma_f32_16x16x32_bf16 v[36:39], a[200:203], a[136:139], v[36:39]
ds_read_b64_tr_b16 a[182:183], v8 offset:54272
v_mfma_f32_16x16x32_bf16 v[40:43], a[200:203], a[152:155], v[40:43]
v_mfma_f32_16x16x32_bf16 v[20:23], a[204:207], a[108:111], v[20:23]
s_waitcnt lgkmcnt(4)
ds_read_b64_tr_b16 a[184:185], v5 offset:49152
v_mfma_f32_16x16x32_bf16 v[24:27], a[204:207], a[124:127], v[24:27]
v_mfma_f32_16x16x32_bf16 v[36:39], a[204:207], a[140:143], v[36:39]
ds_read_b64_tr_b16 a[186:187], v5 offset:53248
v_mfma_f32_16x16x32_bf16 v[40:43], a[204:207], a[156:159], v[40:43]
v_mfma_f32_16x16x32_bf16 v[16:19], a[208:211], a[96:99], 0
ds_read_b64_tr_b16 a[188:189], v5 offset:50176
v_mfma_f32_16x16x32_bf16 v[28:31], a[208:211], a[112:115], 0
v_exp_f32 v20, v20
v_mfma_f32_16x16x32_bf16 v[32:35], a[208:211], a[128:131], 0
ds_read_b64_tr_b16 a[190:191], v5 offset:54272
v_mfma_f32_16x16x32_bf16 v[44:47], a[208:211], a[144:147], 0
v_exp_f32 v21, v21
v_mfma_f32_16x16x32_bf16 v[16:19], a[212:215], a[100:103], v[16:19]
ds_read_b128 a[192:195], v1 offset:57344
v_cvt_pk_bf16_f32 v20, v20, v21
v_mfma_f32_16x16x32_bf16 v[28:31], a[212:215], a[116:119], v[28:31]
v_exp_f32 v22, v22
v_mfma_f32_16x16x32_bf16 v[32:35], a[212:215], a[132:135], v[32:35]
ds_read_b128 a[196:199], v2 offset:57344
v_mfma_f32_16x16x32_bf16 v[44:47], a[212:215], a[148:151], v[44:47]
v_exp_f32 v23, v23
v_mfma_f32_16x16x32_bf16 v[16:19], a[216:219], a[104:107], v[16:19]
buffer_load_dwordx4 v11, s[8:11], s21 offen offset:2048 nt lds
v_mfma_f32_16x16x32_bf16 v[28:31], a[216:219], a[120:123], v[28:31]
ds_read_b128 a[200:203], v1 offset:58368
v_cvt_pk_bf16_f32 v21, v22, v23
v_mfma_f32_16x16x32_bf16 v[32:35], a[216:219], a[136:139], v[32:35]
v_exp_f32 v24, v24
v_mfma_f32_16x16x32_bf16 v[44:47], a[216:219], a[152:155], v[44:47]
ds_read_b128 a[204:207], v2 offset:58368
v_mfma_f32_16x16x32_bf16 v[16:19], a[220:223], a[108:111], v[16:19]
v_exp_f32 v25, v25
v_mfma_f32_16x16x32_bf16 v[28:31], a[220:223], a[124:127], v[28:31]
ds_read_b128 a[208:211], v1 offset:61440
v_cvt_pk_bf16_f32 v24, v24, v25
v_mfma_f32_16x16x32_bf16 v[32:35], a[220:223], a[140:143], v[32:35]
v_exp_f32 v26, v26
v_mfma_f32_16x16x32_bf16 v[44:47], a[220:223], a[156:159], v[44:47]
ds_read_b128 a[212:215], v2 offset:61440
v_mfma_f32_16x16x32_bf16 v[80:83], a[232:235], a[64:67], 0
v_exp_f32 v27, v27
v_mfma_f32_16x16x32_bf16 v[84:87], a[232:235], a[80:83], 0
ds_read_b128 a[232:235], v10 offset:6144
v_cvt_pk_bf16_f32 v25, v26, v27
v_mfma_f32_16x16x32_bf16 v[80:83], a[236:239], a[68:71], v[80:83]
v_exp_f32 v36, v36
v_mfma_f32_16x16x32_bf16 v[84:87], a[236:239], a[84:87], v[84:87]
s_waitcnt lgkmcnt(5)
ds_read_b128 a[236:239], v10 offset:7168
v_mfma_f32_16x16x32_bf16 v[80:83], a[224:227], a[72:75], v[80:83]
v_exp_f32 v37, v37
v_mfma_f32_16x16x32_bf16 v[84:87], a[224:227], a[88:91], v[84:87]
ds_read_b128 a[216:219], v1 offset:62464
v_cvt_pk_bf16_f32 v36, v36, v37
v_mfma_f32_16x16x32_bf16 v[80:83], a[228:231], a[76:79], v[80:83]
v_exp_f32 v38, v38
v_mfma_f32_16x16x32_bf16 v[84:87], a[228:231], a[92:95], v[84:87]
ds_read_b128 a[220:223], v2 offset:62464
v_mfma_f32_16x16x32_bf16 v[132:135], a[160:163], v[52:55], v[132:135]
v_exp_f32 v39, v39
v_mfma_f32_16x16x32_bf16 v[164:167], a[160:163], v[56:59], v[164:167]
v_exp_f32 v40, v40
v_mfma_f32_16x16x32_bf16 v[196:199], a[160:163], v[68:71], v[196:199]
s_add_u32 m0, s30, 0x16000
s_add_u32 s37, s37, 0x2000
v_exp_f32 v80, v80
v_mfma_f32_16x16x32_bf16 v[228:231], a[160:163], v[72:75], v[228:231]
buffer_load_dwordx4 v11, s[12:15], s37 offen nt lds
v_mfma_f32_16x16x32_bf16 v[148:151], a[164:167], v[52:55], v[148:151]
ds_read_b64_tr_b16 a[160:161], v6 offset:57344
v_cvt_pk_bf16_f32 v37, v38, v39
v_mfma_f32_16x16x32_bf16 v[180:183], a[164:167], v[56:59], v[180:183]
v_exp_f32 v81, v81
v_mfma_f32_16x16x32_bf16 v[212:215], a[164:167], v[68:71], v[212:215]
ds_read_b64_tr_b16 a[162:163], v6 offset:61440
v_cvt_pk_bf16_f32 v80, v80, v81
v_mfma_f32_16x16x32_bf16 v[244:247], a[164:167], v[72:75], v[244:247]
v_exp_f32 v82, v82
v_smfmac_f32_16x16x64_bf16 a[244:247], a[240:243], v[52:59], v110
ds_read_b64_tr_b16 a[164:165], v6 offset:58368
v_mfma_f32_16x16x32_bf16 v[136:139], a[168:171], v[52:55], v[136:139]
v_exp_f32 v83, v83
v_mfma_f32_16x16x32_bf16 v[168:171], a[168:171], v[56:59], v[168:171]
ds_read_b64_tr_b16 a[166:167], v6 offset:62464
v_cvt_pk_bf16_f32 v81, v82, v83
v_mfma_f32_16x16x32_bf16 v[200:203], a[168:171], v[68:71], v[200:203]
ds_write_b64 v9, v[80:81] offset:0
v_mfma_f32_16x16x32_bf16 v[232:235], a[168:171], v[72:75], v[232:235]
ds_read_b64_tr_b16 a[168:169], v7 offset:57344
v_mfma_f32_16x16x32_bf16 v[152:155], a[172:175], v[52:55], v[152:155]
v_exp_f32 v84, v84
v_mfma_f32_16x16x32_bf16 v[184:187], a[172:175], v[56:59], v[184:187]
ds_read_b64_tr_b16 a[170:171], v7 offset:61440
v_mfma_f32_16x16x32_bf16 v[216:219], a[172:175], v[68:71], v[216:219]
v_exp_f32 v85, v85
v_mfma_f32_16x16x32_bf16 v[248:251], a[172:175], v[72:75], v[248:251]
s_waitcnt lgkmcnt(6)
ds_read_b64_tr_b16 a[172:173], v7 offset:58368
v_cvt_pk_bf16_f32 v84, v84, v85
v_smfmac_f32_16x16x64_bf16 a[248:251], a[240:243], v[68:75], v110
ds_read_b64_tr_b16 a[174:175], v7 offset:62464
v_mfma_f32_16x16x32_bf16 v[140:143], a[176:179], v[52:55], v[140:143]
v_exp_f32 v86, v86
v_mfma_f32_16x16x32_bf16 v[172:175], a[176:179], v[56:59], v[172:175]
v_exp_f32 v87, v87
v_mfma_f32_16x16x32_bf16 v[204:207], a[176:179], v[68:71], v[204:207]
v_exp_f32 v41, v41
v_mfma_f32_16x16x32_bf16 v[236:239], a[176:179], v[72:75], v[236:239]
ds_read_b64_tr_b16 a[176:177], v8 offset:57344
v_cvt_pk_bf16_f32 v85, v86, v87
v_mfma_f32_16x16x32_bf16 v[156:159], a[180:183], v[52:55], v[156:159]
buffer_load_dwordx4 v11, s[12:15], s37 offen offset:2048 nt lds
v_mfma_f32_16x16x32_bf16 v[188:191], a[180:183], v[56:59], v[188:191]
ds_read_b64_tr_b16 a[178:179], v8 offset:61440
v_cvt_pk_bf16_f32 v40, v40, v41
v_mfma_f32_16x16x32_bf16 v[220:223], a[180:183], v[68:71], v[220:223]
ds_write_b64 v9, v[84:85] offset:1024
v_mfma_f32_16x16x32_bf16 v[252:255], a[180:183], v[72:75], v[252:255]
ds_read_b64_tr_b16 a[180:181], v8 offset:58368
v_mfma_f32_16x16x32_bf16 v[128:131], a[184:187], v[52:55], v[128:131]
v_exp_f32 v42, v42
v_mfma_f32_16x16x32_bf16 v[160:163], a[184:187], v[56:59], v[160:163]
ds_read_b64_tr_b16 a[182:183], v8 offset:62464
v_mfma_f32_16x16x32_bf16 v[192:195], a[184:187], v[68:71], v[192:195]
v_exp_f32 v43, v43
v_mfma_f32_16x16x32_bf16 v[224:227], a[184:187], v[72:75], v[224:227]
v_exp_f32 v16, v16
v_mfma_f32_16x16x32_bf16 v[88:91], a[184:187], a[232:235], v[88:91]
v_exp_f32 v17, v17
v_mfma_f32_16x16x32_bf16 v[96:99], a[184:187], a[236:239], v[96:99]
ds_read_b64_tr_b16 a[184:185], v5 offset:57344
v_cvt_pk_bf16_f32 v22, v16, v17
v_smfmac_f32_16x16x64_bf16 a[252:255], a[240:243], a[232:239], v110
ds_read_b64_tr_b16 a[186:187], v5 offset:61440
v_cvt_pk_bf16_f32 v41, v42, v43
v_mfma_f32_16x16x32_bf16 v[144:147], a[188:191], v[52:55], v[144:147]
v_exp_f32 v18, v18
v_mfma_f32_16x16x32_bf16 v[176:179], a[188:191], v[56:59], v[176:179]
v_exp_f32 v19, v19
v_mfma_f32_16x16x32_bf16 v[208:211], a[188:191], v[68:71], v[208:211]
v_exp_f32 v28, v28
v_mfma_f32_16x16x32_bf16 v[240:243], a[188:191], v[72:75], v[240:243]
v_exp_f32 v29, v29
v_mfma_f32_16x16x32_bf16 v[92:95], a[188:191], a[232:235], v[92:95]
v_exp_f32 v30, v30
v_mfma_f32_16x16x32_bf16 v[100:103], a[188:191], a[236:239], v[100:103]
s_waitcnt lgkmcnt(2)
ds_read_b64_tr_b16 a[188:189], v5 offset:58368
v_cvt_pk_bf16_f32 v23, v18, v19
v_mfma_f32_16x16x32_bf16 v[52:55], a[192:195], a[96:99], 0
v_exp_f32 v31, v31
v_mfma_f32_16x16x32_bf16 v[56:59], a[192:195], a[112:115], 0
s_add_u32 m0, s30, 0x6000
s_add_u32 s21, s21, 0x2000
ds_read_b64_tr_b16 a[190:191], v5 offset:62464
v_cvt_pk_bf16_f32 v26, v28, v29
v_mfma_f32_16x16x32_bf16 v[68:71], a[192:195], a[128:131], 0
buffer_load_dwordx4 v11, s[8:11], s21 offen nt lds
v_mfma_f32_16x16x32_bf16 v[72:75], a[192:195], a[144:147], 0
v_exp_f32 v32, v32
v_mfma_f32_16x16x32_bf16 v[52:55], a[196:199], a[100:103], v[52:55]
v_exp_f32 v33, v33
v_mfma_f32_16x16x32_bf16 v[56:59], a[196:199], a[116:119], v[56:59]
v_exp_f32 v34, v34
v_mfma_f32_16x16x32_bf16 v[68:71], a[196:199], a[132:135], v[68:71]
v_exp_f32 v35, v35
v_mfma_f32_16x16x32_bf16 v[72:75], a[196:199], a[148:151], v[72:75]
v_exp_f32 v44, v44
v_mfma_f32_16x16x32_bf16 v[52:55], a[200:203], a[104:107], v[52:55]
v_exp_f32 v45, v45
v_mfma_f32_16x16x32_bf16 v[56:59], a[200:203], a[120:123], v[56:59]
v_exp_f32 v46, v46
v_mfma_f32_16x16x32_bf16 v[68:71], a[200:203], a[136:139], v[68:71]
v_exp_f32 v47, v47
v_mfma_f32_16x16x32_bf16 v[72:75], a[200:203], a[152:155], v[72:75]
v_cvt_pk_bf16_f32 v27, v30, v31
v_cvt_pk_bf16_f32 v38, v32, v33
v_mfma_f32_16x16x32_bf16 v[52:55], a[204:207], a[108:111], v[52:55]
v_cvt_pk_bf16_f32 v39, v34, v35
v_cvt_pk_bf16_f32 v42, v44, v45
v_mfma_f32_16x16x32_bf16 v[56:59], a[204:207], a[124:127], v[56:59]
v_cvt_pk_bf16_f32 v43, v46, v47
v_mfma_f32_16x16x32_bf16 v[68:71], a[204:207], a[140:143], v[68:71]
v_mfma_f32_16x16x32_bf16 v[72:75], a[204:207], a[156:159], v[72:75]
v_mfma_f32_16x16x32_bf16 v[48:51], a[208:211], a[96:99], 0
v_mfma_f32_16x16x32_bf16 v[60:63], a[208:211], a[112:115], 0
v_exp_f32 v52, v52
v_mfma_f32_16x16x32_bf16 v[64:67], a[208:211], a[128:131], 0
v_exp_f32 v53, v53
v_mfma_f32_16x16x32_bf16 v[76:79], a[208:211], a[144:147], 0
v_exp_f32 v54, v54
v_mfma_f32_16x16x32_bf16 v[48:51], a[212:215], a[100:103], v[48:51]
buffer_load_dwordx4 v11, s[8:11], s21 offen offset:2048 nt lds
v_mfma_f32_16x16x32_bf16 v[60:63], a[212:215], a[116:119], v[60:63]
v_exp_f32 v55, v55
v_mfma_f32_16x16x32_bf16 v[64:67], a[212:215], a[132:135], v[64:67]
v_exp_f32 v56, v56
v_mfma_f32_16x16x32_bf16 v[76:79], a[212:215], a[148:151], v[76:79]
v_exp_f32 v57, v57
v_mfma_f32_16x16x32_bf16 v[48:51], a[216:219], a[104:107], v[48:51]
v_exp_f32 v58, v58
v_mfma_f32_16x16x32_bf16 v[60:63], a[216:219], a[120:123], v[60:63]
v_exp_f32 v59, v59
v_mfma_f32_16x16x32_bf16 v[64:67], a[216:219], a[136:139], v[64:67]
v_exp_f32 v68, v68
v_mfma_f32_16x16x32_bf16 v[76:79], a[216:219], a[152:155], v[76:79]
v_exp_f32 v69, v69
v_mfma_f32_16x16x32_bf16 v[48:51], a[220:223], a[108:111], v[48:51]
v_exp_f32 v70, v70
v_mfma_f32_16x16x32_bf16 v[60:63], a[220:223], a[124:127], v[60:63]
v_exp_f32 v71, v71
v_mfma_f32_16x16x32_bf16 v[64:67], a[220:223], a[140:143], v[64:67]
v_cvt_pk_bf16_f32 v52, v52, v53
v_cvt_pk_bf16_f32 v53, v54, v55
v_mfma_f32_16x16x32_bf16 v[76:79], a[220:223], a[156:159], v[76:79]
s_waitcnt vmcnt(8) lgkmcnt(0)
s_barrier
ds_read_b128 a[224:227], v10 offset:0
v_mfma_f32_16x16x32_bf16 v[132:135], a[160:163], v[20:23], v[132:135]
v_exp_f32 v72, v72
v_mfma_f32_16x16x32_bf16 v[164:167], a[160:163], v[24:27], v[164:167]
ds_read_b128 a[228:231], v10 offset:1024
v_cvt_pk_bf16_f32 v56, v56, v57
v_mfma_f32_16x16x32_bf16 v[196:199], a[160:163], v[36:39], v[196:199]
v_exp_f32 v73, v73
v_mfma_f32_16x16x32_bf16 v[228:231], a[160:163], v[40:43], v[228:231]
ds_read_b128 a[192:195], v1 offset:0
v_cvt_pk_bf16_f32 v57, v58, v59
v_mfma_f32_16x16x32_bf16 v[148:151], a[164:167], v[20:23], v[148:151]
v_exp_f32 v74, v74
v_mfma_f32_16x16x32_bf16 v[180:183], a[164:167], v[24:27], v[180:183]
s_add_u32 m0, s30, 0x18000
s_add_u32 s37, s37, 0x2000
ds_read_b128 a[196:199], v2 offset:0
v_cvt_pk_bf16_f32 v68, v68, v69
v_mfma_f32_16x16x32_bf16 v[212:215], a[164:167], v[36:39], v[212:215]
buffer_load_dwordx4 v11, s[12:15], s37 offen nt lds
v_mfma_f32_16x16x32_bf16 v[244:247], a[164:167], v[40:43], v[244:247]
ds_read_b128 a[200:203], v1 offset:1024
v_cvt_pk_bf16_f32 v69, v70, v71
v_smfmac_f32_16x16x64_bf16 a[244:247], a[240:243], v[20:27], v110
ds_read_b128 a[204:207], v2 offset:1024
v_cvt_pk_bf16_f32 v72, v72, v73
v_mfma_f32_16x16x32_bf16 v[136:139], a[168:171], v[20:23], v[136:139]
v_exp_f32 v75, v75
v_mfma_f32_16x16x32_bf16 v[168:171], a[168:171], v[24:27], v[168:171]
ds_read_b128 a[208:211], v1 offset:4096
v_cvt_pk_bf16_f32 v73, v74, v75
v_mfma_f32_16x16x32_bf16 v[200:203], a[168:171], v[36:39], v[200:203]
v_exp_f32 v48, v48
v_mfma_f32_16x16x32_bf16 v[232:235], a[168:171], v[40:43], v[232:235]
ds_read_b128 a[212:215], v2 offset:4096
v_mfma_f32_16x16x32_bf16 v[152:155], a[172:175], v[20:23], v[152:155]
v_exp_f32 v49, v49
v_mfma_f32_16x16x32_bf16 v[184:187], a[172:175], v[24:27], v[184:187]
ds_read_b128 a[216:219], v1 offset:5120
v_cvt_pk_bf16_f32 v54, v48, v49
v_mfma_f32_16x16x32_bf16 v[216:219], a[172:175], v[36:39], v[216:219]
v_exp_f32 v50, v50
v_mfma_f32_16x16x32_bf16 v[248:251], a[172:175], v[40:43], v[248:251]
ds_read_b128 a[220:223], v2 offset:5120
v_smfmac_f32_16x16x64_bf16 a[248:251], a[240:243], v[36:43], v110
ds_read_b128 a[232:235], v3 offset:0
v_mfma_f32_16x16x32_bf16 v[140:143], a[176:179], v[20:23], v[140:143]
v_exp_f32 v51, v51
v_mfma_f32_16x16x32_bf16 v[172:175], a[176:179], v[24:27], v[172:175]
ds_read_b128 a[236:239], v4 offset:0
v_cvt_pk_bf16_f32 v55, v50, v51
v_mfma_f32_16x16x32_bf16 v[204:207], a[176:179], v[36:39], v[204:207]
buffer_load_dwordx4 v11, s[12:15], s37 offen offset:2048 nt lds
v_mfma_f32_16x16x32_bf16 v[236:239], a[176:179], v[40:43], v[236:239]
ds_read_b64_tr_b16 a[160:161], v6 offset:0
v_mfma_f32_16x16x32_bf16 v[156:159], a[180:183], v[20:23], v[156:159]
v_exp_f32 v60, v60
v_mfma_f32_16x16x32_bf16 v[188:191], a[180:183], v[24:27], v[188:191]
ds_read_b64_tr_b16 a[162:163], v6 offset:4096
v_mfma_f32_16x16x32_bf16 v[220:223], a[180:183], v[36:39], v[220:223]
v_exp_f32 v61, v61
v_mfma_f32_16x16x32_bf16 v[252:255], a[180:183], v[40:43], v[252:255]
ds_read_b64_tr_b16 a[164:165], v6 offset:1024
v_cvt_pk_bf16_f32 v58, v60, v61
v_mfma_f32_16x16x32_bf16 v[128:131], a[184:187], v[20:23], v[128:131]
v_exp_f32 v62, v62
v_mfma_f32_16x16x32_bf16 v[160:163], a[184:187], v[24:27], v[160:163]
s_waitcnt lgkmcnt(5)
ds_read_b64_tr_b16 a[166:167], v6 offset:5120
v_mfma_f32_16x16x32_bf16 v[192:195], a[184:187], v[36:39], v[192:195]
v_exp_f32 v63, v63
v_mfma_f32_16x16x32_bf16 v[224:227], a[184:187], v[40:43], v[224:227]
ds_read_b64_tr_b16 a[168:169], v7 offset:0
v_cvt_pk_bf16_f32 v59, v62, v63
v_mfma_f32_16x16x32_bf16 v[88:91], a[184:187], a[224:227], v[88:91]
v_exp_f32 v64, v64
v_mfma_f32_16x16x32_bf16 v[96:99], a[184:187], a[228:231], v[96:99]
ds_read_b64_tr_b16 a[170:171], v7 offset:4096
v_smfmac_f32_16x16x64_bf16 a[252:255], a[240:243], a[224:231], v110
ds_read_b64_tr_b16 a[172:173], v7 offset:1024
v_mfma_f32_16x16x32_bf16 v[144:147], a[188:191], v[20:23], v[144:147]
v_exp_f32 v65, v65
v_mfma_f32_16x16x32_bf16 v[176:179], a[188:191], v[24:27], v[176:179]
s_add_u32 m0, s30, 0x8000
s_add_u32 s21, s21, 0x2000
ds_read_b64_tr_b16 a[174:175], v7 offset:5120
v_cvt_pk_bf16_f32 v70, v64, v65
v_mfma_f32_16x16x32_bf16 v[208:211], a[188:191], v[36:39], v[208:211]
buffer_load_dwordx4 v11, s[8:11], s21 offen nt lds
v_mfma_f32_16x16x32_bf16 v[240:243], a[188:191], v[40:43], v[240:243]
ds_read_b64_tr_b16 a[176:177], v8 offset:0
v_mfma_f32_16x16x32_bf16 v[92:95], a[188:191], a[224:227], v[92:95]
v_exp_f32 v66, v66
v_mfma_f32_16x16x32_bf16 v[100:103], a[188:191], a[228:231], v[100:103]
ds_read_b128 a[224:227], v3 offset:1024
v_mfma_f32_16x16x32_bf16 v[20:23], a[192:195], a[96:99], 0
v_exp_f32 v67, v67
v_mfma_f32_16x16x32_bf16 v[24:27], a[192:195], a[112:115], 0
ds_read_b128 a[228:231], v4 offset:1024
v_cvt_pk_bf16_f32 v71, v66, v67
v_mfma_f32_16x16x32_bf16 v[36:39], a[192:195], a[128:131], 0
v_exp_f32 v76, v76
v_mfma_f32_16x16x32_bf16 v[40:43], a[192:195], a[144:147], 0
ds_read_b64_tr_b16 a[178:179], v8 offset:4096
v_mfma_f32_16x16x32_bf16 v[20:23], a[196:199], a[100:103], v[20:23]
v_exp_f32 v77, v77
v_mfma_f32_16x16x32_bf16 v[24:27], a[196:199], a[116:119], v[24:27]
ds_read_b64_tr_b16 a[180:181], v8 offset:1024
v_cvt_pk_bf16_f32 v74, v76, v77
v_mfma_f32_16x16x32_bf16 v[36:39], a[196:199], a[132:135], v[36:39]
v_exp_f32 v78, v78
v_mfma_f32_16x16x32_bf16 v[40:43], a[196:199], a[148:151], v[40:43]
s_waitcnt lgkmcnt(5)
ds_read_b64_tr_b16 a[182:183], v8 offset:5120
v_mfma_f32_16x16x32_bf16 v[20:23], a[200:203], a[104:107], v[20:23]
v_exp_f32 v79, v79
v_mfma_f32_16x16x32_bf16 v[24:27], a[200:203], a[120:123], v[24:27]
ds_read_b64_tr_b16 a[184:185], v5 offset:0
v_cvt_pk_bf16_f32 v75, v78, v79
v_mfma_f32_16x16x32_bf16 v[36:39], a[200:203], a[136:139], v[36:39]
v_mfma_f32_16x16x32_bf16 v[40:43], a[200:203], a[152:155], v[40:43]
buffer_load_dwordx4 v11, s[8:11], s21 offen offset:2048 nt lds
v_mfma_f32_16x16x32_bf16 v[20:23], a[204:207], a[108:111], v[20:23]
ds_read_b64_tr_b16 a[186:187], v5 offset:4096
v_mfma_f32_16x16x32_bf16 v[24:27], a[204:207], a[124:127], v[24:27]
v_mfma_f32_16x16x32_bf16 v[36:39], a[204:207], a[140:143], v[36:39]
ds_read_b64_tr_b16 a[188:189], v5 offset:1024
v_mfma_f32_16x16x32_bf16 v[40:43], a[204:207], a[156:159], v[40:43]
v_mfma_f32_16x16x32_bf16 v[16:19], a[208:211], a[96:99], 0
ds_read_b64_tr_b16 a[190:191], v5 offset:5120
v_mfma_f32_16x16x32_bf16 v[28:31], a[208:211], a[112:115], 0
v_exp_f32 v20, v20
v_mfma_f32_16x16x32_bf16 v[32:35], a[208:211], a[128:131], 0
ds_read_b128 a[192:195], v1 offset:8192
v_mfma_f32_16x16x32_bf16 v[44:47], a[208:211], a[144:147], 0
v_exp_f32 v21, v21
v_mfma_f32_16x16x32_bf16 v[16:19], a[212:215], a[100:103], v[16:19]
ds_read_b128 a[196:199], v2 offset:8192
v_cvt_pk_bf16_f32 v20, v20, v21
v_mfma_f32_16x16x32_bf16 v[28:31], a[212:215], a[116:119], v[28:31]
v_exp_f32 v22, v22
v_mfma_f32_16x16x32_bf16 v[32:35], a[212:215], a[132:135], v[32:35]
ds_read_b128 a[200:203], v1 offset:9216
v_mfma_f32_16x16x32_bf16 v[44:47], a[212:215], a[148:151], v[44:47]
v_exp_f32 v23, v23
v_mfma_f32_16x16x32_bf16 v[16:19], a[216:219], a[104:107], v[16:19]
ds_read_b128 a[204:207], v2 offset:9216
v_cvt_pk_bf16_f32 v21, v22, v23
v_mfma_f32_16x16x32_bf16 v[28:31], a[216:219], a[120:123], v[28:31]
s_add_u32 m0, s30, 0x1a000
s_add_u32 s37, s37, 0x2000
v_exp_f32 v24, v24
v_mfma_f32_16x16x32_bf16 v[32:35], a[216:219], a[136:139], v[32:35]
buffer_load_dwordx4 v11, s[12:15], s37 offen nt lds
v_mfma_f32_16x16x32_bf16 v[44:47], a[216:219], a[152:155], v[44:47]
ds_read_b128 a[208:211], v1 offset:12288
v_mfma_f32_16x16x32_bf16 v[16:19], a[220:223], a[108:111], v[16:19]
v_exp_f32 v25, v25
v_mfma_f32_16x16x32_bf16 v[28:31], a[220:223], a[124:127], v[28:31]
s_waitcnt lgkmcnt(4)
ds_read_b128 a[212:215], v2 offset:12288
v_cvt_pk_bf16_f32 v24, v24, v25
v_mfma_f32_16x16x32_bf16 v[32:35], a[220:223], a[140:143], v[32:35]
v_exp_f32 v26, v26
v_mfma_f32_16x16x32_bf16 v[44:47], a[220:223], a[156:159], v[44:47]
ds_read_b128 a[216:219], v1 offset:13312
v_mfma_f32_16x16x32_bf16 v[80:83], a[232:235], a[64:67], 0
v_exp_f32 v27, v27
v_mfma_f32_16x16x32_bf16 v[84:87], a[232:235], a[80:83], 0
ds_read_b128 a[232:235], v10 offset:2048
v_cvt_pk_bf16_f32 v25, v26, v27
v_mfma_f32_16x16x32_bf16 v[80:83], a[236:239], a[68:71], v[80:83]
v_exp_f32 v36, v36
v_mfma_f32_16x16x32_bf16 v[84:87], a[236:239], a[84:87], v[84:87]
ds_read_b128 a[236:239], v10 offset:3072
v_mfma_f32_16x16x32_bf16 v[80:83], a[224:227], a[72:75], v[80:83]
v_exp_f32 v37, v37
v_mfma_f32_16x16x32_bf16 v[84:87], a[224:227], a[88:91], v[84:87]
ds_read_b128 a[220:223], v2 offset:13312
v_cvt_pk_bf16_f32 v36, v36, v37
v_mfma_f32_16x16x32_bf16 v[80:83], a[228:231], a[76:79], v[80:83]
v_exp_f32 v38, v38
v_mfma_f32_16x16x32_bf16 v[84:87], a[228:231], a[92:95], v[84:87]
v_exp_f32 v39, v39
v_mfma_f32_16x16x32_bf16 v[132:135], a[160:163], v[52:55], v[132:135]
v_exp_f32 v40, v40
v_mfma_f32_16x16x32_bf16 v[164:167], a[160:163], v[56:59], v[164:167]
buffer_load_dwordx4 v11, s[12:15], s37 offen offset:2048 nt lds
v_mfma_f32_16x16x32_bf16 v[196:199], a[160:163], v[68:71], v[196:199]
v_exp_f32 v80, v80
v_mfma_f32_16x16x32_bf16 v[228:231], a[160:163], v[72:75], v[228:231]
ds_read_b64_tr_b16 a[160:161], v6 offset:8192
v_cvt_pk_bf16_f32 v37, v38, v39
v_mfma_f32_16x16x32_bf16 v[148:151], a[164:167], v[52:55], v[148:151]
v_exp_f32 v81, v81
v_mfma_f32_16x16x32_bf16 v[180:183], a[164:167], v[56:59], v[180:183]
ds_read_b64_tr_b16 a[162:163], v6 offset:12288
v_cvt_pk_bf16_f32 v80, v80, v81
v_mfma_f32_16x16x32_bf16 v[212:215], a[164:167], v[68:71], v[212:215]
v_exp_f32 v82, v82
v_mfma_f32_16x16x32_bf16 v[244:247], a[164:167], v[72:75], v[244:247]
ds_read_b64_tr_b16 a[164:165], v6 offset:9216
v_smfmac_f32_16x16x64_bf16 a[244:247], a[240:243], v[52:59], v110
ds_read_b64_tr_b16 a[166:167], v6 offset:13312
v_mfma_f32_16x16x32_bf16 v[136:139], a[168:171], v[52:55], v[136:139]
v_exp_f32 v83, v83
v_mfma_f32_16x16x32_bf16 v[168:171], a[168:171], v[56:59], v[168:171]
v_exp_f32 v84, v84
v_mfma_f32_16x16x32_bf16 v[200:203], a[168:171], v[68:71], v[200:203]
v_exp_f32 v85, v85
v_mfma_f32_16x16x32_bf16 v[232:235], a[168:171], v[72:75], v[232:235]
ds_read_b64_tr_b16 a[168:169], v7 offset:8192
v_cvt_pk_bf16_f32 v81, v82, v83
v_mfma_f32_16x16x32_bf16 v[152:155], a[172:175], v[52:55], v[152:155]
ds_write_b64 v9, v[80:81] offset:4096
v_cvt_pk_bf16_f32 v84, v84, v85
v_mfma_f32_16x16x32_bf16 v[184:187], a[172:175], v[56:59], v[184:187]
s_waitcnt lgkmcnt(5)
ds_read_b64_tr_b16 a[170:171], v7 offset:12288
v_mfma_f32_16x16x32_bf16 v[216:219], a[172:175], v[68:71], v[216:219]
s_add_u32 m0, s30, 0xa000
s_add_u32 s21, s21, 0x2000
v_exp_f32 v86, v86
v_mfma_f32_16x16x32_bf16 v[248:251], a[172:175], v[72:75], v[248:251]
buffer_load_dwordx4 v11, s[8:11], s21 offen nt lds
v_smfmac_f32_16x16x64_bf16 a[248:251], a[240:243], v[68:75], v110
ds_read_b64_tr_b16 a[172:173], v7 offset:9216
v_mfma_f32_16x16x32_bf16 v[140:143], a[176:179], v[52:55], v[140:143]
v_exp_f32 v87, v87
v_mfma_f32_16x16x32_bf16 v[172:175], a[176:179], v[56:59], v[172:175]
ds_read_b64_tr_b16 a[174:175], v7 offset:13312
v_cvt_pk_bf16_f32 v85, v86, v87
v_mfma_f32_16x16x32_bf16 v[204:207], a[176:179], v[68:71], v[204:207]
ds_write_b64 v9, v[84:85] offset:5120
v_mfma_f32_16x16x32_bf16 v[236:239], a[176:179], v[72:75], v[236:239]
ds_read_b64_tr_b16 a[176:177], v8 offset:8192
v_mfma_f32_16x16x32_bf16 v[156:159], a[180:183], v[52:55], v[156:159]
v_exp_f32 v41, v41
v_mfma_f32_16x16x32_bf16 v[188:191], a[180:183], v[56:59], v[188:191]
ds_read_b64_tr_b16 a[178:179], v8 offset:12288
v_cvt_pk_bf16_f32 v40, v40, v41
v_mfma_f32_16x16x32_bf16 v[220:223], a[180:183], v[68:71], v[220:223]
v_exp_f32 v42, v42
v_mfma_f32_16x16x32_bf16 v[252:255], a[180:183], v[72:75], v[252:255]
ds_read_b64_tr_b16 a[180:181], v8 offset:9216
v_mfma_f32_16x16x32_bf16 v[128:131], a[184:187], v[52:55], v[128:131]
v_exp_f32 v43, v43
v_mfma_f32_16x16x32_bf16 v[160:163], a[184:187], v[56:59], v[160:163]
ds_read_b64_tr_b16 a[182:183], v8 offset:13312
v_cvt_pk_bf16_f32 v41, v42, v43
v_mfma_f32_16x16x32_bf16 v[192:195], a[184:187], v[68:71], v[192:195]
v_exp_f32 v16, v16
v_mfma_f32_16x16x32_bf16 v[224:227], a[184:187], v[72:75], v[224:227]
v_exp_f32 v17, v17
v_mfma_f32_16x16x32_bf16 v[88:91], a[184:187], a[232:235], v[88:91]
v_exp_f32 v18, v18
v_mfma_f32_16x16x32_bf16 v[96:99], a[184:187], a[236:239], v[96:99]
buffer_load_dwordx4 v11, s[8:11], s21 offen offset:2048 nt lds
v_smfmac_f32_16x16x64_bf16 a[252:255], a[240:243], a[232:239], v110
ds_read_b64_tr_b16 a[184:185], v5 offset:8192
v_cvt_pk_bf16_f32 v22, v16, v17
v_mfma_f32_16x16x32_bf16 v[144:147], a[188:191], v[52:55], v[144:147]
v_exp_f32 v19, v19
v_mfma_f32_16x16x32_bf16 v[176:179], a[188:191], v[56:59], v[176:179]
ds_read_b64_tr_b16 a[186:187], v5 offset:12288
v_cvt_pk_bf16_f32 v23, v18, v19
v_mfma_f32_16x16x32_bf16 v[208:211], a[188:191], v[68:71], v[208:211]
v_exp_f32 v28, v28
v_mfma_f32_16x16x32_bf16 v[240:243], a[188:191], v[72:75], v[240:243]
v_exp_f32 v29, v29
v_mfma_f32_16x16x32_bf16 v[92:95], a[188:191], a[232:235], v[92:95]
v_exp_f32 v30, v30
v_mfma_f32_16x16x32_bf16 v[100:103], a[188:191], a[236:239], v[100:103]
s_waitcnt lgkmcnt(2)
ds_read_b64_tr_b16 a[188:189], v5 offset:9216
v_cvt_pk_bf16_f32 v26, v28, v29
v_mfma_f32_16x16x32_bf16 v[52:55], a[192:195], a[96:99], 0
v_exp_f32 v31, v31
v_mfma_f32_16x16x32_bf16 v[56:59], a[192:195], a[112:115], 0
ds_read_b64_tr_b16 a[190:191], v5 offset:13312
v_cvt_pk_bf16_f32 v27, v30, v31
v_mfma_f32_16x16x32_bf16 v[68:71], a[192:195], a[128:131], 0
v_exp_f32 v32, v32
v_mfma_f32_16x16x32_bf16 v[72:75], a[192:195], a[144:147], 0
v_exp_f32 v33, v33
v_mfma_f32_16x16x32_bf16 v[52:55], a[196:199], a[100:103], v[52:55]
v_exp_f32 v34, v34
v_mfma_f32_16x16x32_bf16 v[56:59], a[196:199], a[116:119], v[56:59]
v_exp_f32 v35, v35
v_mfma_f32_16x16x32_bf16 v[68:71], a[196:199], a[132:135], v[68:71]
s_add_u32 m0, s30, 0x1c000
s_add_u32 s37, s37, 0x2000
v_exp_f32 v44, v44
v_mfma_f32_16x16x32_bf16 v[72:75], a[196:199], a[148:151], v[72:75]
buffer_load_dwordx4 v11, s[12:15], s37 offen nt lds
v_mfma_f32_16x16x32_bf16 v[52:55], a[200:203], a[104:107], v[52:55]
v_exp_f32 v45, v45
v_mfma_f32_16x16x32_bf16 v[56:59], a[200:203], a[120:123], v[56:59]
v_exp_f32 v46, v46
v_mfma_f32_16x16x32_bf16 v[68:71], a[200:203], a[136:139], v[68:71]
v_exp_f32 v47, v47
v_mfma_f32_16x16x32_bf16 v[72:75], a[200:203], a[152:155], v[72:75]
v_cvt_pk_bf16_f32 v38, v32, v33
v_cvt_pk_bf16_f32 v39, v34, v35
v_mfma_f32_16x16x32_bf16 v[52:55], a[204:207], a[108:111], v[52:55]
v_cvt_pk_bf16_f32 v42, v44, v45
v_cvt_pk_bf16_f32 v43, v46, v47
v_mfma_f32_16x16x32_bf16 v[56:59], a[204:207], a[124:127], v[56:59]
v_mfma_f32_16x16x32_bf16 v[68:71], a[204:207], a[140:143], v[68:71]
v_mfma_f32_16x16x32_bf16 v[72:75], a[204:207], a[156:159], v[72:75]
v_mfma_f32_16x16x32_bf16 v[48:51], a[208:211], a[96:99], 0
v_mfma_f32_16x16x32_bf16 v[60:63], a[208:211], a[112:115], 0
v_mfma_f32_16x16x32_bf16 v[64:67], a[208:211], a[128:131], 0
v_exp_f32 v52, v52
v_mfma_f32_16x16x32_bf16 v[76:79], a[208:211], a[144:147], 0
v_exp_f32 v53, v53
v_mfma_f32_16x16x32_bf16 v[48:51], a[212:215], a[100:103], v[48:51]
v_exp_f32 v54, v54
v_mfma_f32_16x16x32_bf16 v[60:63], a[212:215], a[116:119], v[60:63]
v_exp_f32 v55, v55
v_mfma_f32_16x16x32_bf16 v[64:67], a[212:215], a[132:135], v[64:67]
buffer_load_dwordx4 v11, s[12:15], s37 offen offset:2048 nt lds
v_mfma_f32_16x16x32_bf16 v[76:79], a[212:215], a[148:151], v[76:79]
v_exp_f32 v56, v56
v_mfma_f32_16x16x32_bf16 v[48:51], a[216:219], a[104:107], v[48:51]
v_exp_f32 v57, v57
v_mfma_f32_16x16x32_bf16 v[60:63], a[216:219], a[120:123], v[60:63]
v_exp_f32 v58, v58
v_mfma_f32_16x16x32_bf16 v[64:67], a[216:219], a[136:139], v[64:67]
v_exp_f32 v59, v59
v_mfma_f32_16x16x32_bf16 v[76:79], a[216:219], a[152:155], v[76:79]
v_exp_f32 v68, v68
v_mfma_f32_16x16x32_bf16 v[48:51], a[220:223], a[108:111], v[48:51]
v_exp_f32 v69, v69
v_mfma_f32_16x16x32_bf16 v[60:63], a[220:223], a[124:127], v[60:63]
v_exp_f32 v70, v70
v_mfma_f32_16x16x32_bf16 v[64:67], a[220:223], a[140:143], v[64:67]
v_exp_f32 v71, v71
v_mfma_f32_16x16x32_bf16 v[76:79], a[220:223], a[156:159], v[76:79]
s_waitcnt vmcnt(10) lgkmcnt(0)
s_barrier
ds_read_b128 a[224:227], v10 offset:4096
v_mfma_f32_16x16x32_bf16 v[132:135], a[160:163], v[20:23], v[132:135]
v_cvt_pk_bf16_f32 v52, v52, v53
v_cvt_pk_bf16_f32 v53, v54, v55
v_mfma_f32_16x16x32_bf16 v[164:167], a[160:163], v[24:27], v[164:167]
ds_read_b128 a[228:231], v10 offset:5120
v_cvt_pk_bf16_f32 v56, v56, v57
v_mfma_f32_16x16x32_bf16 v[196:199], a[160:163], v[36:39], v[196:199]
v_exp_f32 v72, v72
v_mfma_f32_16x16x32_bf16 v[228:231], a[160:163], v[40:43], v[228:231]
ds_read_b128 a[192:195], v1 offset:16384
v_cvt_pk_bf16_f32 v57, v58, v59
v_mfma_f32_16x16x32_bf16 v[148:151], a[164:167], v[20:23], v[148:151]
v_exp_f32 v73, v73
v_mfma_f32_16x16x32_bf16 v[180:183], a[164:167], v[24:27], v[180:183]
s_add_u32 m0, s30, 0xc000
s_add_u32 s21, s21, 0x2000
ds_read_b128 a[196:199], v2 offset:16384
v_cvt_pk_bf16_f32 v68, v68, v69
v_mfma_f32_16x16x32_bf16 v[212:215], a[164:167], v[36:39], v[212:215]
buffer_load_dwordx4 v11, s[8:11], s21 offen nt lds
v_mfma_f32_16x16x32_bf16 v[244:247], a[164:167], v[40:43], v[244:247]
ds_read_b128 a[200:203], v1 offset:17408
v_cvt_pk_bf16_f32 v69, v70, v71
v_smfmac_f32_16x16x64_bf16 a[244:247], a[240:243], v[20:27], v110
ds_read_b128 a[204:207], v2 offset:17408
v_cvt_pk_bf16_f32 v72, v72, v73
v_mfma_f32_16x16x32_bf16 v[136:139], a[168:171], v[20:23], v[136:139]
v_exp_f32 v74, v74
v_mfma_f32_16x16x32_bf16 v[168:171], a[168:171], v[24:27], v[168:171]
ds_read_b128 a[208:211], v1 offset:20480
v_mfma_f32_16x16x32_bf16 v[200:203], a[168:171], v[36:39], v[200:203]
v_exp_f32 v75, v75
v_mfma_f32_16x16x32_bf16 v[232:235], a[168:171], v[40:43], v[232:235]
ds_read_b128 a[212:215], v2 offset:20480
v_cvt_pk_bf16_f32 v73, v74, v75
v_mfma_f32_16x16x32_bf16 v[152:155], a[172:175], v[20:23], v[152:155]
v_exp_f32 v48, v48
v_mfma_f32_16x16x32_bf16 v[184:187], a[172:175], v[24:27], v[184:187]
ds_read_b128 a[216:219], v1 offset:21504
v_mfma_f32_16x16x32_bf16 v[216:219], a[172:175], v[36:39], v[216:219]
v_exp_f32 v49, v49
v_mfma_f32_16x16x32_bf16 v[248:251], a[172:175], v[40:43], v[248:251]
ds_read_b128 a[220:223], v2 offset:21504
v_cvt_pk_bf16_f32 v54, v48, v49
v_smfmac_f32_16x16x64_bf16 a[248:251], a[240:243], v[36:43], v110
ds_read_b128 a[232:235], v3 offset:16384
v_mfma_f32_16x16x32_bf16 v[140:143], a[176:179], v[20:23], v[140:143]
v_exp_f32 v50, v50
v_mfma_f32_16x16x32_bf16 v[172:175], a[176:179], v[24:27], v[172:175]
ds_read_b128 a[236:239], v4 offset:16384
v_mfma_f32_16x16x32_bf16 v[204:207], a[176:179], v[36:39], v[204:207]
v_exp_f32 v51, v51
v_mfma_f32_16x16x32_bf16 v[236:239], a[176:179], v[40:43], v[236:239]
ds_read_b64_tr_b16 a[160:161], v6 offset:16384
v_cvt_pk_bf16_f32 v55, v50, v51
v_mfma_f32_16x16x32_bf16 v[156:159], a[180:183], v[20:23], v[156:159]
v_exp_f32 v60, v60
v_mfma_f32_16x16x32_bf16 v[188:191], a[180:183], v[24:27], v[188:191]
ds_read_b64_tr_b16 a[162:163], v6 offset:20480
v_mfma_f32_16x16x32_bf16 v[220:223], a[180:183], v[36:39], v[220:223]
v_exp_f32 v61, v61
v_mfma_f32_16x16x32_bf16 v[252:255], a[180:183], v[40:43], v[252:255]
buffer_load_dwordx4 v11, s[8:11], s21 offen offset:2048 nt lds
v_mfma_f32_16x16x32_bf16 v[128:131], a[184:187], v[20:23], v[128:131]
ds_read_b64_tr_b16 a[164:165], v6 offset:17408
v_cvt_pk_bf16_f32 v58, v60, v61
v_mfma_f32_16x16x32_bf16 v[160:163], a[184:187], v[24:27], v[160:163]
v_exp_f32 v62, v62
v_mfma_f32_16x16x32_bf16 v[192:195], a[184:187], v[36:39], v[192:195]
s_waitcnt lgkmcnt(4)
ds_read_b64_tr_b16 a[166:167], v6 offset:21504
v_mfma_f32_16x16x32_bf16 v[224:227], a[184:187], v[40:43], v[224:227]
v_exp_f32 v63, v63
v_mfma_f32_16x16x32_bf16 v[88:91], a[184:187], a[224:227], v[88:91]
ds_read_b64_tr_b16 a[168:169], v7 offset:16384
v_cvt_pk_bf16_f32 v59, v62, v63
v_mfma_f32_16x16x32_bf16 v[96:99], a[184:187], a[228:231], v[96:99]
v_exp_f32 v64, v64
v_smfmac_f32_16x16x64_bf16 a[252:255], a[240:243], a[224:231], v110
ds_read_b64_tr_b16 a[170:171], v7 offset:20480
v_mfma_f32_16x16x32_bf16 v[144:147], a[188:191], v[20:23], v[144:147]
v_exp_f32 v65, v65
v_mfma_f32_16x16x32_bf16 v[176:179], a[188:191], v[24:27], v[176:179]
ds_read_b64_tr_b16 a[172:173], v7 offset:17408
v_cvt_pk_bf16_f32 v70, v64, v65
v_mfma_f32_16x16x32_bf16 v[208:211], a[188:191], v[36:39], v[208:211]
v_exp_f32 v66, v66
v_mfma_f32_16x16x32_bf16 v[240:243], a[188:191], v[40:43], v[240:243]
ds_read_b64_tr_b16 a[174:175], v7 offset:21504
v_mfma_f32_16x16x32_bf16 v[92:95], a[188:191], a[224:227], v[92:95]
v_exp_f32 v67, v67
v_mfma_f32_16x16x32_bf16 v[100:103], a[188:191], a[228:231], v[100:103]
ds_read_b128 a[224:227], v3 offset:17408
v_cvt_pk_bf16_f32 v71, v66, v67
v_mfma_f32_16x16x32_bf16 v[20:23], a[192:195], a[96:99], 0
v_exp_f32 v76, v76
v_mfma_f32_16x16x32_bf16 v[24:27], a[192:195], a[112:115], 0
ds_read_b128 a[228:231], v4 offset:17408
v_mfma_f32_16x16x32_bf16 v[36:39], a[192:195], a[128:131], 0
v_exp_f32 v77, v77
v_mfma_f32_16x16x32_bf16 v[40:43], a[192:195], a[144:147], 0
ds_read_b64_tr_b16 a[176:177], v8 offset:16384
v_cvt_pk_bf16_f32 v74, v76, v77
v_mfma_f32_16x16x32_bf16 v[20:23], a[196:199], a[100:103], v[20:23]
s_add_u32 m0, s30, 0x1e000
s_add_u32 s37, s37, 0x2000
v_exp_f32 v78, v78
v_mfma_f32_16x16x32_bf16 v[24:27], a[196:199], a[116:119], v[24:27]
buffer_load_dwordx4 v11, s[12:15], s37 offen nt lds
v_mfma_f32_16x16x32_bf16 v[36:39], a[196:199], a[132:135], v[36:39]
ds_read_b64_tr_b16 a[178:179], v8 offset:20480
v_mfma_f32_16x16x32_bf16 v[40:43], a[196:199], a[148:151], v[40:43]
v_exp_f32 v79, v79
v_mfma_f32_16x16x32_bf16 v[20:23], a[200:203], a[104:107], v[20:23]
ds_read_b64_tr_b16 a[180:181], v8 offset:17408
v_cvt_pk_bf16_f32 v75, v78, v79
v_mfma_f32_16x16x32_bf16 v[24:27], a[200:203], a[120:123], v[24:27]
v_mfma_f32_16x16x32_bf16 v[36:39], a[200:203], a[136:139], v[36:39]
ds_read_b64_tr_b16 a[182:183], v8 offset:21504
v_mfma_f32_16x16x32_bf16 v[40:43], a[200:203], a[152:155], v[40:43]
v_mfma_f32_16x16x32_bf16 v[20:23], a[204:207], a[108:111], v[20:23]
s_waitcnt lgkmcnt(4)
ds_read_b64_tr_b16 a[184:185], v5 offset:16384
v_mfma_f32_16x16x32_bf16 v[24:27], a[204:207], a[124:127], v[24:27]
v_mfma_f32_16x16x32_bf16 v[36:39], a[204:207], a[140:143], v[36:39]
ds_read_b64_tr_b16 a[186:187], v5 offset:20480
v_mfma_f32_16x16x32_bf16 v[40:43], a[204:207], a[156:159], v[40:43]
v_mfma_f32_16x16x32_bf16 v[16:19], a[208:211], a[96:99], 0
ds_read_b64_tr_b16 a[188:189], v5 offset:17408
v_mfma_f32_16x16x32_bf16 v[28:31], a[208:211], a[112:115], 0
v_exp_f32 v20, v20
v_mfma_f32_16x16x32_bf16 v[32:35], a[208:211], a[128:131], 0
ds_read_b64_tr_b16 a[190:191], v5 offset:21504
v_mfma_f32_16x16x32_bf16 v[44:47], a[208:211], a[144:147], 0
v_exp_f32 v21, v21
v_mfma_f32_16x16x32_bf16 v[16:19], a[212:215], a[100:103], v[16:19]
ds_read_b128 a[192:195], v1 offset:24576
v_cvt_pk_bf16_f32 v20, v20, v21
v_mfma_f32_16x16x32_bf16 v[28:31], a[212:215], a[116:119], v[28:31]
v_exp_f32 v22, v22
v_mfma_f32_16x16x32_bf16 v[32:35], a[212:215], a[132:135], v[32:35]
ds_read_b128 a[196:199], v2 offset:24576
v_mfma_f32_16x16x32_bf16 v[44:47], a[212:215], a[148:151], v[44:47]
v_exp_f32 v23, v23
v_mfma_f32_16x16x32_bf16 v[16:19], a[216:219], a[104:107], v[16:19]
buffer_load_dwordx4 v11, s[12:15], s37 offen offset:2048 nt lds
v_mfma_f32_16x16x32_bf16 v[28:31], a[216:219], a[120:123], v[28:31]
ds_read_b128 a[200:203], v1 offset:25600
v_cvt_pk_bf16_f32 v21, v22, v23
v_mfma_f32_16x16x32_bf16 v[32:35], a[216:219], a[136:139], v[32:35]
v_exp_f32 v24, v24
v_mfma_f32_16x16x32_bf16 v[44:47], a[216:219], a[152:155], v[44:47]
ds_read_b128 a[204:207], v2 offset:25600
v_mfma_f32_16x16x32_bf16 v[16:19], a[220:223], a[108:111], v[16:19]
v_exp_f32 v25, v25
v_mfma_f32_16x16x32_bf16 v[28:31], a[220:223], a[124:127], v[28:31]
ds_read_b128 a[208:211], v1 offset:28672
v_cvt_pk_bf16_f32 v24, v24, v25
v_mfma_f32_16x16x32_bf16 v[32:35], a[220:223], a[140:143], v[32:35]
v_exp_f32 v26, v26
v_mfma_f32_16x16x32_bf16 v[44:47], a[220:223], a[156:159], v[44:47]
ds_read_b128 a[212:215], v2 offset:28672
v_mfma_f32_16x16x32_bf16 v[80:83], a[232:235], a[64:67], 0
v_exp_f32 v27, v27
v_mfma_f32_16x16x32_bf16 v[84:87], a[232:235], a[80:83], 0
ds_read_b128 a[232:235], v10 offset:6144
v_cvt_pk_bf16_f32 v25, v26, v27
v_mfma_f32_16x16x32_bf16 v[80:83], a[236:239], a[68:71], v[80:83]
v_exp_f32 v36, v36
v_mfma_f32_16x16x32_bf16 v[84:87], a[236:239], a[84:87], v[84:87]
s_waitcnt lgkmcnt(5)
ds_read_b128 a[236:239], v10 offset:7168
v_mfma_f32_16x16x32_bf16 v[80:83], a[224:227], a[72:75], v[80:83]
v_exp_f32 v37, v37
v_mfma_f32_16x16x32_bf16 v[84:87], a[224:227], a[88:91], v[84:87]
ds_read_b128 a[216:219], v1 offset:29696
v_cvt_pk_bf16_f32 v36, v36, v37
v_mfma_f32_16x16x32_bf16 v[80:83], a[228:231], a[76:79], v[80:83]
v_exp_f32 v38, v38
v_mfma_f32_16x16x32_bf16 v[84:87], a[228:231], a[92:95], v[84:87]
ds_read_b128 a[220:223], v2 offset:29696
v_mfma_f32_16x16x32_bf16 v[132:135], a[160:163], v[52:55], v[132:135]
v_exp_f32 v39, v39
v_mfma_f32_16x16x32_bf16 v[164:167], a[160:163], v[56:59], v[164:167]
v_exp_f32 v40, v40
v_mfma_f32_16x16x32_bf16 v[196:199], a[160:163], v[68:71], v[196:199]
s_add_u32 m0, s30, 0xe000
s_add_u32 s21, s21, 0x2000
v_exp_f32 v80, v80
v_mfma_f32_16x16x32_bf16 v[228:231], a[160:163], v[72:75], v[228:231]
buffer_load_dwordx4 v11, s[8:11], s21 offen nt lds
v_mfma_f32_16x16x32_bf16 v[148:151], a[164:167], v[52:55], v[148:151]
ds_read_b64_tr_b16 a[160:161], v6 offset:24576
v_cvt_pk_bf16_f32 v37, v38, v39
v_mfma_f32_16x16x32_bf16 v[180:183], a[164:167], v[56:59], v[180:183]
v_exp_f32 v81, v81
v_mfma_f32_16x16x32_bf16 v[212:215], a[164:167], v[68:71], v[212:215]
ds_read_b64_tr_b16 a[162:163], v6 offset:28672
v_cvt_pk_bf16_f32 v80, v80, v81
v_mfma_f32_16x16x32_bf16 v[244:247], a[164:167], v[72:75], v[244:247]
v_exp_f32 v82, v82
v_smfmac_f32_16x16x64_bf16 a[244:247], a[240:243], v[52:59], v110
ds_read_b64_tr_b16 a[164:165], v6 offset:25600
v_mfma_f32_16x16x32_bf16 v[136:139], a[168:171], v[52:55], v[136:139]
v_exp_f32 v83, v83
v_mfma_f32_16x16x32_bf16 v[168:171], a[168:171], v[56:59], v[168:171]
ds_read_b64_tr_b16 a[166:167], v6 offset:29696
v_cvt_pk_bf16_f32 v81, v82, v83
v_mfma_f32_16x16x32_bf16 v[200:203], a[168:171], v[68:71], v[200:203]
ds_write_b64 v9, v[80:81] offset:0
v_mfma_f32_16x16x32_bf16 v[232:235], a[168:171], v[72:75], v[232:235]
ds_read_b64_tr_b16 a[168:169], v7 offset:24576
v_mfma_f32_16x16x32_bf16 v[152:155], a[172:175], v[52:55], v[152:155]
v_exp_f32 v84, v84
v_mfma_f32_16x16x32_bf16 v[184:187], a[172:175], v[56:59], v[184:187]
ds_read_b64_tr_b16 a[170:171], v7 offset:28672
v_mfma_f32_16x16x32_bf16 v[216:219], a[172:175], v[68:71], v[216:219]
v_exp_f32 v85, v85
v_mfma_f32_16x16x32_bf16 v[248:251], a[172:175], v[72:75], v[248:251]
s_waitcnt lgkmcnt(6)
ds_read_b64_tr_b16 a[172:173], v7 offset:25600
v_cvt_pk_bf16_f32 v84, v84, v85
v_smfmac_f32_16x16x64_bf16 a[248:251], a[240:243], v[68:75], v110
ds_read_b64_tr_b16 a[174:175], v7 offset:29696
v_mfma_f32_16x16x32_bf16 v[140:143], a[176:179], v[52:55], v[140:143]
v_exp_f32 v86, v86
v_mfma_f32_16x16x32_bf16 v[172:175], a[176:179], v[56:59], v[172:175]
v_exp_f32 v87, v87
v_mfma_f32_16x16x32_bf16 v[204:207], a[176:179], v[68:71], v[204:207]
v_exp_f32 v41, v41
v_mfma_f32_16x16x32_bf16 v[236:239], a[176:179], v[72:75], v[236:239]
ds_read_b64_tr_b16 a[176:177], v8 offset:24576
v_cvt_pk_bf16_f32 v85, v86, v87
v_mfma_f32_16x16x32_bf16 v[156:159], a[180:183], v[52:55], v[156:159]
buffer_load_dwordx4 v11, s[8:11], s21 offen offset:2048 nt lds
v_mfma_f32_16x16x32_bf16 v[188:191], a[180:183], v[56:59], v[188:191]
ds_read_b64_tr_b16 a[178:179], v8 offset:28672
v_cvt_pk_bf16_f32 v40, v40, v41
v_mfma_f32_16x16x32_bf16 v[220:223], a[180:183], v[68:71], v[220:223]
ds_write_b64 v9, v[84:85] offset:1024
v_mfma_f32_16x16x32_bf16 v[252:255], a[180:183], v[72:75], v[252:255]
ds_read_b64_tr_b16 a[180:181], v8 offset:25600
v_mfma_f32_16x16x32_bf16 v[128:131], a[184:187], v[52:55], v[128:131]
v_exp_f32 v42, v42
v_mfma_f32_16x16x32_bf16 v[160:163], a[184:187], v[56:59], v[160:163]
ds_read_b64_tr_b16 a[182:183], v8 offset:29696
v_mfma_f32_16x16x32_bf16 v[192:195], a[184:187], v[68:71], v[192:195]
v_exp_f32 v43, v43
v_mfma_f32_16x16x32_bf16 v[224:227], a[184:187], v[72:75], v[224:227]
v_exp_f32 v16, v16
v_mfma_f32_16x16x32_bf16 v[88:91], a[184:187], a[232:235], v[88:91]
v_exp_f32 v17, v17
v_mfma_f32_16x16x32_bf16 v[96:99], a[184:187], a[236:239], v[96:99]
ds_read_b64_tr_b16 a[184:185], v5 offset:24576
v_cvt_pk_bf16_f32 v22, v16, v17
v_smfmac_f32_16x16x64_bf16 a[252:255], a[240:243], a[232:239], v110
ds_read_b64_tr_b16 a[186:187], v5 offset:28672
v_cvt_pk_bf16_f32 v41, v42, v43
v_mfma_f32_16x16x32_bf16 v[144:147], a[188:191], v[52:55], v[144:147]
v_exp_f32 v18, v18
v_mfma_f32_16x16x32_bf16 v[176:179], a[188:191], v[56:59], v[176:179]
v_exp_f32 v19, v19
v_mfma_f32_16x16x32_bf16 v[208:211], a[188:191], v[68:71], v[208:211]
v_exp_f32 v28, v28
v_mfma_f32_16x16x32_bf16 v[240:243], a[188:191], v[72:75], v[240:243]
v_exp_f32 v29, v29
v_mfma_f32_16x16x32_bf16 v[92:95], a[188:191], a[232:235], v[92:95]
v_exp_f32 v30, v30
v_mfma_f32_16x16x32_bf16 v[100:103], a[188:191], a[236:239], v[100:103]
s_waitcnt lgkmcnt(2)
ds_read_b64_tr_b16 a[188:189], v5 offset:25600
v_cvt_pk_bf16_f32 v23, v18, v19
v_mfma_f32_16x16x32_bf16 v[52:55], a[192:195], a[96:99], 0
v_exp_f32 v31, v31
v_mfma_f32_16x16x32_bf16 v[56:59], a[192:195], a[112:115], 0
s_add_u32 m0, s30, 0x10000
s_add_u32 s37, s37, 0x2000
ds_read_b64_tr_b16 a[190:191], v5 offset:29696
v_cvt_pk_bf16_f32 v26, v28, v29
v_mfma_f32_16x16x32_bf16 v[68:71], a[192:195], a[128:131], 0
buffer_load_dwordx4 v11, s[12:15], s37 offen nt lds
v_mfma_f32_16x16x32_bf16 v[72:75], a[192:195], a[144:147], 0
v_exp_f32 v32, v32
v_mfma_f32_16x16x32_bf16 v[52:55], a[196:199], a[100:103], v[52:55]
v_exp_f32 v33, v33
v_mfma_f32_16x16x32_bf16 v[56:59], a[196:199], a[116:119], v[56:59]
v_exp_f32 v34, v34
v_mfma_f32_16x16x32_bf16 v[68:71], a[196:199], a[132:135], v[68:71]
v_exp_f32 v35, v35
v_mfma_f32_16x16x32_bf16 v[72:75], a[196:199], a[148:151], v[72:75]
v_exp_f32 v44, v44
v_mfma_f32_16x16x32_bf16 v[52:55], a[200:203], a[104:107], v[52:55]
v_exp_f32 v45, v45
v_mfma_f32_16x16x32_bf16 v[56:59], a[200:203], a[120:123], v[56:59]
v_exp_f32 v46, v46
v_mfma_f32_16x16x32_bf16 v[68:71], a[200:203], a[136:139], v[68:71]
v_exp_f32 v47, v47
v_mfma_f32_16x16x32_bf16 v[72:75], a[200:203], a[152:155], v[72:75]
v_cvt_pk_bf16_f32 v27, v30, v31
v_cvt_pk_bf16_f32 v38, v32, v33
v_mfma_f32_16x16x32_bf16 v[52:55], a[204:207], a[108:111], v[52:55]
v_cvt_pk_bf16_f32 v39, v34, v35
v_cvt_pk_bf16_f32 v42, v44, v45
v_mfma_f32_16x16x32_bf16 v[56:59], a[204:207], a[124:127], v[56:59]
v_cvt_pk_bf16_f32 v43, v46, v47
v_mfma_f32_16x16x32_bf16 v[68:71], a[204:207], a[140:143], v[68:71]
v_mfma_f32_16x16x32_bf16 v[72:75], a[204:207], a[156:159], v[72:75]
v_mfma_f32_16x16x32_bf16 v[48:51], a[208:211], a[96:99], 0
v_mfma_f32_16x16x32_bf16 v[60:63], a[208:211], a[112:115], 0
v_exp_f32 v52, v52
v_mfma_f32_16x16x32_bf16 v[64:67], a[208:211], a[128:131], 0
v_exp_f32 v53, v53
v_mfma_f32_16x16x32_bf16 v[76:79], a[208:211], a[144:147], 0
v_exp_f32 v54, v54
v_mfma_f32_16x16x32_bf16 v[48:51], a[212:215], a[100:103], v[48:51]
buffer_load_dwordx4 v11, s[12:15], s37 offen offset:2048 nt lds
v_mfma_f32_16x16x32_bf16 v[60:63], a[212:215], a[116:119], v[60:63]
v_exp_f32 v55, v55
v_mfma_f32_16x16x32_bf16 v[64:67], a[212:215], a[132:135], v[64:67]
v_exp_f32 v56, v56
v_mfma_f32_16x16x32_bf16 v[76:79], a[212:215], a[148:151], v[76:79]
v_exp_f32 v57, v57
v_mfma_f32_16x16x32_bf16 v[48:51], a[216:219], a[104:107], v[48:51]
v_exp_f32 v58, v58
v_mfma_f32_16x16x32_bf16 v[60:63], a[216:219], a[120:123], v[60:63]
v_exp_f32 v59, v59
v_mfma_f32_16x16x32_bf16 v[64:67], a[216:219], a[136:139], v[64:67]
v_exp_f32 v68, v68
v_mfma_f32_16x16x32_bf16 v[76:79], a[216:219], a[152:155], v[76:79]
v_exp_f32 v69, v69
v_mfma_f32_16x16x32_bf16 v[48:51], a[220:223], a[108:111], v[48:51]
v_exp_f32 v70, v70
v_mfma_f32_16x16x32_bf16 v[60:63], a[220:223], a[124:127], v[60:63]
v_exp_f32 v71, v71
v_mfma_f32_16x16x32_bf16 v[64:67], a[220:223], a[140:143], v[64:67]
v_cvt_pk_bf16_f32 v52, v52, v53
v_cvt_pk_bf16_f32 v53, v54, v55
v_mfma_f32_16x16x32_bf16 v[76:79], a[220:223], a[156:159], v[76:79]
s_waitcnt vmcnt(10) lgkmcnt(0)
s_barrier
ds_read_b128 a[224:227], v10 offset:0
v_mfma_f32_16x16x32_bf16 v[132:135], a[160:163], v[20:23], v[132:135]
v_exp_f32 v72, v72
v_mfma_f32_16x16x32_bf16 v[164:167], a[160:163], v[24:27], v[164:167]
ds_read_b128 a[228:231], v10 offset:1024
v_cvt_pk_bf16_f32 v56, v56, v57
v_mfma_f32_16x16x32_bf16 v[196:199], a[160:163], v[36:39], v[196:199]
v_exp_f32 v73, v73
v_mfma_f32_16x16x32_bf16 v[228:231], a[160:163], v[40:43], v[228:231]
ds_read_b128 a[192:195], v1 offset:32768
v_cvt_pk_bf16_f32 v57, v58, v59
v_mfma_f32_16x16x32_bf16 v[148:151], a[164:167], v[20:23], v[148:151]
v_exp_f32 v74, v74
v_mfma_f32_16x16x32_bf16 v[180:183], a[164:167], v[24:27], v[180:183]
s_add_u32 m0, s30, 0x0
s_add_u32 s21, s21, 0x2000
ds_read_b128 a[196:199], v2 offset:32768
v_cvt_pk_bf16_f32 v68, v68, v69
v_mfma_f32_16x16x32_bf16 v[212:215], a[164:167], v[36:39], v[212:215]
buffer_load_dwordx4 v11, s[8:11], s21 offen nt lds
v_mfma_f32_16x16x32_bf16 v[244:247], a[164:167], v[40:43], v[244:247]
ds_read_b128 a[200:203], v1 offset:33792
v_cvt_pk_bf16_f32 v69, v70, v71
v_smfmac_f32_16x16x64_bf16 a[244:247], a[240:243], v[20:27], v110
ds_read_b128 a[204:207], v2 offset:33792
v_cvt_pk_bf16_f32 v72, v72, v73
v_mfma_f32_16x16x32_bf16 v[136:139], a[168:171], v[20:23], v[136:139]
v_exp_f32 v75, v75
v_mfma_f32_16x16x32_bf16 v[168:171], a[168:171], v[24:27], v[168:171]
ds_read_b128 a[208:211], v1 offset:36864
v_cvt_pk_bf16_f32 v73, v74, v75
v_mfma_f32_16x16x32_bf16 v[200:203], a[168:171], v[36:39], v[200:203]
v_exp_f32 v48, v48
v_mfma_f32_16x16x32_bf16 v[232:235], a[168:171], v[40:43], v[232:235]
ds_read_b128 a[212:215], v2 offset:36864
v_mfma_f32_16x16x32_bf16 v[152:155], a[172:175], v[20:23], v[152:155]
v_exp_f32 v49, v49
v_mfma_f32_16x16x32_bf16 v[184:187], a[172:175], v[24:27], v[184:187]
ds_read_b128 a[216:219], v1 offset:37888
v_cvt_pk_bf16_f32 v54, v48, v49
v_mfma_f32_16x16x32_bf16 v[216:219], a[172:175], v[36:39], v[216:219]
v_exp_f32 v50, v50
v_mfma_f32_16x16x32_bf16 v[248:251], a[172:175], v[40:43], v[248:251]
ds_read_b128 a[220:223], v2 offset:37888
v_smfmac_f32_16x16x64_bf16 a[248:251], a[240:243], v[36:43], v110
ds_read_b128 a[232:235], v3 offset:32768
v_mfma_f32_16x16x32_bf16 v[140:143], a[176:179], v[20:23], v[140:143]
v_exp_f32 v51, v51
v_mfma_f32_16x16x32_bf16 v[172:175], a[176:179], v[24:27], v[172:175]
ds_read_b128 a[236:239], v4 offset:32768
v_cvt_pk_bf16_f32 v55, v50, v51
v_mfma_f32_16x16x32_bf16 v[204:207], a[176:179], v[36:39], v[204:207]
buffer_load_dwordx4 v11, s[8:11], s21 offen offset:2048 nt lds
v_mfma_f32_16x16x32_bf16 v[236:239], a[176:179], v[40:43], v[236:239]
ds_read_b64_tr_b16 a[160:161], v6 offset:32768
v_mfma_f32_16x16x32_bf16 v[156:159], a[180:183], v[20:23], v[156:159]
v_exp_f32 v60, v60
v_mfma_f32_16x16x32_bf16 v[188:191], a[180:183], v[24:27], v[188:191]
ds_read_b64_tr_b16 a[162:163], v6 offset:36864
v_mfma_f32_16x16x32_bf16 v[220:223], a[180:183], v[36:39], v[220:223]
v_exp_f32 v61, v61
v_mfma_f32_16x16x32_bf16 v[252:255], a[180:183], v[40:43], v[252:255]
ds_read_b64_tr_b16 a[164:165], v6 offset:33792
v_cvt_pk_bf16_f32 v58, v60, v61
v_mfma_f32_16x16x32_bf16 v[128:131], a[184:187], v[20:23], v[128:131]
v_exp_f32 v62, v62
v_mfma_f32_16x16x32_bf16 v[160:163], a[184:187], v[24:27], v[160:163]
s_waitcnt lgkmcnt(5)
ds_read_b64_tr_b16 a[166:167], v6 offset:37888
v_mfma_f32_16x16x32_bf16 v[192:195], a[184:187], v[36:39], v[192:195]
v_exp_f32 v63, v63
v_mfma_f32_16x16x32_bf16 v[224:227], a[184:187], v[40:43], v[224:227]
ds_read_b64_tr_b16 a[168:169], v7 offset:32768
v_cvt_pk_bf16_f32 v59, v62, v63
v_mfma_f32_16x16x32_bf16 v[88:91], a[184:187], a[224:227], v[88:91]
v_exp_f32 v64, v64
v_mfma_f32_16x16x32_bf16 v[96:99], a[184:187], a[228:231], v[96:99]
ds_read_b64_tr_b16 a[170:171], v7 offset:36864
v_smfmac_f32_16x16x64_bf16 a[252:255], a[240:243], a[224:231], v110
ds_read_b64_tr_b16 a[172:173], v7 offset:33792
v_mfma_f32_16x16x32_bf16 v[144:147], a[188:191], v[20:23], v[144:147]
v_exp_f32 v65, v65
v_mfma_f32_16x16x32_bf16 v[176:179], a[188:191], v[24:27], v[176:179]
s_add_u32 m0, s30, 0x12000
s_add_u32 s37, s37, 0x2000
ds_read_b64_tr_b16 a[174:175], v7 offset:37888
v_cvt_pk_bf16_f32 v70, v64, v65
v_mfma_f32_16x16x32_bf16 v[208:211], a[188:191], v[36:39], v[208:211]
buffer_load_dwordx4 v11, s[12:15], s37 offen nt lds
v_mfma_f32_16x16x32_bf16 v[240:243], a[188:191], v[40:43], v[240:243]
ds_read_b64_tr_b16 a[176:177], v8 offset:32768
v_mfma_f32_16x16x32_bf16 v[92:95], a[188:191], a[224:227], v[92:95]
v_exp_f32 v66, v66
v_mfma_f32_16x16x32_bf16 v[100:103], a[188:191], a[228:231], v[100:103]
ds_read_b128 a[224:227], v3 offset:33792
v_mfma_f32_16x16x32_bf16 v[20:23], a[192:195], a[96:99], 0
v_exp_f32 v67, v67
v_mfma_f32_16x16x32_bf16 v[24:27], a[192:195], a[112:115], 0
ds_read_b128 a[228:231], v4 offset:33792
v_cvt_pk_bf16_f32 v71, v66, v67
v_mfma_f32_16x16x32_bf16 v[36:39], a[192:195], a[128:131], 0
v_exp_f32 v76, v76
v_mfma_f32_16x16x32_bf16 v[40:43], a[192:195], a[144:147], 0
ds_read_b64_tr_b16 a[178:179], v8 offset:36864
v_mfma_f32_16x16x32_bf16 v[20:23], a[196:199], a[100:103], v[20:23]
v_exp_f32 v77, v77
v_mfma_f32_16x16x32_bf16 v[24:27], a[196:199], a[116:119], v[24:27]
ds_read_b64_tr_b16 a[180:181], v8 offset:33792
v_cvt_pk_bf16_f32 v74, v76, v77
v_mfma_f32_16x16x32_bf16 v[36:39], a[196:199], a[132:135], v[36:39]
v_exp_f32 v78, v78
v_mfma_f32_16x16x32_bf16 v[40:43], a[196:199], a[148:151], v[40:43]
s_waitcnt lgkmcnt(5)
ds_read_b64_tr_b16 a[182:183], v8 offset:37888
v_mfma_f32_16x16x32_bf16 v[20:23], a[200:203], a[104:107], v[20:23]
v_exp_f32 v79, v79
v_mfma_f32_16x16x32_bf16 v[24:27], a[200:203], a[120:123], v[24:27]
ds_read_b64_tr_b16 a[184:185], v5 offset:32768
v_cvt_pk_bf16_f32 v75, v78, v79
v_mfma_f32_16x16x32_bf16 v[36:39], a[200:203], a[136:139], v[36:39]
v_mfma_f32_16x16x32_bf16 v[40:43], a[200:203], a[152:155], v[40:43]
buffer_load_dwordx4 v11, s[12:15], s37 offen offset:2048 nt lds
v_mfma_f32_16x16x32_bf16 v[20:23], a[204:207], a[108:111], v[20:23]
ds_read_b64_tr_b16 a[186:187], v5 offset:36864
v_mfma_f32_16x16x32_bf16 v[24:27], a[204:207], a[124:127], v[24:27]
v_mfma_f32_16x16x32_bf16 v[36:39], a[204:207], a[140:143], v[36:39]
ds_read_b64_tr_b16 a[188:189], v5 offset:33792
v_mfma_f32_16x16x32_bf16 v[40:43], a[204:207], a[156:159], v[40:43]
v_mfma_f32_16x16x32_bf16 v[16:19], a[208:211], a[96:99], 0
ds_read_b64_tr_b16 a[190:191], v5 offset:37888
v_mfma_f32_16x16x32_bf16 v[28:31], a[208:211], a[112:115], 0
v_exp_f32 v20, v20
v_mfma_f32_16x16x32_bf16 v[32:35], a[208:211], a[128:131], 0
ds_read_b128 a[192:195], v1 offset:40960
v_mfma_f32_16x16x32_bf16 v[44:47], a[208:211], a[144:147], 0
v_exp_f32 v21, v21
v_mfma_f32_16x16x32_bf16 v[16:19], a[212:215], a[100:103], v[16:19]
ds_read_b128 a[196:199], v2 offset:40960
v_cvt_pk_bf16_f32 v20, v20, v21
v_mfma_f32_16x16x32_bf16 v[28:31], a[212:215], a[116:119], v[28:31]
v_exp_f32 v22, v22
v_mfma_f32_16x16x32_bf16 v[32:35], a[212:215], a[132:135], v[32:35]
ds_read_b128 a[200:203], v1 offset:41984
v_mfma_f32_16x16x32_bf16 v[44:47], a[212:215], a[148:151], v[44:47]
v_exp_f32 v23, v23
v_mfma_f32_16x16x32_bf16 v[16:19], a[216:219], a[104:107], v[16:19]
ds_read_b128 a[204:207], v2 offset:41984
v_cvt_pk_bf16_f32 v21, v22, v23
v_mfma_f32_16x16x32_bf16 v[28:31], a[216:219], a[120:123], v[28:31]
s_add_u32 m0, s30, 0x2000
s_add_u32 s21, s21, 0x2000
v_exp_f32 v24, v24
v_mfma_f32_16x16x32_bf16 v[32:35], a[216:219], a[136:139], v[32:35]
buffer_load_dwordx4 v11, s[8:11], s21 offen nt lds
v_mfma_f32_16x16x32_bf16 v[44:47], a[216:219], a[152:155], v[44:47]
ds_read_b128 a[208:211], v1 offset:45056
v_mfma_f32_16x16x32_bf16 v[16:19], a[220:223], a[108:111], v[16:19]
v_exp_f32 v25, v25
v_mfma_f32_16x16x32_bf16 v[28:31], a[220:223], a[124:127], v[28:31]
s_waitcnt lgkmcnt(4)
ds_read_b128 a[212:215], v2 offset:45056
v_cvt_pk_bf16_f32 v24, v24, v25
v_mfma_f32_16x16x32_bf16 v[32:35], a[220:223], a[140:143], v[32:35]
v_exp_f32 v26, v26
v_mfma_f32_16x16x32_bf16 v[44:47], a[220:223], a[156:159], v[44:47]
ds_read_b128 a[216:219], v1 offset:46080
v_mfma_f32_16x16x32_bf16 v[80:83], a[232:235], a[64:67], 0
v_exp_f32 v27, v27
v_mfma_f32_16x16x32_bf16 v[84:87], a[232:235], a[80:83], 0
ds_read_b128 a[232:235], v10 offset:2048
v_cvt_pk_bf16_f32 v25, v26, v27
v_mfma_f32_16x16x32_bf16 v[80:83], a[236:239], a[68:71], v[80:83]
v_exp_f32 v36, v36
v_mfma_f32_16x16x32_bf16 v[84:87], a[236:239], a[84:87], v[84:87]
ds_read_b128 a[236:239], v10 offset:3072
v_mfma_f32_16x16x32_bf16 v[80:83], a[224:227], a[72:75], v[80:83]
v_exp_f32 v37, v37
v_mfma_f32_16x16x32_bf16 v[84:87], a[224:227], a[88:91], v[84:87]
ds_read_b128 a[220:223], v2 offset:46080
v_cvt_pk_bf16_f32 v36, v36, v37
v_mfma_f32_16x16x32_bf16 v[80:83], a[228:231], a[76:79], v[80:83]
v_exp_f32 v38, v38
v_mfma_f32_16x16x32_bf16 v[84:87], a[228:231], a[92:95], v[84:87]
v_exp_f32 v39, v39
v_mfma_f32_16x16x32_bf16 v[132:135], a[160:163], v[52:55], v[132:135]
v_exp_f32 v40, v40
v_mfma_f32_16x16x32_bf16 v[164:167], a[160:163], v[56:59], v[164:167]
buffer_load_dwordx4 v11, s[8:11], s21 offen offset:2048 nt lds
v_mfma_f32_16x16x32_bf16 v[196:199], a[160:163], v[68:71], v[196:199]
v_exp_f32 v80, v80
v_mfma_f32_16x16x32_bf16 v[228:231], a[160:163], v[72:75], v[228:231]
ds_read_b64_tr_b16 a[160:161], v6 offset:40960
v_cvt_pk_bf16_f32 v37, v38, v39
v_mfma_f32_16x16x32_bf16 v[148:151], a[164:167], v[52:55], v[148:151]
v_exp_f32 v81, v81
v_mfma_f32_16x16x32_bf16 v[180:183], a[164:167], v[56:59], v[180:183]
ds_read_b64_tr_b16 a[162:163], v6 offset:45056
v_cvt_pk_bf16_f32 v80, v80, v81
v_mfma_f32_16x16x32_bf16 v[212:215], a[164:167], v[68:71], v[212:215]
v_exp_f32 v82, v82
v_mfma_f32_16x16x32_bf16 v[244:247], a[164:167], v[72:75], v[244:247]
ds_read_b64_tr_b16 a[164:165], v6 offset:41984
v_smfmac_f32_16x16x64_bf16 a[244:247], a[240:243], v[52:59], v110
ds_read_b64_tr_b16 a[166:167], v6 offset:46080
v_mfma_f32_16x16x32_bf16 v[136:139], a[168:171], v[52:55], v[136:139]
v_exp_f32 v83, v83
v_mfma_f32_16x16x32_bf16 v[168:171], a[168:171], v[56:59], v[168:171]
v_exp_f32 v84, v84
v_mfma_f32_16x16x32_bf16 v[200:203], a[168:171], v[68:71], v[200:203]
v_exp_f32 v85, v85
v_mfma_f32_16x16x32_bf16 v[232:235], a[168:171], v[72:75], v[232:235]
ds_read_b64_tr_b16 a[168:169], v7 offset:40960
v_cvt_pk_bf16_f32 v81, v82, v83
v_mfma_f32_16x16x32_bf16 v[152:155], a[172:175], v[52:55], v[152:155]
ds_write_b64 v9, v[80:81] offset:4096
v_cvt_pk_bf16_f32 v84, v84, v85
v_mfma_f32_16x16x32_bf16 v[184:187], a[172:175], v[56:59], v[184:187]
s_waitcnt lgkmcnt(5)
ds_read_b64_tr_b16 a[170:171], v7 offset:45056
v_mfma_f32_16x16x32_bf16 v[216:219], a[172:175], v[68:71], v[216:219]
s_add_u32 m0, s30, 0x14000
s_add_u32 s37, s37, 0x2000
v_exp_f32 v86, v86
v_mfma_f32_16x16x32_bf16 v[248:251], a[172:175], v[72:75], v[248:251]
buffer_load_dwordx4 v11, s[12:15], s37 offen nt lds
v_smfmac_f32_16x16x64_bf16 a[248:251], a[240:243], v[68:75], v110
ds_read_b64_tr_b16 a[172:173], v7 offset:41984
v_mfma_f32_16x16x32_bf16 v[140:143], a[176:179], v[52:55], v[140:143]
v_exp_f32 v87, v87
v_mfma_f32_16x16x32_bf16 v[172:175], a[176:179], v[56:59], v[172:175]
ds_read_b64_tr_b16 a[174:175], v7 offset:46080
v_cvt_pk_bf16_f32 v85, v86, v87
v_mfma_f32_16x16x32_bf16 v[204:207], a[176:179], v[68:71], v[204:207]
ds_write_b64 v9, v[84:85] offset:5120
v_mfma_f32_16x16x32_bf16 v[236:239], a[176:179], v[72:75], v[236:239]
ds_read_b64_tr_b16 a[176:177], v8 offset:40960
v_mfma_f32_16x16x32_bf16 v[156:159], a[180:183], v[52:55], v[156:159]
v_exp_f32 v41, v41
v_mfma_f32_16x16x32_bf16 v[188:191], a[180:183], v[56:59], v[188:191]
ds_read_b64_tr_b16 a[178:179], v8 offset:45056
v_cvt_pk_bf16_f32 v40, v40, v41
v_mfma_f32_16x16x32_bf16 v[220:223], a[180:183], v[68:71], v[220:223]
v_exp_f32 v42, v42
v_mfma_f32_16x16x32_bf16 v[252:255], a[180:183], v[72:75], v[252:255]
ds_read_b64_tr_b16 a[180:181], v8 offset:41984
v_mfma_f32_16x16x32_bf16 v[128:131], a[184:187], v[52:55], v[128:131]
v_exp_f32 v43, v43
v_mfma_f32_16x16x32_bf16 v[160:163], a[184:187], v[56:59], v[160:163]
ds_read_b64_tr_b16 a[182:183], v8 offset:46080
v_cvt_pk_bf16_f32 v41, v42, v43
v_mfma_f32_16x16x32_bf16 v[192:195], a[184:187], v[68:71], v[192:195]
v_exp_f32 v16, v16
v_mfma_f32_16x16x32_bf16 v[224:227], a[184:187], v[72:75], v[224:227]
v_exp_f32 v17, v17
v_mfma_f32_16x16x32_bf16 v[88:91], a[184:187], a[232:235], v[88:91]
v_exp_f32 v18, v18
v_mfma_f32_16x16x32_bf16 v[96:99], a[184:187], a[236:239], v[96:99]
buffer_load_dwordx4 v11, s[12:15], s37 offen offset:2048 nt lds
v_smfmac_f32_16x16x64_bf16 a[252:255], a[240:243], a[232:239], v110
ds_read_b64_tr_b16 a[184:185], v5 offset:40960
v_cvt_pk_bf16_f32 v22, v16, v17
v_mfma_f32_16x16x32_bf16 v[144:147], a[188:191], v[52:55], v[144:147]
v_exp_f32 v19, v19
v_mfma_f32_16x16x32_bf16 v[176:179], a[188:191], v[56:59], v[176:179]
ds_read_b64_tr_b16 a[186:187], v5 offset:45056
v_cvt_pk_bf16_f32 v23, v18, v19
v_mfma_f32_16x16x32_bf16 v[208:211], a[188:191], v[68:71], v[208:211]
v_exp_f32 v28, v28
v_mfma_f32_16x16x32_bf16 v[240:243], a[188:191], v[72:75], v[240:243]
v_exp_f32 v29, v29
v_mfma_f32_16x16x32_bf16 v[92:95], a[188:191], a[232:235], v[92:95]
v_exp_f32 v30, v30
v_mfma_f32_16x16x32_bf16 v[100:103], a[188:191], a[236:239], v[100:103]
s_waitcnt lgkmcnt(2)
ds_read_b64_tr_b16 a[188:189], v5 offset:41984
v_cvt_pk_bf16_f32 v26, v28, v29
v_mfma_f32_16x16x32_bf16 v[52:55], a[192:195], a[96:99], 0
v_exp_f32 v31, v31
v_mfma_f32_16x16x32_bf16 v[56:59], a[192:195], a[112:115], 0
ds_read_b64_tr_b16 a[190:191], v5 offset:46080
v_cvt_pk_bf16_f32 v27, v30, v31
v_mfma_f32_16x16x32_bf16 v[68:71], a[192:195], a[128:131], 0
v_exp_f32 v32, v32
v_mfma_f32_16x16x32_bf16 v[72:75], a[192:195], a[144:147], 0
v_exp_f32 v33, v33
v_mfma_f32_16x16x32_bf16 v[52:55], a[196:199], a[100:103], v[52:55]
v_exp_f32 v34, v34
v_mfma_f32_16x16x32_bf16 v[56:59], a[196:199], a[116:119], v[56:59]
v_exp_f32 v35, v35
v_mfma_f32_16x16x32_bf16 v[68:71], a[196:199], a[132:135], v[68:71]
s_add_u32 m0, s30, 0x4000
s_add_u32 s21, s21, 0x2000
v_exp_f32 v44, v44
v_mfma_f32_16x16x32_bf16 v[72:75], a[196:199], a[148:151], v[72:75]
buffer_load_dwordx4 v11, s[8:11], s21 offen nt lds
v_mfma_f32_16x16x32_bf16 v[52:55], a[200:203], a[104:107], v[52:55]
v_exp_f32 v45, v45
v_mfma_f32_16x16x32_bf16 v[56:59], a[200:203], a[120:123], v[56:59]
v_exp_f32 v46, v46
v_mfma_f32_16x16x32_bf16 v[68:71], a[200:203], a[136:139], v[68:71]
v_exp_f32 v47, v47
v_mfma_f32_16x16x32_bf16 v[72:75], a[200:203], a[152:155], v[72:75]
v_cvt_pk_bf16_f32 v38, v32, v33
v_cvt_pk_bf16_f32 v39, v34, v35
v_mfma_f32_16x16x32_bf16 v[52:55], a[204:207], a[108:111], v[52:55]
v_cvt_pk_bf16_f32 v42, v44, v45
v_cvt_pk_bf16_f32 v43, v46, v47
v_mfma_f32_16x16x32_bf16 v[56:59], a[204:207], a[124:127], v[56:59]
v_mfma_f32_16x16x32_bf16 v[68:71], a[204:207], a[140:143], v[68:71]
v_mfma_f32_16x16x32_bf16 v[72:75], a[204:207], a[156:159], v[72:75]
v_mfma_f32_16x16x32_bf16 v[48:51], a[208:211], a[96:99], 0
v_mfma_f32_16x16x32_bf16 v[60:63], a[208:211], a[112:115], 0
v_mfma_f32_16x16x32_bf16 v[64:67], a[208:211], a[128:131], 0
v_exp_f32 v52, v52
v_mfma_f32_16x16x32_bf16 v[76:79], a[208:211], a[144:147], 0
v_exp_f32 v53, v53
v_mfma_f32_16x16x32_bf16 v[48:51], a[212:215], a[100:103], v[48:51]
v_exp_f32 v54, v54
v_mfma_f32_16x16x32_bf16 v[60:63], a[212:215], a[116:119], v[60:63]
v_exp_f32 v55, v55
v_mfma_f32_16x16x32_bf16 v[64:67], a[212:215], a[132:135], v[64:67]
buffer_load_dwordx4 v11, s[8:11], s21 offen offset:2048 nt lds
v_mfma_f32_16x16x32_bf16 v[76:79], a[212:215], a[148:151], v[76:79]
v_exp_f32 v56, v56
v_mfma_f32_16x16x32_bf16 v[48:51], a[216:219], a[104:107], v[48:51]
v_exp_f32 v57, v57
v_mfma_f32_16x16x32_bf16 v[60:63], a[216:219], a[120:123], v[60:63]
v_exp_f32 v58, v58
v_mfma_f32_16x16x32_bf16 v[64:67], a[216:219], a[136:139], v[64:67]
v_exp_f32 v59, v59
v_mfma_f32_16x16x32_bf16 v[76:79], a[216:219], a[152:155], v[76:79]
v_exp_f32 v68, v68
v_mfma_f32_16x16x32_bf16 v[48:51], a[220:223], a[108:111], v[48:51]
v_exp_f32 v69, v69
v_mfma_f32_16x16x32_bf16 v[60:63], a[220:223], a[124:127], v[60:63]
v_exp_f32 v70, v70
v_mfma_f32_16x16x32_bf16 v[64:67], a[220:223], a[140:143], v[64:67]
v_exp_f32 v71, v71
v_mfma_f32_16x16x32_bf16 v[76:79], a[220:223], a[156:159], v[76:79]
s_waitcnt vmcnt(12) lgkmcnt(0)
s_barrier
ds_read_b128 a[224:227], v10 offset:4096
v_mfma_f32_16x16x32_bf16 v[132:135], a[160:163], v[20:23], v[132:135]
v_cvt_pk_bf16_f32 v52, v52, v53
v_cvt_pk_bf16_f32 v53, v54, v55
v_mfma_f32_16x16x32_bf16 v[164:167], a[160:163], v[24:27], v[164:167]
ds_read_b128 a[228:231], v10 offset:5120
v_cvt_pk_bf16_f32 v56, v56, v57
v_mfma_f32_16x16x32_bf16 v[196:199], a[160:163], v[36:39], v[196:199]
v_exp_f32 v72, v72
v_mfma_f32_16x16x32_bf16 v[228:231], a[160:163], v[40:43], v[228:231]
ds_read_b128 a[192:195], v1 offset:49152
v_cvt_pk_bf16_f32 v57, v58, v59
v_mfma_f32_16x16x32_bf16 v[148:151], a[164:167], v[20:23], v[148:151]
v_exp_f32 v73, v73
v_mfma_f32_16x16x32_bf16 v[180:183], a[164:167], v[24:27], v[180:183]
s_add_u32 m0, s30, 0x16000
s_add_u32 s37, s37, 0x2000
ds_read_b128 a[196:199], v2 offset:49152
v_cvt_pk_bf16_f32 v68, v68, v69
v_mfma_f32_16x16x32_bf16 v[212:215], a[164:167], v[36:39], v[212:215]
buffer_load_dwordx4 v11, s[12:15], s37 offen nt lds
v_mfma_f32_16x16x32_bf16 v[244:247], a[164:167], v[40:43], v[244:247]
ds_read_b128 a[200:203], v1 offset:50176
v_cvt_pk_bf16_f32 v69, v70, v71
v_smfmac_f32_16x16x64_bf16 a[244:247], a[240:243], v[20:27], v110
ds_read_b128 a[204:207], v2 offset:50176
v_cvt_pk_bf16_f32 v72, v72, v73
v_mfma_f32_16x16x32_bf16 v[136:139], a[168:171], v[20:23], v[136:139]
v_exp_f32 v74, v74
v_mfma_f32_16x16x32_bf16 v[168:171], a[168:171], v[24:27], v[168:171]
ds_read_b128 a[208:211], v1 offset:53248
v_mfma_f32_16x16x32_bf16 v[200:203], a[168:171], v[36:39], v[200:203]
v_exp_f32 v75, v75
v_mfma_f32_16x16x32_bf16 v[232:235], a[168:171], v[40:43], v[232:235]
ds_read_b128 a[212:215], v2 offset:53248
v_cvt_pk_bf16_f32 v73, v74, v75
v_mfma_f32_16x16x32_bf16 v[152:155], a[172:175], v[20:23], v[152:155]
v_exp_f32 v48, v48
v_mfma_f32_16x16x32_bf16 v[184:187], a[172:175], v[24:27], v[184:187]
ds_read_b128 a[216:219], v1 offset:54272
v_mfma_f32_16x16x32_bf16 v[216:219], a[172:175], v[36:39], v[216:219]
v_exp_f32 v49, v49
v_mfma_f32_16x16x32_bf16 v[248:251], a[172:175], v[40:43], v[248:251]
ds_read_b128 a[220:223], v2 offset:54272
v_cvt_pk_bf16_f32 v54, v48, v49
v_smfmac_f32_16x16x64_bf16 a[248:251], a[240:243], v[36:43], v110
ds_read_b128 a[232:235], v3 offset:49152
v_mfma_f32_16x16x32_bf16 v[140:143], a[176:179], v[20:23], v[140:143]
v_exp_f32 v50, v50
v_mfma_f32_16x16x32_bf16 v[172:175], a[176:179], v[24:27], v[172:175]
ds_read_b128 a[236:239], v4 offset:49152
v_mfma_f32_16x16x32_bf16 v[204:207], a[176:179], v[36:39], v[204:207]
v_exp_f32 v51, v51
v_mfma_f32_16x16x32_bf16 v[236:239], a[176:179], v[40:43], v[236:239]
ds_read_b64_tr_b16 a[160:161], v6 offset:49152
v_cvt_pk_bf16_f32 v55, v50, v51
v_mfma_f32_16x16x32_bf16 v[156:159], a[180:183], v[20:23], v[156:159]
v_exp_f32 v60, v60
v_mfma_f32_16x16x32_bf16 v[188:191], a[180:183], v[24:27], v[188:191]
ds_read_b64_tr_b16 a[162:163], v6 offset:53248
v_mfma_f32_16x16x32_bf16 v[220:223], a[180:183], v[36:39], v[220:223]
v_exp_f32 v61, v61
v_mfma_f32_16x16x32_bf16 v[252:255], a[180:183], v[40:43], v[252:255]
buffer_load_dwordx4 v11, s[12:15], s37 offen offset:2048 nt lds
v_mfma_f32_16x16x32_bf16 v[128:131], a[184:187], v[20:23], v[128:131]
ds_read_b64_tr_b16 a[164:165], v6 offset:50176
v_cvt_pk_bf16_f32 v58, v60, v61
v_mfma_f32_16x16x32_bf16 v[160:163], a[184:187], v[24:27], v[160:163]
v_exp_f32 v62, v62
v_mfma_f32_16x16x32_bf16 v[192:195], a[184:187], v[36:39], v[192:195]
s_waitcnt lgkmcnt(4)
ds_read_b64_tr_b16 a[166:167], v6 offset:54272
v_mfma_f32_16x16x32_bf16 v[224:227], a[184:187], v[40:43], v[224:227]
v_exp_f32 v63, v63
v_mfma_f32_16x16x32_bf16 v[88:91], a[184:187], a[224:227], v[88:91]
ds_read_b64_tr_b16 a[168:169], v7 offset:49152
v_cvt_pk_bf16_f32 v59, v62, v63
v_mfma_f32_16x16x32_bf16 v[96:99], a[184:187], a[228:231], v[96:99]
v_exp_f32 v64, v64
v_smfmac_f32_16x16x64_bf16 a[252:255], a[240:243], a[224:231], v110
ds_read_b64_tr_b16 a[170:171], v7 offset:53248
v_mfma_f32_16x16x32_bf16 v[144:147], a[188:191], v[20:23], v[144:147]
v_exp_f32 v65, v65
v_mfma_f32_16x16x32_bf16 v[176:179], a[188:191], v[24:27], v[176:179]
ds_read_b64_tr_b16 a[172:173], v7 offset:50176
v_cvt_pk_bf16_f32 v70, v64, v65
v_mfma_f32_16x16x32_bf16 v[208:211], a[188:191], v[36:39], v[208:211]
v_exp_f32 v66, v66
v_mfma_f32_16x16x32_bf16 v[240:243], a[188:191], v[40:43], v[240:243]
ds_read_b64_tr_b16 a[174:175], v7 offset:54272
v_mfma_f32_16x16x32_bf16 v[92:95], a[188:191], a[224:227], v[92:95]
v_exp_f32 v67, v67
v_mfma_f32_16x16x32_bf16 v[100:103], a[188:191], a[228:231], v[100:103]
ds_read_b128 a[224:227], v3 offset:50176
v_cvt_pk_bf16_f32 v71, v66, v67
v_mfma_f32_16x16x32_bf16 v[20:23], a[192:195], a[96:99], 0
v_exp_f32 v76, v76
v_mfma_f32_16x16x32_bf16 v[24:27], a[192:195], a[112:115], 0
ds_read_b128 a[228:231], v4 offset:50176
v_mfma_f32_16x16x32_bf16 v[36:39], a[192:195], a[128:131], 0
v_exp_f32 v77, v77
v_mfma_f32_16x16x32_bf16 v[40:43], a[192:195], a[144:147], 0
ds_read_b64_tr_b16 a[176:177], v8 offset:49152
v_cvt_pk_bf16_f32 v74, v76, v77
v_mfma_f32_16x16x32_bf16 v[20:23], a[196:199], a[100:103], v[20:23]
s_add_u32 m0, s30, 0x6000
s_add_u32 s21, s21, 0x2000
v_exp_f32 v78, v78
v_mfma_f32_16x16x32_bf16 v[24:27], a[196:199], a[116:119], v[24:27]
buffer_load_dwordx4 v11, s[8:11], s21 offen nt lds
v_mfma_f32_16x16x32_bf16 v[36:39], a[196:199], a[132:135], v[36:39]
ds_read_b64_tr_b16 a[178:179], v8 offset:53248
v_mfma_f32_16x16x32_bf16 v[40:43], a[196:199], a[148:151], v[40:43]
v_exp_f32 v79, v79
v_mfma_f32_16x16x32_bf16 v[20:23], a[200:203], a[104:107], v[20:23]
ds_read_b64_tr_b16 a[180:181], v8 offset:50176
v_cvt_pk_bf16_f32 v75, v78, v79
v_mfma_f32_16x16x32_bf16 v[24:27], a[200:203], a[120:123], v[24:27]
v_mfma_f32_16x16x32_bf16 v[36:39], a[200:203], a[136:139], v[36:39]
ds_read_b64_tr_b16 a[182:183], v8 offset:54272
v_mfma_f32_16x16x32_bf16 v[40:43], a[200:203], a[152:155], v[40:43]
v_mfma_f32_16x16x32_bf16 v[20:23], a[204:207], a[108:111], v[20:23]
s_waitcnt lgkmcnt(4)
ds_read_b64_tr_b16 a[184:185], v5 offset:49152
v_mfma_f32_16x16x32_bf16 v[24:27], a[204:207], a[124:127], v[24:27]
v_mfma_f32_16x16x32_bf16 v[36:39], a[204:207], a[140:143], v[36:39]
ds_read_b64_tr_b16 a[186:187], v5 offset:53248
v_mfma_f32_16x16x32_bf16 v[40:43], a[204:207], a[156:159], v[40:43]
v_mfma_f32_16x16x32_bf16 v[16:19], a[208:211], a[96:99], 0
ds_read_b64_tr_b16 a[188:189], v5 offset:50176
v_mfma_f32_16x16x32_bf16 v[28:31], a[208:211], a[112:115], 0
v_exp_f32 v20, v20
v_mfma_f32_16x16x32_bf16 v[32:35], a[208:211], a[128:131], 0
ds_read_b64_tr_b16 a[190:191], v5 offset:54272
v_mfma_f32_16x16x32_bf16 v[44:47], a[208:211], a[144:147], 0
v_exp_f32 v21, v21
v_mfma_f32_16x16x32_bf16 v[16:19], a[212:215], a[100:103], v[16:19]
ds_read_b128 a[192:195], v1 offset:57344
v_cvt_pk_bf16_f32 v20, v20, v21
v_mfma_f32_16x16x32_bf16 v[28:31], a[212:215], a[116:119], v[28:31]
v_exp_f32 v22, v22
v_mfma_f32_16x16x32_bf16 v[32:35], a[212:215], a[132:135], v[32:35]
ds_read_b128 a[196:199], v2 offset:57344
v_mfma_f32_16x16x32_bf16 v[44:47], a[212:215], a[148:151], v[44:47]
v_exp_f32 v23, v23
v_mfma_f32_16x16x32_bf16 v[16:19], a[216:219], a[104:107], v[16:19]
buffer_load_dwordx4 v11, s[8:11], s21 offen offset:2048 nt lds
v_mfma_f32_16x16x32_bf16 v[28:31], a[216:219], a[120:123], v[28:31]
ds_read_b128 a[200:203], v1 offset:58368
v_cvt_pk_bf16_f32 v21, v22, v23
v_mfma_f32_16x16x32_bf16 v[32:35], a[216:219], a[136:139], v[32:35]
v_exp_f32 v24, v24
v_mfma_f32_16x16x32_bf16 v[44:47], a[216:219], a[152:155], v[44:47]
ds_read_b128 a[204:207], v2 offset:58368
v_mfma_f32_16x16x32_bf16 v[16:19], a[220:223], a[108:111], v[16:19]
v_exp_f32 v25, v25
v_mfma_f32_16x16x32_bf16 v[28:31], a[220:223], a[124:127], v[28:31]
ds_read_b128 a[208:211], v1 offset:61440
v_cvt_pk_bf16_f32 v24, v24, v25
v_mfma_f32_16x16x32_bf16 v[32:35], a[220:223], a[140:143], v[32:35]
v_exp_f32 v26, v26
v_mfma_f32_16x16x32_bf16 v[44:47], a[220:223], a[156:159], v[44:47]
ds_read_b128 a[212:215], v2 offset:61440
v_mfma_f32_16x16x32_bf16 v[80:83], a[232:235], a[64:67], 0
v_exp_f32 v27, v27
v_mfma_f32_16x16x32_bf16 v[84:87], a[232:235], a[80:83], 0
ds_read_b128 a[232:235], v10 offset:6144
v_cvt_pk_bf16_f32 v25, v26, v27
v_mfma_f32_16x16x32_bf16 v[80:83], a[236:239], a[68:71], v[80:83]
v_exp_f32 v36, v36
v_mfma_f32_16x16x32_bf16 v[84:87], a[236:239], a[84:87], v[84:87]
s_waitcnt lgkmcnt(5)
ds_read_b128 a[236:239], v10 offset:7168
v_mfma_f32_16x16x32_bf16 v[80:83], a[224:227], a[72:75], v[80:83]
v_exp_f32 v37, v37
v_mfma_f32_16x16x32_bf16 v[84:87], a[224:227], a[88:91], v[84:87]
ds_read_b128 a[216:219], v1 offset:62464
v_cvt_pk_bf16_f32 v36, v36, v37
v_mfma_f32_16x16x32_bf16 v[80:83], a[228:231], a[76:79], v[80:83]
v_exp_f32 v38, v38
v_mfma_f32_16x16x32_bf16 v[84:87], a[228:231], a[92:95], v[84:87]
ds_read_b128 a[220:223], v2 offset:62464
v_mfma_f32_16x16x32_bf16 v[132:135], a[160:163], v[52:55], v[132:135]
v_exp_f32 v39, v39
v_mfma_f32_16x16x32_bf16 v[164:167], a[160:163], v[56:59], v[164:167]
v_exp_f32 v40, v40
v_mfma_f32_16x16x32_bf16 v[196:199], a[160:163], v[68:71], v[196:199]
s_add_u32 m0, s30, 0x18000
s_add_u32 s37, s37, 0x2000
v_exp_f32 v80, v80
v_mfma_f32_16x16x32_bf16 v[228:231], a[160:163], v[72:75], v[228:231]
buffer_load_dwordx4 v11, s[12:15], s37 offen nt lds
v_mfma_f32_16x16x32_bf16 v[148:151], a[164:167], v[52:55], v[148:151]
ds_read_b64_tr_b16 a[160:161], v6 offset:57344
v_cvt_pk_bf16_f32 v37, v38, v39
v_mfma_f32_16x16x32_bf16 v[180:183], a[164:167], v[56:59], v[180:183]
v_exp_f32 v81, v81
v_mfma_f32_16x16x32_bf16 v[212:215], a[164:167], v[68:71], v[212:215]
ds_read_b64_tr_b16 a[162:163], v6 offset:61440
v_cvt_pk_bf16_f32 v80, v80, v81
v_mfma_f32_16x16x32_bf16 v[244:247], a[164:167], v[72:75], v[244:247]
v_exp_f32 v82, v82
v_smfmac_f32_16x16x64_bf16 a[244:247], a[240:243], v[52:59], v110
ds_read_b64_tr_b16 a[164:165], v6 offset:58368
v_mfma_f32_16x16x32_bf16 v[136:139], a[168:171], v[52:55], v[136:139]
v_exp_f32 v83, v83
v_mfma_f32_16x16x32_bf16 v[168:171], a[168:171], v[56:59], v[168:171]
ds_read_b64_tr_b16 a[166:167], v6 offset:62464
v_cvt_pk_bf16_f32 v81, v82, v83
v_mfma_f32_16x16x32_bf16 v[200:203], a[168:171], v[68:71], v[200:203]
ds_write_b64 v9, v[80:81] offset:0
v_mfma_f32_16x16x32_bf16 v[232:235], a[168:171], v[72:75], v[232:235]
ds_read_b64_tr_b16 a[168:169], v7 offset:57344
v_mfma_f32_16x16x32_bf16 v[152:155], a[172:175], v[52:55], v[152:155]
v_exp_f32 v84, v84
v_mfma_f32_16x16x32_bf16 v[184:187], a[172:175], v[56:59], v[184:187]
ds_read_b64_tr_b16 a[170:171], v7 offset:61440
v_mfma_f32_16x16x32_bf16 v[216:219], a[172:175], v[68:71], v[216:219]
v_exp_f32 v85, v85
v_mfma_f32_16x16x32_bf16 v[248:251], a[172:175], v[72:75], v[248:251]
s_waitcnt lgkmcnt(6)
ds_read_b64_tr_b16 a[172:173], v7 offset:58368
v_cvt_pk_bf16_f32 v84, v84, v85
v_smfmac_f32_16x16x64_bf16 a[248:251], a[240:243], v[68:75], v110
ds_read_b64_tr_b16 a[174:175], v7 offset:62464
v_mfma_f32_16x16x32_bf16 v[140:143], a[176:179], v[52:55], v[140:143]
v_exp_f32 v86, v86
v_mfma_f32_16x16x32_bf16 v[172:175], a[176:179], v[56:59], v[172:175]
v_exp_f32 v87, v87
v_mfma_f32_16x16x32_bf16 v[204:207], a[176:179], v[68:71], v[204:207]
v_exp_f32 v41, v41
v_mfma_f32_16x16x32_bf16 v[236:239], a[176:179], v[72:75], v[236:239]
ds_read_b64_tr_b16 a[176:177], v8 offset:57344
v_cvt_pk_bf16_f32 v85, v86, v87
v_mfma_f32_16x16x32_bf16 v[156:159], a[180:183], v[52:55], v[156:159]
buffer_load_dwordx4 v11, s[12:15], s37 offen offset:2048 nt lds
v_mfma_f32_16x16x32_bf16 v[188:191], a[180:183], v[56:59], v[188:191]
ds_read_b64_tr_b16 a[178:179], v8 offset:61440
v_cvt_pk_bf16_f32 v40, v40, v41
v_mfma_f32_16x16x32_bf16 v[220:223], a[180:183], v[68:71], v[220:223]
ds_write_b64 v9, v[84:85] offset:1024
v_mfma_f32_16x16x32_bf16 v[252:255], a[180:183], v[72:75], v[252:255]
ds_read_b64_tr_b16 a[180:181], v8 offset:58368
v_mfma_f32_16x16x32_bf16 v[128:131], a[184:187], v[52:55], v[128:131]
v_exp_f32 v42, v42
v_mfma_f32_16x16x32_bf16 v[160:163], a[184:187], v[56:59], v[160:163]
ds_read_b64_tr_b16 a[182:183], v8 offset:62464
v_mfma_f32_16x16x32_bf16 v[192:195], a[184:187], v[68:71], v[192:195]
v_exp_f32 v43, v43
v_mfma_f32_16x16x32_bf16 v[224:227], a[184:187], v[72:75], v[224:227]
v_exp_f32 v16, v16
v_mfma_f32_16x16x32_bf16 v[88:91], a[184:187], a[232:235], v[88:91]
v_exp_f32 v17, v17
v_mfma_f32_16x16x32_bf16 v[96:99], a[184:187], a[236:239], v[96:99]
ds_read_b64_tr_b16 a[184:185], v5 offset:57344
v_cvt_pk_bf16_f32 v22, v16, v17
v_smfmac_f32_16x16x64_bf16 a[252:255], a[240:243], a[232:239], v110
ds_read_b64_tr_b16 a[186:187], v5 offset:61440
v_cvt_pk_bf16_f32 v41, v42, v43
v_mfma_f32_16x16x32_bf16 v[144:147], a[188:191], v[52:55], v[144:147]
v_exp_f32 v18, v18
v_mfma_f32_16x16x32_bf16 v[176:179], a[188:191], v[56:59], v[176:179]
v_exp_f32 v19, v19
v_mfma_f32_16x16x32_bf16 v[208:211], a[188:191], v[68:71], v[208:211]
v_exp_f32 v28, v28
v_mfma_f32_16x16x32_bf16 v[240:243], a[188:191], v[72:75], v[240:243]
v_exp_f32 v29, v29
v_mfma_f32_16x16x32_bf16 v[92:95], a[188:191], a[232:235], v[92:95]
v_exp_f32 v30, v30
v_mfma_f32_16x16x32_bf16 v[100:103], a[188:191], a[236:239], v[100:103]
s_waitcnt lgkmcnt(2)
ds_read_b64_tr_b16 a[188:189], v5 offset:58368
v_cvt_pk_bf16_f32 v23, v18, v19
v_mfma_f32_16x16x32_bf16 v[52:55], a[192:195], a[96:99], 0
v_exp_f32 v31, v31
v_mfma_f32_16x16x32_bf16 v[56:59], a[192:195], a[112:115], 0
s_add_u32 m0, s30, 0x8000
s_add_u32 s21, s21, 0x2000
ds_read_b64_tr_b16 a[190:191], v5 offset:62464
v_cvt_pk_bf16_f32 v26, v28, v29
v_mfma_f32_16x16x32_bf16 v[68:71], a[192:195], a[128:131], 0
buffer_load_dwordx4 v11, s[8:11], s21 offen nt lds
v_mfma_f32_16x16x32_bf16 v[72:75], a[192:195], a[144:147], 0
v_exp_f32 v32, v32
v_mfma_f32_16x16x32_bf16 v[52:55], a[196:199], a[100:103], v[52:55]
v_exp_f32 v33, v33
v_mfma_f32_16x16x32_bf16 v[56:59], a[196:199], a[116:119], v[56:59]
v_exp_f32 v34, v34
v_mfma_f32_16x16x32_bf16 v[68:71], a[196:199], a[132:135], v[68:71]
v_exp_f32 v35, v35
v_mfma_f32_16x16x32_bf16 v[72:75], a[196:199], a[148:151], v[72:75]
v_exp_f32 v44, v44
v_mfma_f32_16x16x32_bf16 v[52:55], a[200:203], a[104:107], v[52:55]
v_exp_f32 v45, v45
v_mfma_f32_16x16x32_bf16 v[56:59], a[200:203], a[120:123], v[56:59]
v_exp_f32 v46, v46
v_mfma_f32_16x16x32_bf16 v[68:71], a[200:203], a[136:139], v[68:71]
v_exp_f32 v47, v47
v_mfma_f32_16x16x32_bf16 v[72:75], a[200:203], a[152:155], v[72:75]
v_cvt_pk_bf16_f32 v27, v30, v31
v_cvt_pk_bf16_f32 v38, v32, v33
v_mfma_f32_16x16x32_bf16 v[52:55], a[204:207], a[108:111], v[52:55]
v_cvt_pk_bf16_f32 v39, v34, v35
v_cvt_pk_bf16_f32 v42, v44, v45
v_mfma_f32_16x16x32_bf16 v[56:59], a[204:207], a[124:127], v[56:59]
v_cvt_pk_bf16_f32 v43, v46, v47
v_mfma_f32_16x16x32_bf16 v[68:71], a[204:207], a[140:143], v[68:71]
v_mfma_f32_16x16x32_bf16 v[72:75], a[204:207], a[156:159], v[72:75]
v_mfma_f32_16x16x32_bf16 v[48:51], a[208:211], a[96:99], 0
v_mfma_f32_16x16x32_bf16 v[60:63], a[208:211], a[112:115], 0
v_exp_f32 v52, v52
v_mfma_f32_16x16x32_bf16 v[64:67], a[208:211], a[128:131], 0
v_exp_f32 v53, v53
v_mfma_f32_16x16x32_bf16 v[76:79], a[208:211], a[144:147], 0
v_exp_f32 v54, v54
v_mfma_f32_16x16x32_bf16 v[48:51], a[212:215], a[100:103], v[48:51]
buffer_load_dwordx4 v11, s[8:11], s21 offen offset:2048 nt lds
v_mfma_f32_16x16x32_bf16 v[60:63], a[212:215], a[116:119], v[60:63]
v_exp_f32 v55, v55
v_mfma_f32_16x16x32_bf16 v[64:67], a[212:215], a[132:135], v[64:67]
v_exp_f32 v56, v56
v_mfma_f32_16x16x32_bf16 v[76:79], a[212:215], a[148:151], v[76:79]
v_exp_f32 v57, v57
v_mfma_f32_16x16x32_bf16 v[48:51], a[216:219], a[104:107], v[48:51]
v_exp_f32 v58, v58
v_mfma_f32_16x16x32_bf16 v[60:63], a[216:219], a[120:123], v[60:63]
v_exp_f32 v59, v59
v_mfma_f32_16x16x32_bf16 v[64:67], a[216:219], a[136:139], v[64:67]
v_exp_f32 v68, v68
v_mfma_f32_16x16x32_bf16 v[76:79], a[216:219], a[152:155], v[76:79]
v_exp_f32 v69, v69
v_mfma_f32_16x16x32_bf16 v[48:51], a[220:223], a[108:111], v[48:51]
v_exp_f32 v70, v70
v_mfma_f32_16x16x32_bf16 v[60:63], a[220:223], a[124:127], v[60:63]
v_exp_f32 v71, v71
v_mfma_f32_16x16x32_bf16 v[64:67], a[220:223], a[140:143], v[64:67]
v_cvt_pk_bf16_f32 v52, v52, v53
v_cvt_pk_bf16_f32 v53, v54, v55
v_mfma_f32_16x16x32_bf16 v[76:79], a[220:223], a[156:159], v[76:79]
s_waitcnt vmcnt(12) lgkmcnt(0)
s_barrier
ds_read_b128 a[224:227], v10 offset:0
v_mfma_f32_16x16x32_bf16 v[132:135], a[160:163], v[20:23], v[132:135]
v_exp_f32 v72, v72
v_mfma_f32_16x16x32_bf16 v[164:167], a[160:163], v[24:27], v[164:167]
ds_read_b128 a[228:231], v10 offset:1024
v_cvt_pk_bf16_f32 v56, v56, v57
v_mfma_f32_16x16x32_bf16 v[196:199], a[160:163], v[36:39], v[196:199]
v_exp_f32 v73, v73
v_mfma_f32_16x16x32_bf16 v[228:231], a[160:163], v[40:43], v[228:231]
ds_read_b128 a[192:195], v1 offset:0
v_cvt_pk_bf16_f32 v57, v58, v59
v_mfma_f32_16x16x32_bf16 v[148:151], a[164:167], v[20:23], v[148:151]
v_exp_f32 v74, v74
v_mfma_f32_16x16x32_bf16 v[180:183], a[164:167], v[24:27], v[180:183]
s_add_u32 m0, s30, 0x1a000
s_add_u32 s37, s37, 0x2000
ds_read_b128 a[196:199], v2 offset:0
v_cvt_pk_bf16_f32 v68, v68, v69
v_mfma_f32_16x16x32_bf16 v[212:215], a[164:167], v[36:39], v[212:215]
buffer_load_dwordx4 v11, s[12:15], s37 offen nt lds
v_mfma_f32_16x16x32_bf16 v[244:247], a[164:167], v[40:43], v[244:247]
ds_read_b128 a[200:203], v1 offset:1024
v_cvt_pk_bf16_f32 v69, v70, v71
v_smfmac_f32_16x16x64_bf16 a[244:247], a[240:243], v[20:27], v110
ds_read_b128 a[204:207], v2 offset:1024
v_cvt_pk_bf16_f32 v72, v72, v73
v_mfma_f32_16x16x32_bf16 v[136:139], a[168:171], v[20:23], v[136:139]
v_exp_f32 v75, v75
v_mfma_f32_16x16x32_bf16 v[168:171], a[168:171], v[24:27], v[168:171]
ds_read_b128 a[208:211], v1 offset:4096
v_cvt_pk_bf16_f32 v73, v74, v75
v_mfma_f32_16x16x32_bf16 v[200:203], a[168:171], v[36:39], v[200:203]
v_exp_f32 v48, v48
v_mfma_f32_16x16x32_bf16 v[232:235], a[168:171], v[40:43], v[232:235]
ds_read_b128 a[212:215], v2 offset:4096
v_mfma_f32_16x16x32_bf16 v[152:155], a[172:175], v[20:23], v[152:155]
v_exp_f32 v49, v49
v_mfma_f32_16x16x32_bf16 v[184:187], a[172:175], v[24:27], v[184:187]
ds_read_b128 a[216:219], v1 offset:5120
v_cvt_pk_bf16_f32 v54, v48, v49
v_mfma_f32_16x16x32_bf16 v[216:219], a[172:175], v[36:39], v[216:219]
v_exp_f32 v50, v50
v_mfma_f32_16x16x32_bf16 v[248:251], a[172:175], v[40:43], v[248:251]
ds_read_b128 a[220:223], v2 offset:5120
v_smfmac_f32_16x16x64_bf16 a[248:251], a[240:243], v[36:43], v110
ds_read_b128 a[232:235], v3 offset:0
v_mfma_f32_16x16x32_bf16 v[140:143], a[176:179], v[20:23], v[140:143]
v_exp_f32 v51, v51
v_mfma_f32_16x16x32_bf16 v[172:175], a[176:179], v[24:27], v[172:175]
ds_read_b128 a[236:239], v4 offset:0
v_cvt_pk_bf16_f32 v55, v50, v51
v_mfma_f32_16x16x32_bf16 v[204:207], a[176:179], v[36:39], v[204:207]
buffer_load_dwordx4 v11, s[12:15], s37 offen offset:2048 nt lds
v_mfma_f32_16x16x32_bf16 v[236:239], a[176:179], v[40:43], v[236:239]
ds_read_b64_tr_b16 a[160:161], v6 offset:0
v_mfma_f32_16x16x32_bf16 v[156:159], a[180:183], v[20:23], v[156:159]
v_exp_f32 v60, v60
v_mfma_f32_16x16x32_bf16 v[188:191], a[180:183], v[24:27], v[188:191]
ds_read_b64_tr_b16 a[162:163], v6 offset:4096
v_mfma_f32_16x16x32_bf16 v[220:223], a[180:183], v[36:39], v[220:223]
v_exp_f32 v61, v61
v_mfma_f32_16x16x32_bf16 v[252:255], a[180:183], v[40:43], v[252:255]
ds_read_b64_tr_b16 a[164:165], v6 offset:1024
v_cvt_pk_bf16_f32 v58, v60, v61
v_mfma_f32_16x16x32_bf16 v[128:131], a[184:187], v[20:23], v[128:131]
v_exp_f32 v62, v62
v_mfma_f32_16x16x32_bf16 v[160:163], a[184:187], v[24:27], v[160:163]
s_waitcnt lgkmcnt(5)
ds_read_b64_tr_b16 a[166:167], v6 offset:5120
v_mfma_f32_16x16x32_bf16 v[192:195], a[184:187], v[36:39], v[192:195]
v_exp_f32 v63, v63
v_mfma_f32_16x16x32_bf16 v[224:227], a[184:187], v[40:43], v[224:227]
ds_read_b64_tr_b16 a[168:169], v7 offset:0
v_cvt_pk_bf16_f32 v59, v62, v63
v_mfma_f32_16x16x32_bf16 v[88:91], a[184:187], a[224:227], v[88:91]
v_exp_f32 v64, v64
v_mfma_f32_16x16x32_bf16 v[96:99], a[184:187], a[228:231], v[96:99]
ds_read_b64_tr_b16 a[170:171], v7 offset:4096
v_smfmac_f32_16x16x64_bf16 a[252:255], a[240:243], a[224:231], v110
ds_read_b64_tr_b16 a[172:173], v7 offset:1024
v_mfma_f32_16x16x32_bf16 v[144:147], a[188:191], v[20:23], v[144:147]
v_exp_f32 v65, v65
v_mfma_f32_16x16x32_bf16 v[176:179], a[188:191], v[24:27], v[176:179]
s_add_u32 m0, s30, 0xa000
s_add_u32 s21, s21, 0x2000
ds_read_b64_tr_b16 a[174:175], v7 offset:5120
v_cvt_pk_bf16_f32 v70, v64, v65
v_mfma_f32_16x16x32_bf16 v[208:211], a[188:191], v[36:39], v[208:211]
buffer_load_dwordx4 v11, s[8:11], s21 offen nt lds
v_mfma_f32_16x16x32_bf16 v[240:243], a[188:191], v[40:43], v[240:243]
ds_read_b64_tr_b16 a[176:177], v8 offset:0
v_mfma_f32_16x16x32_bf16 v[92:95], a[188:191], a[224:227], v[92:95]
v_exp_f32 v66, v66
v_mfma_f32_16x16x32_bf16 v[100:103], a[188:191], a[228:231], v[100:103]
ds_read_b128 a[224:227], v3 offset:1024
v_mfma_f32_16x16x32_bf16 v[20:23], a[192:195], a[96:99], 0
v_exp_f32 v67, v67
v_mfma_f32_16x16x32_bf16 v[24:27], a[192:195], a[112:115], 0
ds_read_b128 a[228:231], v4 offset:1024
v_cvt_pk_bf16_f32 v71, v66, v67
v_mfma_f32_16x16x32_bf16 v[36:39], a[192:195], a[128:131], 0
v_exp_f32 v76, v76
v_mfma_f32_16x16x32_bf16 v[40:43], a[192:195], a[144:147], 0
ds_read_b64_tr_b16 a[178:179], v8 offset:4096
v_mfma_f32_16x16x32_bf16 v[20:23], a[196:199], a[100:103], v[20:23]
v_exp_f32 v77, v77
v_mfma_f32_16x16x32_bf16 v[24:27], a[196:199], a[116:119], v[24:27]
ds_read_b64_tr_b16 a[180:181], v8 offset:1024
v_cvt_pk_bf16_f32 v74, v76, v77
v_mfma_f32_16x16x32_bf16 v[36:39], a[196:199], a[132:135], v[36:39]
v_exp_f32 v78, v78
v_mfma_f32_16x16x32_bf16 v[40:43], a[196:199], a[148:151], v[40:43]
s_waitcnt lgkmcnt(5)
ds_read_b64_tr_b16 a[182:183], v8 offset:5120
v_mfma_f32_16x16x32_bf16 v[20:23], a[200:203], a[104:107], v[20:23]
v_exp_f32 v79, v79
v_mfma_f32_16x16x32_bf16 v[24:27], a[200:203], a[120:123], v[24:27]
ds_read_b64_tr_b16 a[184:185], v5 offset:0
v_cvt_pk_bf16_f32 v75, v78, v79
v_mfma_f32_16x16x32_bf16 v[36:39], a[200:203], a[136:139], v[36:39]
v_mfma_f32_16x16x32_bf16 v[40:43], a[200:203], a[152:155], v[40:43]
buffer_load_dwordx4 v11, s[8:11], s21 offen offset:2048 nt lds
v_mfma_f32_16x16x32_bf16 v[20:23], a[204:207], a[108:111], v[20:23]
ds_read_b64_tr_b16 a[186:187], v5 offset:4096
v_mfma_f32_16x16x32_bf16 v[24:27], a[204:207], a[124:127], v[24:27]
v_mfma_f32_16x16x32_bf16 v[36:39], a[204:207], a[140:143], v[36:39]
ds_read_b64_tr_b16 a[188:189], v5 offset:1024
v_mfma_f32_16x16x32_bf16 v[40:43], a[204:207], a[156:159], v[40:43]
v_mfma_f32_16x16x32_bf16 v[16:19], a[208:211], a[96:99], 0
ds_read_b64_tr_b16 a[190:191], v5 offset:5120
v_mfma_f32_16x16x32_bf16 v[28:31], a[208:211], a[112:115], 0
v_exp_f32 v20, v20
v_mfma_f32_16x16x32_bf16 v[32:35], a[208:211], a[128:131], 0
ds_read_b128 a[192:195], v1 offset:8192
v_mfma_f32_16x16x32_bf16 v[44:47], a[208:211], a[144:147], 0
v_exp_f32 v21, v21
v_mfma_f32_16x16x32_bf16 v[16:19], a[212:215], a[100:103], v[16:19]
ds_read_b128 a[196:199], v2 offset:8192
v_cvt_pk_bf16_f32 v20, v20, v21
v_mfma_f32_16x16x32_bf16 v[28:31], a[212:215], a[116:119], v[28:31]
v_exp_f32 v22, v22
v_mfma_f32_16x16x32_bf16 v[32:35], a[212:215], a[132:135], v[32:35]
ds_read_b128 a[200:203], v1 offset:9216
v_mfma_f32_16x16x32_bf16 v[44:47], a[212:215], a[148:151], v[44:47]
v_exp_f32 v23, v23
v_mfma_f32_16x16x32_bf16 v[16:19], a[216:219], a[104:107], v[16:19]
ds_read_b128 a[204:207], v2 offset:9216
v_cvt_pk_bf16_f32 v21, v22, v23
v_mfma_f32_16x16x32_bf16 v[28:31], a[216:219], a[120:123], v[28:31]
s_add_u32 m0, s30, 0x1c000
s_add_u32 s37, s37, 0x2000
v_exp_f32 v24, v24
v_mfma_f32_16x16x32_bf16 v[32:35], a[216:219], a[136:139], v[32:35]
buffer_load_dwordx4 v11, s[12:15], s37 offen nt lds
v_mfma_f32_16x16x32_bf16 v[44:47], a[216:219], a[152:155], v[44:47]
ds_read_b128 a[208:211], v1 offset:12288
v_mfma_f32_16x16x32_bf16 v[16:19], a[220:223], a[108:111], v[16:19]
v_exp_f32 v25, v25
v_mfma_f32_16x16x32_bf16 v[28:31], a[220:223], a[124:127], v[28:31]
s_waitcnt lgkmcnt(4)
ds_read_b128 a[212:215], v2 offset:12288
v_cvt_pk_bf16_f32 v24, v24, v25
v_mfma_f32_16x16x32_bf16 v[32:35], a[220:223], a[140:143], v[32:35]
v_exp_f32 v26, v26
v_mfma_f32_16x16x32_bf16 v[44:47], a[220:223], a[156:159], v[44:47]
ds_read_b128 a[216:219], v1 offset:13312
v_mfma_f32_16x16x32_bf16 v[80:83], a[232:235], a[64:67], 0
v_exp_f32 v27, v27
v_mfma_f32_16x16x32_bf16 v[84:87], a[232:235], a[80:83], 0
ds_read_b128 a[232:235], v10 offset:2048
v_cvt_pk_bf16_f32 v25, v26, v27
v_mfma_f32_16x16x32_bf16 v[80:83], a[236:239], a[68:71], v[80:83]
v_exp_f32 v36, v36
v_mfma_f32_16x16x32_bf16 v[84:87], a[236:239], a[84:87], v[84:87]
ds_read_b128 a[236:239], v10 offset:3072
v_mfma_f32_16x16x32_bf16 v[80:83], a[224:227], a[72:75], v[80:83]
v_exp_f32 v37, v37
v_mfma_f32_16x16x32_bf16 v[84:87], a[224:227], a[88:91], v[84:87]
ds_read_b128 a[220:223], v2 offset:13312
v_cvt_pk_bf16_f32 v36, v36, v37
v_mfma_f32_16x16x32_bf16 v[80:83], a[228:231], a[76:79], v[80:83]
v_exp_f32 v38, v38
v_mfma_f32_16x16x32_bf16 v[84:87], a[228:231], a[92:95], v[84:87]
v_exp_f32 v39, v39
v_mfma_f32_16x16x32_bf16 v[132:135], a[160:163], v[52:55], v[132:135]
v_exp_f32 v40, v40
v_mfma_f32_16x16x32_bf16 v[164:167], a[160:163], v[56:59], v[164:167]
buffer_load_dwordx4 v11, s[12:15], s37 offen offset:2048 nt lds
v_mfma_f32_16x16x32_bf16 v[196:199], a[160:163], v[68:71], v[196:199]
v_exp_f32 v80, v80
v_mfma_f32_16x16x32_bf16 v[228:231], a[160:163], v[72:75], v[228:231]
ds_read_b64_tr_b16 a[160:161], v6 offset:8192
v_cvt_pk_bf16_f32 v37, v38, v39
v_mfma_f32_16x16x32_bf16 v[148:151], a[164:167], v[52:55], v[148:151]
v_exp_f32 v81, v81
v_mfma_f32_16x16x32_bf16 v[180:183], a[164:167], v[56:59], v[180:183]
ds_read_b64_tr_b16 a[162:163], v6 offset:12288
v_cvt_pk_bf16_f32 v80, v80, v81
v_mfma_f32_16x16x32_bf16 v[212:215], a[164:167], v[68:71], v[212:215]
v_exp_f32 v82, v82
v_mfma_f32_16x16x32_bf16 v[244:247], a[164:167], v[72:75], v[244:247]
ds_read_b64_tr_b16 a[164:165], v6 offset:9216
v_smfmac_f32_16x16x64_bf16 a[244:247], a[240:243], v[52:59], v110
ds_read_b64_tr_b16 a[166:167], v6 offset:13312
v_mfma_f32_16x16x32_bf16 v[136:139], a[168:171], v[52:55], v[136:139]
v_exp_f32 v83, v83
v_mfma_f32_16x16x32_bf16 v[168:171], a[168:171], v[56:59], v[168:171]
v_exp_f32 v84, v84
v_mfma_f32_16x16x32_bf16 v[200:203], a[168:171], v[68:71], v[200:203]
v_exp_f32 v85, v85
v_mfma_f32_16x16x32_bf16 v[232:235], a[168:171], v[72:75], v[232:235]
ds_read_b64_tr_b16 a[168:169], v7 offset:8192
v_cvt_pk_bf16_f32 v81, v82, v83
v_mfma_f32_16x16x32_bf16 v[152:155], a[172:175], v[52:55], v[152:155]
ds_write_b64 v9, v[80:81] offset:4096
v_cvt_pk_bf16_f32 v84, v84, v85
v_mfma_f32_16x16x32_bf16 v[184:187], a[172:175], v[56:59], v[184:187]
s_waitcnt lgkmcnt(5)
ds_read_b64_tr_b16 a[170:171], v7 offset:12288
v_mfma_f32_16x16x32_bf16 v[216:219], a[172:175], v[68:71], v[216:219]
s_add_u32 m0, s30, 0xc000
s_add_u32 s21, s21, 0x2000
v_exp_f32 v86, v86
v_mfma_f32_16x16x32_bf16 v[248:251], a[172:175], v[72:75], v[248:251]
buffer_load_dwordx4 v11, s[8:11], s21 offen nt lds
v_smfmac_f32_16x16x64_bf16 a[248:251], a[240:243], v[68:75], v110
ds_read_b64_tr_b16 a[172:173], v7 offset:9216
v_mfma_f32_16x16x32_bf16 v[140:143], a[176:179], v[52:55], v[140:143]
v_exp_f32 v87, v87
v_mfma_f32_16x16x32_bf16 v[172:175], a[176:179], v[56:59], v[172:175]
ds_read_b64_tr_b16 a[174:175], v7 offset:13312
v_cvt_pk_bf16_f32 v85, v86, v87
v_mfma_f32_16x16x32_bf16 v[204:207], a[176:179], v[68:71], v[204:207]
ds_write_b64 v9, v[84:85] offset:5120
v_mfma_f32_16x16x32_bf16 v[236:239], a[176:179], v[72:75], v[236:239]
ds_read_b64_tr_b16 a[176:177], v8 offset:8192
v_mfma_f32_16x16x32_bf16 v[156:159], a[180:183], v[52:55], v[156:159]
v_exp_f32 v41, v41
v_mfma_f32_16x16x32_bf16 v[188:191], a[180:183], v[56:59], v[188:191]
ds_read_b64_tr_b16 a[178:179], v8 offset:12288
v_cvt_pk_bf16_f32 v40, v40, v41
v_mfma_f32_16x16x32_bf16 v[220:223], a[180:183], v[68:71], v[220:223]
v_exp_f32 v42, v42
v_mfma_f32_16x16x32_bf16 v[252:255], a[180:183], v[72:75], v[252:255]
ds_read_b64_tr_b16 a[180:181], v8 offset:9216
v_mfma_f32_16x16x32_bf16 v[128:131], a[184:187], v[52:55], v[128:131]
v_exp_f32 v43, v43
v_mfma_f32_16x16x32_bf16 v[160:163], a[184:187], v[56:59], v[160:163]
ds_read_b64_tr_b16 a[182:183], v8 offset:13312
v_cvt_pk_bf16_f32 v41, v42, v43
v_mfma_f32_16x16x32_bf16 v[192:195], a[184:187], v[68:71], v[192:195]
v_exp_f32 v16, v16
v_mfma_f32_16x16x32_bf16 v[224:227], a[184:187], v[72:75], v[224:227]
v_exp_f32 v17, v17
v_mfma_f32_16x16x32_bf16 v[88:91], a[184:187], a[232:235], v[88:91]
v_exp_f32 v18, v18
v_mfma_f32_16x16x32_bf16 v[96:99], a[184:187], a[236:239], v[96:99]
buffer_load_dwordx4 v11, s[8:11], s21 offen offset:2048 nt lds
v_smfmac_f32_16x16x64_bf16 a[252:255], a[240:243], a[232:239], v110
ds_read_b64_tr_b16 a[184:185], v5 offset:8192
v_cvt_pk_bf16_f32 v22, v16, v17
v_mfma_f32_16x16x32_bf16 v[144:147], a[188:191], v[52:55], v[144:147]
v_exp_f32 v19, v19
v_mfma_f32_16x16x32_bf16 v[176:179], a[188:191], v[56:59], v[176:179]
ds_read_b64_tr_b16 a[186:187], v5 offset:12288
v_cvt_pk_bf16_f32 v23, v18, v19
v_mfma_f32_16x16x32_bf16 v[208:211], a[188:191], v[68:71], v[208:211]
v_exp_f32 v28, v28
v_mfma_f32_16x16x32_bf16 v[240:243], a[188:191], v[72:75], v[240:243]
v_exp_f32 v29, v29
v_mfma_f32_16x16x32_bf16 v[92:95], a[188:191], a[232:235], v[92:95]
v_exp_f32 v30, v30
v_mfma_f32_16x16x32_bf16 v[100:103], a[188:191], a[236:239], v[100:103]
s_waitcnt lgkmcnt(2)
ds_read_b64_tr_b16 a[188:189], v5 offset:9216
v_cvt_pk_bf16_f32 v26, v28, v29
v_mfma_f32_16x16x32_bf16 v[52:55], a[192:195], a[96:99], 0
v_exp_f32 v31, v31
v_mfma_f32_16x16x32_bf16 v[56:59], a[192:195], a[112:115], 0
ds_read_b64_tr_b16 a[190:191], v5 offset:13312
v_cvt_pk_bf16_f32 v27, v30, v31
v_mfma_f32_16x16x32_bf16 v[68:71], a[192:195], a[128:131], 0
v_exp_f32 v32, v32
v_mfma_f32_16x16x32_bf16 v[72:75], a[192:195], a[144:147], 0
v_exp_f32 v33, v33
v_mfma_f32_16x16x32_bf16 v[52:55], a[196:199], a[100:103], v[52:55]
v_exp_f32 v34, v34
v_mfma_f32_16x16x32_bf16 v[56:59], a[196:199], a[116:119], v[56:59]
v_exp_f32 v35, v35
v_mfma_f32_16x16x32_bf16 v[68:71], a[196:199], a[132:135], v[68:71]
s_add_u32 m0, s30, 0x1e000
s_add_u32 s37, s37, 0x2000
v_exp_f32 v44, v44
v_mfma_f32_16x16x32_bf16 v[72:75], a[196:199], a[148:151], v[72:75]
buffer_load_dwordx4 v11, s[12:15], s37 offen nt lds
v_mfma_f32_16x16x32_bf16 v[52:55], a[200:203], a[104:107], v[52:55]
v_exp_f32 v45, v45
v_mfma_f32_16x16x32_bf16 v[56:59], a[200:203], a[120:123], v[56:59]
v_exp_f32 v46, v46
v_mfma_f32_16x16x32_bf16 v[68:71], a[200:203], a[136:139], v[68:71]
v_exp_f32 v47, v47
v_mfma_f32_16x16x32_bf16 v[72:75], a[200:203], a[152:155], v[72:75]
v_cvt_pk_bf16_f32 v38, v32, v33
v_cvt_pk_bf16_f32 v39, v34, v35
v_mfma_f32_16x16x32_bf16 v[52:55], a[204:207], a[108:111], v[52:55]
v_cvt_pk_bf16_f32 v42, v44, v45
v_cvt_pk_bf16_f32 v43, v46, v47
v_mfma_f32_16x16x32_bf16 v[56:59], a[204:207], a[124:127], v[56:59]
v_mfma_f32_16x16x32_bf16 v[68:71], a[204:207], a[140:143], v[68:71]
v_mfma_f32_16x16x32_bf16 v[72:75], a[204:207], a[156:159], v[72:75]
v_mfma_f32_16x16x32_bf16 v[48:51], a[208:211], a[96:99], 0
v_mfma_f32_16x16x32_bf16 v[60:63], a[208:211], a[112:115], 0
v_mfma_f32_16x16x32_bf16 v[64:67], a[208:211], a[128:131], 0
v_exp_f32 v52, v52
v_mfma_f32_16x16x32_bf16 v[76:79], a[208:211], a[144:147], 0
v_exp_f32 v53, v53
v_mfma_f32_16x16x32_bf16 v[48:51], a[212:215], a[100:103], v[48:51]
v_exp_f32 v54, v54
v_mfma_f32_16x16x32_bf16 v[60:63], a[212:215], a[116:119], v[60:63]
v_exp_f32 v55, v55
v_mfma_f32_16x16x32_bf16 v[64:67], a[212:215], a[132:135], v[64:67]
buffer_load_dwordx4 v11, s[12:15], s37 offen offset:2048 nt lds
v_mfma_f32_16x16x32_bf16 v[76:79], a[212:215], a[148:151], v[76:79]
v_exp_f32 v56, v56
v_mfma_f32_16x16x32_bf16 v[48:51], a[216:219], a[104:107], v[48:51]
v_exp_f32 v57, v57
v_mfma_f32_16x16x32_bf16 v[60:63], a[216:219], a[120:123], v[60:63]
v_exp_f32 v58, v58
v_mfma_f32_16x16x32_bf16 v[64:67], a[216:219], a[136:139], v[64:67]
v_exp_f32 v59, v59
v_mfma_f32_16x16x32_bf16 v[76:79], a[216:219], a[152:155], v[76:79]
v_exp_f32 v68, v68
v_mfma_f32_16x16x32_bf16 v[48:51], a[220:223], a[108:111], v[48:51]
v_exp_f32 v69, v69
v_mfma_f32_16x16x32_bf16 v[60:63], a[220:223], a[124:127], v[60:63]
v_exp_f32 v70, v70
v_mfma_f32_16x16x32_bf16 v[64:67], a[220:223], a[140:143], v[64:67]
v_exp_f32 v71, v71
v_mfma_f32_16x16x32_bf16 v[76:79], a[220:223], a[156:159], v[76:79]
s_waitcnt vmcnt(14) lgkmcnt(0)
s_barrier
ds_read_b128 a[224:227], v10 offset:4096
v_mfma_f32_16x16x32_bf16 v[132:135], a[160:163], v[20:23], v[132:135]
v_cvt_pk_bf16_f32 v52, v52, v53
v_cvt_pk_bf16_f32 v53, v54, v55
v_mfma_f32_16x16x32_bf16 v[164:167], a[160:163], v[24:27], v[164:167]
ds_read_b128 a[228:231], v10 offset:5120
v_cvt_pk_bf16_f32 v56, v56, v57
v_mfma_f32_16x16x32_bf16 v[196:199], a[160:163], v[36:39], v[196:199]
v_exp_f32 v72, v72
v_mfma_f32_16x16x32_bf16 v[228:231], a[160:163], v[40:43], v[228:231]
ds_read_b128 a[192:195], v1 offset:16384
v_cvt_pk_bf16_f32 v57, v58, v59
v_mfma_f32_16x16x32_bf16 v[148:151], a[164:167], v[20:23], v[148:151]
v_exp_f32 v73, v73
v_mfma_f32_16x16x32_bf16 v[180:183], a[164:167], v[24:27], v[180:183]
s_add_u32 m0, s30, 0xe000
s_add_u32 s21, s21, 0x2000
ds_read_b128 a[196:199], v2 offset:16384
v_cvt_pk_bf16_f32 v68, v68, v69
v_mfma_f32_16x16x32_bf16 v[212:215], a[164:167], v[36:39], v[212:215]
buffer_load_dwordx4 v11, s[8:11], s21 offen nt lds
v_mfma_f32_16x16x32_bf16 v[244:247], a[164:167], v[40:43], v[244:247]
ds_read_b128 a[200:203], v1 offset:17408
v_cvt_pk_bf16_f32 v69, v70, v71
v_smfmac_f32_16x16x64_bf16 a[244:247], a[240:243], v[20:27], v110
ds_read_b128 a[204:207], v2 offset:17408
v_cvt_pk_bf16_f32 v72, v72, v73
v_mfma_f32_16x16x32_bf16 v[136:139], a[168:171], v[20:23], v[136:139]
v_exp_f32 v74, v74
v_mfma_f32_16x16x32_bf16 v[168:171], a[168:171], v[24:27], v[168:171]
ds_read_b128 a[208:211], v1 offset:20480
v_mfma_f32_16x16x32_bf16 v[200:203], a[168:171], v[36:39], v[200:203]
v_exp_f32 v75, v75
v_mfma_f32_16x16x32_bf16 v[232:235], a[168:171], v[40:43], v[232:235]
ds_read_b128 a[212:215], v2 offset:20480
v_cvt_pk_bf16_f32 v73, v74, v75
v_mfma_f32_16x16x32_bf16 v[152:155], a[172:175], v[20:23], v[152:155]
v_exp_f32 v48, v48
v_mfma_f32_16x16x32_bf16 v[184:187], a[172:175], v[24:27], v[184:187]
ds_read_b128 a[216:219], v1 offset:21504
v_mfma_f32_16x16x32_bf16 v[216:219], a[172:175], v[36:39], v[216:219]
v_exp_f32 v49, v49
v_mfma_f32_16x16x32_bf16 v[248:251], a[172:175], v[40:43], v[248:251]
ds_read_b128 a[220:223], v2 offset:21504
v_cvt_pk_bf16_f32 v54, v48, v49
v_smfmac_f32_16x16x64_bf16 a[248:251], a[240:243], v[36:43], v110
ds_read_b128 a[232:235], v3 offset:16384
v_mfma_f32_16x16x32_bf16 v[140:143], a[176:179], v[20:23], v[140:143]
v_exp_f32 v50, v50
v_mfma_f32_16x16x32_bf16 v[172:175], a[176:179], v[24:27], v[172:175]
ds_read_b128 a[236:239], v4 offset:16384
v_mfma_f32_16x16x32_bf16 v[204:207], a[176:179], v[36:39], v[204:207]
v_exp_f32 v51, v51
v_mfma_f32_16x16x32_bf16 v[236:239], a[176:179], v[40:43], v[236:239]
ds_read_b64_tr_b16 a[160:161], v6 offset:16384
v_cvt_pk_bf16_f32 v55, v50, v51
v_mfma_f32_16x16x32_bf16 v[156:159], a[180:183], v[20:23], v[156:159]
v_exp_f32 v60, v60
v_mfma_f32_16x16x32_bf16 v[188:191], a[180:183], v[24:27], v[188:191]
ds_read_b64_tr_b16 a[162:163], v6 offset:20480
v_mfma_f32_16x16x32_bf16 v[220:223], a[180:183], v[36:39], v[220:223]
v_exp_f32 v61, v61
v_mfma_f32_16x16x32_bf16 v[252:255], a[180:183], v[40:43], v[252:255]
buffer_load_dwordx4 v11, s[8:11], s21 offen offset:2048 nt lds
v_mfma_f32_16x16x32_bf16 v[128:131], a[184:187], v[20:23], v[128:131]
ds_read_b64_tr_b16 a[164:165], v6 offset:17408
v_cvt_pk_bf16_f32 v58, v60, v61
v_mfma_f32_16x16x32_bf16 v[160:163], a[184:187], v[24:27], v[160:163]
v_exp_f32 v62, v62
v_mfma_f32_16x16x32_bf16 v[192:195], a[184:187], v[36:39], v[192:195]
s_waitcnt lgkmcnt(4)
ds_read_b64_tr_b16 a[166:167], v6 offset:21504
v_mfma_f32_16x16x32_bf16 v[224:227], a[184:187], v[40:43], v[224:227]
v_exp_f32 v63, v63
v_mfma_f32_16x16x32_bf16 v[88:91], a[184:187], a[224:227], v[88:91]
ds_read_b64_tr_b16 a[168:169], v7 offset:16384
v_cvt_pk_bf16_f32 v59, v62, v63
v_mfma_f32_16x16x32_bf16 v[96:99], a[184:187], a[228:231], v[96:99]
v_exp_f32 v64, v64
v_smfmac_f32_16x16x64_bf16 a[252:255], a[240:243], a[224:231], v110
ds_read_b64_tr_b16 a[170:171], v7 offset:20480
v_mfma_f32_16x16x32_bf16 v[144:147], a[188:191], v[20:23], v[144:147]
v_exp_f32 v65, v65
v_mfma_f32_16x16x32_bf16 v[176:179], a[188:191], v[24:27], v[176:179]
ds_read_b64_tr_b16 a[172:173], v7 offset:17408
v_cvt_pk_bf16_f32 v70, v64, v65
v_mfma_f32_16x16x32_bf16 v[208:211], a[188:191], v[36:39], v[208:211]
v_exp_f32 v66, v66
v_mfma_f32_16x16x32_bf16 v[240:243], a[188:191], v[40:43], v[240:243]
ds_read_b64_tr_b16 a[174:175], v7 offset:21504
v_mfma_f32_16x16x32_bf16 v[92:95], a[188:191], a[224:227], v[92:95]
v_exp_f32 v67, v67
v_mfma_f32_16x16x32_bf16 v[100:103], a[188:191], a[228:231], v[100:103]
ds_read_b128 a[224:227], v3 offset:17408
v_cvt_pk_bf16_f32 v71, v66, v67
v_mfma_f32_16x16x32_bf16 v[20:23], a[192:195], a[96:99], 0
v_exp_f32 v76, v76
v_mfma_f32_16x16x32_bf16 v[24:27], a[192:195], a[112:115], 0
ds_read_b128 a[228:231], v4 offset:17408
v_mfma_f32_16x16x32_bf16 v[36:39], a[192:195], a[128:131], 0
v_exp_f32 v77, v77
v_mfma_f32_16x16x32_bf16 v[40:43], a[192:195], a[144:147], 0
ds_read_b64_tr_b16 a[176:177], v8 offset:16384
v_cvt_pk_bf16_f32 v74, v76, v77
v_mfma_f32_16x16x32_bf16 v[20:23], a[196:199], a[100:103], v[20:23]
s_add_u32 m0, s30, 0x10000
s_add_u32 s37, s37, 0x2000
v_exp_f32 v78, v78
v_mfma_f32_16x16x32_bf16 v[24:27], a[196:199], a[116:119], v[24:27]
buffer_load_dwordx4 v11, s[12:15], s37 offen nt lds
v_mfma_f32_16x16x32_bf16 v[36:39], a[196:199], a[132:135], v[36:39]
ds_read_b64_tr_b16 a[178:179], v8 offset:20480
v_mfma_f32_16x16x32_bf16 v[40:43], a[196:199], a[148:151], v[40:43]
v_exp_f32 v79, v79
v_mfma_f32_16x16x32_bf16 v[20:23], a[200:203], a[104:107], v[20:23]
ds_read_b64_tr_b16 a[180:181], v8 offset:17408
v_cvt_pk_bf16_f32 v75, v78, v79
v_mfma_f32_16x16x32_bf16 v[24:27], a[200:203], a[120:123], v[24:27]
v_mfma_f32_16x16x32_bf16 v[36:39], a[200:203], a[136:139], v[36:39]
ds_read_b64_tr_b16 a[182:183], v8 offset:21504
v_mfma_f32_16x16x32_bf16 v[40:43], a[200:203], a[152:155], v[40:43]
v_mfma_f32_16x16x32_bf16 v[20:23], a[204:207], a[108:111], v[20:23]
s_waitcnt lgkmcnt(4)
ds_read_b64_tr_b16 a[184:185], v5 offset:16384
v_mfma_f32_16x16x32_bf16 v[24:27], a[204:207], a[124:127], v[24:27]
v_mfma_f32_16x16x32_bf16 v[36:39], a[204:207], a[140:143], v[36:39]
ds_read_b64_tr_b16 a[186:187], v5 offset:20480
v_mfma_f32_16x16x32_bf16 v[40:43], a[204:207], a[156:159], v[40:43]
v_mfma_f32_16x16x32_bf16 v[16:19], a[208:211], a[96:99], 0
ds_read_b64_tr_b16 a[188:189], v5 offset:17408
v_mfma_f32_16x16x32_bf16 v[28:31], a[208:211], a[112:115], 0
v_exp_f32 v20, v20
v_mfma_f32_16x16x32_bf16 v[32:35], a[208:211], a[128:131], 0
ds_read_b64_tr_b16 a[190:191], v5 offset:21504
v_mfma_f32_16x16x32_bf16 v[44:47], a[208:211], a[144:147], 0
v_exp_f32 v21, v21
v_mfma_f32_16x16x32_bf16 v[16:19], a[212:215], a[100:103], v[16:19]
ds_read_b128 a[192:195], v1 offset:24576
v_cvt_pk_bf16_f32 v20, v20, v21
v_mfma_f32_16x16x32_bf16 v[28:31], a[212:215], a[116:119], v[28:31]
v_exp_f32 v22, v22
v_mfma_f32_16x16x32_bf16 v[32:35], a[212:215], a[132:135], v[32:35]
ds_read_b128 a[196:199], v2 offset:24576
v_mfma_f32_16x16x32_bf16 v[44:47], a[212:215], a[148:151], v[44:47]
v_exp_f32 v23, v23
v_mfma_f32_16x16x32_bf16 v[16:19], a[216:219], a[104:107], v[16:19]
buffer_load_dwordx4 v11, s[12:15], s37 offen offset:2048 nt lds
v_mfma_f32_16x16x32_bf16 v[28:31], a[216:219], a[120:123], v[28:31]
ds_read_b128 a[200:203], v1 offset:25600
v_cvt_pk_bf16_f32 v21, v22, v23
v_mfma_f32_16x16x32_bf16 v[32:35], a[216:219], a[136:139], v[32:35]
v_exp_f32 v24, v24
v_mfma_f32_16x16x32_bf16 v[44:47], a[216:219], a[152:155], v[44:47]
ds_read_b128 a[204:207], v2 offset:25600
v_mfma_f32_16x16x32_bf16 v[16:19], a[220:223], a[108:111], v[16:19]
v_exp_f32 v25, v25
v_mfma_f32_16x16x32_bf16 v[28:31], a[220:223], a[124:127], v[28:31]
ds_read_b128 a[208:211], v1 offset:28672
v_cvt_pk_bf16_f32 v24, v24, v25
v_mfma_f32_16x16x32_bf16 v[32:35], a[220:223], a[140:143], v[32:35]
v_exp_f32 v26, v26
v_mfma_f32_16x16x32_bf16 v[44:47], a[220:223], a[156:159], v[44:47]
ds_read_b128 a[212:215], v2 offset:28672
v_mfma_f32_16x16x32_bf16 v[80:83], a[232:235], a[64:67], 0
v_exp_f32 v27, v27
v_mfma_f32_16x16x32_bf16 v[84:87], a[232:235], a[80:83], 0
ds_read_b128 a[232:235], v10 offset:6144
v_cvt_pk_bf16_f32 v25, v26, v27
v_mfma_f32_16x16x32_bf16 v[80:83], a[236:239], a[68:71], v[80:83]
v_exp_f32 v36, v36
v_mfma_f32_16x16x32_bf16 v[84:87], a[236:239], a[84:87], v[84:87]
s_waitcnt lgkmcnt(5)
ds_read_b128 a[236:239], v10 offset:7168
v_mfma_f32_16x16x32_bf16 v[80:83], a[224:227], a[72:75], v[80:83]
v_exp_f32 v37, v37
v_mfma_f32_16x16x32_bf16 v[84:87], a[224:227], a[88:91], v[84:87]
ds_read_b128 a[216:219], v1 offset:29696
v_cvt_pk_bf16_f32 v36, v36, v37
v_mfma_f32_16x16x32_bf16 v[80:83], a[228:231], a[76:79], v[80:83]
v_exp_f32 v38, v38
v_mfma_f32_16x16x32_bf16 v[84:87], a[228:231], a[92:95], v[84:87]
ds_read_b128 a[220:223], v2 offset:29696
v_mfma_f32_16x16x32_bf16 v[132:135], a[160:163], v[52:55], v[132:135]
v_exp_f32 v39, v39
v_mfma_f32_16x16x32_bf16 v[164:167], a[160:163], v[56:59], v[164:167]
v_exp_f32 v40, v40
v_mfma_f32_16x16x32_bf16 v[196:199], a[160:163], v[68:71], v[196:199]
s_add_u32 m0, s30, 0x0
s_add_u32 s21, s21, 0x2000
v_exp_f32 v80, v80
v_mfma_f32_16x16x32_bf16 v[228:231], a[160:163], v[72:75], v[228:231]
buffer_load_dwordx4 v11, s[8:11], s21 offen nt lds
v_mfma_f32_16x16x32_bf16 v[148:151], a[164:167], v[52:55], v[148:151]
ds_read_b64_tr_b16 a[160:161], v6 offset:24576
v_cvt_pk_bf16_f32 v37, v38, v39
v_mfma_f32_16x16x32_bf16 v[180:183], a[164:167], v[56:59], v[180:183]
v_exp_f32 v81, v81
v_mfma_f32_16x16x32_bf16 v[212:215], a[164:167], v[68:71], v[212:215]
ds_read_b64_tr_b16 a[162:163], v6 offset:28672
v_cvt_pk_bf16_f32 v80, v80, v81
v_mfma_f32_16x16x32_bf16 v[244:247], a[164:167], v[72:75], v[244:247]
v_exp_f32 v82, v82
v_smfmac_f32_16x16x64_bf16 a[244:247], a[240:243], v[52:59], v110
ds_read_b64_tr_b16 a[164:165], v6 offset:25600
v_mfma_f32_16x16x32_bf16 v[136:139], a[168:171], v[52:55], v[136:139]
v_exp_f32 v83, v83
v_mfma_f32_16x16x32_bf16 v[168:171], a[168:171], v[56:59], v[168:171]
ds_read_b64_tr_b16 a[166:167], v6 offset:29696
v_cvt_pk_bf16_f32 v81, v82, v83
v_mfma_f32_16x16x32_bf16 v[200:203], a[168:171], v[68:71], v[200:203]
ds_write_b64 v9, v[80:81] offset:0
v_mfma_f32_16x16x32_bf16 v[232:235], a[168:171], v[72:75], v[232:235]
ds_read_b64_tr_b16 a[168:169], v7 offset:24576
v_mfma_f32_16x16x32_bf16 v[152:155], a[172:175], v[52:55], v[152:155]
v_exp_f32 v84, v84
v_mfma_f32_16x16x32_bf16 v[184:187], a[172:175], v[56:59], v[184:187]
ds_read_b64_tr_b16 a[170:171], v7 offset:28672
v_mfma_f32_16x16x32_bf16 v[216:219], a[172:175], v[68:71], v[216:219]
v_exp_f32 v85, v85
v_mfma_f32_16x16x32_bf16 v[248:251], a[172:175], v[72:75], v[248:251]
s_waitcnt lgkmcnt(6)
ds_read_b64_tr_b16 a[172:173], v7 offset:25600
v_cvt_pk_bf16_f32 v84, v84, v85
v_smfmac_f32_16x16x64_bf16 a[248:251], a[240:243], v[68:75], v110
ds_read_b64_tr_b16 a[174:175], v7 offset:29696
v_mfma_f32_16x16x32_bf16 v[140:143], a[176:179], v[52:55], v[140:143]
v_exp_f32 v86, v86
v_mfma_f32_16x16x32_bf16 v[172:175], a[176:179], v[56:59], v[172:175]
v_exp_f32 v87, v87
v_mfma_f32_16x16x32_bf16 v[204:207], a[176:179], v[68:71], v[204:207]
v_exp_f32 v41, v41
v_mfma_f32_16x16x32_bf16 v[236:239], a[176:179], v[72:75], v[236:239]
ds_read_b64_tr_b16 a[176:177], v8 offset:24576
v_cvt_pk_bf16_f32 v85, v86, v87
v_mfma_f32_16x16x32_bf16 v[156:159], a[180:183], v[52:55], v[156:159]
buffer_load_dwordx4 v11, s[8:11], s21 offen offset:2048 nt lds
v_mfma_f32_16x16x32_bf16 v[188:191], a[180:183], v[56:59], v[188:191]
ds_read_b64_tr_b16 a[178:179], v8 offset:28672
v_cvt_pk_bf16_f32 v40, v40, v41
v_mfma_f32_16x16x32_bf16 v[220:223], a[180:183], v[68:71], v[220:223]
ds_write_b64 v9, v[84:85] offset:1024
v_mfma_f32_16x16x32_bf16 v[252:255], a[180:183], v[72:75], v[252:255]
ds_read_b64_tr_b16 a[180:181], v8 offset:25600
v_mfma_f32_16x16x32_bf16 v[128:131], a[184:187], v[52:55], v[128:131]
v_exp_f32 v42, v42
v_mfma_f32_16x16x32_bf16 v[160:163], a[184:187], v[56:59], v[160:163]
ds_read_b64_tr_b16 a[182:183], v8 offset:29696
v_mfma_f32_16x16x32_bf16 v[192:195], a[184:187], v[68:71], v[192:195]
v_exp_f32 v43, v43
v_mfma_f32_16x16x32_bf16 v[224:227], a[184:187], v[72:75], v[224:227]
v_exp_f32 v16, v16
v_mfma_f32_16x16x32_bf16 v[88:91], a[184:187], a[232:235], v[88:91]
v_exp_f32 v17, v17
v_mfma_f32_16x16x32_bf16 v[96:99], a[184:187], a[236:239], v[96:99]
ds_read_b64_tr_b16 a[184:185], v5 offset:24576
v_cvt_pk_bf16_f32 v22, v16, v17
v_smfmac_f32_16x16x64_bf16 a[252:255], a[240:243], a[232:239], v110
ds_read_b64_tr_b16 a[186:187], v5 offset:28672
v_cvt_pk_bf16_f32 v41, v42, v43
v_mfma_f32_16x16x32_bf16 v[144:147], a[188:191], v[52:55], v[144:147]
v_exp_f32 v18, v18
v_mfma_f32_16x16x32_bf16 v[176:179], a[188:191], v[56:59], v[176:179]
v_exp_f32 v19, v19
v_mfma_f32_16x16x32_bf16 v[208:211], a[188:191], v[68:71], v[208:211]
v_exp_f32 v28, v28
v_mfma_f32_16x16x32_bf16 v[240:243], a[188:191], v[72:75], v[240:243]
v_exp_f32 v29, v29
v_mfma_f32_16x16x32_bf16 v[92:95], a[188:191], a[232:235], v[92:95]
v_exp_f32 v30, v30
v_mfma_f32_16x16x32_bf16 v[100:103], a[188:191], a[236:239], v[100:103]
s_waitcnt lgkmcnt(2)
ds_read_b64_tr_b16 a[188:189], v5 offset:25600
v_cvt_pk_bf16_f32 v23, v18, v19
v_mfma_f32_16x16x32_bf16 v[52:55], a[192:195], a[96:99], 0
v_exp_f32 v31, v31
v_mfma_f32_16x16x32_bf16 v[56:59], a[192:195], a[112:115], 0
s_add_u32 m0, s30, 0x12000
s_add_u32 s37, s37, 0x2000
ds_read_b64_tr_b16 a[190:191], v5 offset:29696
v_cvt_pk_bf16_f32 v26, v28, v29
v_mfma_f32_16x16x32_bf16 v[68:71], a[192:195], a[128:131], 0
buffer_load_dwordx4 v11, s[12:15], s37 offen nt lds
v_mfma_f32_16x16x32_bf16 v[72:75], a[192:195], a[144:147], 0
v_exp_f32 v32, v32
v_mfma_f32_16x16x32_bf16 v[52:55], a[196:199], a[100:103], v[52:55]
v_exp_f32 v33, v33
v_mfma_f32_16x16x32_bf16 v[56:59], a[196:199], a[116:119], v[56:59]
v_exp_f32 v34, v34
v_mfma_f32_16x16x32_bf16 v[68:71], a[196:199], a[132:135], v[68:71]
v_exp_f32 v35, v35
v_mfma_f32_16x16x32_bf16 v[72:75], a[196:199], a[148:151], v[72:75]
v_exp_f32 v44, v44
v_mfma_f32_16x16x32_bf16 v[52:55], a[200:203], a[104:107], v[52:55]
v_exp_f32 v45, v45
v_mfma_f32_16x16x32_bf16 v[56:59], a[200:203], a[120:123], v[56:59]
v_exp_f32 v46, v46
v_mfma_f32_16x16x32_bf16 v[68:71], a[200:203], a[136:139], v[68:71]
v_exp_f32 v47, v47
v_mfma_f32_16x16x32_bf16 v[72:75], a[200:203], a[152:155], v[72:75]
v_cvt_pk_bf16_f32 v27, v30, v31
v_cvt_pk_bf16_f32 v38, v32, v33
v_mfma_f32_16x16x32_bf16 v[52:55], a[204:207], a[108:111], v[52:55]
v_cvt_pk_bf16_f32 v39, v34, v35
v_cvt_pk_bf16_f32 v42, v44, v45
v_mfma_f32_16x16x32_bf16 v[56:59], a[204:207], a[124:127], v[56:59]
v_cvt_pk_bf16_f32 v43, v46, v47
v_mfma_f32_16x16x32_bf16 v[68:71], a[204:207], a[140:143], v[68:71]
v_mfma_f32_16x16x32_bf16 v[72:75], a[204:207], a[156:159], v[72:75]
v_mfma_f32_16x16x32_bf16 v[48:51], a[208:211], a[96:99], 0
v_mfma_f32_16x16x32_bf16 v[60:63], a[208:211], a[112:115], 0
v_exp_f32 v52, v52
v_mfma_f32_16x16x32_bf16 v[64:67], a[208:211], a[128:131], 0
v_exp_f32 v53, v53
v_mfma_f32_16x16x32_bf16 v[76:79], a[208:211], a[144:147], 0
v_exp_f32 v54, v54
v_mfma_f32_16x16x32_bf16 v[48:51], a[212:215], a[100:103], v[48:51]
buffer_load_dwordx4 v11, s[12:15], s37 offen offset:2048 nt lds
v_mfma_f32_16x16x32_bf16 v[60:63], a[212:215], a[116:119], v[60:63]
v_exp_f32 v55, v55
v_mfma_f32_16x16x32_bf16 v[64:67], a[212:215], a[132:135], v[64:67]
v_exp_f32 v56, v56
v_mfma_f32_16x16x32_bf16 v[76:79], a[212:215], a[148:151], v[76:79]
v_exp_f32 v57, v57
v_mfma_f32_16x16x32_bf16 v[48:51], a[216:219], a[104:107], v[48:51]
v_exp_f32 v58, v58
v_mfma_f32_16x16x32_bf16 v[60:63], a[216:219], a[120:123], v[60:63]
v_exp_f32 v59, v59
v_mfma_f32_16x16x32_bf16 v[64:67], a[216:219], a[136:139], v[64:67]
v_exp_f32 v68, v68
v_mfma_f32_16x16x32_bf16 v[76:79], a[216:219], a[152:155], v[76:79]
v_exp_f32 v69, v69
v_mfma_f32_16x16x32_bf16 v[48:51], a[220:223], a[108:111], v[48:51]
v_exp_f32 v70, v70
v_mfma_f32_16x16x32_bf16 v[60:63], a[220:223], a[124:127], v[60:63]
v_exp_f32 v71, v71
v_mfma_f32_16x16x32_bf16 v[64:67], a[220:223], a[140:143], v[64:67]
v_cvt_pk_bf16_f32 v52, v52, v53
v_cvt_pk_bf16_f32 v53, v54, v55
v_mfma_f32_16x16x32_bf16 v[76:79], a[220:223], a[156:159], v[76:79]
s_waitcnt vmcnt(14) lgkmcnt(0)
s_barrier
ds_read_b128 a[224:227], v10 offset:0
v_mfma_f32_16x16x32_bf16 v[132:135], a[160:163], v[20:23], v[132:135]
v_exp_f32 v72, v72
v_mfma_f32_16x16x32_bf16 v[164:167], a[160:163], v[24:27], v[164:167]
ds_read_b128 a[228:231], v10 offset:1024
v_cvt_pk_bf16_f32 v56, v56, v57
v_mfma_f32_16x16x32_bf16 v[196:199], a[160:163], v[36:39], v[196:199]
v_exp_f32 v73, v73
v_mfma_f32_16x16x32_bf16 v[228:231], a[160:163], v[40:43], v[228:231]
ds_read_b128 a[192:195], v1 offset:32768
v_cvt_pk_bf16_f32 v57, v58, v59
v_mfma_f32_16x16x32_bf16 v[148:151], a[164:167], v[20:23], v[148:151]
v_exp_f32 v74, v74
v_mfma_f32_16x16x32_bf16 v[180:183], a[164:167], v[24:27], v[180:183]
s_add_u32 m0, s30, 0x2000
s_add_u32 s21, s21, 0x2000
ds_read_b128 a[196:199], v2 offset:32768
v_cvt_pk_bf16_f32 v68, v68, v69
v_mfma_f32_16x16x32_bf16 v[212:215], a[164:167], v[36:39], v[212:215]
buffer_load_dwordx4 v11, s[8:11], s21 offen nt lds
v_mfma_f32_16x16x32_bf16 v[244:247], a[164:167], v[40:43], v[244:247]
ds_read_b128 a[200:203], v1 offset:33792
v_cvt_pk_bf16_f32 v69, v70, v71
v_smfmac_f32_16x16x64_bf16 a[244:247], a[240:243], v[20:27], v110
ds_read_b128 a[204:207], v2 offset:33792
v_cvt_pk_bf16_f32 v72, v72, v73
v_mfma_f32_16x16x32_bf16 v[136:139], a[168:171], v[20:23], v[136:139]
v_exp_f32 v75, v75
v_mfma_f32_16x16x32_bf16 v[168:171], a[168:171], v[24:27], v[168:171]
ds_read_b128 a[208:211], v1 offset:36864
v_cvt_pk_bf16_f32 v73, v74, v75
v_mfma_f32_16x16x32_bf16 v[200:203], a[168:171], v[36:39], v[200:203]
v_exp_f32 v48, v48
v_mfma_f32_16x16x32_bf16 v[232:235], a[168:171], v[40:43], v[232:235]
ds_read_b128 a[212:215], v2 offset:36864
v_mfma_f32_16x16x32_bf16 v[152:155], a[172:175], v[20:23], v[152:155]
v_exp_f32 v49, v49
v_mfma_f32_16x16x32_bf16 v[184:187], a[172:175], v[24:27], v[184:187]
ds_read_b128 a[216:219], v1 offset:37888
v_cvt_pk_bf16_f32 v54, v48, v49
v_mfma_f32_16x16x32_bf16 v[216:219], a[172:175], v[36:39], v[216:219]
v_exp_f32 v50, v50
v_mfma_f32_16x16x32_bf16 v[248:251], a[172:175], v[40:43], v[248:251]
ds_read_b128 a[220:223], v2 offset:37888
v_smfmac_f32_16x16x64_bf16 a[248:251], a[240:243], v[36:43], v110
ds_read_b128 a[232:235], v3 offset:32768
v_mfma_f32_16x16x32_bf16 v[140:143], a[176:179], v[20:23], v[140:143]
v_exp_f32 v51, v51
v_mfma_f32_16x16x32_bf16 v[172:175], a[176:179], v[24:27], v[172:175]
ds_read_b128 a[236:239], v4 offset:32768
v_cvt_pk_bf16_f32 v55, v50, v51
v_mfma_f32_16x16x32_bf16 v[204:207], a[176:179], v[36:39], v[204:207]
buffer_load_dwordx4 v11, s[8:11], s21 offen offset:2048 nt lds
v_mfma_f32_16x16x32_bf16 v[236:239], a[176:179], v[40:43], v[236:239]
ds_read_b64_tr_b16 a[160:161], v6 offset:32768
v_mfma_f32_16x16x32_bf16 v[156:159], a[180:183], v[20:23], v[156:159]
v_exp_f32 v60, v60
v_mfma_f32_16x16x32_bf16 v[188:191], a[180:183], v[24:27], v[188:191]
ds_read_b64_tr_b16 a[162:163], v6 offset:36864
v_mfma_f32_16x16x32_bf16 v[220:223], a[180:183], v[36:39], v[220:223]
v_exp_f32 v61, v61
v_mfma_f32_16x16x32_bf16 v[252:255], a[180:183], v[40:43], v[252:255]
ds_read_b64_tr_b16 a[164:165], v6 offset:33792
v_cvt_pk_bf16_f32 v58, v60, v61
v_mfma_f32_16x16x32_bf16 v[128:131], a[184:187], v[20:23], v[128:131]
v_exp_f32 v62, v62
v_mfma_f32_16x16x32_bf16 v[160:163], a[184:187], v[24:27], v[160:163]
s_waitcnt lgkmcnt(5)
ds_read_b64_tr_b16 a[166:167], v6 offset:37888
v_mfma_f32_16x16x32_bf16 v[192:195], a[184:187], v[36:39], v[192:195]
v_exp_f32 v63, v63
v_mfma_f32_16x16x32_bf16 v[224:227], a[184:187], v[40:43], v[224:227]
ds_read_b64_tr_b16 a[168:169], v7 offset:32768
v_cvt_pk_bf16_f32 v59, v62, v63
v_mfma_f32_16x16x32_bf16 v[88:91], a[184:187], a[224:227], v[88:91]
v_exp_f32 v64, v64
v_mfma_f32_16x16x32_bf16 v[96:99], a[184:187], a[228:231], v[96:99]
ds_read_b64_tr_b16 a[170:171], v7 offset:36864
v_smfmac_f32_16x16x64_bf16 a[252:255], a[240:243], a[224:231], v110
ds_read_b64_tr_b16 a[172:173], v7 offset:33792
v_mfma_f32_16x16x32_bf16 v[144:147], a[188:191], v[20:23], v[144:147]
v_exp_f32 v65, v65
v_mfma_f32_16x16x32_bf16 v[176:179], a[188:191], v[24:27], v[176:179]
s_add_u32 m0, s30, 0x14000
s_add_u32 s37, s37, 0x2000
ds_read_b64_tr_b16 a[174:175], v7 offset:37888
v_cvt_pk_bf16_f32 v70, v64, v65
v_mfma_f32_16x16x32_bf16 v[208:211], a[188:191], v[36:39], v[208:211]
buffer_load_dwordx4 v11, s[12:15], s37 offen nt lds
v_mfma_f32_16x16x32_bf16 v[240:243], a[188:191], v[40:43], v[240:243]
ds_read_b64_tr_b16 a[176:177], v8 offset:32768
v_mfma_f32_16x16x32_bf16 v[92:95], a[188:191], a[224:227], v[92:95]
v_exp_f32 v66, v66
v_mfma_f32_16x16x32_bf16 v[100:103], a[188:191], a[228:231], v[100:103]
ds_read_b128 a[224:227], v3 offset:33792
v_mfma_f32_16x16x32_bf16 v[20:23], a[192:195], a[96:99], 0
v_exp_f32 v67, v67
v_mfma_f32_16x16x32_bf16 v[24:27], a[192:195], a[112:115], 0
ds_read_b128 a[228:231], v4 offset:33792
v_cvt_pk_bf16_f32 v71, v66, v67
v_mfma_f32_16x16x32_bf16 v[36:39], a[192:195], a[128:131], 0
v_exp_f32 v76, v76
v_mfma_f32_16x16x32_bf16 v[40:43], a[192:195], a[144:147], 0
ds_read_b64_tr_b16 a[178:179], v8 offset:36864
v_mfma_f32_16x16x32_bf16 v[20:23], a[196:199], a[100:103], v[20:23]
v_exp_f32 v77, v77
v_mfma_f32_16x16x32_bf16 v[24:27], a[196:199], a[116:119], v[24:27]
ds_read_b64_tr_b16 a[180:181], v8 offset:33792
v_cvt_pk_bf16_f32 v74, v76, v77
v_mfma_f32_16x16x32_bf16 v[36:39], a[196:199], a[132:135], v[36:39]
v_exp_f32 v78, v78
v_mfma_f32_16x16x32_bf16 v[40:43], a[196:199], a[148:151], v[40:43]
s_waitcnt lgkmcnt(5)
ds_read_b64_tr_b16 a[182:183], v8 offset:37888
v_mfma_f32_16x16x32_bf16 v[20:23], a[200:203], a[104:107], v[20:23]
v_exp_f32 v79, v79
v_mfma_f32_16x16x32_bf16 v[24:27], a[200:203], a[120:123], v[24:27]
ds_read_b64_tr_b16 a[184:185], v5 offset:32768
v_cvt_pk_bf16_f32 v75, v78, v79
v_mfma_f32_16x16x32_bf16 v[36:39], a[200:203], a[136:139], v[36:39]
v_mfma_f32_16x16x32_bf16 v[40:43], a[200:203], a[152:155], v[40:43]
buffer_load_dwordx4 v11, s[12:15], s37 offen offset:2048 nt lds
v_mfma_f32_16x16x32_bf16 v[20:23], a[204:207], a[108:111], v[20:23]
ds_read_b64_tr_b16 a[186:187], v5 offset:36864
v_mfma_f32_16x16x32_bf16 v[24:27], a[204:207], a[124:127], v[24:27]
v_mfma_f32_16x16x32_bf16 v[36:39], a[204:207], a[140:143], v[36:39]
ds_read_b64_tr_b16 a[188:189], v5 offset:33792
v_mfma_f32_16x16x32_bf16 v[40:43], a[204:207], a[156:159], v[40:43]
v_mfma_f32_16x16x32_bf16 v[16:19], a[208:211], a[96:99], 0
ds_read_b64_tr_b16 a[190:191], v5 offset:37888
v_mfma_f32_16x16x32_bf16 v[28:31], a[208:211], a[112:115], 0
v_exp_f32 v20, v20
v_mfma_f32_16x16x32_bf16 v[32:35], a[208:211], a[128:131], 0
ds_read_b128 a[192:195], v1 offset:40960
v_mfma_f32_16x16x32_bf16 v[44:47], a[208:211], a[144:147], 0
v_exp_f32 v21, v21
v_mfma_f32_16x16x32_bf16 v[16:19], a[212:215], a[100:103], v[16:19]
ds_read_b128 a[196:199], v2 offset:40960
v_cvt_pk_bf16_f32 v20, v20, v21
v_mfma_f32_16x16x32_bf16 v[28:31], a[212:215], a[116:119], v[28:31]
v_exp_f32 v22, v22
v_mfma_f32_16x16x32_bf16 v[32:35], a[212:215], a[132:135], v[32:35]
ds_read_b128 a[200:203], v1 offset:41984
v_mfma_f32_16x16x32_bf16 v[44:47], a[212:215], a[148:151], v[44:47]
v_exp_f32 v23, v23
v_mfma_f32_16x16x32_bf16 v[16:19], a[216:219], a[104:107], v[16:19]
ds_read_b128 a[204:207], v2 offset:41984
v_cvt_pk_bf16_f32 v21, v22, v23
v_mfma_f32_16x16x32_bf16 v[28:31], a[216:219], a[120:123], v[28:31]
s_add_u32 m0, s30, 0x4000
s_add_u32 s21, s21, 0x2000
v_exp_f32 v24, v24
v_mfma_f32_16x16x32_bf16 v[32:35], a[216:219], a[136:139], v[32:35]
buffer_load_dwordx4 v11, s[8:11], s21 offen nt lds
v_mfma_f32_16x16x32_bf16 v[44:47], a[216:219], a[152:155], v[44:47]
ds_read_b128 a[208:211], v1 offset:45056
v_mfma_f32_16x16x32_bf16 v[16:19], a[220:223], a[108:111], v[16:19]
v_exp_f32 v25, v25
v_mfma_f32_16x16x32_bf16 v[28:31], a[220:223], a[124:127], v[28:31]
s_waitcnt lgkmcnt(4)
ds_read_b128 a[212:215], v2 offset:45056
v_cvt_pk_bf16_f32 v24, v24, v25
v_mfma_f32_16x16x32_bf16 v[32:35], a[220:223], a[140:143], v[32:35]
v_exp_f32 v26, v26
v_mfma_f32_16x16x32_bf16 v[44:47], a[220:223], a[156:159], v[44:47]
ds_read_b128 a[216:219], v1 offset:46080
v_mfma_f32_16x16x32_bf16 v[80:83], a[232:235], a[64:67], 0
v_exp_f32 v27, v27
v_mfma_f32_16x16x32_bf16 v[84:87], a[232:235], a[80:83], 0
ds_read_b128 a[232:235], v10 offset:2048
v_cvt_pk_bf16_f32 v25, v26, v27
v_mfma_f32_16x16x32_bf16 v[80:83], a[236:239], a[68:71], v[80:83]
v_exp_f32 v36, v36
v_mfma_f32_16x16x32_bf16 v[84:87], a[236:239], a[84:87], v[84:87]
ds_read_b128 a[236:239], v10 offset:3072
v_mfma_f32_16x16x32_bf16 v[80:83], a[224:227], a[72:75], v[80:83]
v_exp_f32 v37, v37
v_mfma_f32_16x16x32_bf16 v[84:87], a[224:227], a[88:91], v[84:87]
ds_read_b128 a[220:223], v2 offset:46080
v_cvt_pk_bf16_f32 v36, v36, v37
v_mfma_f32_16x16x32_bf16 v[80:83], a[228:231], a[76:79], v[80:83]
v_exp_f32 v38, v38
v_mfma_f32_16x16x32_bf16 v[84:87], a[228:231], a[92:95], v[84:87]
v_exp_f32 v39, v39
v_mfma_f32_16x16x32_bf16 v[132:135], a[160:163], v[52:55], v[132:135]
v_exp_f32 v40, v40
v_mfma_f32_16x16x32_bf16 v[164:167], a[160:163], v[56:59], v[164:167]
buffer_load_dwordx4 v11, s[8:11], s21 offen offset:2048 nt lds
v_mfma_f32_16x16x32_bf16 v[196:199], a[160:163], v[68:71], v[196:199]
v_exp_f32 v80, v80
v_mfma_f32_16x16x32_bf16 v[228:231], a[160:163], v[72:75], v[228:231]
ds_read_b64_tr_b16 a[160:161], v6 offset:40960
v_cvt_pk_bf16_f32 v37, v38, v39
v_mfma_f32_16x16x32_bf16 v[148:151], a[164:167], v[52:55], v[148:151]
v_exp_f32 v81, v81
v_mfma_f32_16x16x32_bf16 v[180:183], a[164:167], v[56:59], v[180:183]
ds_read_b64_tr_b16 a[162:163], v6 offset:45056
v_cvt_pk_bf16_f32 v80, v80, v81
v_mfma_f32_16x16x32_bf16 v[212:215], a[164:167], v[68:71], v[212:215]
v_exp_f32 v82, v82
v_mfma_f32_16x16x32_bf16 v[244:247], a[164:167], v[72:75], v[244:247]
ds_read_b64_tr_b16 a[164:165], v6 offset:41984
v_smfmac_f32_16x16x64_bf16 a[244:247], a[240:243], v[52:59], v110
ds_read_b64_tr_b16 a[166:167], v6 offset:46080
v_mfma_f32_16x16x32_bf16 v[136:139], a[168:171], v[52:55], v[136:139]
v_exp_f32 v83, v83
v_mfma_f32_16x16x32_bf16 v[168:171], a[168:171], v[56:59], v[168:171]
v_exp_f32 v84, v84
v_mfma_f32_16x16x32_bf16 v[200:203], a[168:171], v[68:71], v[200:203]
v_exp_f32 v85, v85
v_mfma_f32_16x16x32_bf16 v[232:235], a[168:171], v[72:75], v[232:235]
ds_read_b64_tr_b16 a[168:169], v7 offset:40960
v_cvt_pk_bf16_f32 v81, v82, v83
v_mfma_f32_16x16x32_bf16 v[152:155], a[172:175], v[52:55], v[152:155]
ds_write_b64 v9, v[80:81] offset:4096
v_cvt_pk_bf16_f32 v84, v84, v85
v_mfma_f32_16x16x32_bf16 v[184:187], a[172:175], v[56:59], v[184:187]
s_waitcnt lgkmcnt(5)
ds_read_b64_tr_b16 a[170:171], v7 offset:45056
v_mfma_f32_16x16x32_bf16 v[216:219], a[172:175], v[68:71], v[216:219]
s_add_u32 m0, s30, 0x16000
s_add_u32 s37, s37, 0x2000
v_exp_f32 v86, v86
v_mfma_f32_16x16x32_bf16 v[248:251], a[172:175], v[72:75], v[248:251]
buffer_load_dwordx4 v11, s[12:15], s37 offen nt lds
v_smfmac_f32_16x16x64_bf16 a[248:251], a[240:243], v[68:75], v110
ds_read_b64_tr_b16 a[172:173], v7 offset:41984
v_mfma_f32_16x16x32_bf16 v[140:143], a[176:179], v[52:55], v[140:143]
v_exp_f32 v87, v87
v_mfma_f32_16x16x32_bf16 v[172:175], a[176:179], v[56:59], v[172:175]
ds_read_b64_tr_b16 a[174:175], v7 offset:46080
v_cvt_pk_bf16_f32 v85, v86, v87
v_mfma_f32_16x16x32_bf16 v[204:207], a[176:179], v[68:71], v[204:207]
ds_write_b64 v9, v[84:85] offset:5120
v_mfma_f32_16x16x32_bf16 v[236:239], a[176:179], v[72:75], v[236:239]
ds_read_b64_tr_b16 a[176:177], v8 offset:40960
v_mfma_f32_16x16x32_bf16 v[156:159], a[180:183], v[52:55], v[156:159]
v_exp_f32 v41, v41
v_mfma_f32_16x16x32_bf16 v[188:191], a[180:183], v[56:59], v[188:191]
ds_read_b64_tr_b16 a[178:179], v8 offset:45056
v_cvt_pk_bf16_f32 v40, v40, v41
v_mfma_f32_16x16x32_bf16 v[220:223], a[180:183], v[68:71], v[220:223]
v_exp_f32 v42, v42
v_mfma_f32_16x16x32_bf16 v[252:255], a[180:183], v[72:75], v[252:255]
ds_read_b64_tr_b16 a[180:181], v8 offset:41984
v_mfma_f32_16x16x32_bf16 v[128:131], a[184:187], v[52:55], v[128:131]
v_exp_f32 v43, v43
v_mfma_f32_16x16x32_bf16 v[160:163], a[184:187], v[56:59], v[160:163]
ds_read_b64_tr_b16 a[182:183], v8 offset:46080
v_cvt_pk_bf16_f32 v41, v42, v43
v_mfma_f32_16x16x32_bf16 v[192:195], a[184:187], v[68:71], v[192:195]
v_exp_f32 v16, v16
v_mfma_f32_16x16x32_bf16 v[224:227], a[184:187], v[72:75], v[224:227]
v_exp_f32 v17, v17
v_mfma_f32_16x16x32_bf16 v[88:91], a[184:187], a[232:235], v[88:91]
v_exp_f32 v18, v18
v_mfma_f32_16x16x32_bf16 v[96:99], a[184:187], a[236:239], v[96:99]
buffer_load_dwordx4 v11, s[12:15], s37 offen offset:2048 nt lds
v_smfmac_f32_16x16x64_bf16 a[252:255], a[240:243], a[232:239], v110
ds_read_b64_tr_b16 a[184:185], v5 offset:40960
v_cvt_pk_bf16_f32 v22, v16, v17
v_mfma_f32_16x16x32_bf16 v[144:147], a[188:191], v[52:55], v[144:147]
v_exp_f32 v19, v19
v_mfma_f32_16x16x32_bf16 v[176:179], a[188:191], v[56:59], v[176:179]
ds_read_b64_tr_b16 a[186:187], v5 offset:45056
v_cvt_pk_bf16_f32 v23, v18, v19
v_mfma_f32_16x16x32_bf16 v[208:211], a[188:191], v[68:71], v[208:211]
v_exp_f32 v28, v28
v_mfma_f32_16x16x32_bf16 v[240:243], a[188:191], v[72:75], v[240:243]
v_exp_f32 v29, v29
v_mfma_f32_16x16x32_bf16 v[92:95], a[188:191], a[232:235], v[92:95]
v_exp_f32 v30, v30
v_mfma_f32_16x16x32_bf16 v[100:103], a[188:191], a[236:239], v[100:103]
s_waitcnt lgkmcnt(2)
ds_read_b64_tr_b16 a[188:189], v5 offset:41984
v_cvt_pk_bf16_f32 v26, v28, v29
v_mfma_f32_16x16x32_bf16 v[52:55], a[192:195], a[96:99], 0
v_exp_f32 v31, v31
v_mfma_f32_16x16x32_bf16 v[56:59], a[192:195], a[112:115], 0
ds_read_b64_tr_b16 a[190:191], v5 offset:46080
v_cvt_pk_bf16_f32 v27, v30, v31
v_mfma_f32_16x16x32_bf16 v[68:71], a[192:195], a[128:131], 0
v_exp_f32 v32, v32
v_mfma_f32_16x16x32_bf16 v[72:75], a[192:195], a[144:147], 0
v_exp_f32 v33, v33
v_mfma_f32_16x16x32_bf16 v[52:55], a[196:199], a[100:103], v[52:55]
v_exp_f32 v34, v34
v_mfma_f32_16x16x32_bf16 v[56:59], a[196:199], a[116:119], v[56:59]
v_exp_f32 v35, v35
v_mfma_f32_16x16x32_bf16 v[68:71], a[196:199], a[132:135], v[68:71]
s_add_u32 m0, s30, 0x6000
s_add_u32 s21, s21, 0x2000
v_exp_f32 v44, v44
v_mfma_f32_16x16x32_bf16 v[72:75], a[196:199], a[148:151], v[72:75]
buffer_load_dwordx4 v11, s[8:11], s21 offen nt lds
v_mfma_f32_16x16x32_bf16 v[52:55], a[200:203], a[104:107], v[52:55]
v_exp_f32 v45, v45
v_mfma_f32_16x16x32_bf16 v[56:59], a[200:203], a[120:123], v[56:59]
v_exp_f32 v46, v46
v_mfma_f32_16x16x32_bf16 v[68:71], a[200:203], a[136:139], v[68:71]
v_exp_f32 v47, v47
v_mfma_f32_16x16x32_bf16 v[72:75], a[200:203], a[152:155], v[72:75]
v_cvt_pk_bf16_f32 v38, v32, v33
v_cvt_pk_bf16_f32 v39, v34, v35
v_mfma_f32_16x16x32_bf16 v[52:55], a[204:207], a[108:111], v[52:55]
v_cvt_pk_bf16_f32 v42, v44, v45
v_cvt_pk_bf16_f32 v43, v46, v47
v_mfma_f32_16x16x32_bf16 v[56:59], a[204:207], a[124:127], v[56:59]
v_mfma_f32_16x16x32_bf16 v[68:71], a[204:207], a[140:143], v[68:71]
v_mfma_f32_16x16x32_bf16 v[72:75], a[204:207], a[156:159], v[72:75]
v_mfma_f32_16x16x32_bf16 v[48:51], a[208:211], a[96:99], 0
v_mfma_f32_16x16x32_bf16 v[60:63], a[208:211], a[112:115], 0
v_mfma_f32_16x16x32_bf16 v[64:67], a[208:211], a[128:131], 0
v_exp_f32 v52, v52
v_mfma_f32_16x16x32_bf16 v[76:79], a[208:211], a[144:147], 0
v_exp_f32 v53, v53
v_mfma_f32_16x16x32_bf16 v[48:51], a[212:215], a[100:103], v[48:51]
v_exp_f32 v54, v54
v_mfma_f32_16x16x32_bf16 v[60:63], a[212:215], a[116:119], v[60:63]
v_exp_f32 v55, v55
v_mfma_f32_16x16x32_bf16 v[64:67], a[212:215], a[132:135], v[64:67]
buffer_load_dwordx4 v11, s[8:11], s21 offen offset:2048 nt lds
v_mfma_f32_16x16x32_bf16 v[76:79], a[212:215], a[148:151], v[76:79]
v_exp_f32 v56, v56
v_mfma_f32_16x16x32_bf16 v[48:51], a[216:219], a[104:107], v[48:51]
v_exp_f32 v57, v57
v_mfma_f32_16x16x32_bf16 v[60:63], a[216:219], a[120:123], v[60:63]
v_exp_f32 v58, v58
v_mfma_f32_16x16x32_bf16 v[64:67], a[216:219], a[136:139], v[64:67]
v_exp_f32 v59, v59
v_mfma_f32_16x16x32_bf16 v[76:79], a[216:219], a[152:155], v[76:79]
v_exp_f32 v68, v68
v_mfma_f32_16x16x32_bf16 v[48:51], a[220:223], a[108:111], v[48:51]
v_exp_f32 v69, v69
v_mfma_f32_16x16x32_bf16 v[60:63], a[220:223], a[124:127], v[60:63]
v_exp_f32 v70, v70
v_mfma_f32_16x16x32_bf16 v[64:67], a[220:223], a[140:143], v[64:67]
v_exp_f32 v71, v71
v_mfma_f32_16x16x32_bf16 v[76:79], a[220:223], a[156:159], v[76:79]
s_waitcnt vmcnt(16) lgkmcnt(0)
s_barrier
ds_read_b128 a[224:227], v10 offset:4096
v_mfma_f32_16x16x32_bf16 v[132:135], a[160:163], v[20:23], v[132:135]
v_cvt_pk_bf16_f32 v52, v52, v53
v_cvt_pk_bf16_f32 v53, v54, v55
v_mfma_f32_16x16x32_bf16 v[164:167], a[160:163], v[24:27], v[164:167]
ds_read_b128 a[228:231], v10 offset:5120
v_cvt_pk_bf16_f32 v56, v56, v57
v_mfma_f32_16x16x32_bf16 v[196:199], a[160:163], v[36:39], v[196:199]
v_exp_f32 v72, v72
v_mfma_f32_16x16x32_bf16 v[228:231], a[160:163], v[40:43], v[228:231]
ds_read_b128 a[192:195], v1 offset:49152
v_cvt_pk_bf16_f32 v57, v58, v59
v_mfma_f32_16x16x32_bf16 v[148:151], a[164:167], v[20:23], v[148:151]
v_exp_f32 v73, v73
v_mfma_f32_16x16x32_bf16 v[180:183], a[164:167], v[24:27], v[180:183]
s_add_u32 m0, s30, 0x18000
s_add_u32 s37, s37, 0x2000
ds_read_b128 a[196:199], v2 offset:49152
v_cvt_pk_bf16_f32 v68, v68, v69
v_mfma_f32_16x16x32_bf16 v[212:215], a[164:167], v[36:39], v[212:215]
buffer_load_dwordx4 v11, s[12:15], s37 offen nt lds
v_mfma_f32_16x16x32_bf16 v[244:247], a[164:167], v[40:43], v[244:247]
ds_read_b128 a[200:203], v1 offset:50176
v_cvt_pk_bf16_f32 v69, v70, v71
v_smfmac_f32_16x16x64_bf16 a[244:247], a[240:243], v[20:27], v110
ds_read_b128 a[204:207], v2 offset:50176
v_cvt_pk_bf16_f32 v72, v72, v73
v_mfma_f32_16x16x32_bf16 v[136:139], a[168:171], v[20:23], v[136:139]
v_exp_f32 v74, v74
v_mfma_f32_16x16x32_bf16 v[168:171], a[168:171], v[24:27], v[168:171]
ds_read_b128 a[208:211], v1 offset:53248
v_mfma_f32_16x16x32_bf16 v[200:203], a[168:171], v[36:39], v[200:203]
v_exp_f32 v75, v75
v_mfma_f32_16x16x32_bf16 v[232:235], a[168:171], v[40:43], v[232:235]
ds_read_b128 a[212:215], v2 offset:53248
v_cvt_pk_bf16_f32 v73, v74, v75
v_mfma_f32_16x16x32_bf16 v[152:155], a[172:175], v[20:23], v[152:155]
v_exp_f32 v48, v48
v_mfma_f32_16x16x32_bf16 v[184:187], a[172:175], v[24:27], v[184:187]
ds_read_b128 a[216:219], v1 offset:54272
v_mfma_f32_16x16x32_bf16 v[216:219], a[172:175], v[36:39], v[216:219]
v_exp_f32 v49, v49
v_mfma_f32_16x16x32_bf16 v[248:251], a[172:175], v[40:43], v[248:251]
ds_read_b128 a[220:223], v2 offset:54272
v_cvt_pk_bf16_f32 v54, v48, v49
v_smfmac_f32_16x16x64_bf16 a[248:251], a[240:243], v[36:43], v110
ds_read_b128 a[232:235], v3 offset:49152
v_mfma_f32_16x16x32_bf16 v[140:143], a[176:179], v[20:23], v[140:143]
v_exp_f32 v50, v50
v_mfma_f32_16x16x32_bf16 v[172:175], a[176:179], v[24:27], v[172:175]
ds_read_b128 a[236:239], v4 offset:49152
v_mfma_f32_16x16x32_bf16 v[204:207], a[176:179], v[36:39], v[204:207]
v_exp_f32 v51, v51
v_mfma_f32_16x16x32_bf16 v[236:239], a[176:179], v[40:43], v[236:239]
ds_read_b64_tr_b16 a[160:161], v6 offset:49152
v_cvt_pk_bf16_f32 v55, v50, v51
v_mfma_f32_16x16x32_bf16 v[156:159], a[180:183], v[20:23], v[156:159]
v_exp_f32 v60, v60
v_mfma_f32_16x16x32_bf16 v[188:191], a[180:183], v[24:27], v[188:191]
ds_read_b64_tr_b16 a[162:163], v6 offset:53248
v_mfma_f32_16x16x32_bf16 v[220:223], a[180:183], v[36:39], v[220:223]
v_exp_f32 v61, v61
v_mfma_f32_16x16x32_bf16 v[252:255], a[180:183], v[40:43], v[252:255]
buffer_load_dwordx4 v11, s[12:15], s37 offen offset:2048 nt lds
v_mfma_f32_16x16x32_bf16 v[128:131], a[184:187], v[20:23], v[128:131]
ds_read_b64_tr_b16 a[164:165], v6 offset:50176
v_cvt_pk_bf16_f32 v58, v60, v61
v_mfma_f32_16x16x32_bf16 v[160:163], a[184:187], v[24:27], v[160:163]
v_exp_f32 v62, v62
v_mfma_f32_16x16x32_bf16 v[192:195], a[184:187], v[36:39], v[192:195]
s_waitcnt lgkmcnt(4)
ds_read_b64_tr_b16 a[166:167], v6 offset:54272
v_mfma_f32_16x16x32_bf16 v[224:227], a[184:187], v[40:43], v[224:227]
v_exp_f32 v63, v63
v_mfma_f32_16x16x32_bf16 v[88:91], a[184:187], a[224:227], v[88:91]
ds_read_b64_tr_b16 a[168:169], v7 offset:49152
v_cvt_pk_bf16_f32 v59, v62, v63
v_mfma_f32_16x16x32_bf16 v[96:99], a[184:187], a[228:231], v[96:99]
v_exp_f32 v64, v64
v_smfmac_f32_16x16x64_bf16 a[252:255], a[240:243], a[224:231], v110
ds_read_b64_tr_b16 a[170:171], v7 offset:53248
v_mfma_f32_16x16x32_bf16 v[144:147], a[188:191], v[20:23], v[144:147]
v_exp_f32 v65, v65
v_mfma_f32_16x16x32_bf16 v[176:179], a[188:191], v[24:27], v[176:179]
ds_read_b64_tr_b16 a[172:173], v7 offset:50176
v_cvt_pk_bf16_f32 v70, v64, v65
v_mfma_f32_16x16x32_bf16 v[208:211], a[188:191], v[36:39], v[208:211]
v_exp_f32 v66, v66
v_mfma_f32_16x16x32_bf16 v[240:243], a[188:191], v[40:43], v[240:243]
ds_read_b64_tr_b16 a[174:175], v7 offset:54272
v_mfma_f32_16x16x32_bf16 v[92:95], a[188:191], a[224:227], v[92:95]
v_exp_f32 v67, v67
v_mfma_f32_16x16x32_bf16 v[100:103], a[188:191], a[228:231], v[100:103]
ds_read_b128 a[224:227], v3 offset:50176
v_cvt_pk_bf16_f32 v71, v66, v67
v_mfma_f32_16x16x32_bf16 v[20:23], a[192:195], a[96:99], 0
v_exp_f32 v76, v76
v_mfma_f32_16x16x32_bf16 v[24:27], a[192:195], a[112:115], 0
ds_read_b128 a[228:231], v4 offset:50176
v_mfma_f32_16x16x32_bf16 v[36:39], a[192:195], a[128:131], 0
v_exp_f32 v77, v77
v_mfma_f32_16x16x32_bf16 v[40:43], a[192:195], a[144:147], 0
ds_read_b64_tr_b16 a[176:177], v8 offset:49152
v_cvt_pk_bf16_f32 v74, v76, v77
v_mfma_f32_16x16x32_bf16 v[20:23], a[196:199], a[100:103], v[20:23]
s_add_u32 m0, s30, 0x8000
s_add_u32 s21, s21, 0x2000
v_exp_f32 v78, v78
v_mfma_f32_16x16x32_bf16 v[24:27], a[196:199], a[116:119], v[24:27]
buffer_load_dwordx4 v11, s[8:11], s21 offen nt lds
v_mfma_f32_16x16x32_bf16 v[36:39], a[196:199], a[132:135], v[36:39]
ds_read_b64_tr_b16 a[178:179], v8 offset:53248
v_mfma_f32_16x16x32_bf16 v[40:43], a[196:199], a[148:151], v[40:43]
v_exp_f32 v79, v79
v_mfma_f32_16x16x32_bf16 v[20:23], a[200:203], a[104:107], v[20:23]
ds_read_b64_tr_b16 a[180:181], v8 offset:50176
v_cvt_pk_bf16_f32 v75, v78, v79
v_mfma_f32_16x16x32_bf16 v[24:27], a[200:203], a[120:123], v[24:27]
v_mfma_f32_16x16x32_bf16 v[36:39], a[200:203], a[136:139], v[36:39]
ds_read_b64_tr_b16 a[182:183], v8 offset:54272
v_mfma_f32_16x16x32_bf16 v[40:43], a[200:203], a[152:155], v[40:43]
v_mfma_f32_16x16x32_bf16 v[20:23], a[204:207], a[108:111], v[20:23]
s_waitcnt lgkmcnt(4)
ds_read_b64_tr_b16 a[184:185], v5 offset:49152
v_mfma_f32_16x16x32_bf16 v[24:27], a[204:207], a[124:127], v[24:27]
v_mfma_f32_16x16x32_bf16 v[36:39], a[204:207], a[140:143], v[36:39]
ds_read_b64_tr_b16 a[186:187], v5 offset:53248
v_mfma_f32_16x16x32_bf16 v[40:43], a[204:207], a[156:159], v[40:43]
v_mfma_f32_16x16x32_bf16 v[16:19], a[208:211], a[96:99], 0
ds_read_b64_tr_b16 a[188:189], v5 offset:50176
v_mfma_f32_16x16x32_bf16 v[28:31], a[208:211], a[112:115], 0
v_exp_f32 v20, v20
v_mfma_f32_16x16x32_bf16 v[32:35], a[208:211], a[128:131], 0
ds_read_b64_tr_b16 a[190:191], v5 offset:54272
v_mfma_f32_16x16x32_bf16 v[44:47], a[208:211], a[144:147], 0
v_exp_f32 v21, v21
v_mfma_f32_16x16x32_bf16 v[16:19], a[212:215], a[100:103], v[16:19]
ds_read_b128 a[192:195], v1 offset:57344
v_cvt_pk_bf16_f32 v20, v20, v21
v_mfma_f32_16x16x32_bf16 v[28:31], a[212:215], a[116:119], v[28:31]
v_exp_f32 v22, v22
v_mfma_f32_16x16x32_bf16 v[32:35], a[212:215], a[132:135], v[32:35]
ds_read_b128 a[196:199], v2 offset:57344
v_mfma_f32_16x16x32_bf16 v[44:47], a[212:215], a[148:151], v[44:47]
v_exp_f32 v23, v23
v_mfma_f32_16x16x32_bf16 v[16:19], a[216:219], a[104:107], v[16:19]
buffer_load_dwordx4 v11, s[8:11], s21 offen offset:2048 nt lds
v_mfma_f32_16x16x32_bf16 v[28:31], a[216:219], a[120:123], v[28:31]
ds_read_b128 a[200:203], v1 offset:58368
v_cvt_pk_bf16_f32 v21, v22, v23
v_mfma_f32_16x16x32_bf16 v[32:35], a[216:219], a[136:139], v[32:35]
v_exp_f32 v24, v24
v_mfma_f32_16x16x32_bf16 v[44:47], a[216:219], a[152:155], v[44:47]
ds_read_b128 a[204:207], v2 offset:58368
v_mfma_f32_16x16x32_bf16 v[16:19], a[220:223], a[108:111], v[16:19]
v_exp_f32 v25, v25
v_mfma_f32_16x16x32_bf16 v[28:31], a[220:223], a[124:127], v[28:31]
ds_read_b128 a[208:211], v1 offset:61440
v_cvt_pk_bf16_f32 v24, v24, v25
v_mfma_f32_16x16x32_bf16 v[32:35], a[220:223], a[140:143], v[32:35]
v_exp_f32 v26, v26
v_mfma_f32_16x16x32_bf16 v[44:47], a[220:223], a[156:159], v[44:47]
ds_read_b128 a[212:215], v2 offset:61440
v_mfma_f32_16x16x32_bf16 v[80:83], a[232:235], a[64:67], 0
v_exp_f32 v27, v27
v_mfma_f32_16x16x32_bf16 v[84:87], a[232:235], a[80:83], 0
ds_read_b128 a[232:235], v10 offset:6144
v_cvt_pk_bf16_f32 v25, v26, v27
v_mfma_f32_16x16x32_bf16 v[80:83], a[236:239], a[68:71], v[80:83]
v_exp_f32 v36, v36
v_mfma_f32_16x16x32_bf16 v[84:87], a[236:239], a[84:87], v[84:87]
s_waitcnt lgkmcnt(5)
ds_read_b128 a[236:239], v10 offset:7168
v_mfma_f32_16x16x32_bf16 v[80:83], a[224:227], a[72:75], v[80:83]
v_exp_f32 v37, v37
v_mfma_f32_16x16x32_bf16 v[84:87], a[224:227], a[88:91], v[84:87]
ds_read_b128 a[216:219], v1 offset:62464
v_cvt_pk_bf16_f32 v36, v36, v37
v_mfma_f32_16x16x32_bf16 v[80:83], a[228:231], a[76:79], v[80:83]
v_exp_f32 v38, v38
v_mfma_f32_16x16x32_bf16 v[84:87], a[228:231], a[92:95], v[84:87]
ds_read_b128 a[220:223], v2 offset:62464
v_mfma_f32_16x16x32_bf16 v[132:135], a[160:163], v[52:55], v[132:135]
v_exp_f32 v39, v39
v_mfma_f32_16x16x32_bf16 v[164:167], a[160:163], v[56:59], v[164:167]
v_exp_f32 v40, v40
v_mfma_f32_16x16x32_bf16 v[196:199], a[160:163], v[68:71], v[196:199]
s_add_u32 m0, s30, 0x1a000
s_add_u32 s37, s37, 0x2000
v_exp_f32 v80, v80
v_mfma_f32_16x16x32_bf16 v[228:231], a[160:163], v[72:75], v[228:231]
buffer_load_dwordx4 v11, s[12:15], s37 offen nt lds
v_mfma_f32_16x16x32_bf16 v[148:151], a[164:167], v[52:55], v[148:151]
ds_read_b64_tr_b16 a[160:161], v6 offset:57344
v_cvt_pk_bf16_f32 v37, v38, v39
v_mfma_f32_16x16x32_bf16 v[180:183], a[164:167], v[56:59], v[180:183]
v_exp_f32 v81, v81
v_mfma_f32_16x16x32_bf16 v[212:215], a[164:167], v[68:71], v[212:215]
ds_read_b64_tr_b16 a[162:163], v6 offset:61440
v_cvt_pk_bf16_f32 v80, v80, v81
v_mfma_f32_16x16x32_bf16 v[244:247], a[164:167], v[72:75], v[244:247]
v_exp_f32 v82, v82
v_smfmac_f32_16x16x64_bf16 a[244:247], a[240:243], v[52:59], v110
ds_read_b64_tr_b16 a[164:165], v6 offset:58368
v_mfma_f32_16x16x32_bf16 v[136:139], a[168:171], v[52:55], v[136:139]
v_exp_f32 v83, v83
v_mfma_f32_16x16x32_bf16 v[168:171], a[168:171], v[56:59], v[168:171]
ds_read_b64_tr_b16 a[166:167], v6 offset:62464
v_cvt_pk_bf16_f32 v81, v82, v83
v_mfma_f32_16x16x32_bf16 v[200:203], a[168:171], v[68:71], v[200:203]
ds_write_b64 v9, v[80:81] offset:0
v_mfma_f32_16x16x32_bf16 v[232:235], a[168:171], v[72:75], v[232:235]
ds_read_b64_tr_b16 a[168:169], v7 offset:57344
v_mfma_f32_16x16x32_bf16 v[152:155], a[172:175], v[52:55], v[152:155]
v_exp_f32 v84, v84
v_mfma_f32_16x16x32_bf16 v[184:187], a[172:175], v[56:59], v[184:187]
ds_read_b64_tr_b16 a[170:171], v7 offset:61440
v_mfma_f32_16x16x32_bf16 v[216:219], a[172:175], v[68:71], v[216:219]
v_exp_f32 v85, v85
v_mfma_f32_16x16x32_bf16 v[248:251], a[172:175], v[72:75], v[248:251]
s_waitcnt lgkmcnt(6)
ds_read_b64_tr_b16 a[172:173], v7 offset:58368
v_cvt_pk_bf16_f32 v84, v84, v85
v_smfmac_f32_16x16x64_bf16 a[248:251], a[240:243], v[68:75], v110
ds_read_b64_tr_b16 a[174:175], v7 offset:62464
v_mfma_f32_16x16x32_bf16 v[140:143], a[176:179], v[52:55], v[140:143]
v_exp_f32 v86, v86
v_mfma_f32_16x16x32_bf16 v[172:175], a[176:179], v[56:59], v[172:175]
v_exp_f32 v87, v87
v_mfma_f32_16x16x32_bf16 v[204:207], a[176:179], v[68:71], v[204:207]
v_exp_f32 v41, v41
v_mfma_f32_16x16x32_bf16 v[236:239], a[176:179], v[72:75], v[236:239]
ds_read_b64_tr_b16 a[176:177], v8 offset:57344
v_cvt_pk_bf16_f32 v85, v86, v87
v_mfma_f32_16x16x32_bf16 v[156:159], a[180:183], v[52:55], v[156:159]
buffer_load_dwordx4 v11, s[12:15], s37 offen offset:2048 nt lds
v_mfma_f32_16x16x32_bf16 v[188:191], a[180:183], v[56:59], v[188:191]
ds_read_b64_tr_b16 a[178:179], v8 offset:61440
v_cvt_pk_bf16_f32 v40, v40, v41
v_mfma_f32_16x16x32_bf16 v[220:223], a[180:183], v[68:71], v[220:223]
ds_write_b64 v9, v[84:85] offset:1024
v_mfma_f32_16x16x32_bf16 v[252:255], a[180:183], v[72:75], v[252:255]
ds_read_b64_tr_b16 a[180:181], v8 offset:58368
v_mfma_f32_16x16x32_bf16 v[128:131], a[184:187], v[52:55], v[128:131]
v_exp_f32 v42, v42
v_mfma_f32_16x16x32_bf16 v[160:163], a[184:187], v[56:59], v[160:163]
ds_read_b64_tr_b16 a[182:183], v8 offset:62464
v_mfma_f32_16x16x32_bf16 v[192:195], a[184:187], v[68:71], v[192:195]
v_exp_f32 v43, v43
v_mfma_f32_16x16x32_bf16 v[224:227], a[184:187], v[72:75], v[224:227]
v_exp_f32 v16, v16
v_mfma_f32_16x16x32_bf16 v[88:91], a[184:187], a[232:235], v[88:91]
v_exp_f32 v17, v17
v_mfma_f32_16x16x32_bf16 v[96:99], a[184:187], a[236:239], v[96:99]
ds_read_b64_tr_b16 a[184:185], v5 offset:57344
v_cvt_pk_bf16_f32 v22, v16, v17
v_smfmac_f32_16x16x64_bf16 a[252:255], a[240:243], a[232:239], v110
ds_read_b64_tr_b16 a[186:187], v5 offset:61440
v_cvt_pk_bf16_f32 v41, v42, v43
v_mfma_f32_16x16x32_bf16 v[144:147], a[188:191], v[52:55], v[144:147]
v_exp_f32 v18, v18
v_mfma_f32_16x16x32_bf16 v[176:179], a[188:191], v[56:59], v[176:179]
v_exp_f32 v19, v19
v_mfma_f32_16x16x32_bf16 v[208:211], a[188:191], v[68:71], v[208:211]
v_exp_f32 v28, v28
v_mfma_f32_16x16x32_bf16 v[240:243], a[188:191], v[72:75], v[240:243]
v_exp_f32 v29, v29
v_mfma_f32_16x16x32_bf16 v[92:95], a[188:191], a[232:235], v[92:95]
v_exp_f32 v30, v30
v_mfma_f32_16x16x32_bf16 v[100:103], a[188:191], a[236:239], v[100:103]
s_waitcnt lgkmcnt(2)
ds_read_b64_tr_b16 a[188:189], v5 offset:58368
v_cvt_pk_bf16_f32 v23, v18, v19
v_mfma_f32_16x16x32_bf16 v[52:55], a[192:195], a[96:99], 0
v_exp_f32 v31, v31
v_mfma_f32_16x16x32_bf16 v[56:59], a[192:195], a[112:115], 0
s_add_u32 m0, s30, 0xa000
s_add_u32 s21, s21, 0x2000
ds_read_b64_tr_b16 a[190:191], v5 offset:62464
v_cvt_pk_bf16_f32 v26, v28, v29
v_mfma_f32_16x16x32_bf16 v[68:71], a[192:195], a[128:131], 0
buffer_load_dwordx4 v11, s[8:11], s21 offen nt lds
v_mfma_f32_16x16x32_bf16 v[72:75], a[192:195], a[144:147], 0
v_exp_f32 v32, v32
v_mfma_f32_16x16x32_bf16 v[52:55], a[196:199], a[100:103], v[52:55]
v_exp_f32 v33, v33
v_mfma_f32_16x16x32_bf16 v[56:59], a[196:199], a[116:119], v[56:59]
v_exp_f32 v34, v34
v_mfma_f32_16x16x32_bf16 v[68:71], a[196:199], a[132:135], v[68:71]
v_exp_f32 v35, v35
v_mfma_f32_16x16x32_bf16 v[72:75], a[196:199], a[148:151], v[72:75]
v_exp_f32 v44, v44
v_mfma_f32_16x16x32_bf16 v[52:55], a[200:203], a[104:107], v[52:55]
v_exp_f32 v45, v45
v_mfma_f32_16x16x32_bf16 v[56:59], a[200:203], a[120:123], v[56:59]
v_exp_f32 v46, v46
v_mfma_f32_16x16x32_bf16 v[68:71], a[200:203], a[136:139], v[68:71]
v_exp_f32 v47, v47
v_mfma_f32_16x16x32_bf16 v[72:75], a[200:203], a[152:155], v[72:75]
v_cvt_pk_bf16_f32 v27, v30, v31
v_cvt_pk_bf16_f32 v38, v32, v33
v_mfma_f32_16x16x32_bf16 v[52:55], a[204:207], a[108:111], v[52:55]
v_cvt_pk_bf16_f32 v39, v34, v35
v_cvt_pk_bf16_f32 v42, v44, v45
v_mfma_f32_16x16x32_bf16 v[56:59], a[204:207], a[124:127], v[56:59]
v_cvt_pk_bf16_f32 v43, v46, v47
v_mfma_f32_16x16x32_bf16 v[68:71], a[204:207], a[140:143], v[68:71]
v_mfma_f32_16x16x32_bf16 v[72:75], a[204:207], a[156:159], v[72:75]
v_mfma_f32_16x16x32_bf16 v[48:51], a[208:211], a[96:99], 0
v_mfma_f32_16x16x32_bf16 v[60:63], a[208:211], a[112:115], 0
v_exp_f32 v52, v52
v_mfma_f32_16x16x32_bf16 v[64:67], a[208:211], a[128:131], 0
v_exp_f32 v53, v53
v_mfma_f32_16x16x32_bf16 v[76:79], a[208:211], a[144:147], 0
v_exp_f32 v54, v54
v_mfma_f32_16x16x32_bf16 v[48:51], a[212:215], a[100:103], v[48:51]
buffer_load_dwordx4 v11, s[8:11], s21 offen offset:2048 nt lds
v_mfma_f32_16x16x32_bf16 v[60:63], a[212:215], a[116:119], v[60:63]
v_exp_f32 v55, v55
v_mfma_f32_16x16x32_bf16 v[64:67], a[212:215], a[132:135], v[64:67]
v_exp_f32 v56, v56
v_mfma_f32_16x16x32_bf16 v[76:79], a[212:215], a[148:151], v[76:79]
v_exp_f32 v57, v57
v_mfma_f32_16x16x32_bf16 v[48:51], a[216:219], a[104:107], v[48:51]
v_exp_f32 v58, v58
v_mfma_f32_16x16x32_bf16 v[60:63], a[216:219], a[120:123], v[60:63]
v_exp_f32 v59, v59
v_mfma_f32_16x16x32_bf16 v[64:67], a[216:219], a[136:139], v[64:67]
v_exp_f32 v68, v68
v_mfma_f32_16x16x32_bf16 v[76:79], a[216:219], a[152:155], v[76:79]
v_exp_f32 v69, v69
v_mfma_f32_16x16x32_bf16 v[48:51], a[220:223], a[108:111], v[48:51]
v_exp_f32 v70, v70
v_mfma_f32_16x16x32_bf16 v[60:63], a[220:223], a[124:127], v[60:63]
v_exp_f32 v71, v71
v_mfma_f32_16x16x32_bf16 v[64:67], a[220:223], a[140:143], v[64:67]
v_cvt_pk_bf16_f32 v52, v52, v53
v_cvt_pk_bf16_f32 v53, v54, v55
v_mfma_f32_16x16x32_bf16 v[76:79], a[220:223], a[156:159], v[76:79]
s_waitcnt vmcnt(16) lgkmcnt(0)
s_barrier
ds_read_b128 a[224:227], v10 offset:0
v_mfma_f32_16x16x32_bf16 v[132:135], a[160:163], v[20:23], v[132:135]
v_exp_f32 v72, v72
v_mfma_f32_16x16x32_bf16 v[164:167], a[160:163], v[24:27], v[164:167]
ds_read_b128 a[228:231], v10 offset:1024
v_cvt_pk_bf16_f32 v56, v56, v57
v_mfma_f32_16x16x32_bf16 v[196:199], a[160:163], v[36:39], v[196:199]
v_exp_f32 v73, v73
v_mfma_f32_16x16x32_bf16 v[228:231], a[160:163], v[40:43], v[228:231]
ds_read_b128 a[192:195], v1 offset:0
v_cvt_pk_bf16_f32 v57, v58, v59
v_mfma_f32_16x16x32_bf16 v[148:151], a[164:167], v[20:23], v[148:151]
v_exp_f32 v74, v74
v_mfma_f32_16x16x32_bf16 v[180:183], a[164:167], v[24:27], v[180:183]
s_add_u32 m0, s30, 0x1c000
s_add_u32 s37, s37, 0x2000
ds_read_b128 a[196:199], v2 offset:0
v_cvt_pk_bf16_f32 v68, v68, v69
v_mfma_f32_16x16x32_bf16 v[212:215], a[164:167], v[36:39], v[212:215]
buffer_load_dwordx4 v11, s[12:15], s37 offen nt lds
v_mfma_f32_16x16x32_bf16 v[244:247], a[164:167], v[40:43], v[244:247]
ds_read_b128 a[200:203], v1 offset:1024
v_cvt_pk_bf16_f32 v69, v70, v71
v_smfmac_f32_16x16x64_bf16 a[244:247], a[240:243], v[20:27], v110
ds_read_b128 a[204:207], v2 offset:1024
v_cvt_pk_bf16_f32 v72, v72, v73
v_mfma_f32_16x16x32_bf16 v[136:139], a[168:171], v[20:23], v[136:139]
v_exp_f32 v75, v75
v_mfma_f32_16x16x32_bf16 v[168:171], a[168:171], v[24:27], v[168:171]
ds_read_b128 a[208:211], v1 offset:4096
v_cvt_pk_bf16_f32 v73, v74, v75
v_mfma_f32_16x16x32_bf16 v[200:203], a[168:171], v[36:39], v[200:203]
v_exp_f32 v48, v48
v_mfma_f32_16x16x32_bf16 v[232:235], a[168:171], v[40:43], v[232:235]
ds_read_b128 a[212:215], v2 offset:4096
v_mfma_f32_16x16x32_bf16 v[152:155], a[172:175], v[20:23], v[152:155]
v_exp_f32 v49, v49
v_mfma_f32_16x16x32_bf16 v[184:187], a[172:175], v[24:27], v[184:187]
ds_read_b128 a[216:219], v1 offset:5120
v_cvt_pk_bf16_f32 v54, v48, v49
v_mfma_f32_16x16x32_bf16 v[216:219], a[172:175], v[36:39], v[216:219]
v_exp_f32 v50, v50
v_mfma_f32_16x16x32_bf16 v[248:251], a[172:175], v[40:43], v[248:251]
ds_read_b128 a[220:223], v2 offset:5120
v_smfmac_f32_16x16x64_bf16 a[248:251], a[240:243], v[36:43], v110
ds_read_b128 a[232:235], v3 offset:0
v_mfma_f32_16x16x32_bf16 v[140:143], a[176:179], v[20:23], v[140:143]
v_exp_f32 v51, v51
v_mfma_f32_16x16x32_bf16 v[172:175], a[176:179], v[24:27], v[172:175]
ds_read_b128 a[236:239], v4 offset:0
v_cvt_pk_bf16_f32 v55, v50, v51
v_mfma_f32_16x16x32_bf16 v[204:207], a[176:179], v[36:39], v[204:207]
v_exp_f32 v60, v60
v_mfma_f32_16x16x32_bf16 v[236:239], a[176:179], v[40:43], v[236:239]
ds_read_b64_tr_b16 a[160:161], v6 offset:0
v_mfma_f32_16x16x32_bf16 v[156:159], a[180:183], v[20:23], v[156:159]
v_exp_f32 v61, v61
v_mfma_f32_16x16x32_bf16 v[188:191], a[180:183], v[24:27], v[188:191]
ds_read_b64_tr_b16 a[162:163], v6 offset:4096
v_cvt_pk_bf16_f32 v58, v60, v61
v_mfma_f32_16x16x32_bf16 v[220:223], a[180:183], v[36:39], v[220:223]
v_exp_f32 v62, v62
v_mfma_f32_16x16x32_bf16 v[252:255], a[180:183], v[40:43], v[252:255]
buffer_load_dwordx4 v11, s[12:15], s37 offen offset:2048 nt lds
v_mfma_f32_16x16x32_bf16 v[128:131], a[184:187], v[20:23], v[128:131]
ds_read_b64_tr_b16 a[164:165], v6 offset:1024
v_mfma_f32_16x16x32_bf16 v[160:163], a[184:187], v[24:27], v[160:163]
v_exp_f32 v63, v63
v_mfma_f32_16x16x32_bf16 v[192:195], a[184:187], v[36:39], v[192:195]
s_waitcnt lgkmcnt(4)
ds_read_b64_tr_b16 a[166:167], v6 offset:5120
v_cvt_pk_bf16_f32 v59, v62, v63
v_mfma_f32_16x16x32_bf16 v[224:227], a[184:187], v[40:43], v[224:227]
v_exp_f32 v64, v64
v_mfma_f32_16x16x32_bf16 v[88:91], a[184:187], a[224:227], v[88:91]
ds_read_b64_tr_b16 a[168:169], v7 offset:0
v_mfma_f32_16x16x32_bf16 v[96:99], a[184:187], a[228:231], v[96:99]
v_exp_f32 v65, v65
v_smfmac_f32_16x16x64_bf16 a[252:255], a[240:243], a[224:231], v110
ds_read_b64_tr_b16 a[170:171], v7 offset:4096
v_cvt_pk_bf16_f32 v70, v64, v65
v_mfma_f32_16x16x32_bf16 v[144:147], a[188:191], v[20:23], v[144:147]
v_exp_f32 v66, v66
v_mfma_f32_16x16x32_bf16 v[176:179], a[188:191], v[24:27], v[176:179]
ds_read_b64_tr_b16 a[172:173], v7 offset:1024
v_mfma_f32_16x16x32_bf16 v[208:211], a[188:191], v[36:39], v[208:211]
v_exp_f32 v67, v67
v_mfma_f32_16x16x32_bf16 v[240:243], a[188:191], v[40:43], v[240:243]
ds_read_b64_tr_b16 a[174:175], v7 offset:5120
v_cvt_pk_bf16_f32 v71, v66, v67
v_mfma_f32_16x16x32_bf16 v[92:95], a[188:191], a[224:227], v[92:95]
v_exp_f32 v76, v76
v_mfma_f32_16x16x32_bf16 v[100:103], a[188:191], a[228:231], v[100:103]
ds_read_b128 a[224:227], v3 offset:1024
v_mfma_f32_16x16x32_bf16 v[20:23], a[192:195], a[96:99], 0
v_exp_f32 v77, v77
v_mfma_f32_16x16x32_bf16 v[24:27], a[192:195], a[112:115], 0
ds_read_b128 a[228:231], v4 offset:1024
v_cvt_pk_bf16_f32 v74, v76, v77
v_mfma_f32_16x16x32_bf16 v[36:39], a[192:195], a[128:131], 0
v_exp_f32 v78, v78
v_mfma_f32_16x16x32_bf16 v[40:43], a[192:195], a[144:147], 0
ds_read_b64_tr_b16 a[176:177], v8 offset:0
v_mfma_f32_16x16x32_bf16 v[20:23], a[196:199], a[100:103], v[20:23]
v_exp_f32 v79, v79
v_mfma_f32_16x16x32_bf16 v[24:27], a[196:199], a[116:119], v[24:27]
buffer_store_dwordx4 a[0:3], v15, s[16:19], s68 offen sc0 sc1
v_mfma_f32_16x16x32_bf16 v[36:39], a[196:199], a[132:135], v[36:39]
buffer_store_dwordx4 a[4:7], v15, s[16:19], s68 offen offset:2048 sc0 sc1
v_mfma_f32_16x16x32_bf16 v[40:43], a[196:199], a[148:151], v[40:43]
ds_read_b64_tr_b16 a[178:179], v8 offset:4096
v_cvt_pk_bf16_f32 v75, v78, v79
v_mfma_f32_16x16x32_bf16 v[20:23], a[200:203], a[104:107], v[20:23]
v_mfma_f32_16x16x32_bf16 v[24:27], a[200:203], a[120:123], v[24:27]
ds_read_b64_tr_b16 a[180:181], v8 offset:1024
v_mfma_f32_16x16x32_bf16 v[36:39], a[200:203], a[136:139], v[36:39]
v_mfma_f32_16x16x32_bf16 v[40:43], a[200:203], a[152:155], v[40:43]
ds_read_b64_tr_b16 a[182:183], v8 offset:5120
v_mfma_f32_16x16x32_bf16 v[20:23], a[204:207], a[108:111], v[20:23]
v_mfma_f32_16x16x32_bf16 v[24:27], a[204:207], a[124:127], v[24:27]
s_waitcnt lgkmcnt(4)
ds_read_b64_tr_b16 a[184:185], v5 offset:0
v_mfma_f32_16x16x32_bf16 v[36:39], a[204:207], a[140:143], v[36:39]
v_mfma_f32_16x16x32_bf16 v[40:43], a[204:207], a[156:159], v[40:43]
ds_read_b64_tr_b16 a[186:187], v5 offset:4096
v_mfma_f32_16x16x32_bf16 v[16:19], a[208:211], a[96:99], 0
v_mfma_f32_16x16x32_bf16 v[28:31], a[208:211], a[112:115], 0
ds_read_b64_tr_b16 a[188:189], v5 offset:1024
v_mfma_f32_16x16x32_bf16 v[32:35], a[208:211], a[128:131], 0
v_exp_f32 v20, v20
v_mfma_f32_16x16x32_bf16 v[44:47], a[208:211], a[144:147], 0
ds_read_b64_tr_b16 a[190:191], v5 offset:5120
v_mfma_f32_16x16x32_bf16 v[16:19], a[212:215], a[100:103], v[16:19]
v_exp_f32 v21, v21
v_mfma_f32_16x16x32_bf16 v[28:31], a[212:215], a[116:119], v[28:31]
ds_read_b128 a[192:195], v1 offset:8192
v_cvt_pk_bf16_f32 v20, v20, v21
v_mfma_f32_16x16x32_bf16 v[32:35], a[212:215], a[132:135], v[32:35]
v_exp_f32 v22, v22
v_mfma_f32_16x16x32_bf16 v[44:47], a[212:215], a[148:151], v[44:47]
ds_read_b128 a[196:199], v2 offset:8192
v_mfma_f32_16x16x32_bf16 v[16:19], a[216:219], a[104:107], v[16:19]
v_exp_f32 v23, v23
v_mfma_f32_16x16x32_bf16 v[28:31], a[216:219], a[120:123], v[28:31]
ds_read_b128 a[200:203], v1 offset:9216
v_cvt_pk_bf16_f32 v21, v22, v23
v_mfma_f32_16x16x32_bf16 v[32:35], a[216:219], a[136:139], v[32:35]
v_exp_f32 v24, v24
v_mfma_f32_16x16x32_bf16 v[44:47], a[216:219], a[152:155], v[44:47]
ds_read_b128 a[204:207], v2 offset:9216
v_mfma_f32_16x16x32_bf16 v[16:19], a[220:223], a[108:111], v[16:19]
v_exp_f32 v25, v25
v_mfma_f32_16x16x32_bf16 v[28:31], a[220:223], a[124:127], v[28:31]
ds_read_b128 a[208:211], v1 offset:12288
v_cvt_pk_bf16_f32 v24, v24, v25
v_mfma_f32_16x16x32_bf16 v[32:35], a[220:223], a[140:143], v[32:35]
v_exp_f32 v26, v26
v_mfma_f32_16x16x32_bf16 v[44:47], a[220:223], a[156:159], v[44:47]
ds_read_b128 a[212:215], v2 offset:12288
v_mfma_f32_16x16x32_bf16 v[80:83], a[232:235], a[64:67], 0
v_exp_f32 v27, v27
v_mfma_f32_16x16x32_bf16 v[84:87], a[232:235], a[80:83], 0
ds_read_b128 a[232:235], v10 offset:2048
v_cvt_pk_bf16_f32 v25, v26, v27
v_mfma_f32_16x16x32_bf16 v[80:83], a[236:239], a[68:71], v[80:83]
v_exp_f32 v36, v36
v_mfma_f32_16x16x32_bf16 v[84:87], a[236:239], a[84:87], v[84:87]
s_waitcnt lgkmcnt(5)
ds_read_b128 a[236:239], v10 offset:3072
v_mfma_f32_16x16x32_bf16 v[80:83], a[224:227], a[72:75], v[80:83]
v_exp_f32 v37, v37
v_mfma_f32_16x16x32_bf16 v[84:87], a[224:227], a[88:91], v[84:87]
ds_read_b128 a[216:219], v1 offset:13312
v_cvt_pk_bf16_f32 v36, v36, v37
v_mfma_f32_16x16x32_bf16 v[80:83], a[228:231], a[76:79], v[80:83]
v_exp_f32 v38, v38
v_mfma_f32_16x16x32_bf16 v[84:87], a[228:231], a[92:95], v[84:87]
ds_read_b128 a[220:223], v2 offset:13312
v_mfma_f32_16x16x32_bf16 v[132:135], a[160:163], v[52:55], v[132:135]
v_exp_f32 v39, v39
v_mfma_f32_16x16x32_bf16 v[164:167], a[160:163], v[56:59], v[164:167]
v_exp_f32 v40, v40
v_mfma_f32_16x16x32_bf16 v[196:199], a[160:163], v[68:71], v[196:199]
v_exp_f32 v80, v80
v_mfma_f32_16x16x32_bf16 v[228:231], a[160:163], v[72:75], v[228:231]
buffer_store_dwordx4 a[8:11], v15, s[16:19], s68 offen offset:128 sc0 sc1
v_mfma_f32_16x16x32_bf16 v[148:151], a[164:167], v[52:55], v[148:151]
buffer_store_dwordx4 a[12:15], v15, s[16:19], s68 offen offset:2176 sc0 sc1
v_mfma_f32_16x16x32_bf16 v[180:183], a[164:167], v[56:59], v[180:183]
ds_read_b64_tr_b16 a[160:161], v6 offset:8192
v_cvt_pk_bf16_f32 v37, v38, v39
v_mfma_f32_16x16x32_bf16 v[212:215], a[164:167], v[68:71], v[212:215]
v_exp_f32 v81, v81
v_mfma_f32_16x16x32_bf16 v[244:247], a[164:167], v[72:75], v[244:247]
ds_read_b64_tr_b16 a[162:163], v6 offset:12288
v_cvt_pk_bf16_f32 v80, v80, v81
v_smfmac_f32_16x16x64_bf16 a[244:247], a[240:243], v[52:59], v110
ds_read_b64_tr_b16 a[164:165], v6 offset:9216
v_mfma_f32_16x16x32_bf16 v[136:139], a[168:171], v[52:55], v[136:139]
v_exp_f32 v82, v82
v_mfma_f32_16x16x32_bf16 v[168:171], a[168:171], v[56:59], v[168:171]
ds_read_b64_tr_b16 a[166:167], v6 offset:13312
v_mfma_f32_16x16x32_bf16 v[200:203], a[168:171], v[68:71], v[200:203]
v_exp_f32 v83, v83
v_mfma_f32_16x16x32_bf16 v[232:235], a[168:171], v[72:75], v[232:235]
ds_read_b64_tr_b16 a[168:169], v7 offset:8192
v_cvt_pk_bf16_f32 v81, v82, v83
v_mfma_f32_16x16x32_bf16 v[152:155], a[172:175], v[52:55], v[152:155]
ds_write_b64 v9, v[80:81] offset:4096
v_mfma_f32_16x16x32_bf16 v[184:187], a[172:175], v[56:59], v[184:187]
ds_read_b64_tr_b16 a[170:171], v7 offset:12288
v_mfma_f32_16x16x32_bf16 v[216:219], a[172:175], v[68:71], v[216:219]
v_exp_f32 v84, v84
v_mfma_f32_16x16x32_bf16 v[248:251], a[172:175], v[72:75], v[248:251]
s_waitcnt lgkmcnt(6)
ds_read_b64_tr_b16 a[172:173], v7 offset:9216
v_smfmac_f32_16x16x64_bf16 a[248:251], a[240:243], v[68:75], v110
ds_read_b64_tr_b16 a[174:175], v7 offset:13312
v_mfma_f32_16x16x32_bf16 v[140:143], a[176:179], v[52:55], v[140:143]
v_exp_f32 v85, v85
v_mfma_f32_16x16x32_bf16 v[172:175], a[176:179], v[56:59], v[172:175]
v_exp_f32 v86, v86
v_mfma_f32_16x16x32_bf16 v[204:207], a[176:179], v[68:71], v[204:207]
v_exp_f32 v87, v87
v_mfma_f32_16x16x32_bf16 v[236:239], a[176:179], v[72:75], v[236:239]
ds_read_b64_tr_b16 a[176:177], v8 offset:8192
v_cvt_pk_bf16_f32 v84, v84, v85
v_mfma_f32_16x16x32_bf16 v[156:159], a[180:183], v[52:55], v[156:159]
v_exp_f32 v41, v41
v_mfma_f32_16x16x32_bf16 v[188:191], a[180:183], v[56:59], v[188:191]
ds_read_b64_tr_b16 a[178:179], v8 offset:12288
v_cvt_pk_bf16_f32 v85, v86, v87
v_mfma_f32_16x16x32_bf16 v[220:223], a[180:183], v[68:71], v[220:223]
ds_write_b64 v9, v[84:85] offset:5120
v_cvt_pk_bf16_f32 v40, v40, v41
v_mfma_f32_16x16x32_bf16 v[252:255], a[180:183], v[72:75], v[252:255]
ds_read_b64_tr_b16 a[180:181], v8 offset:9216
v_mfma_f32_16x16x32_bf16 v[128:131], a[184:187], v[52:55], v[128:131]
v_exp_f32 v42, v42
v_mfma_f32_16x16x32_bf16 v[160:163], a[184:187], v[56:59], v[160:163]
ds_read_b64_tr_b16 a[182:183], v8 offset:13312
v_mfma_f32_16x16x32_bf16 v[192:195], a[184:187], v[68:71], v[192:195]
v_exp_f32 v43, v43
v_mfma_f32_16x16x32_bf16 v[224:227], a[184:187], v[72:75], v[224:227]
v_exp_f32 v16, v16
v_mfma_f32_16x16x32_bf16 v[88:91], a[184:187], a[232:235], v[88:91]
v_exp_f32 v17, v17
v_mfma_f32_16x16x32_bf16 v[96:99], a[184:187], a[236:239], v[96:99]
ds_read_b64_tr_b16 a[184:185], v5 offset:8192
v_cvt_pk_bf16_f32 v22, v16, v17
v_smfmac_f32_16x16x64_bf16 a[252:255], a[240:243], a[232:239], v110
ds_read_b64_tr_b16 a[186:187], v5 offset:12288
v_cvt_pk_bf16_f32 v41, v42, v43
v_mfma_f32_16x16x32_bf16 v[144:147], a[188:191], v[52:55], v[144:147]
v_exp_f32 v18, v18
v_mfma_f32_16x16x32_bf16 v[176:179], a[188:191], v[56:59], v[176:179]
v_exp_f32 v19, v19
v_mfma_f32_16x16x32_bf16 v[208:211], a[188:191], v[68:71], v[208:211]
v_exp_f32 v28, v28
v_mfma_f32_16x16x32_bf16 v[240:243], a[188:191], v[72:75], v[240:243]
v_exp_f32 v29, v29
v_mfma_f32_16x16x32_bf16 v[92:95], a[188:191], a[232:235], v[92:95]
v_exp_f32 v30, v30
v_mfma_f32_16x16x32_bf16 v[100:103], a[188:191], a[236:239], v[100:103]
s_waitcnt lgkmcnt(2)
ds_read_b64_tr_b16 a[188:189], v5 offset:9216
v_cvt_pk_bf16_f32 v23, v18, v19
v_mfma_f32_16x16x32_bf16 v[52:55], a[192:195], a[96:99], 0
v_exp_f32 v31, v31
v_mfma_f32_16x16x32_bf16 v[56:59], a[192:195], a[112:115], 0
ds_read_b64_tr_b16 a[190:191], v5 offset:13312
v_cvt_pk_bf16_f32 v26, v28, v29
v_mfma_f32_16x16x32_bf16 v[68:71], a[192:195], a[128:131], 0
buffer_store_dwordx4 a[16:19], v15, s[16:19], s69 offen sc0 sc1
v_mfma_f32_16x16x32_bf16 v[72:75], a[192:195], a[144:147], 0
buffer_store_dwordx4 a[20:23], v15, s[16:19], s69 offen offset:2048 sc0 sc1
v_mfma_f32_16x16x32_bf16 v[52:55], a[196:199], a[100:103], v[52:55]
v_exp_f32 v32, v32
v_mfma_f32_16x16x32_bf16 v[56:59], a[196:199], a[116:119], v[56:59]
v_exp_f32 v33, v33
v_mfma_f32_16x16x32_bf16 v[68:71], a[196:199], a[132:135], v[68:71]
v_exp_f32 v34, v34
v_mfma_f32_16x16x32_bf16 v[72:75], a[196:199], a[148:151], v[72:75]
v_exp_f32 v35, v35
v_mfma_f32_16x16x32_bf16 v[52:55], a[200:203], a[104:107], v[52:55]
v_exp_f32 v44, v44
v_mfma_f32_16x16x32_bf16 v[56:59], a[200:203], a[120:123], v[56:59]
v_exp_f32 v45, v45
v_mfma_f32_16x16x32_bf16 v[68:71], a[200:203], a[136:139], v[68:71]
v_exp_f32 v46, v46
v_mfma_f32_16x16x32_bf16 v[72:75], a[200:203], a[152:155], v[72:75]
v_exp_f32 v47, v47
v_mfma_f32_16x16x32_bf16 v[52:55], a[204:207], a[108:111], v[52:55]
v_cvt_pk_bf16_f32 v27, v30, v31
v_cvt_pk_bf16_f32 v38, v32, v33
v_mfma_f32_16x16x32_bf16 v[56:59], a[204:207], a[124:127], v[56:59]
v_cvt_pk_bf16_f32 v39, v34, v35
v_cvt_pk_bf16_f32 v42, v44, v45
v_mfma_f32_16x16x32_bf16 v[68:71], a[204:207], a[140:143], v[68:71]
v_cvt_pk_bf16_f32 v43, v46, v47
v_mfma_f32_16x16x32_bf16 v[72:75], a[204:207], a[156:159], v[72:75]
v_exp_f32 v52, v52
v_mfma_f32_16x16x32_bf16 v[48:51], a[208:211], a[96:99], 0
v_exp_f32 v53, v53
v_mfma_f32_16x16x32_bf16 v[60:63], a[208:211], a[112:115], 0
v_exp_f32 v54, v54
v_mfma_f32_16x16x32_bf16 v[64:67], a[208:211], a[128:131], 0
v_exp_f32 v55, v55
v_mfma_f32_16x16x32_bf16 v[76:79], a[208:211], a[144:147], 0
v_exp_f32 v56, v56
v_mfma_f32_16x16x32_bf16 v[48:51], a[212:215], a[100:103], v[48:51]
v_exp_f32 v57, v57
v_mfma_f32_16x16x32_bf16 v[60:63], a[212:215], a[116:119], v[60:63]
v_exp_f32 v58, v58
v_mfma_f32_16x16x32_bf16 v[64:67], a[212:215], a[132:135], v[64:67]
v_exp_f32 v59, v59
v_mfma_f32_16x16x32_bf16 v[76:79], a[212:215], a[148:151], v[76:79]
v_exp_f32 v68, v68
v_mfma_f32_16x16x32_bf16 v[48:51], a[216:219], a[104:107], v[48:51]
v_exp_f32 v69, v69
v_mfma_f32_16x16x32_bf16 v[60:63], a[216:219], a[120:123], v[60:63]
v_exp_f32 v70, v70
v_mfma_f32_16x16x32_bf16 v[64:67], a[216:219], a[136:139], v[64:67]
v_exp_f32 v71, v71
v_mfma_f32_16x16x32_bf16 v[76:79], a[216:219], a[152:155], v[76:79]
v_cvt_pk_bf16_f32 v52, v52, v53
v_cvt_pk_bf16_f32 v53, v54, v55
v_mfma_f32_16x16x32_bf16 v[48:51], a[220:223], a[108:111], v[48:51]
v_exp_f32 v72, v72
v_mfma_f32_16x16x32_bf16 v[60:63], a[220:223], a[124:127], v[60:63]
v_exp_f32 v73, v73
v_mfma_f32_16x16x32_bf16 v[64:67], a[220:223], a[140:143], v[64:67]
v_exp_f32 v74, v74
v_mfma_f32_16x16x32_bf16 v[76:79], a[220:223], a[156:159], v[76:79]
s_waitcnt vmcnt(16) lgkmcnt(0)
s_barrier
ds_read_b128 a[224:227], v10 offset:4096
v_mfma_f32_16x16x32_bf16 v[132:135], a[160:163], v[20:23], v[132:135]
v_exp_f32 v75, v75
v_mfma_f32_16x16x32_bf16 v[164:167], a[160:163], v[24:27], v[164:167]
ds_read_b128 a[228:231], v10 offset:5120
v_cvt_pk_bf16_f32 v56, v56, v57
v_mfma_f32_16x16x32_bf16 v[196:199], a[160:163], v[36:39], v[196:199]
v_exp_f32 v48, v48
v_mfma_f32_16x16x32_bf16 v[228:231], a[160:163], v[40:43], v[228:231]
ds_read_b128 a[192:195], v1 offset:16384
v_cvt_pk_bf16_f32 v57, v58, v59
v_mfma_f32_16x16x32_bf16 v[148:151], a[164:167], v[20:23], v[148:151]
v_exp_f32 v49, v49
v_mfma_f32_16x16x32_bf16 v[180:183], a[164:167], v[24:27], v[180:183]
ds_read_b128 a[196:199], v2 offset:16384
v_cvt_pk_bf16_f32 v54, v48, v49
v_mfma_f32_16x16x32_bf16 v[212:215], a[164:167], v[36:39], v[212:215]
buffer_store_dwordx4 a[24:27], v15, s[16:19], s69 offen offset:128 sc0 sc1
v_mfma_f32_16x16x32_bf16 v[244:247], a[164:167], v[40:43], v[244:247]
buffer_store_dwordx4 a[28:31], v15, s[16:19], s69 offen offset:2176 sc0 sc1
v_smfmac_f32_16x16x64_bf16 a[244:247], a[240:243], v[20:27], v110
ds_read_b128 a[200:203], v1 offset:17408
v_cvt_pk_bf16_f32 v68, v68, v69
v_mfma_f32_16x16x32_bf16 v[136:139], a[168:171], v[20:23], v[136:139]
v_exp_f32 v50, v50
v_mfma_f32_16x16x32_bf16 v[168:171], a[168:171], v[24:27], v[168:171]
ds_read_b128 a[204:207], v2 offset:17408
v_cvt_pk_bf16_f32 v69, v70, v71
v_mfma_f32_16x16x32_bf16 v[200:203], a[168:171], v[36:39], v[200:203]
v_exp_f32 v51, v51
v_mfma_f32_16x16x32_bf16 v[232:235], a[168:171], v[40:43], v[232:235]
ds_read_b128 a[208:211], v1 offset:20480
v_cvt_pk_bf16_f32 v55, v50, v51
v_mfma_f32_16x16x32_bf16 v[152:155], a[172:175], v[20:23], v[152:155]
v_exp_f32 v60, v60
v_mfma_f32_16x16x32_bf16 v[184:187], a[172:175], v[24:27], v[184:187]
ds_read_b128 a[212:215], v2 offset:20480
v_cvt_pk_bf16_f32 v72, v72, v73
v_mfma_f32_16x16x32_bf16 v[216:219], a[172:175], v[36:39], v[216:219]
v_exp_f32 v61, v61
v_mfma_f32_16x16x32_bf16 v[248:251], a[172:175], v[40:43], v[248:251]
ds_read_b128 a[216:219], v1 offset:21504
v_cvt_pk_bf16_f32 v58, v60, v61
v_smfmac_f32_16x16x64_bf16 a[248:251], a[240:243], v[36:43], v110
ds_read_b128 a[220:223], v2 offset:21504
v_cvt_pk_bf16_f32 v73, v74, v75
v_mfma_f32_16x16x32_bf16 v[140:143], a[176:179], v[20:23], v[140:143]
v_exp_f32 v62, v62
v_mfma_f32_16x16x32_bf16 v[172:175], a[176:179], v[24:27], v[172:175]
ds_read_b128 a[232:235], v3 offset:16384
v_mfma_f32_16x16x32_bf16 v[204:207], a[176:179], v[36:39], v[204:207]
v_exp_f32 v63, v63
v_mfma_f32_16x16x32_bf16 v[236:239], a[176:179], v[40:43], v[236:239]
ds_read_b128 a[236:239], v4 offset:16384
v_cvt_pk_bf16_f32 v59, v62, v63
v_mfma_f32_16x16x32_bf16 v[156:159], a[180:183], v[20:23], v[156:159]
v_exp_f32 v64, v64
v_mfma_f32_16x16x32_bf16 v[188:191], a[180:183], v[24:27], v[188:191]
ds_read_b64_tr_b16 a[160:161], v6 offset:16384
v_mfma_f32_16x16x32_bf16 v[220:223], a[180:183], v[36:39], v[220:223]
v_exp_f32 v65, v65
v_mfma_f32_16x16x32_bf16 v[252:255], a[180:183], v[40:43], v[252:255]
ds_read_b64_tr_b16 a[162:163], v6 offset:20480
v_cvt_pk_bf16_f32 v70, v64, v65
v_mfma_f32_16x16x32_bf16 v[128:131], a[184:187], v[20:23], v[128:131]
v_exp_f32 v66, v66
v_mfma_f32_16x16x32_bf16 v[160:163], a[184:187], v[24:27], v[160:163]
ds_read_b64_tr_b16 a[164:165], v6 offset:17408
v_mfma_f32_16x16x32_bf16 v[192:195], a[184:187], v[36:39], v[192:195]
v_exp_f32 v67, v67
v_mfma_f32_16x16x32_bf16 v[224:227], a[184:187], v[40:43], v[224:227]
s_waitcnt lgkmcnt(5)
ds_read_b64_tr_b16 a[166:167], v6 offset:21504
v_cvt_pk_bf16_f32 v71, v66, v67
v_mfma_f32_16x16x32_bf16 v[88:91], a[184:187], a[224:227], v[88:91]
v_exp_f32 v76, v76
v_mfma_f32_16x16x32_bf16 v[96:99], a[184:187], a[228:231], v[96:99]
ds_read_b64_tr_b16 a[168:169], v7 offset:16384
v_smfmac_f32_16x16x64_bf16 a[252:255], a[240:243], a[224:231], v110
ds_read_b64_tr_b16 a[170:171], v7 offset:20480
v_mfma_f32_16x16x32_bf16 v[144:147], a[188:191], v[20:23], v[144:147]
v_exp_f32 v77, v77
v_mfma_f32_16x16x32_bf16 v[176:179], a[188:191], v[24:27], v[176:179]
ds_read_b64_tr_b16 a[172:173], v7 offset:17408
v_cvt_pk_bf16_f32 v74, v76, v77
v_mfma_f32_16x16x32_bf16 v[208:211], a[188:191], v[36:39], v[208:211]
v_exp_f32 v78, v78
v_mfma_f32_16x16x32_bf16 v[240:243], a[188:191], v[40:43], v[240:243]
ds_read_b64_tr_b16 a[174:175], v7 offset:21504
v_mfma_f32_16x16x32_bf16 v[92:95], a[188:191], a[224:227], v[92:95]
v_exp_f32 v79, v79
v_mfma_f32_16x16x32_bf16 v[100:103], a[188:191], a[228:231], v[100:103]
ds_read_b128 a[224:227], v3 offset:17408
v_cvt_pk_bf16_f32 v75, v78, v79
v_mfma_f32_16x16x32_bf16 v[20:23], a[192:195], a[96:99], 0
v_mfma_f32_16x16x32_bf16 v[24:27], a[192:195], a[112:115], 0
ds_read_b128 a[228:231], v4 offset:17408
v_mfma_f32_16x16x32_bf16 v[36:39], a[192:195], a[128:131], 0
v_mfma_f32_16x16x32_bf16 v[40:43], a[192:195], a[144:147], 0
ds_read_b64_tr_b16 a[176:177], v8 offset:16384
v_mfma_f32_16x16x32_bf16 v[20:23], a[196:199], a[100:103], v[20:23]
v_mfma_f32_16x16x32_bf16 v[24:27], a[196:199], a[116:119], v[24:27]
buffer_store_dwordx4 a[32:35], v15, s[16:19], s70 offen sc0 sc1
v_mfma_f32_16x16x32_bf16 v[36:39], a[196:199], a[132:135], v[36:39]
buffer_store_dwordx4 a[36:39], v15, s[16:19], s70 offen offset:2048 sc0 sc1
v_mfma_f32_16x16x32_bf16 v[40:43], a[196:199], a[148:151], v[40:43]
ds_read_b64_tr_b16 a[178:179], v8 offset:20480
v_mfma_f32_16x16x32_bf16 v[20:23], a[200:203], a[104:107], v[20:23]
v_mfma_f32_16x16x32_bf16 v[24:27], a[200:203], a[120:123], v[24:27]
ds_read_b64_tr_b16 a[180:181], v8 offset:17408
v_mfma_f32_16x16x32_bf16 v[36:39], a[200:203], a[136:139], v[36:39]
v_mfma_f32_16x16x32_bf16 v[40:43], a[200:203], a[152:155], v[40:43]
s_waitcnt lgkmcnt(4)
ds_read_b64_tr_b16 a[182:183], v8 offset:21504
v_mfma_f32_16x16x32_bf16 v[20:23], a[204:207], a[108:111], v[20:23]
v_mfma_f32_16x16x32_bf16 v[24:27], a[204:207], a[124:127], v[24:27]
ds_read_b64_tr_b16 a[184:185], v5 offset:16384
v_mfma_f32_16x16x32_bf16 v[36:39], a[204:207], a[140:143], v[36:39]
v_mfma_f32_16x16x32_bf16 v[40:43], a[204:207], a[156:159], v[40:43]
ds_read_b64_tr_b16 a[186:187], v5 offset:20480
v_mfma_f32_16x16x32_bf16 v[16:19], a[208:211], a[96:99], 0
v_mfma_f32_16x16x32_bf16 v[28:31], a[208:211], a[112:115], 0
ds_read_b64_tr_b16 a[188:189], v5 offset:17408
v_mfma_f32_16x16x32_bf16 v[32:35], a[208:211], a[128:131], 0
v_exp_f32 v20, v20
v_mfma_f32_16x16x32_bf16 v[44:47], a[208:211], a[144:147], 0
ds_read_b64_tr_b16 a[190:191], v5 offset:21504
v_mfma_f32_16x16x32_bf16 v[16:19], a[212:215], a[100:103], v[16:19]
v_exp_f32 v21, v21
v_mfma_f32_16x16x32_bf16 v[28:31], a[212:215], a[116:119], v[28:31]
ds_read_b128 a[192:195], v1 offset:24576
v_cvt_pk_bf16_f32 v20, v20, v21
v_mfma_f32_16x16x32_bf16 v[32:35], a[212:215], a[132:135], v[32:35]
v_exp_f32 v22, v22
v_mfma_f32_16x16x32_bf16 v[44:47], a[212:215], a[148:151], v[44:47]
ds_read_b128 a[196:199], v2 offset:24576
v_mfma_f32_16x16x32_bf16 v[16:19], a[216:219], a[104:107], v[16:19]
v_exp_f32 v23, v23
v_mfma_f32_16x16x32_bf16 v[28:31], a[216:219], a[120:123], v[28:31]
ds_read_b128 a[200:203], v1 offset:25600
v_cvt_pk_bf16_f32 v21, v22, v23
v_mfma_f32_16x16x32_bf16 v[32:35], a[216:219], a[136:139], v[32:35]
v_exp_f32 v24, v24
v_mfma_f32_16x16x32_bf16 v[44:47], a[216:219], a[152:155], v[44:47]
ds_read_b128 a[204:207], v2 offset:25600
v_mfma_f32_16x16x32_bf16 v[16:19], a[220:223], a[108:111], v[16:19]
v_exp_f32 v25, v25
v_mfma_f32_16x16x32_bf16 v[28:31], a[220:223], a[124:127], v[28:31]
ds_read_b128 a[208:211], v1 offset:28672
v_cvt_pk_bf16_f32 v24, v24, v25
v_mfma_f32_16x16x32_bf16 v[32:35], a[220:223], a[140:143], v[32:35]
v_exp_f32 v26, v26
v_mfma_f32_16x16x32_bf16 v[44:47], a[220:223], a[156:159], v[44:47]
ds_read_b128 a[212:215], v2 offset:28672
v_mfma_f32_16x16x32_bf16 v[80:83], a[232:235], a[64:67], 0
v_exp_f32 v27, v27
v_mfma_f32_16x16x32_bf16 v[84:87], a[232:235], a[80:83], 0
s_waitcnt lgkmcnt(5)
ds_read_b128 a[232:235], v10 offset:6144
v_cvt_pk_bf16_f32 v25, v26, v27
v_mfma_f32_16x16x32_bf16 v[80:83], a[236:239], a[68:71], v[80:83]
v_exp_f32 v36, v36
v_mfma_f32_16x16x32_bf16 v[84:87], a[236:239], a[84:87], v[84:87]
ds_read_b128 a[236:239], v10 offset:7168
v_mfma_f32_16x16x32_bf16 v[80:83], a[224:227], a[72:75], v[80:83]
v_exp_f32 v37, v37
v_mfma_f32_16x16x32_bf16 v[84:87], a[224:227], a[88:91], v[84:87]
ds_read_b128 a[216:219], v1 offset:29696
v_cvt_pk_bf16_f32 v36, v36, v37
v_mfma_f32_16x16x32_bf16 v[80:83], a[228:231], a[76:79], v[80:83]
v_exp_f32 v38, v38
v_mfma_f32_16x16x32_bf16 v[84:87], a[228:231], a[92:95], v[84:87]
ds_read_b128 a[220:223], v2 offset:29696
v_mfma_f32_16x16x32_bf16 v[132:135], a[160:163], v[52:55], v[132:135]
v_exp_f32 v39, v39
v_mfma_f32_16x16x32_bf16 v[164:167], a[160:163], v[56:59], v[164:167]
v_exp_f32 v40, v40
v_mfma_f32_16x16x32_bf16 v[196:199], a[160:163], v[68:71], v[196:199]
v_exp_f32 v80, v80
v_mfma_f32_16x16x32_bf16 v[228:231], a[160:163], v[72:75], v[228:231]
buffer_store_dwordx4 a[40:43], v15, s[16:19], s70 offen offset:128 sc0 sc1
v_mfma_f32_16x16x32_bf16 v[148:151], a[164:167], v[52:55], v[148:151]
buffer_store_dwordx4 a[44:47], v15, s[16:19], s70 offen offset:2176 sc0 sc1
v_mfma_f32_16x16x32_bf16 v[180:183], a[164:167], v[56:59], v[180:183]
ds_read_b64_tr_b16 a[160:161], v6 offset:24576
v_cvt_pk_bf16_f32 v37, v38, v39
v_mfma_f32_16x16x32_bf16 v[212:215], a[164:167], v[68:71], v[212:215]
v_exp_f32 v81, v81
v_mfma_f32_16x16x32_bf16 v[244:247], a[164:167], v[72:75], v[244:247]
ds_read_b64_tr_b16 a[162:163], v6 offset:28672
v_cvt_pk_bf16_f32 v80, v80, v81
v_smfmac_f32_16x16x64_bf16 a[244:247], a[240:243], v[52:59], v110
ds_read_b64_tr_b16 a[164:165], v6 offset:25600
v_mfma_f32_16x16x32_bf16 v[136:139], a[168:171], v[52:55], v[136:139]
v_exp_f32 v82, v82
v_mfma_f32_16x16x32_bf16 v[168:171], a[168:171], v[56:59], v[168:171]
ds_read_b64_tr_b16 a[166:167], v6 offset:29696
v_mfma_f32_16x16x32_bf16 v[200:203], a[168:171], v[68:71], v[200:203]
v_exp_f32 v83, v83
v_mfma_f32_16x16x32_bf16 v[232:235], a[168:171], v[72:75], v[232:235]
ds_read_b64_tr_b16 a[168:169], v7 offset:24576
v_cvt_pk_bf16_f32 v81, v82, v83
v_mfma_f32_16x16x32_bf16 v[152:155], a[172:175], v[52:55], v[152:155]
ds_write_b64 v9, v[80:81] offset:0
v_mfma_f32_16x16x32_bf16 v[184:187], a[172:175], v[56:59], v[184:187]
s_waitcnt lgkmcnt(6)
ds_read_b64_tr_b16 a[170:171], v7 offset:28672
v_mfma_f32_16x16x32_bf16 v[216:219], a[172:175], v[68:71], v[216:219]
v_exp_f32 v84, v84
v_mfma_f32_16x16x32_bf16 v[248:251], a[172:175], v[72:75], v[248:251]
ds_read_b64_tr_b16 a[172:173], v7 offset:25600
v_smfmac_f32_16x16x64_bf16 a[248:251], a[240:243], v[68:75], v110
ds_read_b64_tr_b16 a[174:175], v7 offset:29696
v_mfma_f32_16x16x32_bf16 v[140:143], a[176:179], v[52:55], v[140:143]
v_exp_f32 v85, v85
v_mfma_f32_16x16x32_bf16 v[172:175], a[176:179], v[56:59], v[172:175]
v_exp_f32 v86, v86
v_mfma_f32_16x16x32_bf16 v[204:207], a[176:179], v[68:71], v[204:207]
v_exp_f32 v87, v87
v_mfma_f32_16x16x32_bf16 v[236:239], a[176:179], v[72:75], v[236:239]
ds_read_b64_tr_b16 a[176:177], v8 offset:24576
v_cvt_pk_bf16_f32 v84, v84, v85
v_mfma_f32_16x16x32_bf16 v[156:159], a[180:183], v[52:55], v[156:159]
v_exp_f32 v41, v41
v_mfma_f32_16x16x32_bf16 v[188:191], a[180:183], v[56:59], v[188:191]
ds_read_b64_tr_b16 a[178:179], v8 offset:28672
v_cvt_pk_bf16_f32 v85, v86, v87
v_mfma_f32_16x16x32_bf16 v[220:223], a[180:183], v[68:71], v[220:223]
ds_write_b64 v9, v[84:85] offset:1024
v_cvt_pk_bf16_f32 v40, v40, v41
v_mfma_f32_16x16x32_bf16 v[252:255], a[180:183], v[72:75], v[252:255]
ds_read_b64_tr_b16 a[180:181], v8 offset:25600
v_mfma_f32_16x16x32_bf16 v[128:131], a[184:187], v[52:55], v[128:131]
v_exp_f32 v42, v42
v_mfma_f32_16x16x32_bf16 v[160:163], a[184:187], v[56:59], v[160:163]
ds_read_b64_tr_b16 a[182:183], v8 offset:29696
v_mfma_f32_16x16x32_bf16 v[192:195], a[184:187], v[68:71], v[192:195]
v_exp_f32 v43, v43
v_mfma_f32_16x16x32_bf16 v[224:227], a[184:187], v[72:75], v[224:227]
v_exp_f32 v16, v16
v_mfma_f32_16x16x32_bf16 v[88:91], a[184:187], a[232:235], v[88:91]
v_exp_f32 v17, v17
v_mfma_f32_16x16x32_bf16 v[96:99], a[184:187], a[236:239], v[96:99]
ds_read_b64_tr_b16 a[184:185], v5 offset:24576
v_cvt_pk_bf16_f32 v22, v16, v17
v_smfmac_f32_16x16x64_bf16 a[252:255], a[240:243], a[232:239], v110
s_waitcnt lgkmcnt(5)
ds_read_b64_tr_b16 a[186:187], v5 offset:28672
v_cvt_pk_bf16_f32 v41, v42, v43
v_mfma_f32_16x16x32_bf16 v[144:147], a[188:191], v[52:55], v[144:147]
v_exp_f32 v18, v18
v_mfma_f32_16x16x32_bf16 v[176:179], a[188:191], v[56:59], v[176:179]
v_exp_f32 v19, v19
v_mfma_f32_16x16x32_bf16 v[208:211], a[188:191], v[68:71], v[208:211]
v_exp_f32 v28, v28
v_mfma_f32_16x16x32_bf16 v[240:243], a[188:191], v[72:75], v[240:243]
v_exp_f32 v29, v29
v_mfma_f32_16x16x32_bf16 v[92:95], a[188:191], a[232:235], v[92:95]
v_exp_f32 v30, v30
v_mfma_f32_16x16x32_bf16 v[100:103], a[188:191], a[236:239], v[100:103]
ds_read_b64_tr_b16 a[188:189], v5 offset:25600
v_cvt_pk_bf16_f32 v23, v18, v19
v_mfma_f32_16x16x32_bf16 v[52:55], a[192:195], a[96:99], 0
v_exp_f32 v31, v31
v_mfma_f32_16x16x32_bf16 v[56:59], a[192:195], a[112:115], 0
ds_read_b64_tr_b16 a[190:191], v5 offset:29696
v_cvt_pk_bf16_f32 v26, v28, v29
v_mfma_f32_16x16x32_bf16 v[68:71], a[192:195], a[128:131], 0
v_exp_f32 v32, v32
v_mfma_f32_16x16x32_bf16 v[72:75], a[192:195], a[144:147], 0
v_exp_f32 v33, v33
v_mfma_f32_16x16x32_bf16 v[52:55], a[196:199], a[100:103], v[52:55]
v_exp_f32 v34, v34
v_mfma_f32_16x16x32_bf16 v[56:59], a[196:199], a[116:119], v[56:59]
v_exp_f32 v35, v35
v_mfma_f32_16x16x32_bf16 v[68:71], a[196:199], a[132:135], v[68:71]
v_exp_f32 v44, v44
v_mfma_f32_16x16x32_bf16 v[72:75], a[196:199], a[148:151], v[72:75]
v_exp_f32 v45, v45
v_mfma_f32_16x16x32_bf16 v[52:55], a[200:203], a[104:107], v[52:55]
v_exp_f32 v46, v46
v_mfma_f32_16x16x32_bf16 v[56:59], a[200:203], a[120:123], v[56:59]
v_exp_f32 v47, v47
v_mfma_f32_16x16x32_bf16 v[68:71], a[200:203], a[136:139], v[68:71]
v_cvt_pk_bf16_f32 v27, v30, v31
v_cvt_pk_bf16_f32 v38, v32, v33
v_mfma_f32_16x16x32_bf16 v[72:75], a[200:203], a[152:155], v[72:75]
v_cvt_pk_bf16_f32 v39, v34, v35
v_cvt_pk_bf16_f32 v42, v44, v45
v_mfma_f32_16x16x32_bf16 v[52:55], a[204:207], a[108:111], v[52:55]
v_cvt_pk_bf16_f32 v43, v46, v47
v_mfma_f32_16x16x32_bf16 v[56:59], a[204:207], a[124:127], v[56:59]
v_mfma_f32_16x16x32_bf16 v[68:71], a[204:207], a[140:143], v[68:71]
v_mfma_f32_16x16x32_bf16 v[72:75], a[204:207], a[156:159], v[72:75]
v_mfma_f32_16x16x32_bf16 v[48:51], a[208:211], a[96:99], 0
v_mfma_f32_16x16x32_bf16 v[60:63], a[208:211], a[112:115], 0
v_mfma_f32_16x16x32_bf16 v[64:67], a[208:211], a[128:131], 0
v_mfma_f32_16x16x32_bf16 v[76:79], a[208:211], a[144:147], 0
v_exp_f32 v52, v52
v_mfma_f32_16x16x32_bf16 v[48:51], a[212:215], a[100:103], v[48:51]
v_exp_f32 v53, v53
v_mfma_f32_16x16x32_bf16 v[60:63], a[212:215], a[116:119], v[60:63]
v_exp_f32 v54, v54
v_mfma_f32_16x16x32_bf16 v[64:67], a[212:215], a[132:135], v[64:67]
v_exp_f32 v55, v55
v_mfma_f32_16x16x32_bf16 v[76:79], a[212:215], a[148:151], v[76:79]
v_exp_f32 v56, v56
v_mfma_f32_16x16x32_bf16 v[48:51], a[216:219], a[104:107], v[48:51]
v_exp_f32 v57, v57
v_mfma_f32_16x16x32_bf16 v[60:63], a[216:219], a[120:123], v[60:63]
v_exp_f32 v58, v58
v_mfma_f32_16x16x32_bf16 v[64:67], a[216:219], a[136:139], v[64:67]
v_exp_f32 v59, v59
v_mfma_f32_16x16x32_bf16 v[76:79], a[216:219], a[152:155], v[76:79]
v_exp_f32 v68, v68
v_mfma_f32_16x16x32_bf16 v[48:51], a[220:223], a[108:111], v[48:51]
v_exp_f32 v69, v69
v_mfma_f32_16x16x32_bf16 v[60:63], a[220:223], a[124:127], v[60:63]
v_exp_f32 v70, v70
v_mfma_f32_16x16x32_bf16 v[64:67], a[220:223], a[140:143], v[64:67]
v_exp_f32 v71, v71
v_mfma_f32_16x16x32_bf16 v[76:79], a[220:223], a[156:159], v[76:79]
s_waitcnt vmcnt(14) lgkmcnt(0)
s_barrier
ds_read_b128 a[224:227], v10 offset:0
v_mfma_f32_16x16x32_bf16 v[132:135], a[160:163], v[20:23], v[132:135]
v_cvt_pk_bf16_f32 v52, v52, v53
v_cvt_pk_bf16_f32 v53, v54, v55
v_mfma_f32_16x16x32_bf16 v[164:167], a[160:163], v[24:27], v[164:167]
ds_read_b128 a[228:231], v10 offset:1024
v_cvt_pk_bf16_f32 v56, v56, v57
v_mfma_f32_16x16x32_bf16 v[196:199], a[160:163], v[36:39], v[196:199]
v_exp_f32 v72, v72
v_mfma_f32_16x16x32_bf16 v[228:231], a[160:163], v[40:43], v[228:231]
ds_read_b128 a[192:195], v1 offset:32768
v_cvt_pk_bf16_f32 v57, v58, v59
v_mfma_f32_16x16x32_bf16 v[148:151], a[164:167], v[20:23], v[148:151]
v_exp_f32 v73, v73
v_mfma_f32_16x16x32_bf16 v[180:183], a[164:167], v[24:27], v[180:183]
ds_read_b128 a[196:199], v2 offset:32768
v_cvt_pk_bf16_f32 v68, v68, v69
v_mfma_f32_16x16x32_bf16 v[212:215], a[164:167], v[36:39], v[212:215]
buffer_store_dwordx4 a[48:51], v15, s[16:19], s71 offen sc0 sc1
v_mfma_f32_16x16x32_bf16 v[244:247], a[164:167], v[40:43], v[244:247]
buffer_store_dwordx4 a[52:55], v15, s[16:19], s71 offen offset:2048 sc0 sc1
v_smfmac_f32_16x16x64_bf16 a[244:247], a[240:243], v[20:27], v110
ds_read_b128 a[200:203], v1 offset:33792
v_cvt_pk_bf16_f32 v69, v70, v71
v_mfma_f32_16x16x32_bf16 v[136:139], a[168:171], v[20:23], v[136:139]
v_exp_f32 v74, v74
v_mfma_f32_16x16x32_bf16 v[168:171], a[168:171], v[24:27], v[168:171]
ds_read_b128 a[204:207], v2 offset:33792
v_cvt_pk_bf16_f32 v72, v72, v73
v_mfma_f32_16x16x32_bf16 v[200:203], a[168:171], v[36:39], v[200:203]
v_exp_f32 v75, v75
v_mfma_f32_16x16x32_bf16 v[232:235], a[168:171], v[40:43], v[232:235]
ds_read_b128 a[208:211], v1 offset:36864
v_cvt_pk_bf16_f32 v73, v74, v75
v_mfma_f32_16x16x32_bf16 v[152:155], a[172:175], v[20:23], v[152:155]
v_exp_f32 v48, v48
v_mfma_f32_16x16x32_bf16 v[184:187], a[172:175], v[24:27], v[184:187]
ds_read_b128 a[212:215], v2 offset:36864
v_mfma_f32_16x16x32_bf16 v[216:219], a[172:175], v[36:39], v[216:219]
v_exp_f32 v49, v49
v_mfma_f32_16x16x32_bf16 v[248:251], a[172:175], v[40:43], v[248:251]
ds_read_b128 a[216:219], v1 offset:37888
v_cvt_pk_bf16_f32 v54, v48, v49
v_smfmac_f32_16x16x64_bf16 a[248:251], a[240:243], v[36:43], v110
ds_read_b128 a[220:223], v2 offset:37888
v_mfma_f32_16x16x32_bf16 v[140:143], a[176:179], v[20:23], v[140:143]
v_exp_f32 v50, v50
v_mfma_f32_16x16x32_bf16 v[172:175], a[176:179], v[24:27], v[172:175]
ds_read_b128 a[232:235], v3 offset:32768
v_mfma_f32_16x16x32_bf16 v[204:207], a[176:179], v[36:39], v[204:207]
v_exp_f32 v51, v51
v_mfma_f32_16x16x32_bf16 v[236:239], a[176:179], v[40:43], v[236:239]
ds_read_b128 a[236:239], v4 offset:32768
v_cvt_pk_bf16_f32 v55, v50, v51
v_mfma_f32_16x16x32_bf16 v[156:159], a[180:183], v[20:23], v[156:159]
v_exp_f32 v60, v60
v_mfma_f32_16x16x32_bf16 v[188:191], a[180:183], v[24:27], v[188:191]
ds_read_b64_tr_b16 a[160:161], v6 offset:32768
v_mfma_f32_16x16x32_bf16 v[220:223], a[180:183], v[36:39], v[220:223]
v_exp_f32 v61, v61
v_mfma_f32_16x16x32_bf16 v[252:255], a[180:183], v[40:43], v[252:255]
ds_read_b64_tr_b16 a[162:163], v6 offset:36864
v_cvt_pk_bf16_f32 v58, v60, v61
v_mfma_f32_16x16x32_bf16 v[128:131], a[184:187], v[20:23], v[128:131]
v_exp_f32 v62, v62
v_mfma_f32_16x16x32_bf16 v[160:163], a[184:187], v[24:27], v[160:163]
ds_read_b128 v[120:123], v117 offset:0
v_mfma_f32_16x16x32_bf16 v[192:195], a[184:187], v[36:39], v[192:195]
v_exp_f32 v63, v63
v_mfma_f32_16x16x32_bf16 v[224:227], a[184:187], v[40:43], v[224:227]
s_waitcnt lgkmcnt(5)
ds_read_b128 v[124:127], v117 offset:1088
v_cvt_pk_bf16_f32 v59, v62, v63
v_mfma_f32_16x16x32_bf16 v[88:91], a[184:187], a[224:227], v[88:91]
v_exp_f32 v64, v64
v_mfma_f32_16x16x32_bf16 v[96:99], a[184:187], a[228:231], v[96:99]
ds_read_b64_tr_b16 a[164:165], v6 offset:33792
v_smfmac_f32_16x16x64_bf16 a[252:255], a[240:243], a[224:231], v110
ds_read_b64_tr_b16 a[166:167], v6 offset:37888
v_mfma_f32_16x16x32_bf16 v[144:147], a[188:191], v[20:23], v[144:147]
v_exp_f32 v65, v65
v_mfma_f32_16x16x32_bf16 v[176:179], a[188:191], v[24:27], v[176:179]
ds_read_b64_tr_b16 a[168:169], v7 offset:32768
v_cvt_pk_bf16_f32 v70, v64, v65
v_mfma_f32_16x16x32_bf16 v[208:211], a[188:191], v[36:39], v[208:211]
v_exp_f32 v66, v66
v_mfma_f32_16x16x32_bf16 v[240:243], a[188:191], v[40:43], v[240:243]
ds_read_b64_tr_b16 a[170:171], v7 offset:36864
v_mfma_f32_16x16x32_bf16 v[92:95], a[188:191], a[224:227], v[92:95]
v_exp_f32 v67, v67
v_mfma_f32_16x16x32_bf16 v[100:103], a[188:191], a[228:231], v[100:103]
ds_read_b128 a[224:227], v3 offset:33792
v_cvt_pk_bf16_f32 v71, v66, v67
v_mfma_f32_16x16x32_bf16 v[20:23], a[192:195], a[96:99], 0
v_exp_f32 v76, v76
v_mfma_f32_16x16x32_bf16 v[24:27], a[192:195], a[112:115], 0
ds_read_b128 a[228:231], v4 offset:33792
v_mfma_f32_16x16x32_bf16 v[36:39], a[192:195], a[128:131], 0
v_exp_f32 v77, v77
v_mfma_f32_16x16x32_bf16 v[40:43], a[192:195], a[144:147], 0
ds_read_b64_tr_b16 a[172:173], v7 offset:33792
v_cvt_pk_bf16_f32 v74, v76, v77
v_mfma_f32_16x16x32_bf16 v[20:23], a[196:199], a[100:103], v[20:23]
v_exp_f32 v78, v78
v_mfma_f32_16x16x32_bf16 v[24:27], a[196:199], a[116:119], v[24:27]
buffer_store_dwordx4 a[56:59], v15, s[16:19], s71 offen offset:128 sc0 sc1
v_mfma_f32_16x16x32_bf16 v[36:39], a[196:199], a[132:135], v[36:39]
buffer_store_dwordx4 a[60:63], v15, s[16:19], s71 offen offset:2176 sc0 sc1
v_mfma_f32_16x16x32_bf16 v[40:43], a[196:199], a[148:151], v[40:43]
ds_read_b64_tr_b16 a[174:175], v7 offset:37888
v_mfma_f32_16x16x32_bf16 v[20:23], a[200:203], a[104:107], v[20:23]
v_exp_f32 v79, v79
v_mfma_f32_16x16x32_bf16 v[24:27], a[200:203], a[120:123], v[24:27]
ds_read_b64_tr_b16 a[176:177], v8 offset:32768
v_cvt_pk_bf16_f32 v75, v78, v79
v_mfma_f32_16x16x32_bf16 v[36:39], a[200:203], a[136:139], v[36:39]
v_mfma_f32_16x16x32_bf16 v[40:43], a[200:203], a[152:155], v[40:43]
s_waitcnt lgkmcnt(4)
ds_read_b64_tr_b16 a[178:179], v8 offset:36864
v_mfma_f32_16x16x32_bf16 v[20:23], a[204:207], a[108:111], v[20:23]
v_mfma_f32_16x16x32_bf16 v[24:27], a[204:207], a[124:127], v[24:27]
ds_read_b64_tr_b16 a[180:181], v8 offset:33792
v_mfma_f32_16x16x32_bf16 v[36:39], a[204:207], a[140:143], v[36:39]
v_mfma_f32_16x16x32_bf16 v[40:43], a[204:207], a[156:159], v[40:43]
ds_read_b64_tr_b16 a[182:183], v8 offset:37888
v_mfma_f32_16x16x32_bf16 v[16:19], a[208:211], a[96:99], 0
v_mfma_f32_16x16x32_bf16 v[28:31], a[208:211], a[112:115], 0
ds_read_b64_tr_b16 a[184:185], v5 offset:32768
v_mfma_f32_16x16x32_bf16 v[32:35], a[208:211], a[128:131], 0
v_exp_f32 v20, v20
v_mfma_f32_16x16x32_bf16 v[44:47], a[208:211], a[144:147], 0
ds_read_b64_tr_b16 a[186:187], v5 offset:36864
v_mfma_f32_16x16x32_bf16 v[16:19], a[212:215], a[100:103], v[16:19]
v_exp_f32 v21, v21
v_mfma_f32_16x16x32_bf16 v[28:31], a[212:215], a[116:119], v[28:31]
ds_read_b64_tr_b16 a[188:189], v5 offset:33792
v_cvt_pk_bf16_f32 v20, v20, v21
v_mfma_f32_16x16x32_bf16 v[32:35], a[212:215], a[132:135], v[32:35]
v_exp_f32 v22, v22
v_mfma_f32_16x16x32_bf16 v[44:47], a[212:215], a[148:151], v[44:47]
ds_read_b64_tr_b16 a[190:191], v5 offset:37888
v_mfma_f32_16x16x32_bf16 v[16:19], a[216:219], a[104:107], v[16:19]
v_exp_f32 v23, v23
v_mfma_f32_16x16x32_bf16 v[28:31], a[216:219], a[120:123], v[28:31]
ds_read_b128 a[192:195], v1 offset:40960
v_cvt_pk_bf16_f32 v21, v22, v23
v_mfma_f32_16x16x32_bf16 v[32:35], a[216:219], a[136:139], v[32:35]
v_exp_f32 v24, v24
v_mfma_f32_16x16x32_bf16 v[44:47], a[216:219], a[152:155], v[44:47]
ds_read_b128 a[196:199], v2 offset:40960
v_mfma_f32_16x16x32_bf16 v[16:19], a[220:223], a[108:111], v[16:19]
v_exp_f32 v25, v25
v_mfma_f32_16x16x32_bf16 v[28:31], a[220:223], a[124:127], v[28:31]
ds_read_b128 a[200:203], v1 offset:41984
v_cvt_pk_bf16_f32 v24, v24, v25
v_mfma_f32_16x16x32_bf16 v[32:35], a[220:223], a[140:143], v[32:35]
v_exp_f32 v26, v26
v_mfma_f32_16x16x32_bf16 v[44:47], a[220:223], a[156:159], v[44:47]
ds_read_b128 a[204:207], v2 offset:41984
v_mfma_f32_16x16x32_bf16 v[80:83], a[232:235], a[64:67], 0
v_exp_f32 v27, v27
v_mfma_f32_16x16x32_bf16 v[84:87], a[232:235], a[80:83], 0
s_waitcnt lgkmcnt(5)
ds_read_b128 a[232:235], v10 offset:2048
v_cvt_pk_bf16_f32 v25, v26, v27
v_mfma_f32_16x16x32_bf16 v[80:83], a[236:239], a[68:71], v[80:83]
v_exp_f32 v16, v16
v_mfma_f32_16x16x32_bf16 v[84:87], a[236:239], a[84:87], v[84:87]
ds_read_b128 a[236:239], v10 offset:3072
v_mfma_f32_16x16x32_bf16 v[80:83], a[224:227], a[72:75], v[80:83]
v_exp_f32 v17, v17
v_mfma_f32_16x16x32_bf16 v[84:87], a[224:227], a[88:91], v[84:87]
ds_read_b128 a[208:211], v1 offset:45056
v_cvt_pk_bf16_f32 v22, v16, v17
v_mfma_f32_16x16x32_bf16 v[80:83], a[228:231], a[76:79], v[80:83]
v_exp_f32 v18, v18
v_mfma_f32_16x16x32_bf16 v[84:87], a[228:231], a[92:95], v[84:87]
ds_read_b128 a[212:215], v2 offset:45056
v_mfma_f32_16x16x32_bf16 v[132:135], a[160:163], v[52:55], v[132:135]
v_exp_f32 v19, v19
v_mfma_f32_16x16x32_bf16 v[164:167], a[160:163], v[56:59], v[164:167]
ds_read_b128 a[216:219], v1 offset:46080
v_cvt_pk_bf16_f32 v23, v18, v19
v_mfma_f32_16x16x32_bf16 v[196:199], a[160:163], v[68:71], v[196:199]
v_exp_f32 v80, v80
v_mfma_f32_16x16x32_bf16 v[228:231], a[160:163], v[72:75], v[228:231]
buffer_store_dwordx4 v[120:123], v12, s[16:19], s72 offen sc0 sc1
v_mfma_f32_16x16x32_bf16 v[148:151], a[164:167], v[52:55], v[148:151]
buffer_store_dwordx4 v[124:127], v12, s[16:19], s72 offen offset:1024 sc0 sc1
v_mfma_f32_16x16x32_bf16 v[180:183], a[164:167], v[56:59], v[180:183]
ds_read_b128 a[220:223], v2 offset:46080
v_mfma_f32_16x16x32_bf16 v[212:215], a[164:167], v[68:71], v[212:215]
v_exp_f32 v81, v81
v_mfma_f32_16x16x32_bf16 v[244:247], a[164:167], v[72:75], v[244:247]
ds_read_b64_tr_b16 a[160:161], v6 offset:40960
v_cvt_pk_bf16_f32 v80, v80, v81
v_smfmac_f32_16x16x64_bf16 a[244:247], a[240:243], v[52:59], v110
ds_read_b64_tr_b16 a[162:163], v6 offset:45056
v_mfma_f32_16x16x32_bf16 v[136:139], a[168:171], v[52:55], v[136:139]
v_exp_f32 v82, v82
v_mfma_f32_16x16x32_bf16 v[168:171], a[168:171], v[56:59], v[168:171]
ds_read_b64_tr_b16 a[164:165], v6 offset:41984
v_mfma_f32_16x16x32_bf16 v[200:203], a[168:171], v[68:71], v[200:203]
v_exp_f32 v83, v83
v_mfma_f32_16x16x32_bf16 v[232:235], a[168:171], v[72:75], v[232:235]
ds_read_b64_tr_b16 a[166:167], v6 offset:46080
v_cvt_pk_bf16_f32 v81, v82, v83
v_mfma_f32_16x16x32_bf16 v[152:155], a[172:175], v[52:55], v[152:155]
s_waitcnt lgkmcnt(5)
ds_write_b64 v9, v[80:81] offset:4096
v_mfma_f32_16x16x32_bf16 v[184:187], a[172:175], v[56:59], v[184:187]
ds_read_b64_tr_b16 a[168:169], v7 offset:40960
v_mfma_f32_16x16x32_bf16 v[216:219], a[172:175], v[68:71], v[216:219]
v_exp_f32 v84, v84
v_mfma_f32_16x16x32_bf16 v[248:251], a[172:175], v[72:75], v[248:251]
ds_read_b64_tr_b16 a[170:171], v7 offset:45056
v_smfmac_f32_16x16x64_bf16 a[248:251], a[240:243], v[68:75], v110
ds_read_b64_tr_b16 a[172:173], v7 offset:41984
v_mfma_f32_16x16x32_bf16 v[140:143], a[176:179], v[52:55], v[140:143]
v_exp_f32 v85, v85
v_mfma_f32_16x16x32_bf16 v[172:175], a[176:179], v[56:59], v[172:175]
ds_read_b64_tr_b16 a[174:175], v7 offset:46080
v_cvt_pk_bf16_f32 v84, v84, v85
v_mfma_f32_16x16x32_bf16 v[204:207], a[176:179], v[68:71], v[204:207]
v_exp_f32 v86, v86
v_mfma_f32_16x16x32_bf16 v[236:239], a[176:179], v[72:75], v[236:239]
ds_read_b64_tr_b16 a[176:177], v8 offset:40960
v_mfma_f32_16x16x32_bf16 v[156:159], a[180:183], v[52:55], v[156:159]
v_exp_f32 v87, v87
v_mfma_f32_16x16x32_bf16 v[188:191], a[180:183], v[56:59], v[188:191]
ds_read_b64_tr_b16 a[178:179], v8 offset:45056
v_cvt_pk_bf16_f32 v85, v86, v87
v_mfma_f32_16x16x32_bf16 v[220:223], a[180:183], v[68:71], v[220:223]
ds_write_b64 v9, v[84:85] offset:5120
v_mfma_f32_16x16x32_bf16 v[252:255], a[180:183], v[72:75], v[252:255]
ds_read_b64_tr_b16 a[180:181], v8 offset:41984
v_mfma_f32_16x16x32_bf16 v[128:131], a[184:187], v[52:55], v[128:131]
v_exp_f32 v28, v28
v_mfma_f32_16x16x32_bf16 v[160:163], a[184:187], v[56:59], v[160:163]
ds_read_b64_tr_b16 a[182:183], v8 offset:46080
v_mfma_f32_16x16x32_bf16 v[192:195], a[184:187], v[68:71], v[192:195]
v_exp_f32 v29, v29
v_mfma_f32_16x16x32_bf16 v[224:227], a[184:187], v[72:75], v[224:227]
v_exp_f32 v30, v30
v_mfma_f32_16x16x32_bf16 v[88:91], a[184:187], a[232:235], v[88:91]
v_exp_f32 v31, v31
v_mfma_f32_16x16x32_bf16 v[96:99], a[184:187], a[236:239], v[96:99]
s_waitcnt lgkmcnt(5)
ds_read_b64_tr_b16 a[184:185], v5 offset:40960
v_cvt_pk_bf16_f32 v26, v28, v29
v_smfmac_f32_16x16x64_bf16 a[252:255], a[240:243], a[232:239], v110
ds_read_b64_tr_b16 a[186:187], v5 offset:45056
v_cvt_pk_bf16_f32 v27, v30, v31
v_mfma_f32_16x16x32_bf16 v[144:147], a[188:191], v[52:55], v[144:147]
v_exp_f32 v36, v36
v_mfma_f32_16x16x32_bf16 v[176:179], a[188:191], v[56:59], v[176:179]
v_exp_f32 v37, v37
v_mfma_f32_16x16x32_bf16 v[208:211], a[188:191], v[68:71], v[208:211]
v_exp_f32 v38, v38
v_mfma_f32_16x16x32_bf16 v[240:243], a[188:191], v[72:75], v[240:243]
v_exp_f32 v39, v39
v_mfma_f32_16x16x32_bf16 v[92:95], a[188:191], a[232:235], v[92:95]
v_exp_f32 v40, v40
v_mfma_f32_16x16x32_bf16 v[100:103], a[188:191], a[236:239], v[100:103]
ds_read_b64_tr_b16 a[188:189], v5 offset:41984
v_cvt_pk_bf16_f32 v36, v36, v37
v_mfma_f32_16x16x32_bf16 v[52:55], a[192:195], a[96:99], 0
v_exp_f32 v41, v41
v_mfma_f32_16x16x32_bf16 v[56:59], a[192:195], a[112:115], 0
ds_read_b64_tr_b16 a[190:191], v5 offset:46080
v_cvt_pk_bf16_f32 v37, v38, v39
v_mfma_f32_16x16x32_bf16 v[68:71], a[192:195], a[128:131], 0
v_exp_f32 v42, v42
v_mfma_f32_16x16x32_bf16 v[72:75], a[192:195], a[144:147], 0
v_exp_f32 v43, v43
v_mfma_f32_16x16x32_bf16 v[52:55], a[196:199], a[100:103], v[52:55]
v_exp_f32 v32, v32
v_mfma_f32_16x16x32_bf16 v[56:59], a[196:199], a[116:119], v[56:59]
v_exp_f32 v33, v33
v_mfma_f32_16x16x32_bf16 v[68:71], a[196:199], a[132:135], v[68:71]
v_exp_f32 v34, v34
v_mfma_f32_16x16x32_bf16 v[72:75], a[196:199], a[148:151], v[72:75]
v_exp_f32 v35, v35
v_mfma_f32_16x16x32_bf16 v[52:55], a[200:203], a[104:107], v[52:55]
v_exp_f32 v44, v44
v_mfma_f32_16x16x32_bf16 v[56:59], a[200:203], a[120:123], v[56:59]
v_exp_f32 v45, v45
v_mfma_f32_16x16x32_bf16 v[68:71], a[200:203], a[136:139], v[68:71]
v_exp_f32 v46, v46
v_mfma_f32_16x16x32_bf16 v[72:75], a[200:203], a[152:155], v[72:75]
v_exp_f32 v47, v47
v_mfma_f32_16x16x32_bf16 v[52:55], a[204:207], a[108:111], v[52:55]
v_cvt_pk_bf16_f32 v40, v40, v41
v_cvt_pk_bf16_f32 v41, v42, v43
v_mfma_f32_16x16x32_bf16 v[56:59], a[204:207], a[124:127], v[56:59]
v_cvt_pk_bf16_f32 v38, v32, v33
v_cvt_pk_bf16_f32 v39, v34, v35
v_mfma_f32_16x16x32_bf16 v[68:71], a[204:207], a[140:143], v[68:71]
v_cvt_pk_bf16_f32 v42, v44, v45
v_cvt_pk_bf16_f32 v43, v46, v47
v_mfma_f32_16x16x32_bf16 v[72:75], a[204:207], a[156:159], v[72:75]
v_exp_f32 v52, v52
v_mfma_f32_16x16x32_bf16 v[48:51], a[208:211], a[96:99], 0
v_exp_f32 v53, v53
v_mfma_f32_16x16x32_bf16 v[60:63], a[208:211], a[112:115], 0
v_exp_f32 v54, v54
v_mfma_f32_16x16x32_bf16 v[64:67], a[208:211], a[128:131], 0
v_exp_f32 v55, v55
v_mfma_f32_16x16x32_bf16 v[76:79], a[208:211], a[144:147], 0
v_exp_f32 v56, v56
v_mfma_f32_16x16x32_bf16 v[48:51], a[212:215], a[100:103], v[48:51]
v_exp_f32 v57, v57
v_mfma_f32_16x16x32_bf16 v[60:63], a[212:215], a[116:119], v[60:63]
v_exp_f32 v58, v58
v_mfma_f32_16x16x32_bf16 v[64:67], a[212:215], a[132:135], v[64:67]
v_exp_f32 v59, v59
v_mfma_f32_16x16x32_bf16 v[76:79], a[212:215], a[148:151], v[76:79]
v_exp_f32 v68, v68
v_mfma_f32_16x16x32_bf16 v[48:51], a[216:219], a[104:107], v[48:51]
v_exp_f32 v69, v69
v_mfma_f32_16x16x32_bf16 v[60:63], a[216:219], a[120:123], v[60:63]
v_exp_f32 v70, v70
v_mfma_f32_16x16x32_bf16 v[64:67], a[216:219], a[136:139], v[64:67]
v_exp_f32 v71, v71
v_mfma_f32_16x16x32_bf16 v[76:79], a[216:219], a[152:155], v[76:79]
v_cvt_pk_bf16_f32 v52, v52, v53
v_cvt_pk_bf16_f32 v53, v54, v55
v_mfma_f32_16x16x32_bf16 v[48:51], a[220:223], a[108:111], v[48:51]
v_exp_f32 v72, v72
v_mfma_f32_16x16x32_bf16 v[60:63], a[220:223], a[124:127], v[60:63]
v_exp_f32 v73, v73
v_mfma_f32_16x16x32_bf16 v[64:67], a[220:223], a[140:143], v[64:67]
v_exp_f32 v74, v74
v_mfma_f32_16x16x32_bf16 v[76:79], a[220:223], a[156:159], v[76:79]
s_waitcnt vmcnt(18) lgkmcnt(0)
s_barrier
ds_read_b128 a[224:227], v10 offset:4096
v_cvt_pk_bf16_f32 v56, v56, v57
v_mfma_f32_16x16x32_bf16 v[132:135], a[160:163], v[20:23], v[132:135]
ds_read_b128 a[228:231], v10 offset:5120
v_exp_f32 v48, v48
v_mfma_f32_16x16x32_bf16 v[164:167], a[160:163], v[24:27], v[164:167]
ds_read_b64_tr_b16 a[216:217], v5 offset:49152
v_exp_f32 v49, v49
v_mfma_f32_16x16x32_bf16 v[148:151], a[164:167], v[20:23], v[148:151]
ds_read_b64_tr_b16 a[218:219], v5 offset:53248
v_exp_f32 v50, v50
v_mfma_f32_16x16x32_bf16 v[180:183], a[164:167], v[24:27], v[180:183]
ds_read_b64_tr_b16 a[192:193], v6 offset:49152
v_exp_f32 v51, v51
v_smfmac_f32_16x16x64_bf16 a[244:247], a[240:243], v[20:27], v110
ds_read_b64_tr_b16 a[194:195], v6 offset:53248
v_cvt_pk_bf16_f32 v57, v58, v59
v_mfma_f32_16x16x32_bf16 v[136:139], a[168:171], v[20:23], v[136:139]
ds_read_b64_tr_b16 a[200:201], v7 offset:49152
v_exp_f32 v60, v60
v_mfma_f32_16x16x32_bf16 v[168:171], a[168:171], v[24:27], v[168:171]
ds_read_b64_tr_b16 a[202:203], v7 offset:53248
v_exp_f32 v61, v61
v_mfma_f32_16x16x32_bf16 v[152:155], a[172:175], v[20:23], v[152:155]
ds_read_b64_tr_b16 a[208:209], v8 offset:49152
v_exp_f32 v62, v62
v_mfma_f32_16x16x32_bf16 v[184:187], a[172:175], v[24:27], v[184:187]
ds_read_b64_tr_b16 a[210:211], v8 offset:53248
v_exp_f32 v63, v63
v_mfma_f32_16x16x32_bf16 v[140:143], a[176:179], v[20:23], v[140:143]
ds_read_b64_tr_b16 a[220:221], v5 offset:50176
v_cvt_pk_bf16_f32 v54, v48, v49
v_mfma_f32_16x16x32_bf16 v[172:175], a[176:179], v[24:27], v[172:175]
ds_read_b64_tr_b16 a[222:223], v5 offset:54272
v_cvt_pk_bf16_f32 v55, v50, v51
v_mfma_f32_16x16x32_bf16 v[156:159], a[180:183], v[20:23], v[156:159]
ds_read_b64_tr_b16 a[196:197], v6 offset:50176
v_cvt_pk_bf16_f32 v58, v60, v61
v_mfma_f32_16x16x32_bf16 v[188:191], a[180:183], v[24:27], v[188:191]
ds_read_b64_tr_b16 a[198:199], v6 offset:54272
v_cvt_pk_bf16_f32 v59, v62, v63
v_smfmac_f32_16x16x64_bf16 a[248:251], a[240:243], v[36:43], v110
ds_read_b64_tr_b16 a[204:205], v7 offset:50176
v_cvt_pk_bf16_f32 v68, v68, v69
v_mfma_f32_16x16x32_bf16 v[128:131], a[184:187], v[20:23], v[128:131]
s_waitcnt lgkmcnt(8)
ds_read_b64_tr_b16 a[206:207], v7 offset:54272
v_exp_f32 v75, v75
v_mfma_f32_16x16x32_bf16 v[160:163], a[184:187], v[24:27], v[160:163]
ds_read_b64_tr_b16 a[212:213], v8 offset:50176
v_exp_f32 v64, v64
v_mfma_f32_16x16x32_bf16 v[144:147], a[188:191], v[20:23], v[144:147]
ds_read_b64_tr_b16 a[214:215], v8 offset:54272
v_exp_f32 v65, v65
v_mfma_f32_16x16x32_bf16 v[176:179], a[188:191], v[24:27], v[176:179]
v_exp_f32 v66, v66
v_mfma_f32_16x16x32_bf16 v[88:91], a[184:187], a[224:227], v[88:91]
ds_read_b128 a[232:235], v10 offset:6144
v_exp_f32 v67, v67
v_mfma_f32_16x16x32_bf16 v[96:99], a[184:187], a[228:231], v[96:99]
v_exp_f32 v76, v76
v_smfmac_f32_16x16x64_bf16 a[252:255], a[240:243], a[224:231], v110
ds_read_b128 a[236:239], v10 offset:7168
v_cvt_pk_bf16_f32 v69, v70, v71
v_smfmac_f32_16x16x64_bf16 a[244:247], a[240:243], v[52:59], v110
v_cvt_pk_bf16_f32 v72, v72, v73
v_mfma_f32_16x16x32_bf16 v[92:95], a[188:191], a[224:227], v[92:95]
v_exp_f32 v77, v77
v_mfma_f32_16x16x32_bf16 v[100:103], a[188:191], a[228:231], v[100:103]
v_exp_f32 v78, v78
v_mfma_f32_16x16x32_bf16 v[128:131], a[216:219], v[52:55], v[128:131]
v_exp_f32 v79, v79
v_mfma_f32_16x16x32_bf16 v[132:135], a[192:195], v[52:55], v[132:135]
v_accvgpr_read_b32 v104, a244
v_accvgpr_read_b32 v111, a245
s_waitcnt lgkmcnt(2)
v_mfma_f32_16x16x32_bf16 v[136:139], a[200:203], v[52:55], v[136:139]
v_add_f32 v104, v104, v111
v_accvgpr_read_b32 v105, a246
v_mfma_f32_16x16x32_bf16 v[140:143], a[208:211], v[52:55], v[140:143]
v_rcp_f32 v114, v104
v_mfma_f32_16x16x32_bf16 v[144:147], a[220:223], v[52:55], v[144:147]
v_rcp_f32 v115, v104
s_nop 0
v_pk_mul_f32 v[128:129], v[128:129], v[114:115]
v_pk_mul_f32 v[130:131], v[130:131], v[114:115]
v_pk_mul_f32 v[132:133], v[132:133], v[114:115]
v_pk_mul_f32 v[134:135], v[134:135], v[114:115]
v_mfma_f32_16x16x32_bf16 v[148:151], a[196:199], v[52:55], v[148:151]
v_accvgpr_read_b32 v111, a247
v_add_f32 v105, v105, v111
v_mfma_f32_16x16x32_bf16 v[152:155], a[204:207], v[52:55], v[152:155]
v_rcp_f32 v112, v105
v_cvt_pk_bf16_f32 v128, v128, v129
v_cvt_pk_bf16_f32 v129, v130, v131
v_cvt_pk_bf16_f32 v130, v132, v133
v_cvt_pk_bf16_f32 v131, v134, v135
v_pk_mul_f32 v[136:137], v[136:137], v[114:115]
v_pk_mul_f32 v[138:139], v[138:139], v[114:115]
v_pk_mul_f32 v[140:141], v[140:141], v[114:115]
v_pk_mul_f32 v[142:143], v[142:143], v[114:115]
v_mfma_f32_16x16x32_bf16 v[156:159], a[212:215], v[52:55], v[156:159]
ds_write2_b64 v13, v[128:129], v[130:131] offset0:0 offset1:4
v_mfma_f32_16x16x32_bf16 v[160:163], a[216:219], v[56:59], v[160:163]
v_rcp_f32 v113, v105
v_cvt_pk_bf16_f32 v136, v136, v137
v_cvt_pk_bf16_f32 v137, v138, v139
v_cvt_pk_bf16_f32 v138, v140, v141
v_cvt_pk_bf16_f32 v139, v142, v143
v_pk_mul_f32 v[144:145], v[144:145], v[114:115]
v_pk_mul_f32 v[146:147], v[146:147], v[114:115]
v_pk_mul_f32 v[148:149], v[148:149], v[114:115]
v_pk_mul_f32 v[150:151], v[150:151], v[114:115]
v_mfma_f32_16x16x32_bf16 v[164:167], a[192:195], v[56:59], v[164:167]
ds_write2_b64 v13, v[136:137], v[138:139] offset0:8 offset1:12
ds_read_b128 v[132:135], v14 offset:0
v_mfma_f32_16x16x32_bf16 v[168:171], a[200:203], v[56:59], v[168:171]
ds_read_b128 v[140:143], v14 offset:1152
v_cvt_pk_bf16_f32 v73, v74, v75
v_cvt_pk_bf16_f32 v144, v144, v145
v_cvt_pk_bf16_f32 v145, v146, v147
v_cvt_pk_bf16_f32 v146, v148, v149
v_cvt_pk_bf16_f32 v147, v150, v151
v_pk_mul_f32 v[152:153], v[152:153], v[114:115]
v_pk_mul_f32 v[154:155], v[154:155], v[114:115]
v_pk_mul_f32 v[156:157], v[156:157], v[114:115]
v_pk_mul_f32 v[158:159], v[158:159], v[114:115]
v_mfma_f32_16x16x32_bf16 v[172:175], a[208:211], v[56:59], v[172:175]
ds_write2_b64 v13, v[144:145], v[146:147] offset0:0 offset1:4
v_mfma_f32_16x16x32_bf16 v[176:179], a[220:223], v[56:59], v[176:179]
v_cvt_pk_bf16_f32 v70, v64, v65
v_cvt_pk_bf16_f32 v71, v66, v67
v_cvt_pk_bf16_f32 v152, v152, v153
v_cvt_pk_bf16_f32 v153, v154, v155
v_cvt_pk_bf16_f32 v154, v156, v157
v_cvt_pk_bf16_f32 v155, v158, v159
v_pk_mul_f32 v[160:161], v[160:161], v[112:113]
v_pk_mul_f32 v[162:163], v[162:163], v[112:113]
v_pk_mul_f32 v[164:165], v[164:165], v[112:113]
v_pk_mul_f32 v[166:167], v[166:167], v[112:113]
v_mfma_f32_16x16x32_bf16 v[180:183], a[196:199], v[56:59], v[180:183]
ds_write2_b64 v13, v[152:153], v[154:155] offset0:8 offset1:12
v_mfma_f32_16x16x32_bf16 v[184:187], a[204:207], v[56:59], v[184:187]
s_waitcnt lgkmcnt(3)
buffer_store_dwordx4 v[132:135], v15, s[16:19], s74 offen sc0 sc1
s_waitcnt lgkmcnt(2)
buffer_store_dwordx4 v[140:143], v15, s[16:19], s74 offen offset:2048 sc0 sc1
v_cvt_pk_bf16_f32 v160, v160, v161
v_cvt_pk_bf16_f32 v161, v162, v163
v_cvt_pk_bf16_f32 v162, v164, v165
v_cvt_pk_bf16_f32 v163, v166, v167
v_pk_mul_f32 v[168:169], v[168:169], v[112:113]
v_pk_mul_f32 v[170:171], v[170:171], v[112:113]
v_pk_mul_f32 v[172:173], v[172:173], v[112:113]
v_pk_mul_f32 v[174:175], v[174:175], v[112:113]
v_mfma_f32_16x16x32_bf16 v[188:191], a[212:215], v[56:59], v[188:191]
ds_read_b128 v[148:151], v14 offset:0
ds_read_b128 v[156:159], v14 offset:1152
v_cvt_pk_bf16_f32 v74, v76, v77
v_mfma_f32_16x16x32_bf16 v[88:91], a[216:219], a[232:235], v[88:91]
ds_write2_b64 v13, v[160:161], v[162:163] offset0:0 offset1:4
v_cvt_pk_bf16_f32 v168, v168, v169
v_cvt_pk_bf16_f32 v169, v170, v171
v_cvt_pk_bf16_f32 v170, v172, v173
v_cvt_pk_bf16_f32 v171, v174, v175
v_pk_mul_f32 v[176:177], v[176:177], v[112:113]
v_pk_mul_f32 v[178:179], v[178:179], v[112:113]
v_pk_mul_f32 v[180:181], v[180:181], v[112:113]
v_pk_mul_f32 v[182:183], v[182:183], v[112:113]
v_mfma_f32_16x16x32_bf16 v[96:99], a[216:219], a[236:239], v[96:99]
ds_write2_b64 v13, v[168:169], v[170:171] offset0:8 offset1:12
v_cvt_pk_bf16_f32 v75, v78, v79
v_smfmac_f32_16x16x64_bf16 a[252:255], a[240:243], a[232:239], v110
s_waitcnt lgkmcnt(3)
buffer_store_dwordx4 v[148:151], v15, s[16:19], s74 offen offset:128 sc0 sc1
s_waitcnt lgkmcnt(2)
buffer_store_dwordx4 v[156:159], v15, s[16:19], s74 offen offset:2176 sc0 sc1
v_cvt_pk_bf16_f32 v176, v176, v177
v_cvt_pk_bf16_f32 v177, v178, v179
v_cvt_pk_bf16_f32 v178, v180, v181
v_cvt_pk_bf16_f32 v179, v182, v183
v_pk_mul_f32 v[184:185], v[184:185], v[112:113]
v_pk_mul_f32 v[186:187], v[186:187], v[112:113]
v_pk_mul_f32 v[188:189], v[188:189], v[112:113]
v_pk_mul_f32 v[190:191], v[190:191], v[112:113]
v_smfmac_f32_16x16x64_bf16 a[248:251], a[240:243], v[68:75], v110
ds_read_b128 v[164:167], v14 offset:0
ds_read_b128 v[172:175], v14 offset:1152
v_accvgpr_read_b32 v108, a252
v_mfma_f32_16x16x32_bf16 v[92:95], a[220:223], a[232:235], v[92:95]
ds_write2_b64 v13, v[176:177], v[178:179] offset0:0 offset1:4
v_mfma_f32_16x16x32_bf16 v[100:103], a[220:223], a[236:239], v[100:103]
v_accvgpr_read_b32 v111, a253
v_add_f32 v108, v108, v111
v_mfma_f32_16x16x32_bf16 v[192:195], a[184:187], v[36:39], v[192:195]
v_rcp_f32 v114, v108
v_mfma_f32_16x16x32_bf16 v[196:199], a[160:163], v[36:39], v[196:199]
v_rcp_f32 v115, v108
v_cvt_pk_bf16_f32 v184, v184, v185
v_cvt_pk_bf16_f32 v185, v186, v187
v_cvt_pk_bf16_f32 v186, v188, v189
v_cvt_pk_bf16_f32 v187, v190, v191
v_pk_mul_f32 v[88:89], v[88:89], v[114:115]
v_pk_mul_f32 v[90:91], v[90:91], v[114:115]
v_pk_mul_f32 v[92:93], v[92:93], v[114:115]
v_pk_mul_f32 v[94:95], v[94:95], v[114:115]
v_mfma_f32_16x16x32_bf16 v[192:195], a[216:219], v[68:71], v[192:195]
ds_write2_b64 v13, v[184:185], v[186:187] offset0:8 offset1:12
v_accvgpr_read_b32 v109, a254
v_accvgpr_read_b32 v111, a255
v_add_f32 v109, v109, v111
v_mfma_f32_16x16x32_bf16 v[196:199], a[192:195], v[68:71], v[196:199]
s_waitcnt lgkmcnt(3)
buffer_store_dwordx4 v[164:167], v15, s[16:19], s75 offen sc0 sc1
s_waitcnt lgkmcnt(2)
buffer_store_dwordx4 v[172:175], v15, s[16:19], s75 offen offset:2048 sc0 sc1
v_rcp_f32 v112, v109
v_rcp_f32 v113, v109
v_cvt_pk_bf16_f32 v88, v88, v89
v_cvt_pk_bf16_f32 v89, v90, v91
v_cvt_pk_bf16_f32 v90, v92, v93
v_cvt_pk_bf16_f32 v91, v94, v95
v_pk_mul_f32 v[96:97], v[96:97], v[112:113]
v_pk_mul_f32 v[98:99], v[98:99], v[112:113]
v_pk_mul_f32 v[100:101], v[100:101], v[112:113]
v_pk_mul_f32 v[102:103], v[102:103], v[112:113]
v_mfma_f32_16x16x32_bf16 v[200:203], a[168:171], v[36:39], v[200:203]
ds_read_b128 v[180:183], v14 offset:0
ds_read_b128 v[188:191], v14 offset:1152
v_accvgpr_read_b32 v106, a248
v_mfma_f32_16x16x32_bf16 v[204:207], a[176:179], v[36:39], v[204:207]
ds_write_b64 v116, v[88:89] offset:0
v_accvgpr_read_b32 v111, a249
v_add_f32 v106, v106, v111
v_mfma_f32_16x16x32_bf16 v[200:203], a[200:203], v[68:71], v[200:203]
ds_write_b64 v116, v[90:91] offset:128
v_rcp_f32 v114, v106
v_rcp_f32 v115, v106
v_cvt_pk_bf16_f32 v96, v96, v97
v_cvt_pk_bf16_f32 v97, v98, v99
v_cvt_pk_bf16_f32 v98, v100, v101
v_cvt_pk_bf16_f32 v99, v102, v103
v_pk_mul_f32 v[192:193], v[192:193], v[114:115]
v_pk_mul_f32 v[194:195], v[194:195], v[114:115]
v_pk_mul_f32 v[196:197], v[196:197], v[114:115]
v_pk_mul_f32 v[198:199], v[198:199], v[114:115]
v_mfma_f32_16x16x32_bf16 v[204:207], a[208:211], v[68:71], v[204:207]
ds_write_b64 v116, v[96:97] offset:4352
v_mfma_f32_16x16x32_bf16 v[208:211], a[188:191], v[36:39], v[208:211]
ds_write_b64 v116, v[98:99] offset:4480
v_mfma_f32_16x16x32_bf16 v[212:215], a[164:167], v[36:39], v[212:215]
v_accvgpr_read_b32 v107, a250
v_accvgpr_read_b32 v111, a251
v_mfma_f32_16x16x32_bf16 v[208:211], a[220:223], v[68:71], v[208:211]
v_add_f32 v107, v107, v111
v_cvt_pk_bf16_f32 v192, v192, v193
v_cvt_pk_bf16_f32 v193, v194, v195
v_cvt_pk_bf16_f32 v194, v196, v197
v_cvt_pk_bf16_f32 v195, v198, v199
v_pk_mul_f32 v[200:201], v[200:201], v[114:115]
v_pk_mul_f32 v[202:203], v[202:203], v[114:115]
v_pk_mul_f32 v[204:205], v[204:205], v[114:115]
v_pk_mul_f32 v[206:207], v[206:207], v[114:115]
v_mfma_f32_16x16x32_bf16 v[212:215], a[196:199], v[68:71], v[212:215]
ds_write2_b64 v13, v[192:193], v[194:195] offset0:0 offset1:4
v_mfma_f32_16x16x32_bf16 v[216:219], a[172:175], v[36:39], v[216:219]
v_rcp_f32 v112, v107
v_mfma_f32_16x16x32_bf16 v[220:223], a[180:183], v[36:39], v[220:223]
v_rcp_f32 v113, v107
v_mfma_f32_16x16x32_bf16 v[216:219], a[204:207], v[68:71], v[216:219]
v_cvt_pk_bf16_f32 v200, v200, v201
v_cvt_pk_bf16_f32 v201, v202, v203
v_cvt_pk_bf16_f32 v202, v204, v205
v_cvt_pk_bf16_f32 v203, v206, v207
v_pk_mul_f32 v[208:209], v[208:209], v[114:115]
v_pk_mul_f32 v[210:211], v[210:211], v[114:115]
v_pk_mul_f32 v[212:213], v[212:213], v[114:115]
v_pk_mul_f32 v[214:215], v[214:215], v[114:115]
v_mfma_f32_16x16x32_bf16 v[220:223], a[212:215], v[68:71], v[220:223]
ds_write2_b64 v13, v[200:201], v[202:203] offset0:8 offset1:12
v_mfma_f32_16x16x32_bf16 v[224:227], a[184:187], v[40:43], v[224:227]
s_waitcnt lgkmcnt(2)
buffer_store_dwordx4 v[180:183], v15, s[16:19], s75 offen offset:128 sc0 sc1
v_mfma_f32_16x16x32_bf16 v[228:231], a[160:163], v[40:43], v[228:231]
buffer_store_dwordx4 v[188:191], v15, s[16:19], s75 offen offset:2176 sc0 sc1
ds_read_b128 v[196:199], v14 offset:0
v_mfma_f32_16x16x32_bf16 v[224:227], a[216:219], v[72:75], v[224:227]
ds_read_b128 v[204:207], v14 offset:1152
v_cvt_pk_bf16_f32 v208, v208, v209
v_cvt_pk_bf16_f32 v209, v210, v211
v_cvt_pk_bf16_f32 v210, v212, v213
v_cvt_pk_bf16_f32 v211, v214, v215
v_pk_mul_f32 v[216:217], v[216:217], v[114:115]
v_pk_mul_f32 v[218:219], v[218:219], v[114:115]
v_pk_mul_f32 v[220:221], v[220:221], v[114:115]
v_pk_mul_f32 v[222:223], v[222:223], v[114:115]
v_mfma_f32_16x16x32_bf16 v[228:231], a[192:195], v[72:75], v[228:231]
ds_write2_b64 v13, v[208:209], v[210:211] offset0:0 offset1:4
s_barrier
v_mfma_f32_16x16x32_bf16 v[232:235], a[168:171], v[40:43], v[232:235]
ds_read_b128 v[120:123], v117 offset:0
ds_read_b128 v[124:127], v117 offset:1088
v_mfma_f32_16x16x32_bf16 v[236:239], a[176:179], v[40:43], v[236:239]
v_mfma_f32_16x16x32_bf16 v[232:235], a[200:203], v[72:75], v[232:235]
v_cvt_pk_bf16_f32 v216, v216, v217
v_cvt_pk_bf16_f32 v217, v218, v219
v_cvt_pk_bf16_f32 v218, v220, v221
v_cvt_pk_bf16_f32 v219, v222, v223
v_pk_mul_f32 v[224:225], v[224:225], v[112:113]
v_pk_mul_f32 v[226:227], v[226:227], v[112:113]
v_pk_mul_f32 v[228:229], v[228:229], v[112:113]
v_pk_mul_f32 v[230:231], v[230:231], v[112:113]
v_mfma_f32_16x16x32_bf16 v[236:239], a[208:211], v[72:75], v[236:239]
ds_write2_b64 v13, v[216:217], v[218:219] offset0:8 offset1:12
v_mfma_f32_16x16x32_bf16 v[240:243], a[188:191], v[40:43], v[240:243]
s_waitcnt lgkmcnt(5)
buffer_store_dwordx4 v[196:199], v15, s[16:19], s76 offen sc0 sc1
v_mfma_f32_16x16x32_bf16 v[244:247], a[164:167], v[40:43], v[244:247]
s_waitcnt lgkmcnt(4)
buffer_store_dwordx4 v[204:207], v15, s[16:19], s76 offen offset:2048 sc0 sc1
ds_read_b128 v[212:215], v14 offset:0
v_mfma_f32_16x16x32_bf16 v[240:243], a[220:223], v[72:75], v[240:243]
ds_read_b128 v[220:223], v14 offset:1152
v_cvt_pk_bf16_f32 v224, v224, v225
v_cvt_pk_bf16_f32 v225, v226, v227
v_cvt_pk_bf16_f32 v226, v228, v229
v_cvt_pk_bf16_f32 v227, v230, v231
v_pk_mul_f32 v[232:233], v[232:233], v[112:113]
v_pk_mul_f32 v[234:235], v[234:235], v[112:113]
v_pk_mul_f32 v[236:237], v[236:237], v[112:113]
v_pk_mul_f32 v[238:239], v[238:239], v[112:113]
v_mfma_f32_16x16x32_bf16 v[244:247], a[196:199], v[72:75], v[244:247]
ds_write2_b64 v13, v[224:225], v[226:227] offset0:0 offset1:4
v_mfma_f32_16x16x32_bf16 v[248:251], a[172:175], v[40:43], v[248:251]
v_mfma_f32_16x16x32_bf16 v[252:255], a[180:183], v[40:43], v[252:255]
v_mfma_f32_16x16x32_bf16 v[248:251], a[204:207], v[72:75], v[248:251]
v_cvt_pk_bf16_f32 v232, v232, v233
v_cvt_pk_bf16_f32 v233, v234, v235
v_cvt_pk_bf16_f32 v234, v236, v237
v_cvt_pk_bf16_f32 v235, v238, v239
v_pk_mul_f32 v[240:241], v[240:241], v[112:113]
v_pk_mul_f32 v[242:243], v[242:243], v[112:113]
v_pk_mul_f32 v[244:245], v[244:245], v[112:113]
v_pk_mul_f32 v[246:247], v[246:247], v[112:113]
v_mfma_f32_16x16x32_bf16 v[252:255], a[212:215], v[72:75], v[252:255]
ds_write2_b64 v13, v[232:233], v[234:235] offset0:8 offset1:12
s_waitcnt lgkmcnt(3)
buffer_store_dwordx4 v[212:215], v15, s[16:19], s76 offen offset:128 sc0 sc1
s_waitcnt lgkmcnt(2)
buffer_store_dwordx4 v[220:223], v15, s[16:19], s76 offen offset:2176 sc0 sc1
ds_read_b128 v[228:231], v14 offset:0
ds_read_b128 v[236:239], v14 offset:1152
buffer_store_dwordx4 v[120:123], v12, s[16:19], s78 offen sc0 sc1
buffer_store_dwordx4 v[124:127], v12, s[16:19], s78 offen offset:1024 sc0 sc1
v_cvt_pk_bf16_f32 v240, v240, v241
v_cvt_pk_bf16_f32 v241, v242, v243
v_cvt_pk_bf16_f32 v242, v244, v245
v_cvt_pk_bf16_f32 v243, v246, v247
v_pk_mul_f32 v[248:249], v[248:249], v[112:113]
v_pk_mul_f32 v[250:251], v[250:251], v[112:113]
v_pk_mul_f32 v[252:253], v[252:253], v[112:113]
v_pk_mul_f32 v[254:255], v[254:255], v[112:113]
ds_write2_b64 v13, v[240:241], v[242:243] offset0:0 offset1:4
v_cvt_pk_bf16_f32 v248, v248, v249
v_cvt_pk_bf16_f32 v249, v250, v251
v_cvt_pk_bf16_f32 v250, v252, v253
v_cvt_pk_bf16_f32 v251, v254, v255
ds_write2_b64 v13, v[248:249], v[250:251] offset0:8 offset1:12
s_waitcnt lgkmcnt(3)
buffer_store_dwordx4 v[228:231], v15, s[16:19], s77 offen sc0 sc1
s_waitcnt lgkmcnt(2)
buffer_store_dwordx4 v[236:239], v15, s[16:19], s77 offen offset:2048 sc0 sc1
ds_read_b128 v[244:247], v14 offset:0
ds_read_b128 v[252:255], v14 offset:1152
v_subrev_u32 v118, s28, v104
v_subrev_u32 v119, s28, v105
v_max_u32 v118, v118, v119
v_subrev_u32 v119, s28, v106
v_cmp_lt_u32 s[48:49], s29, v118
v_subrev_u32 v118, s28, v107
v_max_u32 v118, v118, v119
v_subrev_u32 v119, s28, v108
v_cmp_lt_u32 s[50:51], s29, v118
v_subrev_u32 v118, s28, v109
v_max_u32 v118, v118, v119
s_lshl_b32 s34, s34, 3
v_cmp_lt_u32 s[52:53], s29, v118
s_cmp_lg_u64 s[48:49], 0
s_cselect_b32 s55, 1, 0
s_or_b32 s34, s34, s55
s_cmp_lg_u64 s[50:51], 0
s_cselect_b32 s55, 2, 0
s_or_b32 s34, s34, s55
s_cmp_lg_u64 s[52:53], 0
s_cselect_b32 s55, 4, 0
s_or_b32 s34, s34, s55
s_waitcnt lgkmcnt(1)
buffer_store_dwordx4 v[244:247], v15, s[16:19], s77 offen offset:128 sc0 sc1
s_waitcnt lgkmcnt(0)
buffer_store_dwordx4 v[252:255], v15, s[16:19], s77 offen offset:2176 sc0 sc1
L_fin:
s_cmp_lg_u32 s34, 0
s_cbranch_scc1 L_slow
L_end:
s_endpgm
L_slow:
s_waitcnt vmcnt(0) lgkmcnt(0)
s_and_b32 s49, s34, 0x24
s_cbranch_scc0 L_sl1
s_barrier
s_cmp_eq_u32 s20, 0
s_cbranch_scc1 L_sl1
s_and_b32 s34, s34, 0x1b
s_cbranch_scc0 L_end
L_sl1:
v_subrev_u32 v1, 131072, v10
v_lshrrev_b32 v1, 4, v1
v_and_b32 v2, 31, v1
v_lshrrev_b32 v8, 5, v1
v_lshlrev_b32 v2, 8, v2
v_lshl_add_u32 v13, v8, 5, v2
v_lshl_add_u32 v2, v8, 4, v2
v_lshrrev_b32 v17, 3, v1
v_and_b32 v18, 7, v1
v_and_b32 v19, 2, v17
v_lshlrev_b32 v19, 1, v19
v_xor_b32 v18, v18, v19
v_lshlrev_b32 v17, 8, v17
v_lshl_add_u32 v5, v18, 4, v17
v_bfe_u32 v16, v1, 2, 2
v_lshl_add_u32 v18, v8, 2, v16
v_lshlrev_b32 v18, 7, v18
v_lshrrev_b32 v16, 1, v16
v_lshl_add_u32 v18, v16, 6, v18
v_and_b32 v16, 1, v1
v_lshl_add_u32 v18, v16, 5, v18
v_bfe_u32 v16, v1, 4, 1
v_lshl_add_u32 v18, v16, 4, v18
v_bfe_u32 v16, v1, 1, 1
v_lshl_add_u32 v18, v16, 3, v18
s_lshl_b32 s55, s20, 13
v_add_u32 v3, s55, v18
v_xor_b32 v4, 64, v3
L_sl2:
s_ff1_i32_b32 s49, s34
s_bitset0_b32 s34, s49
s_cmp_ge_u32 s49, 3
s_cselect_b32 s50, 0, 73728
s_cselect_b32 s51, 0, 262144
s_cselect_b32 s53, 3, 0
s_sub_u32 s49, s49, s53
s_lshl_b32 s53, s2, 19
s_add_u32 s51, s51, s53
s_lshl_b32 s53, s49, 13
s_add_u32 s53, s53, s35
s_add_u32 s52, s22, 0x10000
s_cmp_eq_u32 s49, 2
s_cselect_b32 s53, s52, s53
s_add_u32 s50, s50, s53
buffer_load_dwordx4 v[128:131], v2, s[4:7], s50 offen offset:0
buffer_load_dwordx4 v[132:135], v2, s[4:7], s50 offen offset:32
buffer_load_dwordx4 v[136:139], v2, s[4:7], s50 offen offset:64
buffer_load_dwordx4 v[140:143], v2, s[4:7], s50 offen offset:96
buffer_load_dwordx4 v[144:147], v2, s[4:7], s50 offen offset:128
buffer_load_dwordx4 v[148:151], v2, s[4:7], s50 offen offset:160
buffer_load_dwordx4 v[152:155], v2, s[4:7], s50 offen offset:192
buffer_load_dwordx4 v[156:159], v2, s[4:7], s50 offen offset:224
v_mov_b64 v[160:161], 0
v_mov_b64 v[162:163], 0
v_mov_b64 v[164:165], 0
v_mov_b64 v[166:167], 0
v_mov_b64 v[168:169], 0
v_mov_b64 v[170:171], 0
v_mov_b64 v[172:173], 0
v_mov_b64 v[174:175], 0
v_mov_b64 v[176:177], 0
v_mov_b64 v[178:179], 0
v_mov_b64 v[180:181], 0
v_mov_b64 v[182:183], 0
v_mov_b64 v[184:185], 0
v_mov_b64 v[186:187], 0
v_mov_b64 v[188:189], 0
v_mov_b64 v[190:191], 0
v_mov_b64 v[192:193], 0
v_mov_b64 v[194:195], 0
v_mov_b64 v[196:197], 0
v_mov_b64 v[198:199], 0
v_mov_b64 v[200:201], 0
v_mov_b64 v[202:203], 0
v_mov_b64 v[204:205], 0
v_mov_b64 v[206:207], 0
v_mov_b64 v[208:209], 0
v_mov_b64 v[210:211], 0
v_mov_b64 v[212:213], 0
v_mov_b64 v[214:215], 0
v_mov_b64 v[216:217], 0
v_mov_b64 v[218:219], 0
v_mov_b64 v[220:221], 0
v_mov_b64 v[222:223], 0
v_mov_b32 v6, 0xff800000
v_mov_b32 v7, 0
s_mov_b32 s52, 0
s_waitcnt vmcnt(0)
v_lshlrev_b32 v240, 16, v128
v_lshlrev_b32 v242, 16, v129
v_lshlrev_b32 v244, 16, v130
v_lshlrev_b32 v246, 16, v131
v_and_b32 v241, s25, v128
v_and_b32 v243, s25, v129
v_and_b32 v245, s25, v130
v_and_b32 v247, s25, v131
v_pk_mul_f32 v[240:241], v[240:241], s[26:27]
v_pk_mul_f32 v[242:243], v[242:243], s[26:27]
v_pk_mul_f32 v[244:245], v[244:245], s[26:27]
v_pk_mul_f32 v[246:247], v[246:247], s[26:27]
v_cvt_pk_bf16_f32 v128, v240, v241
v_cvt_pk_bf16_f32 v129, v242, v243
v_cvt_pk_bf16_f32 v130, v244, v245
v_cvt_pk_bf16_f32 v131, v246, v247
v_lshlrev_b32 v240, 16, v132
v_lshlrev_b32 v242, 16, v133
v_lshlrev_b32 v244, 16, v134
v_lshlrev_b32 v246, 16, v135
v_and_b32 v241, s25, v132
v_and_b32 v243, s25, v133
v_and_b32 v245, s25, v134
v_and_b32 v247, s25, v135
v_pk_mul_f32 v[240:241], v[240:241], s[26:27]
v_pk_mul_f32 v[242:243], v[242:243], s[26:27]
v_pk_mul_f32 v[244:245], v[244:245], s[26:27]
v_pk_mul_f32 v[246:247], v[246:247], s[26:27]
v_cvt_pk_bf16_f32 v132, v240, v241
v_cvt_pk_bf16_f32 v133, v242, v243
v_cvt_pk_bf16_f32 v134, v244, v245
v_cvt_pk_bf16_f32 v135, v246, v247
v_lshlrev_b32 v240, 16, v136
v_lshlrev_b32 v242, 16, v137
v_lshlrev_b32 v244, 16, v138
v_lshlrev_b32 v246, 16, v139
v_and_b32 v241, s25, v136
v_and_b32 v243, s25, v137
v_and_b32 v245, s25, v138
v_and_b32 v247, s25, v139
v_pk_mul_f32 v[240:241], v[240:241], s[26:27]
v_pk_mul_f32 v[242:243], v[242:243], s[26:27]
v_pk_mul_f32 v[244:245], v[244:245], s[26:27]
v_pk_mul_f32 v[246:247], v[246:247], s[26:27]
v_cvt_pk_bf16_f32 v136, v240, v241
v_cvt_pk_bf16_f32 v137, v242, v243
v_cvt_pk_bf16_f32 v138, v244, v245
v_cvt_pk_bf16_f32 v139, v246, v247
v_lshlrev_b32 v240, 16, v140
v_lshlrev_b32 v242, 16, v141
v_lshlrev_b32 v244, 16, v142
v_lshlrev_b32 v246, 16, v143
v_and_b32 v241, s25, v140
v_and_b32 v243, s25, v141
v_and_b32 v245, s25, v142
v_and_b32 v247, s25, v143
v_pk_mul_f32 v[240:241], v[240:241], s[26:27]
v_pk_mul_f32 v[242:243], v[242:243], s[26:27]
v_pk_mul_f32 v[244:245], v[244:245], s[26:27]
v_pk_mul_f32 v[246:247], v[246:247], s[26:27]
v_cvt_pk_bf16_f32 v140, v240, v241
v_cvt_pk_bf16_f32 v141, v242, v243
v_cvt_pk_bf16_f32 v142, v244, v245
v_cvt_pk_bf16_f32 v143, v246, v247
v_lshlrev_b32 v240, 16, v144
v_lshlrev_b32 v242, 16, v145
v_lshlrev_b32 v244, 16, v146
v_lshlrev_b32 v246, 16, v147
v_and_b32 v241, s25, v144
v_and_b32 v243, s25, v145
v_and_b32 v245, s25, v146
v_and_b32 v247, s25, v147
v_pk_mul_f32 v[240:241], v[240:241], s[26:27]
v_pk_mul_f32 v[242:243], v[242:243], s[26:27]
v_pk_mul_f32 v[244:245], v[244:245], s[26:27]
v_pk_mul_f32 v[246:247], v[246:247], s[26:27]
v_cvt_pk_bf16_f32 v144, v240, v241
v_cvt_pk_bf16_f32 v145, v242, v243
v_cvt_pk_bf16_f32 v146, v244, v245
v_cvt_pk_bf16_f32 v147, v246, v247
v_lshlrev_b32 v240, 16, v148
v_lshlrev_b32 v242, 16, v149
v_lshlrev_b32 v244, 16, v150
v_lshlrev_b32 v246, 16, v151
v_and_b32 v241, s25, v148
v_and_b32 v243, s25, v149
v_and_b32 v245, s25, v150
v_and_b32 v247, s25, v151
v_pk_mul_f32 v[240:241], v[240:241], s[26:27]
v_pk_mul_f32 v[242:243], v[242:243], s[26:27]
v_pk_mul_f32 v[244:245], v[244:245], s[26:27]
v_pk_mul_f32 v[246:247], v[246:247], s[26:27]
v_cvt_pk_bf16_f32 v148, v240, v241
v_cvt_pk_bf16_f32 v149, v242, v243
v_cvt_pk_bf16_f32 v150, v244, v245
v_cvt_pk_bf16_f32 v151, v246, v247
v_lshlrev_b32 v240, 16, v152
v_lshlrev_b32 v242, 16, v153
v_lshlrev_b32 v244, 16, v154
v_lshlrev_b32 v246, 16, v155
v_and_b32 v241, s25, v152
v_and_b32 v243, s25, v153
v_and_b32 v245, s25, v154
v_and_b32 v247, s25, v155
v_pk_mul_f32 v[240:241], v[240:241], s[26:27]
v_pk_mul_f32 v[242:243], v[242:243], s[26:27]
v_pk_mul_f32 v[244:245], v[244:245], s[26:27]
v_pk_mul_f32 v[246:247], v[246:247], s[26:27]
v_cvt_pk_bf16_f32 v152, v240, v241
v_cvt_pk_bf16_f32 v153, v242, v243
v_cvt_pk_bf16_f32 v154, v244, v245
v_cvt_pk_bf16_f32 v155, v246, v247
v_lshlrev_b32 v240, 16, v156
v_lshlrev_b32 v242, 16, v157
v_lshlrev_b32 v244, 16, v158
v_lshlrev_b32 v246, 16, v159
v_and_b32 v241, s25, v156
v_and_b32 v243, s25, v157
v_and_b32 v245, s25, v158
v_and_b32 v247, s25, v159
v_pk_mul_f32 v[240:241], v[240:241], s[26:27]
v_pk_mul_f32 v[242:243], v[242:243], s[26:27]
v_pk_mul_f32 v[244:245], v[244:245], s[26:27]
v_pk_mul_f32 v[246:247], v[246:247], s[26:27]
v_cvt_pk_bf16_f32 v156, v240, v241
v_cvt_pk_bf16_f32 v157, v242, v243
v_cvt_pk_bf16_f32 v158, v244, v245
v_cvt_pk_bf16_f32 v159, v246, v247
L_sl3:
buffer_load_dwordx4 v[16:19], v2, s[8:11], s51 offen offset:0
buffer_load_dwordx4 v[20:23], v2, s[8:11], s51 offen offset:32
buffer_load_dwordx4 v[24:27], v2, s[8:11], s51 offen offset:64
buffer_load_dwordx4 v[28:31], v2, s[8:11], s51 offen offset:96
buffer_load_dwordx4 v[32:35], v2, s[8:11], s51 offen offset:128
buffer_load_dwordx4 v[36:39], v2, s[8:11], s51 offen offset:160
buffer_load_dwordx4 v[40:43], v2, s[8:11], s51 offen offset:192
buffer_load_dwordx4 v[44:47], v2, s[8:11], s51 offen offset:224
s_add_u32 m0, s55, 0
s_add_u32 s53, s51, 0
buffer_load_dwordx4 v5, s[12:15], s53 offen nt lds
buffer_load_dwordx4 v5, s[12:15], s53 offen offset:2048 nt lds
s_add_u32 m0, s55, 1024
s_add_u32 s53, s51, 128
buffer_load_dwordx4 v5, s[12:15], s53 offen nt lds
buffer_load_dwordx4 v5, s[12:15], s53 offen offset:2048 nt lds
s_add_u32 m0, s55, 4096
s_add_u32 s53, s51, 4096
buffer_load_dwordx4 v5, s[12:15], s53 offen nt lds
buffer_load_dwordx4 v5, s[12:15], s53 offen offset:2048 nt lds
s_add_u32 m0, s55, 5120
s_add_u32 s53, s51, 4224
buffer_load_dwordx4 v5, s[12:15], s53 offen nt lds
buffer_load_dwordx4 v5, s[12:15], s53 offen offset:2048 nt lds
s_waitcnt vmcnt(0)
v_mfma_f32_32x32x16_bf16 v[48:63], v[16:19], v[128:131], 0
v_mfma_f32_32x32x16_bf16 v[48:63], v[20:23], v[132:135], v[48:63]
v_mfma_f32_32x32x16_bf16 v[48:63], v[24:27], v[136:139], v[48:63]
v_mfma_f32_32x32x16_bf16 v[48:63], v[28:31], v[140:143], v[48:63]
v_mfma_f32_32x32x16_bf16 v[48:63], v[32:35], v[144:147], v[48:63]
v_mfma_f32_32x32x16_bf16 v[48:63], v[36:39], v[148:151], v[48:63]
v_mfma_f32_32x32x16_bf16 v[48:63], v[40:43], v[152:155], v[48:63]
v_mfma_f32_32x32x16_bf16 v[48:63], v[44:47], v[156:159], v[48:63]
ds_read_b64_tr_b16 v[64:65], v3 offset:0
ds_read_b64_tr_b16 v[66:67], v3 offset:2048
ds_read_b64_tr_b16 v[68:69], v4 offset:0
ds_read_b64_tr_b16 v[70:71], v4 offset:2048
ds_read_b64_tr_b16 v[72:73], v3 offset:1024
ds_read_b64_tr_b16 v[74:75], v3 offset:3072
ds_read_b64_tr_b16 v[76:77], v4 offset:1024
ds_read_b64_tr_b16 v[78:79], v4 offset:3072
s_waitcnt lgkmcnt(0)
ds_read_b64_tr_b16 v[80:81], v3 offset:4096
ds_read_b64_tr_b16 v[82:83], v3 offset:6144
ds_read_b64_tr_b16 v[84:85], v4 offset:4096
ds_read_b64_tr_b16 v[86:87], v4 offset:6144
ds_read_b64_tr_b16 v[88:89], v3 offset:5120
ds_read_b64_tr_b16 v[90:91], v3 offset:7168
ds_read_b64_tr_b16 v[92:93], v4 offset:5120
ds_read_b64_tr_b16 v[94:95], v4 offset:7168
s_waitcnt lgkmcnt(0)
v_max3_f32 v8, v48, v49, v6
v_max3_f32 v8, v8, v50, v51
v_max3_f32 v8, v8, v52, v53
v_max3_f32 v8, v8, v54, v55
v_max3_f32 v8, v8, v56, v57
v_max3_f32 v8, v8, v58, v59
v_max3_f32 v8, v8, v60, v61
v_max3_f32 v8, v8, v62, v63
v_mov_b32 v9, v8
s_nop 1
v_permlane32_swap_b32 v8, v9
v_max_f32 v8, v8, v9
v_sub_f32 v9, v6, v8
v_mov_b32 v6, v8
v_exp_f32 v9, v9
v_sub_f32 v48, v48, v6
v_sub_f32 v49, v49, v6
v_sub_f32 v50, v50, v6
v_sub_f32 v51, v51, v6
v_sub_f32 v52, v52, v6
v_sub_f32 v53, v53, v6
v_sub_f32 v54, v54, v6
v_sub_f32 v55, v55, v6
v_sub_f32 v56, v56, v6
v_sub_f32 v57, v57, v6
v_sub_f32 v58, v58, v6
v_sub_f32 v59, v59, v6
v_sub_f32 v60, v60, v6
v_sub_f32 v61, v61, v6
v_sub_f32 v62, v62, v6
v_sub_f32 v63, v63, v6
v_mul_f32 v7, v7, v9
v_mul_f32 v160, v160, v9
v_mul_f32 v161, v161, v9
v_mul_f32 v162, v162, v9
v_mul_f32 v163, v163, v9
v_mul_f32 v164, v164, v9
v_mul_f32 v165, v165, v9
v_mul_f32 v166, v166, v9
v_mul_f32 v167, v167, v9
v_mul_f32 v168, v168, v9
v_mul_f32 v169, v169, v9
v_mul_f32 v170, v170, v9
v_mul_f32 v171, v171, v9
v_mul_f32 v172, v172, v9
v_mul_f32 v173, v173, v9
v_mul_f32 v174, v174, v9
v_mul_f32 v175, v175, v9
v_mul_f32 v176, v176, v9
v_mul_f32 v177, v177, v9
v_mul_f32 v178, v178, v9
v_mul_f32 v179, v179, v9
v_mul_f32 v180, v180, v9
v_mul_f32 v181, v181, v9
v_mul_f32 v182, v182, v9
v_mul_f32 v183, v183, v9
v_mul_f32 v184, v184, v9
v_mul_f32 v185, v185, v9
v_mul_f32 v186, v186, v9
v_mul_f32 v187, v187, v9
v_mul_f32 v188, v188, v9
v_mul_f32 v189, v189, v9
v_mul_f32 v190, v190, v9
v_mul_f32 v191, v191, v9
v_mul_f32 v192, v192, v9
v_mul_f32 v193, v193, v9
v_mul_f32 v194, v194, v9
v_mul_f32 v195, v195, v9
v_mul_f32 v196, v196, v9
v_mul_f32 v197, v197, v9
v_mul_f32 v198, v198, v9
v_mul_f32 v199, v199, v9
v_mul_f32 v200, v200, v9
v_mul_f32 v201, v201, v9
v_mul_f32 v202, v202, v9
v_mul_f32 v203, v203, v9
v_mul_f32 v204, v204, v9
v_mul_f32 v205, v205, v9
v_mul_f32 v206, v206, v9
v_mul_f32 v207, v207, v9
v_mul_f32 v208, v208, v9
v_mul_f32 v209, v209, v9
v_mul_f32 v210, v210, v9
v_mul_f32 v211, v211, v9
v_mul_f32 v212, v212, v9
v_mul_f32 v213, v213, v9
v_mul_f32 v214, v214, v9
v_mul_f32 v215, v215, v9
v_mul_f32 v216, v216, v9
v_mul_f32 v217, v217, v9
v_mul_f32 v218, v218, v9
v_mul_f32 v219, v219, v9
v_mul_f32 v220, v220, v9
v_mul_f32 v221, v221, v9
v_mul_f32 v222, v222, v9
v_mul_f32 v223, v223, v9
v_exp_f32 v48, v48
v_exp_f32 v49, v49
v_exp_f32 v50, v50
v_exp_f32 v51, v51
v_exp_f32 v52, v52
v_exp_f32 v53, v53
v_exp_f32 v54, v54
v_exp_f32 v55, v55
v_exp_f32 v56, v56
v_exp_f32 v57, v57
v_exp_f32 v58, v58
v_exp_f32 v59, v59
v_exp_f32 v60, v60
v_exp_f32 v61, v61
v_exp_f32 v62, v62
v_exp_f32 v63, v63
v_add_f32 v7, v7, v48
v_add_f32 v7, v7, v49
v_add_f32 v7, v7, v50
v_add_f32 v7, v7, v51
v_add_f32 v7, v7, v52
v_add_f32 v7, v7, v53
v_add_f32 v7, v7, v54
v_add_f32 v7, v7, v55
v_add_f32 v7, v7, v56
v_add_f32 v7, v7, v57
v_add_f32 v7, v7, v58
v_add_f32 v7, v7, v59
v_add_f32 v7, v7, v60
v_add_f32 v7, v7, v61
v_add_f32 v7, v7, v62
v_add_f32 v7, v7, v63
v_cvt_pk_bf16_f32 v48, v48, v49
v_cvt_pk_bf16_f32 v49, v50, v51
v_cvt_pk_bf16_f32 v50, v52, v53
v_cvt_pk_bf16_f32 v51, v54, v55
v_cvt_pk_bf16_f32 v56, v56, v57
v_cvt_pk_bf16_f32 v57, v58, v59
v_cvt_pk_bf16_f32 v58, v60, v61
v_cvt_pk_bf16_f32 v59, v62, v63
v_mfma_f32_32x32x16_bf16 v[160:175], v[64:67], v[48:51], v[160:175]
v_mfma_f32_32x32x16_bf16 v[176:191], v[68:71], v[48:51], v[176:191]
v_mfma_f32_32x32x16_bf16 v[192:207], v[72:75], v[48:51], v[192:207]
v_mfma_f32_32x32x16_bf16 v[208:223], v[76:79], v[48:51], v[208:223]
v_mfma_f32_32x32x16_bf16 v[160:175], v[80:83], v[56:59], v[160:175]
v_mfma_f32_32x32x16_bf16 v[176:191], v[84:87], v[56:59], v[176:191]
v_mfma_f32_32x32x16_bf16 v[192:207], v[88:91], v[56:59], v[192:207]
v_mfma_f32_32x32x16_bf16 v[208:223], v[92:95], v[56:59], v[208:223]
s_nop 15
s_add_u32 s51, s51, 0x2000
s_add_u32 s52, s52, 1
s_cmp_lt_u32 s52, 32
s_cbranch_scc1 L_sl3
v_mov_b32 v8, v7
s_nop 1
v_permlane32_swap_b32 v7, v8
v_add_f32 v7, v7, v8
v_rcp_f32 v7, v7
s_nop 0
v_mul_f32 v160, v160, v7
v_mul_f32 v161, v161, v7
v_mul_f32 v162, v162, v7
v_mul_f32 v163, v163, v7
v_mul_f32 v164, v164, v7
v_mul_f32 v165, v165, v7
v_mul_f32 v166, v166, v7
v_mul_f32 v167, v167, v7
v_mul_f32 v168, v168, v7
v_mul_f32 v169, v169, v7
v_mul_f32 v170, v170, v7
v_mul_f32 v171, v171, v7
v_mul_f32 v172, v172, v7
v_mul_f32 v173, v173, v7
v_mul_f32 v174, v174, v7
v_mul_f32 v175, v175, v7
v_mul_f32 v176, v176, v7
v_mul_f32 v177, v177, v7
v_mul_f32 v178, v178, v7
v_mul_f32 v179, v179, v7
v_mul_f32 v180, v180, v7
v_mul_f32 v181, v181, v7
v_mul_f32 v182, v182, v7
v_mul_f32 v183, v183, v7
v_mul_f32 v184, v184, v7
v_mul_f32 v185, v185, v7
v_mul_f32 v186, v186, v7
v_mul_f32 v187, v187, v7
v_mul_f32 v188, v188, v7
v_mul_f32 v189, v189, v7
v_mul_f32 v190, v190, v7
v_mul_f32 v191, v191, v7
v_mul_f32 v192, v192, v7
v_mul_f32 v193, v193, v7
v_mul_f32 v194, v194, v7
v_mul_f32 v195, v195, v7
v_mul_f32 v196, v196, v7
v_mul_f32 v197, v197, v7
v_mul_f32 v198, v198, v7
v_mul_f32 v199, v199, v7
v_mul_f32 v200, v200, v7
v_mul_f32 v201, v201, v7
v_mul_f32 v202, v202, v7
v_mul_f32 v203, v203, v7
v_mul_f32 v204, v204, v7
v_mul_f32 v205, v205, v7
v_mul_f32 v206, v206, v7
v_mul_f32 v207, v207, v7
v_mul_f32 v208, v208, v7
v_mul_f32 v209, v209, v7
v_mul_f32 v210, v210, v7
v_mul_f32 v211, v211, v7
v_mul_f32 v212, v212, v7
v_mul_f32 v213, v213, v7
v_mul_f32 v214, v214, v7
v_mul_f32 v215, v215, v7
v_mul_f32 v216, v216, v7
v_mul_f32 v217, v217, v7
v_mul_f32 v218, v218, v7
v_mul_f32 v219, v219, v7
v_mul_f32 v220, v220, v7
v_mul_f32 v221, v221, v7
v_mul_f32 v222, v222, v7
v_mul_f32 v223, v223, v7
v_cvt_pk_bf16_f32 v160, v160, v161
v_cvt_pk_bf16_f32 v161, v162, v163
v_cvt_pk_bf16_f32 v162, v164, v165
v_cvt_pk_bf16_f32 v163, v166, v167
v_cvt_pk_bf16_f32 v164, v168, v169
v_cvt_pk_bf16_f32 v165, v170, v171
v_cvt_pk_bf16_f32 v166, v172, v173
v_cvt_pk_bf16_f32 v167, v174, v175
v_cvt_pk_bf16_f32 v168, v176, v177
v_cvt_pk_bf16_f32 v169, v178, v179
v_cvt_pk_bf16_f32 v170, v180, v181
v_cvt_pk_bf16_f32 v171, v182, v183
v_cvt_pk_bf16_f32 v172, v184, v185
v_cvt_pk_bf16_f32 v173, v186, v187
v_cvt_pk_bf16_f32 v174, v188, v189
v_cvt_pk_bf16_f32 v175, v190, v191
v_cvt_pk_bf16_f32 v176, v192, v193
v_cvt_pk_bf16_f32 v177, v194, v195
v_cvt_pk_bf16_f32 v178, v196, v197
v_cvt_pk_bf16_f32 v179, v198, v199
v_cvt_pk_bf16_f32 v180, v200, v201
v_cvt_pk_bf16_f32 v181, v202, v203
v_cvt_pk_bf16_f32 v182, v204, v205
v_cvt_pk_bf16_f32 v183, v206, v207
v_cvt_pk_bf16_f32 v184, v208, v209
v_cvt_pk_bf16_f32 v185, v210, v211
v_cvt_pk_bf16_f32 v186, v212, v213
v_cvt_pk_bf16_f32 v187, v214, v215
v_cvt_pk_bf16_f32 v188, v216, v217
v_cvt_pk_bf16_f32 v189, v218, v219
v_cvt_pk_bf16_f32 v190, v220, v221
v_cvt_pk_bf16_f32 v191, v222, v223
buffer_store_dwordx4 v[160:163], v13, s[16:19], s50 offen offset:0
buffer_store_dwordx4 v[164:167], v13, s[16:19], s50 offen offset:16
buffer_store_dwordx4 v[168:171], v13, s[16:19], s50 offen offset:64
buffer_store_dwordx4 v[172:175], v13, s[16:19], s50 offen offset:80
buffer_store_dwordx4 v[176:179], v13, s[16:19], s50 offen offset:128
buffer_store_dwordx4 v[180:183], v13, s[16:19], s50 offen offset:144
buffer_store_dwordx4 v[184:187], v13, s[16:19], s50 offen offset:192
buffer_store_dwordx4 v[188:191], v13, s[16:19], s50 offen offset:208
s_waitcnt vmcnt(0)
s_cmp_lg_u32 s34, 0
s_cbranch_scc1 L_sl2
s_endpgm
.section .rodata,"a"
.p2align 6
.amdhsa_kernel standalone__mha_softmax__near_ridge_kernel
  .amdhsa_next_free_vgpr 512
  .amdhsa_next_free_sgpr 102
  .amdhsa_accum_offset 256
  .amdhsa_group_segment_fixed_size 0
  .amdhsa_kernarg_size 48
  .amdhsa_user_sgpr_count 2
  .amdhsa_user_sgpr_kernarg_segment_ptr 1
  .amdhsa_system_sgpr_workgroup_id_x 1
.end_amdhsa_kernel
```
